```python
import torch

def _softmax(x, axis=-1):
    return torch.softmax(x, dim=axis)
def _gelu(x):
    return torch.nn.functional.gelu(x, approximate="tanh")
def _silu(x):
    return torch.nn.functional.silu(x)
def _sigmoid(x):
    return torch.sigmoid(x)
def _layernorm(x, axis=-1, eps=1e-5):
    m = x.mean(dim=axis, keepdim=True)
    v = x.var(dim=axis, keepdim=True, unbiased=False)
    return (x - m) / torch.sqrt(v + eps)
def _scatter_add(tgt, idx, src, axis=0):
    return tgt.clone().index_add_(axis, idx, src)
def _segment_sum(src, seg, n):
    out = torch.zeros((n,) + src.shape[1:], dtype=src.dtype)
    return out.index_add_(0, seg, src)
def _pad(x, pw):
    flat = tuple(v for pair in reversed(pw) for v in pair)
    return torch.nn.functional.pad(x, flat)

kernel_name = 'concat_heads__mha_block_cached__mha_block_cached__near_ridge'

def setup_inputs():

    _w = (lambda a: (lambda t: t.to(torch.bfloat16) if t.is_floating_point() else t)(torch.as_tensor(a)))
    def _A_setup():
        B, Sq, D = 8, 304, 448
        H, Sk, Dh = 16, 1024, 256
        return {
            "x": _w((lambda *s: torch.randn(*s, dtype=torch.bfloat16) * 0.8)(B, Sq, D)),
            "k_cache": _w((lambda *s: torch.randn(*s, dtype=torch.bfloat16) * 0.8)(B, H, Sk, Dh)),
            "v_cache": _w((lambda *s: torch.randn(*s, dtype=torch.bfloat16) * 0.05)(B, H, Sk, Dh)),
            "wq": _w((lambda *s: torch.randn(*s, dtype=torch.bfloat16) * 0.8)(D, H * Dh) * (D ** -0.5)),
            "wo": _w((lambda *s: torch.randn(*s, dtype=torch.bfloat16) * 0.05)(H * Dh, D) * ((H * Dh) ** -0.5)),
        }
    _A_in = _A_setup()

    def _B_setup():
        B, Sq, D = 8, 304, 448
        H, Sk, Dh = 16, 1024, 256
        return {
            "x": _w((lambda *s: torch.randn(*s, dtype=torch.bfloat16) * 0.8)(B, Sq, D)),
            "k_cache": _w((lambda *s: torch.randn(*s, dtype=torch.bfloat16) * 0.8)(B, H, Sk, Dh)),
            "v_cache": _w((lambda *s: torch.randn(*s, dtype=torch.bfloat16) * 0.05)(B, H, Sk, Dh)),
            "wq": _w((lambda *s: torch.randn(*s, dtype=torch.bfloat16) * 0.8)(D, H * Dh) * (D ** -0.5)),
            "wo": _w((lambda *s: torch.randn(*s, dtype=torch.bfloat16) * 0.05)(H * Dh, D) * ((H * Dh) ** -0.5)),
        }
    _B_in = _B_setup()

    return {
        "A_x": _A_in["x"],
        "A_k_cache": _A_in["k_cache"],
        "A_v_cache": _A_in["v_cache"],
        "A_wq": _A_in["wq"],
        "A_wo": _A_in["wo"],
        "B_x": _B_in["x"],
        "B_k_cache": _B_in["k_cache"],
        "B_v_cache": _B_in["v_cache"],
        "B_wq": _B_in["wq"],
        "B_wo": _B_in["wo"],
    }

def reference(A_x, A_k_cache, A_v_cache, A_wq, A_wo, B_x, B_k_cache, B_v_cache, B_wq, B_wo):
    def _A_ref(x, k_cache, v_cache, wq, wo):
        B, Sq, D = x.shape
        H, Dh = 16, 256
        q = (lambda x, *d: x.permute(*d))((x @ wq).reshape(B, Sq, H, Dh), 0, 2, 1, 3)
        scores = torch.einsum("bhqd,bhkd->bhqk", q, k_cache) * (Dh ** -0.5)
        p = _softmax(scores, axis=-1)
        o = torch.einsum("bhqk,bhkd->bhqd", p, v_cache)
        return (lambda x, *d: x.permute(*d))(o, 0, 2, 1, 3).reshape(B, Sq, H * Dh) @ wo

    def _B_ref(x, k_cache, v_cache, wq, wo):
        B, Sq, D = x.shape
        H, Dh = 16, 256
        q = (lambda x, *d: x.permute(*d))((x @ wq).reshape(B, Sq, H, Dh), 0, 2, 1, 3)
        scores = torch.einsum("bhqd,bhkd->bhqk", q, k_cache) * (Dh ** -0.5)
        p = _softmax(scores, axis=-1)
        o = torch.einsum("bhqk,bhkd->bhqd", p, v_cache)
        return (lambda x, *d: x.permute(*d))(o, 0, 2, 1, 3).reshape(B, Sq, H * Dh) @ wo

    a = _A_ref(A_x, A_k_cache, A_v_cache, A_wq, A_wo)
    b = _B_ref(B_x, B_k_cache, B_v_cache, B_wq, B_wo)
    return torch.concatenate([a, b], axis=-1)
```

```asm
; @launch grid=(256,1,1) block=(256,1,1) lds=163840
.amdgcn_target "amdgcn-amd-amdhsa--gfx950"
.text
.globl concat_heads__mha_block_cached__mha_block_cached__near_ridge_kernel
.p2align 8
.type concat_heads__mha_block_cached__mha_block_cached__near_ridge_kernel,@function
concat_heads__mha_block_cached__mha_block_cached__near_ridge_kernel:
.macro M d,a,b,c
v_mfma_f32_16x16x32_bf16 \d, \a, \b, \c
.endm
.macro TR d,a,o
ds_read_b64_tr_b16 \d, \a offset:\o
.endm
.macro RD d,a,o
ds_read_b128 \d, \a offset:\o
.endm
.macro AR d,a
v_accvgpr_read_b32 \d, \a
.endm
.macro AW d,a
v_accvgpr_write_b32 \d, \a
.endm
.macro CV d,a,b
v_cvt_pk_bf16_f32 \d, \a, \b
.endm
.macro PM d,a,b
v_pk_mul_f32 \d, \a, \b
.endm
.macro WL n
s_waitcnt lgkmcnt(\n)
.endm
.macro WV n
s_waitcnt vmcnt(\n)
.endm
s_cmp_lt_u32 s2, 256
s_cbranch_scc1 L1_go
s_endpgm
L1_go:
v_lshrrev_b32 v9, 6, v0
v_and_b32 v10, 63, v0
s_and_b32 s4, s2, 7
s_lshr_b32 s5, s2, 3
s_lshr_b32 s6, s5, 4
s_lshl_b32 s4, s4, 1
v_readfirstlane_b32 s3, v9
s_getpc_b64 s[96:97]
L_pc:
s_sub_u32 s96, s96, L_pc-concat_heads__mha_block_cached__mha_block_cached__near_ridge_kernel
s_subb_u32 s97, s97, 0
s_and_b32 s97, s97, 0xffff
s_mov_b32 s98, L1_end-concat_heads__mha_block_cached__mha_block_cached__near_ridge_kernel
s_mov_b32 s99, 0x20000
s_mov_b32 s101, s5
s_lshl_b32 s7, s5, 2
s_add_u32 s7, s7, s3
s_lshl_b32 s7, s7, 10
v_lshlrev_b32 v11, 4, v10
buffer_load_dwordx4 v[184:187], v11, s[96:99], s7 offen
s_add_u32 s59, s4, s6
s_and_b32 s56, s5, 15
s_lshr_b32 s58, s59, 3
s_and_b32 s57, s59, 7
s_mul_i32 s4, s58, 40
s_add_u32 s4, s0, s4
s_addc_u32 s5, s1, 0
s_load_dwordx2 s[8:9], s[4:5], 0
s_load_dwordx2 s[16:17], s[4:5], 8
s_load_dwordx2 s[20:21], s[4:5], 16
s_load_dwordx2 s[12:13], s[4:5], 24
s_load_dwordx2 s[24:25], s[4:5], 32
s_load_dwordx2 s[32:33], s[0:1], 96
s_load_dwordx2 s[70:71], s[0:1], 80
s_load_dwordx2 s[64:65], s[0:1], 88
v_bfe_u32 v11, v10, 4, 1
v_lshlrev_b32 v11, 1, v11
v_and_b32 v9, 3, v10
v_xor_b32 v11, v11, v9
v_lshlrev_b32 v11, 4, v11
v_lshrrev_b32 v9, 5, v10
v_lshl_add_u32 v11, v9, 6, v11
v_bfe_u32 v9, v10, 2, 3
v_lshl_add_u32 v3, v9, 9, v11
v_lshrrev_b32 v4, 2, v9
v_lshlrev_b32 v4, 3, v4
v_and_b32 v9, 3, v9
v_add_u32 v4, v4, v9
v_lshl_add_u32 v4, v4, 13, v11
s_movk_i32 s6, 896
v_lshrrev_b32 v11, 3, v10
v_lshrrev_b32 v9, 4, v10
v_and_b32 v5, 7, v10
v_xor_b32 v5, v5, v9
v_lshlrev_b32 v5, 4, v5
v_mad_u32_u24 v5, v11, s6, v5
v_xor_b32 v6, 64, v5
s_lshl_b32 s62, s3, 14
v_bfe_u32 v11, v10, 1, 3
v_lshrrev_b32 v9, 4, v10
v_xor_b32 v11, v11, v9
v_lshlrev_b32 v7, 4, v11
v_and_b32 v11, 7, v10
v_lshl_add_u32 v7, v11, 7, v7
v_bfe_u32 v11, v10, 3, 1
v_lshl_add_u32 v7, v11, 10, v7
v_add_u32 v7, s62, v7
v_xor_b32 v8, 64, v7
v_bfe_u32 v11, v10, 2, 1
v_lshlrev_b32 v11, 1, v11
v_lshrrev_b32 v9, 4, v10
v_xor_b32 v11, v11, v9
v_lshlrev_b32 v0, 4, v11
v_and_b32 v11, 7, v10
v_lshl_add_u32 v0, v11, 6, v0
v_bfe_u32 v11, v10, 3, 1
v_lshl_add_u32 v0, v11, 12, v0
v_add_u32 v0, 98304, v0
v_bfe_u32 v11, v10, 4, 1
v_lshlrev_b32 v11, 1, v11
v_and_b32 v9, 3, v10
v_xor_b32 v11, v11, v9
v_lshlrev_b32 v1, 4, v11
v_bfe_u32 v11, v10, 2, 3
v_lshl_add_u32 v1, v11, 6, v1
v_lshrrev_b32 v11, 5, v10
v_lshl_add_u32 v1, v11, 12, v1
v_add_u32 v1, 65536, v1
v_lshlrev_b32 v11, 4, v10
v_add_u32 v2, s62, v11
WL 0
s_mov_b32 s28, s32
s_mov_b32 s29, s33
s_mov_b32 s68, s32
s_mov_b32 s69, s33
s_and_b32 s65, s65, 0xffff
s_mov_b32 s66, 256
s_mov_b32 s67, 0x20000
s_mul_i32 s6, s57, 272384
s_add_u32 s8, s8, s6
s_addc_u32 s9, s9, 0
s_and_b32 s9, s9, 0xffff
s_mov_b32 s10, 272384
s_mov_b32 s11, 0x20000
s_lshl_b32 s6, s56, 9
s_add_u32 s12, s12, s6
s_addc_u32 s13, s13, 0
s_and_b32 s13, s13, 0xffff
s_sub_u32 s14, 3670016, s6
s_mov_b32 s15, 0x20000
s_mul_i32 s6, s3, 71680
s_add_u32 s36, s6, 0
s_add_u32 s44, s6, 7168
s_add_u32 s37, s6, 14336
s_add_u32 s45, s6, 21504
s_add_u32 s38, s6, 28672
s_add_u32 s46, s6, 35840
s_add_u32 s39, s6, 43008
s_add_u32 s47, s6, 50176
s_add_u32 s40, s6, 57344
s_add_u32 s48, s6, 64512
s_lshl_b32 s6, s3, 12
s_add_u32 s53, s6, 65536
s_mov_b32 s42, s6
s_mov_b32 s43, s6
s_and_b32 s6, s3, 1
s_lshl_b32 s6, s6, 4
s_lshr_b32 s7, s3, 1
s_lshl_b32 s7, s7, 2
s_add_u32 s6, s6, s7
s_lshl_b32 s41, s6, 13
s_mov_b32 s54, 0x3db8aa3b
s_mov_b32 s55, 0x3db8aa3b
s_cmp_eq_u32 s3, 3
s_cbranch_scc1 L1_v4
L1_v5:
s_add_u32 m0, s53, 0
s_nop 0
buffer_load_dwordx4 v4, s[12:15], s41 offen offset:0 lds
s_add_u32 m0, s53, 896
s_nop 0
buffer_load_dwordx4 v4, s[12:15], s41 offen offset:128 lds
s_add_u32 m0, s53, 1792
s_nop 0
buffer_load_dwordx4 v4, s[12:15], s41 offen offset:256 lds
s_add_u32 m0, s53, 2688
s_nop 0
buffer_load_dwordx4 v4, s[12:15], s41 offen offset:384 lds
s_add_u32 s41, s41, 262144
s_add_u32 m0, s62, 0
s_nop 0
buffer_load_dwordx4 v5, s[8:11], s36 offen lds
s_add_u32 m0, s62, 1024
s_nop 0
buffer_load_dwordx4 v6, s[8:11], s44 offen lds
s_add_u32 m0, s62, 2048
s_nop 0
buffer_load_dwordx4 v5, s[8:11], s37 offen lds
s_add_u32 m0, s62, 3072
s_nop 0
buffer_load_dwordx4 v6, s[8:11], s45 offen lds
s_add_u32 m0, s62, 4096
s_nop 0
buffer_load_dwordx4 v5, s[8:11], s38 offen lds
s_add_u32 m0, s62, 5120
s_nop 0
buffer_load_dwordx4 v6, s[8:11], s46 offen lds
s_add_u32 m0, s62, 6144
s_nop 0
buffer_load_dwordx4 v5, s[8:11], s39 offen lds
s_add_u32 m0, s62, 7168
s_nop 0
buffer_load_dwordx4 v6, s[8:11], s47 offen lds
s_add_u32 m0, s62, 8192
s_nop 0
buffer_load_dwordx4 v5, s[8:11], s40 offen lds
s_add_u32 m0, s62, 9216
s_nop 0
buffer_load_dwordx4 v6, s[8:11], s48 offen lds
s_lshl_b32 s6, s57, 4
s_add_u32 s6, s6, s56
s_lshl_b32 s6, s6, 19
s_add_u32 s16, s16, s6
s_addc_u32 s17, s17, 0
s_and_b32 s17, s17, 0xffff
s_mov_b32 s18, 524288
s_mov_b32 s19, 0x20000
s_add_u32 s20, s20, s6
s_addc_u32 s21, s21, 0
s_and_b32 s21, s21, 0xffff
s_mov_b32 s22, 524288
s_mov_b32 s23, 0x20000
s_lshl_b32 s6, s56, 3
s_add_u32 s7, s6, s57
s_mul_i32 s6, s7, 28672
s_add_u32 s24, s24, s6
s_addc_u32 s25, s25, 0
s_and_b32 s25, s25, 0xffff
s_mov_b32 s26, 28672
s_mov_b32 s27, 0x20000
s_mul_i32 s6, s58, 3670016
s_add_u32 s6, s6, 41943040
s_add_u32 s28, s28, s6
s_addc_u32 s29, s29, 0
s_and_b32 s29, s29, 0xffff
s_mov_b32 s30, 3670016
s_mov_b32 s31, 0x20000
s_lshl_b32 s6, s3, 7
s_add_u32 s6, s6, s7
s_mul_i32 s60, s6, 7168
s_lshl_b32 s6, s59, 2
s_add_u32 s6, s6, s3
s_mul_i32 s6, s6, 655360
s_add_u32 s32, s32, s6
s_addc_u32 s33, s33, 0
s_and_b32 s33, s33, 0xffff
s_mov_b32 s34, 655360
s_mov_b32 s35, 0x20000
s_mul_i32 s63, s56, 40960
s_add_u32 m0, s53, 16384
s_nop 0
buffer_load_dwordx4 v4, s[12:15], s41 offen offset:0 lds
s_add_u32 m0, s53, 17280
s_nop 0
buffer_load_dwordx4 v4, s[12:15], s41 offen offset:128 lds
s_add_u32 m0, s53, 18176
s_nop 0
buffer_load_dwordx4 v4, s[12:15], s41 offen offset:256 lds
s_add_u32 m0, s53, 19072
s_nop 0
buffer_load_dwordx4 v4, s[12:15], s41 offen offset:384 lds
s_add_u32 s41, s41, 262144
s_add_u32 m0, s62, 10240
v_add_u32 v5, 128, v5
v_add_u32 v6, 128, v6
s_nop 0
buffer_load_dwordx4 v5, s[8:11], s36 offen lds
s_add_u32 m0, s62, 11264
s_nop 0
buffer_load_dwordx4 v6, s[8:11], s44 offen lds
s_add_u32 m0, s62, 12288
s_nop 0
buffer_load_dwordx4 v5, s[8:11], s37 offen lds
s_add_u32 m0, s62, 13312
s_nop 0
buffer_load_dwordx4 v6, s[8:11], s45 offen lds
s_add_u32 m0, s62, 14336
s_nop 0
buffer_load_dwordx4 v5, s[8:11], s38 offen lds
s_add_u32 m0, s62, 15360
s_nop 0
buffer_load_dwordx4 v6, s[8:11], s46 offen lds
WV 10
s_barrier
TR v[12:13],v1,0
TR v[14:15],v1,8192
TR v[16:17],v1,8
TR v[18:19],v1,8200
TR v[20:21],v1,512
TR v[22:23],v1,8704
RD v[56:59],v7,0
RD v[76:79],v8,0
RD v[60:63],v7,2048
RD v[80:83],v8,2048
RD v[64:67],v7,4096
RD v[84:87],v8,4096
RD v[68:71],v7,6144
RD v[88:91],v8,6144
RD v[72:75],v7,8192
RD v[92:95],v8,8192
WL 9
M a[0:3],v[12:15],v[56:59],0
WL 7
M a[4:7],v[12:15],v[60:63],0
WL 5
s_add_u32 m0, s62, 0
s_nop 0
buffer_load_dwordx4 v5, s[8:11], s39 offen lds
M a[8:11],v[12:15],v[64:67],0
WL 3
M a[12:15],v[12:15],v[68:71],0
WL 1
TR v[24:25],v1,520
M a[16:19],v[12:15],v[72:75],0
TR v[26:27],v1,8712
M a[20:23],v[16:19],v[56:59],0
s_add_u32 m0, s62, 1024
s_nop 0
buffer_load_dwordx4 v6, s[8:11], s47 offen lds
M a[24:27],v[16:19],v[60:63],0
M a[28:31],v[16:19],v[64:67],0
M a[32:35],v[16:19],v[68:71],0
TR v[12:13],v1,1024
M a[36:39],v[16:19],v[72:75],0
TR v[14:15],v1,9216
M a[40:43],v[20:23],v[56:59],0
s_add_u32 m0, s62, 2048
s_nop 0
buffer_load_dwordx4 v5, s[8:11], s40 offen lds
M a[44:47],v[20:23],v[60:63],0
M a[48:51],v[20:23],v[64:67],0
M a[52:55],v[20:23],v[68:71],0
TR v[16:17],v1,1032
M a[56:59],v[20:23],v[72:75],0
WL 3
TR v[18:19],v1,9224
M a[60:63],v[24:27],v[56:59],0
s_add_u32 m0, s62, 3072
s_nop 0
buffer_load_dwordx4 v6, s[8:11], s48 offen lds
M a[64:67],v[24:27],v[60:63],0
M a[68:71],v[24:27],v[64:67],0
M a[72:75],v[24:27],v[68:71],0
s_add_u32 m0, s62, 4096
v_add_u32 v5, 128, v5
v_add_u32 v6, 128, v6
TR v[20:21],v1,1536
buffer_load_dwordx4 v5, s[8:11], s36 offen lds
M a[76:79],v[24:27],v[72:75],0
WL 3
TR v[22:23],v1,9728
M a[80:83],v[12:15],v[56:59],0
M a[84:87],v[12:15],v[60:63],0
M a[88:91],v[12:15],v[64:67],0
M a[92:95],v[12:15],v[68:71],0
s_add_u32 m0, s62, 5120
TR v[24:25],v1,1544
buffer_load_dwordx4 v6, s[8:11], s44 offen lds
M a[96:99],v[12:15],v[72:75],0
WL 3
TR v[26:27],v1,9736
M a[100:103],v[16:19],v[56:59],0
M a[104:107],v[16:19],v[60:63],0
M a[108:111],v[16:19],v[64:67],0
M a[112:115],v[16:19],v[68:71],0
s_add_u32 m0, s62, 6144
TR v[12:13],v1,2048
buffer_load_dwordx4 v5, s[8:11], s37 offen lds
M a[116:119],v[16:19],v[72:75],0
WL 3
TR v[14:15],v1,10240
M a[120:123],v[20:23],v[56:59],0
M a[124:127],v[20:23],v[60:63],0
M a[128:131],v[20:23],v[64:67],0
s_add_u32 m0, s62, 7168
s_nop 0
buffer_load_dwordx4 v6, s[8:11], s45 offen lds
M a[132:135],v[20:23],v[68:71],0
TR v[16:17],v1,2056
M a[136:139],v[20:23],v[72:75],0
WL 3
TR v[18:19],v1,10248
M a[140:143],v[24:27],v[56:59],0
M a[144:147],v[24:27],v[60:63],0
s_add_u32 m0, s62, 8192
s_nop 0
buffer_load_dwordx4 v5, s[8:11], s38 offen lds
M a[148:151],v[24:27],v[64:67],0
M a[152:155],v[24:27],v[68:71],0
TR v[20:21],v1,2560
M a[156:159],v[24:27],v[72:75],0
WL 3
TR v[22:23],v1,10752
M a[160:163],v[12:15],v[56:59],0
M a[164:167],v[12:15],v[60:63],0
s_add_u32 m0, s62, 9216
s_nop 0
buffer_load_dwordx4 v6, s[8:11], s46 offen lds
M a[168:171],v[12:15],v[64:67],0
M a[172:175],v[12:15],v[68:71],0
TR v[24:25],v1,2568
M a[176:179],v[12:15],v[72:75],0
WL 3
TR v[26:27],v1,10760
M a[180:183],v[16:19],v[56:59],0
s_add_u32 m0, s53, 32768
s_nop 0
buffer_load_dwordx4 v4, s[12:15], s41 offen offset:0 lds
M a[184:187],v[16:19],v[60:63],0
M a[188:191],v[16:19],v[64:67],0
M a[192:195],v[16:19],v[68:71],0
TR v[12:13],v1,3072
M a[196:199],v[16:19],v[72:75],0
WL 3
TR v[14:15],v1,11264
M a[200:203],v[20:23],v[56:59],0
s_add_u32 m0, s53, 33664
s_nop 0
buffer_load_dwordx4 v4, s[12:15], s41 offen offset:128 lds
M a[204:207],v[20:23],v[60:63],0
M a[208:211],v[20:23],v[64:67],0
M a[212:215],v[20:23],v[68:71],0
TR v[16:17],v1,3080
M a[216:219],v[20:23],v[72:75],0
WL 3
TR v[18:19],v1,11272
M a[220:223],v[24:27],v[56:59],0
s_add_u32 m0, s53, 34560
s_nop 0
buffer_load_dwordx4 v4, s[12:15], s41 offen offset:256 lds
M a[224:227],v[24:27],v[60:63],0
M a[228:231],v[24:27],v[64:67],0
M a[232:235],v[24:27],v[68:71],0
s_add_u32 m0, s53, 35456
TR v[20:21],v1,3584
buffer_load_dwordx4 v4, s[12:15], s41 offen offset:384 lds
s_add_u32 s41, s41, 262144
M a[236:239],v[24:27],v[72:75],0
WL 3
TR v[22:23],v1,11776
M a[240:243],v[12:15],v[56:59],0
M a[244:247],v[12:15],v[60:63],0
M a[248:251],v[12:15],v[64:67],0
M a[252:255],v[12:15],v[68:71],0
TR v[24:25],v1,3592
M v[192:195],v[12:15],v[72:75],0
WL 3
TR v[26:27],v1,11784
M v[196:199],v[16:19],v[56:59],0
v_add_u32 v1, 0x4000, v1
M v[200:203],v[16:19],v[60:63],0
WV 20
M v[204:207],v[16:19],v[64:67],0
s_barrier
M v[208:211],v[16:19],v[68:71],0
TR v[12:13],v1,0
M v[212:215],v[16:19],v[72:75],0
WL 3
TR v[14:15],v1,8192
M v[216:219],v[20:23],v[56:59],0
M v[220:223],v[20:23],v[60:63],0
M v[224:227],v[20:23],v[64:67],0
M v[228:231],v[20:23],v[68:71],0
TR v[16:17],v1,8
M v[232:235],v[20:23],v[72:75],0
WL 3
TR v[18:19],v1,8200
M v[236:239],v[24:27],v[56:59],0
M v[240:243],v[24:27],v[60:63],0
M v[244:247],v[24:27],v[64:67],0
M v[248:251],v[24:27],v[68:71],0
TR v[20:21],v1,512
M v[252:255],v[24:27],v[72:75],0
WL 3
TR v[22:23],v1,8704
M a[0:3],v[12:15],v[76:79],a[0:3]
M a[4:7],v[12:15],v[80:83],a[4:7]
s_add_u32 m0, s53, 49152
s_nop 0
buffer_load_dwordx4 v4, s[12:15], s41 offen offset:0 lds
M a[8:11],v[12:15],v[84:87],a[8:11]
M a[12:15],v[12:15],v[88:91],a[12:15]
TR v[24:25],v1,520
M a[16:19],v[12:15],v[92:95],a[16:19]
WL 3
TR v[26:27],v1,8712
M a[20:23],v[16:19],v[76:79],a[20:23]
M a[24:27],v[16:19],v[80:83],a[24:27]
M a[28:31],v[16:19],v[84:87],a[28:31]
M a[32:35],v[16:19],v[88:91],a[32:35]
TR v[12:13],v1,1024
M a[36:39],v[16:19],v[92:95],a[36:39]
WL 3
TR v[14:15],v1,9216
M a[40:43],v[20:23],v[76:79],a[40:43]
M a[44:47],v[20:23],v[80:83],a[44:47]
M a[48:51],v[20:23],v[84:87],a[48:51]
s_add_u32 m0, s53, 50048
s_nop 0
buffer_load_dwordx4 v4, s[12:15], s41 offen offset:128 lds
M a[52:55],v[20:23],v[88:91],a[52:55]
TR v[16:17],v1,1032
M a[56:59],v[20:23],v[92:95],a[56:59]
WL 3
TR v[18:19],v1,9224
M a[60:63],v[24:27],v[76:79],a[60:63]
WV 20
M a[64:67],v[24:27],v[80:83],a[64:67]
RD v[96:99],v7,10240
M a[68:71],v[24:27],v[84:87],a[68:71]
RD v[116:119],v8,10240
M a[72:75],v[24:27],v[88:91],a[72:75]
TR v[20:21],v1,1536
M a[76:79],v[24:27],v[92:95],a[76:79]
WL 5
TR v[22:23],v1,9728
M a[80:83],v[12:15],v[76:79],a[80:83]
WV 18
M a[84:87],v[12:15],v[80:83],a[84:87]
RD v[100:103],v7,12288
M a[88:91],v[12:15],v[84:87],a[88:91]
RD v[120:123],v8,12288
M a[92:95],v[12:15],v[88:91],a[92:95]
s_add_u32 m0, s53, 50944
TR v[24:25],v1,1544
buffer_load_dwordx4 v4, s[12:15], s41 offen offset:256 lds
M a[96:99],v[12:15],v[92:95],a[96:99]
WL 7
TR v[26:27],v1,9736
M a[100:103],v[16:19],v[76:79],a[100:103]
WV 17
M a[104:107],v[16:19],v[80:83],a[104:107]
RD v[104:107],v7,14336
M a[108:111],v[16:19],v[84:87],a[108:111]
RD v[124:127],v8,14336
M a[112:115],v[16:19],v[88:91],a[112:115]
TR v[12:13],v1,2048
M a[116:119],v[16:19],v[92:95],a[116:119]
WL 7
TR v[14:15],v1,10240
M a[120:123],v[20:23],v[76:79],a[120:123]
WV 15
M a[124:127],v[20:23],v[80:83],a[124:127]
RD v[108:111],v7,0
M a[128:131],v[20:23],v[84:87],a[128:131]
RD v[128:131],v8,0
M a[132:135],v[20:23],v[88:91],a[132:135]
TR v[16:17],v1,2056
M a[136:139],v[20:23],v[92:95],a[136:139]
WL 7
TR v[18:19],v1,10248
M a[140:143],v[24:27],v[76:79],a[140:143]
WV 13
M a[144:147],v[24:27],v[80:83],a[144:147]
s_add_u32 m0, s53, 51840
RD v[112:115],v7,2048
buffer_load_dwordx4 v4, s[12:15], s41 offen offset:384 lds
s_add_u32 s41, s41, 262144
M a[148:151],v[24:27],v[84:87],a[148:151]
RD v[132:135],v8,2048
M a[152:155],v[24:27],v[88:91],a[152:155]
TR v[20:21],v1,2560
M a[156:159],v[24:27],v[92:95],a[156:159]
WL 7
TR v[22:23],v1,10752
M a[160:163],v[12:15],v[76:79],a[160:163]
M a[164:167],v[12:15],v[80:83],a[164:167]
M a[168:171],v[12:15],v[84:87],a[168:171]
M a[172:175],v[12:15],v[88:91],a[172:175]
TR v[24:25],v1,2568
M a[176:179],v[12:15],v[92:95],a[176:179]
WL 5
TR v[26:27],v1,10760
M a[180:183],v[16:19],v[76:79],a[180:183]
M a[184:187],v[16:19],v[80:83],a[184:187]
M a[188:191],v[16:19],v[84:87],a[188:191]
M a[192:195],v[16:19],v[88:91],a[192:195]
s_add_u32 m0, s62, 10240
TR v[12:13],v1,3072
buffer_load_dwordx4 v5, s[8:11], s39 offen lds
M a[196:199],v[16:19],v[92:95],a[196:199]
WL 3
TR v[14:15],v1,11264
M a[200:203],v[20:23],v[76:79],a[200:203]
M a[204:207],v[20:23],v[80:83],a[204:207]
M a[208:211],v[20:23],v[84:87],a[208:211]
s_add_u32 m0, s62, 11264
s_nop 0
buffer_load_dwordx4 v6, s[8:11], s47 offen lds
M a[212:215],v[20:23],v[88:91],a[212:215]
TR v[16:17],v1,3080
M a[216:219],v[20:23],v[92:95],a[216:219]
WL 3
TR v[18:19],v1,11272
M a[220:223],v[24:27],v[76:79],a[220:223]
s_add_u32 m0, s62, 12288
s_nop 0
buffer_load_dwordx4 v5, s[8:11], s40 offen lds
M a[224:227],v[24:27],v[80:83],a[224:227]
M a[228:231],v[24:27],v[84:87],a[228:231]
M a[232:235],v[24:27],v[88:91],a[232:235]
TR v[20:21],v1,3584
M a[236:239],v[24:27],v[92:95],a[236:239]
WL 3
TR v[22:23],v1,11776
M a[240:243],v[12:15],v[76:79],a[240:243]
s_add_u32 m0, s62, 13312
s_nop 0
buffer_load_dwordx4 v6, s[8:11], s48 offen lds
M a[244:247],v[12:15],v[80:83],a[244:247]
M a[248:251],v[12:15],v[84:87],a[248:251]
M a[252:255],v[12:15],v[88:91],a[252:255]
TR v[24:25],v1,3592
M v[192:195],v[12:15],v[92:95],v[192:195]
WL 3
TR v[26:27],v1,11784
M v[196:199],v[16:19],v[76:79],v[196:199]
v_add_u32 v1, 0x4000, v1
M v[200:203],v[16:19],v[80:83],v[200:203]
WV 8
M v[204:207],v[16:19],v[84:87],v[204:207]
s_barrier
M v[208:211],v[16:19],v[88:91],v[208:211]
TR v[12:13],v1,0
M v[212:215],v[16:19],v[92:95],v[212:215]
WL 3
TR v[14:15],v1,8192
M v[216:219],v[20:23],v[76:79],v[216:219]
M v[220:223],v[20:23],v[80:83],v[220:223]
M v[224:227],v[20:23],v[84:87],v[224:227]
M v[228:231],v[20:23],v[88:91],v[228:231]
TR v[16:17],v1,8
M v[232:235],v[20:23],v[92:95],v[232:235]
WL 3
TR v[18:19],v1,8200
M v[236:239],v[24:27],v[76:79],v[236:239]
M v[240:243],v[24:27],v[80:83],v[240:243]
M v[244:247],v[24:27],v[84:87],v[244:247]
M v[248:251],v[24:27],v[88:91],v[248:251]
TR v[20:21],v1,512
M v[252:255],v[24:27],v[92:95],v[252:255]
WL 3
TR v[22:23],v1,8704
M a[0:3],v[12:15],v[96:99],a[0:3]
M a[4:7],v[12:15],v[100:103],a[4:7]
s_add_u32 m0, s62, 14336
v_add_u32 v5, 128, v5
v_add_u32 v6, 128, v6
s_nop 0
buffer_load_dwordx4 v5, s[8:11], s36 offen lds
M a[8:11],v[12:15],v[104:107],a[8:11]
M a[12:15],v[12:15],v[108:111],a[12:15]
TR v[24:25],v1,520
M a[16:19],v[12:15],v[112:115],a[16:19]
WL 3
TR v[26:27],v1,8712
M a[20:23],v[16:19],v[96:99],a[20:23]
s_add_u32 m0, s62, 15360
s_nop 0
buffer_load_dwordx4 v6, s[8:11], s44 offen lds
M a[24:27],v[16:19],v[100:103],a[24:27]
M a[28:31],v[16:19],v[104:107],a[28:31]
M a[32:35],v[16:19],v[108:111],a[32:35]
TR v[12:13],v1,1024
M a[36:39],v[16:19],v[112:115],a[36:39]
WL 3
TR v[14:15],v1,9216
M a[40:43],v[20:23],v[96:99],a[40:43]
s_add_u32 m0, s62, 0
s_nop 0
buffer_load_dwordx4 v5, s[8:11], s37 offen lds
M a[44:47],v[20:23],v[100:103],a[44:47]
M a[48:51],v[20:23],v[104:107],a[48:51]
M a[52:55],v[20:23],v[108:111],a[52:55]
TR v[16:17],v1,1032
M a[56:59],v[20:23],v[112:115],a[56:59]
WL 3
TR v[18:19],v1,9224
M a[60:63],v[24:27],v[96:99],a[60:63]
s_add_u32 m0, s62, 1024
s_nop 0
buffer_load_dwordx4 v6, s[8:11], s45 offen lds
M a[64:67],v[24:27],v[100:103],a[64:67]
M a[68:71],v[24:27],v[104:107],a[68:71]
M a[72:75],v[24:27],v[108:111],a[72:75]
s_add_u32 m0, s62, 2048
TR v[20:21],v1,1536
buffer_load_dwordx4 v5, s[8:11], s38 offen lds
M a[76:79],v[24:27],v[112:115],a[76:79]
WL 3
TR v[22:23],v1,9728
M a[80:83],v[12:15],v[96:99],a[80:83]
M a[84:87],v[12:15],v[100:103],a[84:87]
M a[88:91],v[12:15],v[104:107],a[88:91]
M a[92:95],v[12:15],v[108:111],a[92:95]
s_add_u32 m0, s62, 3072
TR v[24:25],v1,1544
buffer_load_dwordx4 v6, s[8:11], s46 offen lds
M a[96:99],v[12:15],v[112:115],a[96:99]
WL 3
TR v[26:27],v1,9736
M a[100:103],v[16:19],v[96:99],a[100:103]
M a[104:107],v[16:19],v[100:103],a[104:107]
M a[108:111],v[16:19],v[104:107],a[108:111]
M a[112:115],v[16:19],v[108:111],a[112:115]
s_add_u32 m0, s53, 65536
TR v[12:13],v1,2048
buffer_load_dwordx4 v4, s[12:15], s41 offen offset:0 lds
M a[116:119],v[16:19],v[112:115],a[116:119]
WL 3
TR v[14:15],v1,10240
M a[120:123],v[20:23],v[96:99],a[120:123]
M a[124:127],v[20:23],v[100:103],a[124:127]
M a[128:131],v[20:23],v[104:107],a[128:131]
s_add_u32 m0, s53, 66432
s_nop 0
buffer_load_dwordx4 v4, s[12:15], s41 offen offset:128 lds
M a[132:135],v[20:23],v[108:111],a[132:135]
TR v[16:17],v1,2056
M a[136:139],v[20:23],v[112:115],a[136:139]
WL 3
TR v[18:19],v1,10248
M a[140:143],v[24:27],v[96:99],a[140:143]
M a[144:147],v[24:27],v[100:103],a[144:147]
s_add_u32 m0, s53, 67328
s_nop 0
buffer_load_dwordx4 v4, s[12:15], s41 offen offset:256 lds
M a[148:151],v[24:27],v[104:107],a[148:151]
M a[152:155],v[24:27],v[108:111],a[152:155]
TR v[20:21],v1,2560
M a[156:159],v[24:27],v[112:115],a[156:159]
WL 3
TR v[22:23],v1,10752
M a[160:163],v[12:15],v[96:99],a[160:163]
M a[164:167],v[12:15],v[100:103],a[164:167]
s_add_u32 m0, s53, 68224
s_nop 0
buffer_load_dwordx4 v4, s[12:15], s41 offen offset:384 lds
s_add_u32 s41, s41, 262144
M a[168:171],v[12:15],v[104:107],a[168:171]
M a[172:175],v[12:15],v[108:111],a[172:175]
TR v[24:25],v1,2568
M a[176:179],v[12:15],v[112:115],a[176:179]
WL 3
TR v[26:27],v1,10760
M a[180:183],v[16:19],v[96:99],a[180:183]
s_add_u32 m0, s53, 81920
s_nop 0
buffer_load_dwordx4 v4, s[12:15], s41 offen offset:0 lds
M a[184:187],v[16:19],v[100:103],a[184:187]
M a[188:191],v[16:19],v[104:107],a[188:191]
M a[192:195],v[16:19],v[108:111],a[192:195]
TR v[12:13],v1,3072
M a[196:199],v[16:19],v[112:115],a[196:199]
WL 3
TR v[14:15],v1,11264
M a[200:203],v[20:23],v[96:99],a[200:203]
s_add_u32 m0, s53, 82816
s_nop 0
buffer_load_dwordx4 v4, s[12:15], s41 offen offset:128 lds
M a[204:207],v[20:23],v[100:103],a[204:207]
M a[208:211],v[20:23],v[104:107],a[208:211]
M a[212:215],v[20:23],v[108:111],a[212:215]
TR v[16:17],v1,3080
M a[216:219],v[20:23],v[112:115],a[216:219]
WL 3
TR v[18:19],v1,11272
M a[220:223],v[24:27],v[96:99],a[220:223]
s_add_u32 m0, s53, 83712
s_nop 0
buffer_load_dwordx4 v4, s[12:15], s41 offen offset:256 lds
M a[224:227],v[24:27],v[100:103],a[224:227]
M a[228:231],v[24:27],v[104:107],a[228:231]
M a[232:235],v[24:27],v[108:111],a[232:235]
s_add_u32 m0, s53, 84608
TR v[20:21],v1,3584
buffer_load_dwordx4 v4, s[12:15], s41 offen offset:384 lds
s_add_u32 s41, s41, 262144
M a[236:239],v[24:27],v[112:115],a[236:239]
WL 3
TR v[22:23],v1,11776
M a[240:243],v[12:15],v[96:99],a[240:243]
M a[244:247],v[12:15],v[100:103],a[244:247]
M a[248:251],v[12:15],v[104:107],a[248:251]
M a[252:255],v[12:15],v[108:111],a[252:255]
TR v[24:25],v1,3592
M v[192:195],v[12:15],v[112:115],v[192:195]
WL 3
TR v[26:27],v1,11784
M v[196:199],v[16:19],v[96:99],v[196:199]
v_add_u32 v1, 0x4000, v1
M v[200:203],v[16:19],v[100:103],v[200:203]
WV 18
M v[204:207],v[16:19],v[104:107],v[204:207]
s_barrier
M v[208:211],v[16:19],v[108:111],v[208:211]
TR v[12:13],v1,0
M v[212:215],v[16:19],v[112:115],v[212:215]
WL 3
TR v[14:15],v1,8192
M v[216:219],v[20:23],v[96:99],v[216:219]
M v[220:223],v[20:23],v[100:103],v[220:223]
M v[224:227],v[20:23],v[104:107],v[224:227]
M v[228:231],v[20:23],v[108:111],v[228:231]
TR v[16:17],v1,8
M v[232:235],v[20:23],v[112:115],v[232:235]
WL 3
TR v[18:19],v1,8200
M v[236:239],v[24:27],v[96:99],v[236:239]
M v[240:243],v[24:27],v[100:103],v[240:243]
M v[244:247],v[24:27],v[104:107],v[244:247]
M v[248:251],v[24:27],v[108:111],v[248:251]
TR v[20:21],v1,512
M v[252:255],v[24:27],v[112:115],v[252:255]
WL 3
TR v[22:23],v1,8704
M a[0:3],v[12:15],v[116:119],a[0:3]
M a[4:7],v[12:15],v[120:123],a[4:7]
s_add_u32 m0, s53, 0
s_nop 0
buffer_load_dwordx4 v4, s[12:15], s41 offen offset:0 lds
M a[8:11],v[12:15],v[124:127],a[8:11]
M a[12:15],v[12:15],v[128:131],a[12:15]
TR v[24:25],v1,520
M a[16:19],v[12:15],v[132:135],a[16:19]
WL 3
TR v[26:27],v1,8712
M a[20:23],v[16:19],v[116:119],a[20:23]
M a[24:27],v[16:19],v[120:123],a[24:27]
M a[28:31],v[16:19],v[124:127],a[28:31]
s_add_u32 m0, s53, 896
s_nop 0
buffer_load_dwordx4 v4, s[12:15], s41 offen offset:128 lds
M a[32:35],v[16:19],v[128:131],a[32:35]
TR v[12:13],v1,1024
M a[36:39],v[16:19],v[132:135],a[36:39]
WL 3
TR v[14:15],v1,9216
M a[40:43],v[20:23],v[116:119],a[40:43]
M a[44:47],v[20:23],v[120:123],a[44:47]
M a[48:51],v[20:23],v[124:127],a[48:51]
s_add_u32 m0, s53, 1792
s_nop 0
buffer_load_dwordx4 v4, s[12:15], s41 offen offset:256 lds
M a[52:55],v[20:23],v[128:131],a[52:55]
TR v[16:17],v1,1032
M a[56:59],v[20:23],v[132:135],a[56:59]
WL 3
TR v[18:19],v1,9224
M a[60:63],v[24:27],v[116:119],a[60:63]
WV 33
M a[64:67],v[24:27],v[120:123],a[64:67]
RD v[136:139],v7,4096
M a[68:71],v[24:27],v[124:127],a[68:71]
RD v[156:159],v8,4096
M a[72:75],v[24:27],v[128:131],a[72:75]
s_add_u32 m0, s53, 2688
TR v[20:21],v1,1536
buffer_load_dwordx4 v4, s[12:15], s41 offen offset:384 lds
s_add_u32 s41, s41, 262144
M a[76:79],v[24:27],v[132:135],a[76:79]
WL 5
TR v[22:23],v1,9728
M a[80:83],v[12:15],v[116:119],a[80:83]
WV 32
M a[84:87],v[12:15],v[120:123],a[84:87]
RD v[140:143],v7,6144
M a[88:91],v[12:15],v[124:127],a[88:91]
RD v[160:163],v8,6144
M a[92:95],v[12:15],v[128:131],a[92:95]
s_add_u32 m0, s53, 16384
TR v[24:25],v1,1544
buffer_load_dwordx4 v4, s[12:15], s41 offen offset:0 lds
M a[96:99],v[12:15],v[132:135],a[96:99]
WL 7
TR v[26:27],v1,9736
M a[100:103],v[16:19],v[116:119],a[100:103]
WV 31
M a[104:107],v[16:19],v[120:123],a[104:107]
RD v[144:147],v7,8192
M a[108:111],v[16:19],v[124:127],a[108:111]
RD v[164:167],v8,8192
M a[112:115],v[16:19],v[128:131],a[112:115]
TR v[12:13],v1,2048
M a[116:119],v[16:19],v[132:135],a[116:119]
WL 7
TR v[14:15],v1,10240
M a[120:123],v[20:23],v[116:119],a[120:123]
WV 21
M a[124:127],v[20:23],v[120:123],a[124:127]
s_add_u32 m0, s53, 17280
RD v[148:151],v7,10240
buffer_load_dwordx4 v4, s[12:15], s41 offen offset:128 lds
M a[128:131],v[20:23],v[124:127],a[128:131]
RD v[168:171],v8,10240
M a[132:135],v[20:23],v[128:131],a[132:135]
TR v[16:17],v1,2056
M a[136:139],v[20:23],v[132:135],a[136:139]
WL 7
TR v[18:19],v1,10248
M a[140:143],v[24:27],v[116:119],a[140:143]
WV 20
M a[144:147],v[24:27],v[120:123],a[144:147]
s_add_u32 m0, s53, 18176
RD v[152:155],v7,12288
buffer_load_dwordx4 v4, s[12:15], s41 offen offset:256 lds
M a[148:151],v[24:27],v[124:127],a[148:151]
RD v[172:175],v8,12288
M a[152:155],v[24:27],v[128:131],a[152:155]
TR v[20:21],v1,2560
M a[156:159],v[24:27],v[132:135],a[156:159]
WL 7
TR v[22:23],v1,10752
M a[160:163],v[12:15],v[116:119],a[160:163]
M a[164:167],v[12:15],v[120:123],a[164:167]
s_add_u32 m0, s53, 19072
s_nop 0
buffer_load_dwordx4 v4, s[12:15], s41 offen offset:384 lds
s_add_u32 s41, s41, 262144
M a[168:171],v[12:15],v[124:127],a[168:171]
M a[172:175],v[12:15],v[128:131],a[172:175]
TR v[24:25],v1,2568
M a[176:179],v[12:15],v[132:135],a[176:179]
WL 5
TR v[26:27],v1,10760
M a[180:183],v[16:19],v[116:119],a[180:183]
M a[184:187],v[16:19],v[120:123],a[184:187]
M a[188:191],v[16:19],v[124:127],a[188:191]
M a[192:195],v[16:19],v[128:131],a[192:195]
s_add_u32 m0, s62, 4096
TR v[12:13],v1,3072
buffer_load_dwordx4 v5, s[8:11], s39 offen lds
M a[196:199],v[16:19],v[132:135],a[196:199]
WL 3
TR v[14:15],v1,11264
M a[200:203],v[20:23],v[116:119],a[200:203]
M a[204:207],v[20:23],v[120:123],a[204:207]
M a[208:211],v[20:23],v[124:127],a[208:211]
s_add_u32 m0, s62, 5120
s_nop 0
buffer_load_dwordx4 v6, s[8:11], s47 offen lds
M a[212:215],v[20:23],v[128:131],a[212:215]
TR v[16:17],v1,3080
M a[216:219],v[20:23],v[132:135],a[216:219]
WL 3
TR v[18:19],v1,11272
M a[220:223],v[24:27],v[116:119],a[220:223]
s_add_u32 m0, s62, 6144
s_nop 0
buffer_load_dwordx4 v5, s[8:11], s40 offen lds
M a[224:227],v[24:27],v[120:123],a[224:227]
M a[228:231],v[24:27],v[124:127],a[228:231]
M a[232:235],v[24:27],v[128:131],a[232:235]
TR v[20:21],v1,3584
M a[236:239],v[24:27],v[132:135],a[236:239]
WL 3
TR v[22:23],v1,11776
M a[240:243],v[12:15],v[116:119],a[240:243]
s_add_u32 m0, s62, 7168
s_nop 0
buffer_load_dwordx4 v6, s[8:11], s48 offen lds
M a[244:247],v[12:15],v[120:123],a[244:247]
M a[248:251],v[12:15],v[124:127],a[248:251]
M a[252:255],v[12:15],v[128:131],a[252:255]
TR v[24:25],v1,3592
M v[192:195],v[12:15],v[132:135],v[192:195]
WL 3
TR v[26:27],v1,11784
M v[196:199],v[16:19],v[116:119],v[196:199]
v_add_u32 v1, 0x4000, v1
M v[200:203],v[16:19],v[120:123],v[200:203]
WV 16
M v[204:207],v[16:19],v[124:127],v[204:207]
s_barrier
M v[208:211],v[16:19],v[128:131],v[208:211]
TR v[12:13],v1,0
M v[212:215],v[16:19],v[132:135],v[212:215]
WL 3
TR v[14:15],v1,8192
M v[216:219],v[20:23],v[116:119],v[216:219]
M v[220:223],v[20:23],v[120:123],v[220:223]
M v[224:227],v[20:23],v[124:127],v[224:227]
M v[228:231],v[20:23],v[128:131],v[228:231]
TR v[16:17],v1,8
M v[232:235],v[20:23],v[132:135],v[232:235]
WL 3
TR v[18:19],v1,8200
M v[236:239],v[24:27],v[116:119],v[236:239]
M v[240:243],v[24:27],v[120:123],v[240:243]
M v[244:247],v[24:27],v[124:127],v[244:247]
M v[248:251],v[24:27],v[128:131],v[248:251]
TR v[20:21],v1,512
M v[252:255],v[24:27],v[132:135],v[252:255]
WL 3
TR v[22:23],v1,8704
M a[0:3],v[12:15],v[136:139],a[0:3]
M a[4:7],v[12:15],v[140:143],a[4:7]
s_add_u32 m0, s62, 8192
v_add_u32 v5, 128, v5
v_add_u32 v6, 128, v6
s_nop 0
buffer_load_dwordx4 v5, s[8:11], s36 offen lds
M a[8:11],v[12:15],v[144:147],a[8:11]
M a[12:15],v[12:15],v[148:151],a[12:15]
TR v[24:25],v1,520
M a[16:19],v[12:15],v[152:155],a[16:19]
WL 3
TR v[26:27],v1,8712
M a[20:23],v[16:19],v[136:139],a[20:23]
M a[24:27],v[16:19],v[140:143],a[24:27]
M a[28:31],v[16:19],v[144:147],a[28:31]
s_add_u32 m0, s62, 9216
s_nop 0
buffer_load_dwordx4 v6, s[8:11], s44 offen lds
M a[32:35],v[16:19],v[148:151],a[32:35]
TR v[12:13],v1,1024
M a[36:39],v[16:19],v[152:155],a[36:39]
WL 3
TR v[14:15],v1,9216
M a[40:43],v[20:23],v[136:139],a[40:43]
M a[44:47],v[20:23],v[140:143],a[44:47]
M a[48:51],v[20:23],v[144:147],a[48:51]
M a[52:55],v[20:23],v[148:151],a[52:55]
s_add_u32 m0, s62, 10240
TR v[16:17],v1,1032
buffer_load_dwordx4 v5, s[8:11], s37 offen lds
M a[56:59],v[20:23],v[152:155],a[56:59]
WL 3
TR v[18:19],v1,9224
M a[60:63],v[24:27],v[136:139],a[60:63]
M a[64:67],v[24:27],v[140:143],a[64:67]
M a[68:71],v[24:27],v[144:147],a[68:71]
M a[72:75],v[24:27],v[148:151],a[72:75]
TR v[20:21],v1,1536
M a[76:79],v[24:27],v[152:155],a[76:79]
WL 3
TR v[22:23],v1,9728
M a[80:83],v[12:15],v[136:139],a[80:83]
s_add_u32 m0, s62, 11264
s_nop 0
buffer_load_dwordx4 v6, s[8:11], s45 offen lds
M a[84:87],v[12:15],v[140:143],a[84:87]
M a[88:91],v[12:15],v[144:147],a[88:91]
M a[92:95],v[12:15],v[148:151],a[92:95]
TR v[24:25],v1,1544
M a[96:99],v[12:15],v[152:155],a[96:99]
WL 3
TR v[26:27],v1,9736
M a[100:103],v[16:19],v[136:139],a[100:103]
M a[104:107],v[16:19],v[140:143],a[104:107]
s_add_u32 m0, s62, 12288
s_nop 0
buffer_load_dwordx4 v5, s[8:11], s38 offen lds
M a[108:111],v[16:19],v[144:147],a[108:111]
M a[112:115],v[16:19],v[148:151],a[112:115]
TR v[12:13],v1,2048
M a[116:119],v[16:19],v[152:155],a[116:119]
WL 3
TR v[14:15],v1,10240
M a[120:123],v[20:23],v[136:139],a[120:123]
M a[124:127],v[20:23],v[140:143],a[124:127]
M a[128:131],v[20:23],v[144:147],a[128:131]
s_add_u32 m0, s62, 13312
s_nop 0
buffer_load_dwordx4 v6, s[8:11], s46 offen lds
M a[132:135],v[20:23],v[148:151],a[132:135]
TR v[16:17],v1,2056
M a[136:139],v[20:23],v[152:155],a[136:139]
WL 3
TR v[18:19],v1,10248
M a[140:143],v[24:27],v[136:139],a[140:143]
M a[144:147],v[24:27],v[140:143],a[144:147]
M a[148:151],v[24:27],v[144:147],a[148:151]
M a[152:155],v[24:27],v[148:151],a[152:155]
s_add_u32 m0, s53, 32768
TR v[20:21],v1,2560
buffer_load_dwordx4 v4, s[12:15], s41 offen offset:0 lds
M a[156:159],v[24:27],v[152:155],a[156:159]
WL 3
TR v[22:23],v1,10752
M a[160:163],v[12:15],v[136:139],a[160:163]
M a[164:167],v[12:15],v[140:143],a[164:167]
M a[168:171],v[12:15],v[144:147],a[168:171]
M a[172:175],v[12:15],v[148:151],a[172:175]
TR v[24:25],v1,2568
M a[176:179],v[12:15],v[152:155],a[176:179]
WL 3
TR v[26:27],v1,10760
M a[180:183],v[16:19],v[136:139],a[180:183]
s_add_u32 m0, s53, 33664
s_nop 0
buffer_load_dwordx4 v4, s[12:15], s41 offen offset:128 lds
M a[184:187],v[16:19],v[140:143],a[184:187]
M a[188:191],v[16:19],v[144:147],a[188:191]
M a[192:195],v[16:19],v[148:151],a[192:195]
TR v[12:13],v1,3072
M a[196:199],v[16:19],v[152:155],a[196:199]
WL 3
TR v[14:15],v1,11264
M a[200:203],v[20:23],v[136:139],a[200:203]
M a[204:207],v[20:23],v[140:143],a[204:207]
s_add_u32 m0, s53, 34560
s_nop 0
buffer_load_dwordx4 v4, s[12:15], s41 offen offset:256 lds
M a[208:211],v[20:23],v[144:147],a[208:211]
M a[212:215],v[20:23],v[148:151],a[212:215]
TR v[16:17],v1,3080
M a[216:219],v[20:23],v[152:155],a[216:219]
WL 3
TR v[18:19],v1,11272
M a[220:223],v[24:27],v[136:139],a[220:223]
M a[224:227],v[24:27],v[140:143],a[224:227]
M a[228:231],v[24:27],v[144:147],a[228:231]
s_add_u32 m0, s53, 35456
s_nop 0
buffer_load_dwordx4 v4, s[12:15], s41 offen offset:384 lds
s_add_u32 s41, s41, 262144
M a[232:235],v[24:27],v[148:151],a[232:235]
TR v[20:21],v1,3584
M a[236:239],v[24:27],v[152:155],a[236:239]
WL 3
TR v[22:23],v1,11776
M a[240:243],v[12:15],v[136:139],a[240:243]
M a[244:247],v[12:15],v[140:143],a[244:247]
M a[248:251],v[12:15],v[144:147],a[248:251]
M a[252:255],v[12:15],v[148:151],a[252:255]
TR v[24:25],v1,3592
M v[192:195],v[12:15],v[152:155],v[192:195]
WL 3
TR v[26:27],v1,11784
M v[196:199],v[16:19],v[136:139],v[196:199]
v_add_u32 v1, 0x4000, v1
M v[200:203],v[16:19],v[140:143],v[200:203]
WV 22
M v[204:207],v[16:19],v[144:147],v[204:207]
s_barrier
M v[208:211],v[16:19],v[148:151],v[208:211]
TR v[12:13],v1,0
M v[212:215],v[16:19],v[152:155],v[212:215]
WL 3
TR v[14:15],v1,8192
M v[216:219],v[20:23],v[136:139],v[216:219]
M v[220:223],v[20:23],v[140:143],v[220:223]
M v[224:227],v[20:23],v[144:147],v[224:227]
M v[228:231],v[20:23],v[148:151],v[228:231]
TR v[16:17],v1,8
M v[232:235],v[20:23],v[152:155],v[232:235]
WL 3
TR v[18:19],v1,8200
M v[236:239],v[24:27],v[136:139],v[236:239]
M v[240:243],v[24:27],v[140:143],v[240:243]
M v[244:247],v[24:27],v[144:147],v[244:247]
M v[248:251],v[24:27],v[148:151],v[248:251]
TR v[20:21],v1,512
M v[252:255],v[24:27],v[152:155],v[252:255]
WL 3
TR v[22:23],v1,8704
M a[0:3],v[12:15],v[156:159],a[0:3]
M a[4:7],v[12:15],v[160:163],a[4:7]
s_add_u32 m0, s53, 49152
s_nop 0
buffer_load_dwordx4 v4, s[12:15], s41 offen offset:0 lds
M a[8:11],v[12:15],v[164:167],a[8:11]
M a[12:15],v[12:15],v[168:171],a[12:15]
TR v[24:25],v1,520
M a[16:19],v[12:15],v[172:175],a[16:19]
WL 3
TR v[26:27],v1,8712
M a[20:23],v[16:19],v[156:159],a[20:23]
M a[24:27],v[16:19],v[160:163],a[24:27]
M a[28:31],v[16:19],v[164:167],a[28:31]
M a[32:35],v[16:19],v[168:171],a[32:35]
TR v[12:13],v1,1024
M a[36:39],v[16:19],v[172:175],a[36:39]
WL 3
TR v[14:15],v1,9216
M a[40:43],v[20:23],v[156:159],a[40:43]
M a[44:47],v[20:23],v[160:163],a[44:47]
M a[48:51],v[20:23],v[164:167],a[48:51]
s_add_u32 m0, s53, 50048
s_nop 0
buffer_load_dwordx4 v4, s[12:15], s41 offen offset:128 lds
M a[52:55],v[20:23],v[168:171],a[52:55]
TR v[16:17],v1,1032
M a[56:59],v[20:23],v[172:175],a[56:59]
WL 3
TR v[18:19],v1,9224
M a[60:63],v[24:27],v[156:159],a[60:63]
WV 36
M a[64:67],v[24:27],v[160:163],a[64:67]
RD v[36:39],v7,14336
M a[68:71],v[24:27],v[164:167],a[68:71]
RD v[56:59],v8,14336
M a[72:75],v[24:27],v[168:171],a[72:75]
TR v[20:21],v1,1536
M a[76:79],v[24:27],v[172:175],a[76:79]
WL 5
TR v[22:23],v1,9728
M a[80:83],v[12:15],v[156:159],a[80:83]
WV 34
M a[84:87],v[12:15],v[160:163],a[84:87]
RD v[40:43],v7,0
M a[88:91],v[12:15],v[164:167],a[88:91]
RD v[60:63],v8,0
M a[92:95],v[12:15],v[168:171],a[92:95]
s_add_u32 m0, s53, 50944
TR v[24:25],v1,1544
buffer_load_dwordx4 v4, s[12:15], s41 offen offset:256 lds
M a[96:99],v[12:15],v[172:175],a[96:99]
WL 7
TR v[26:27],v1,9736
M a[100:103],v[16:19],v[156:159],a[100:103]
WV 33
M a[104:107],v[16:19],v[160:163],a[104:107]
RD v[44:47],v7,2048
M a[108:111],v[16:19],v[164:167],a[108:111]
RD v[64:67],v8,2048
M a[112:115],v[16:19],v[168:171],a[112:115]
TR v[12:13],v1,2048
M a[116:119],v[16:19],v[172:175],a[116:119]
WL 7
TR v[14:15],v1,10240
M a[120:123],v[20:23],v[156:159],a[120:123]
WV 15
M a[124:127],v[20:23],v[160:163],a[124:127]
RD v[48:51],v7,4096
M a[128:131],v[20:23],v[164:167],a[128:131]
RD v[68:71],v8,4096
M a[132:135],v[20:23],v[168:171],a[132:135]
TR v[16:17],v1,2056
M a[136:139],v[20:23],v[172:175],a[136:139]
WL 7
TR v[18:19],v1,10248
M a[140:143],v[24:27],v[156:159],a[140:143]
WV 13
M a[144:147],v[24:27],v[160:163],a[144:147]
s_add_u32 m0, s53, 51840
RD v[52:55],v7,6144
buffer_load_dwordx4 v4, s[12:15], s41 offen offset:384 lds
s_add_u32 s41, s41, 262144
M a[148:151],v[24:27],v[164:167],a[148:151]
RD v[72:75],v8,6144
M a[152:155],v[24:27],v[168:171],a[152:155]
TR v[20:21],v1,2560
M a[156:159],v[24:27],v[172:175],a[156:159]
WL 7
TR v[22:23],v1,10752
M a[160:163],v[12:15],v[156:159],a[160:163]
M a[164:167],v[12:15],v[160:163],a[164:167]
M a[168:171],v[12:15],v[164:167],a[168:171]
M a[172:175],v[12:15],v[168:171],a[172:175]
TR v[24:25],v1,2568
M a[176:179],v[12:15],v[172:175],a[176:179]
WL 5
TR v[26:27],v1,10760
M a[180:183],v[16:19],v[156:159],a[180:183]
M a[184:187],v[16:19],v[160:163],a[184:187]
M a[188:191],v[16:19],v[164:167],a[188:191]
M a[192:195],v[16:19],v[168:171],a[192:195]
s_add_u32 m0, s62, 14336
TR v[12:13],v1,3072
buffer_load_dwordx4 v5, s[8:11], s39 offen lds
M a[196:199],v[16:19],v[172:175],a[196:199]
WL 3
TR v[14:15],v1,11264
M a[200:203],v[20:23],v[156:159],a[200:203]
M a[204:207],v[20:23],v[160:163],a[204:207]
M a[208:211],v[20:23],v[164:167],a[208:211]
s_add_u32 m0, s62, 15360
s_nop 0
buffer_load_dwordx4 v6, s[8:11], s47 offen lds
M a[212:215],v[20:23],v[168:171],a[212:215]
TR v[16:17],v1,3080
M a[216:219],v[20:23],v[172:175],a[216:219]
WL 3
TR v[18:19],v1,11272
M a[220:223],v[24:27],v[156:159],a[220:223]
s_add_u32 m0, s62, 0
s_nop 0
buffer_load_dwordx4 v5, s[8:11], s40 offen lds
M a[224:227],v[24:27],v[160:163],a[224:227]
M a[228:231],v[24:27],v[164:167],a[228:231]
M a[232:235],v[24:27],v[168:171],a[232:235]
TR v[20:21],v1,3584
M a[236:239],v[24:27],v[172:175],a[236:239]
WL 3
TR v[22:23],v1,11776
M a[240:243],v[12:15],v[156:159],a[240:243]
s_add_u32 m0, s62, 1024
s_nop 0
buffer_load_dwordx4 v6, s[8:11], s48 offen lds
M a[244:247],v[12:15],v[160:163],a[244:247]
M a[248:251],v[12:15],v[164:167],a[248:251]
M a[252:255],v[12:15],v[168:171],a[252:255]
TR v[24:25],v1,3592
M v[192:195],v[12:15],v[172:175],v[192:195]
WL 3
TR v[26:27],v1,11784
M v[196:199],v[16:19],v[156:159],v[196:199]
v_add_u32 v1, 0xfffec000, v1
M v[200:203],v[16:19],v[160:163],v[200:203]
WV 26
M v[204:207],v[16:19],v[164:167],v[204:207]
s_barrier
M v[208:211],v[16:19],v[168:171],v[208:211]
TR v[12:13],v1,0
M v[212:215],v[16:19],v[172:175],v[212:215]
WL 3
TR v[14:15],v1,8192
M v[216:219],v[20:23],v[156:159],v[216:219]
M v[220:223],v[20:23],v[160:163],v[220:223]
M v[224:227],v[20:23],v[164:167],v[224:227]
M v[228:231],v[20:23],v[168:171],v[228:231]
TR v[16:17],v1,8
M v[232:235],v[20:23],v[172:175],v[232:235]
WL 3
TR v[18:19],v1,8200
M v[236:239],v[24:27],v[156:159],v[236:239]
M v[240:243],v[24:27],v[160:163],v[240:243]
M v[244:247],v[24:27],v[164:167],v[244:247]
M v[248:251],v[24:27],v[168:171],v[248:251]
TR v[20:21],v1,512
M v[252:255],v[24:27],v[172:175],v[252:255]
WL 3
TR v[22:23],v1,8704
L1_qp_5:
M a[0:3],v[12:15],v[36:39],a[0:3]
M a[4:7],v[12:15],v[40:43],a[4:7]
s_add_u32 m0, s62, 2048
v_add_u32 v5, 128, v5
v_add_u32 v6, 128, v6
s_nop 0
buffer_load_dwordx4 v5, s[8:11], s36 offen lds
M a[8:11],v[12:15],v[44:47],a[8:11]
M a[12:15],v[12:15],v[48:51],a[12:15]
TR v[24:25],v1,520
M a[16:19],v[12:15],v[52:55],a[16:19]
WL 3
TR v[26:27],v1,8712
M a[20:23],v[16:19],v[36:39],a[20:23]
M a[24:27],v[16:19],v[40:43],a[24:27]
M a[28:31],v[16:19],v[44:47],a[28:31]
s_add_u32 m0, s62, 3072
s_nop 0
buffer_load_dwordx4 v6, s[8:11], s44 offen lds
M a[32:35],v[16:19],v[48:51],a[32:35]
TR v[12:13],v1,1024
M a[36:39],v[16:19],v[52:55],a[36:39]
WL 3
TR v[14:15],v1,9216
M a[40:43],v[20:23],v[36:39],a[40:43]
M a[44:47],v[20:23],v[40:43],a[44:47]
M a[48:51],v[20:23],v[44:47],a[48:51]
M a[52:55],v[20:23],v[48:51],a[52:55]
s_add_u32 m0, s62, 4096
TR v[16:17],v1,1032
buffer_load_dwordx4 v5, s[8:11], s37 offen lds
M a[56:59],v[20:23],v[52:55],a[56:59]
WL 3
TR v[18:19],v1,9224
M a[60:63],v[24:27],v[36:39],a[60:63]
M a[64:67],v[24:27],v[40:43],a[64:67]
M a[68:71],v[24:27],v[44:47],a[68:71]
M a[72:75],v[24:27],v[48:51],a[72:75]
TR v[20:21],v1,1536
M a[76:79],v[24:27],v[52:55],a[76:79]
WL 3
TR v[22:23],v1,9728
M a[80:83],v[12:15],v[36:39],a[80:83]
s_add_u32 m0, s62, 5120
s_nop 0
buffer_load_dwordx4 v6, s[8:11], s45 offen lds
M a[84:87],v[12:15],v[40:43],a[84:87]
M a[88:91],v[12:15],v[44:47],a[88:91]
M a[92:95],v[12:15],v[48:51],a[92:95]
TR v[24:25],v1,1544
M a[96:99],v[12:15],v[52:55],a[96:99]
WL 3
TR v[26:27],v1,9736
M a[100:103],v[16:19],v[36:39],a[100:103]
M a[104:107],v[16:19],v[40:43],a[104:107]
s_add_u32 m0, s62, 6144
s_nop 0
buffer_load_dwordx4 v5, s[8:11], s38 offen lds
M a[108:111],v[16:19],v[44:47],a[108:111]
M a[112:115],v[16:19],v[48:51],a[112:115]
TR v[12:13],v1,2048
M a[116:119],v[16:19],v[52:55],a[116:119]
WL 3
TR v[14:15],v1,10240
M a[120:123],v[20:23],v[36:39],a[120:123]
M a[124:127],v[20:23],v[40:43],a[124:127]
M a[128:131],v[20:23],v[44:47],a[128:131]
s_add_u32 m0, s62, 7168
s_nop 0
buffer_load_dwordx4 v6, s[8:11], s46 offen lds
M a[132:135],v[20:23],v[48:51],a[132:135]
TR v[16:17],v1,2056
M a[136:139],v[20:23],v[52:55],a[136:139]
WL 3
TR v[18:19],v1,10248
M a[140:143],v[24:27],v[36:39],a[140:143]
M a[144:147],v[24:27],v[40:43],a[144:147]
M a[148:151],v[24:27],v[44:47],a[148:151]
M a[152:155],v[24:27],v[48:51],a[152:155]
s_add_u32 m0, s53, 65536
TR v[20:21],v1,2560
buffer_load_dwordx4 v4, s[12:15], s41 offen offset:0 lds
M a[156:159],v[24:27],v[52:55],a[156:159]
WL 3
TR v[22:23],v1,10752
M a[160:163],v[12:15],v[36:39],a[160:163]
M a[164:167],v[12:15],v[40:43],a[164:167]
M a[168:171],v[12:15],v[44:47],a[168:171]
M a[172:175],v[12:15],v[48:51],a[172:175]
TR v[24:25],v1,2568
M a[176:179],v[12:15],v[52:55],a[176:179]
WL 3
TR v[26:27],v1,10760
M a[180:183],v[16:19],v[36:39],a[180:183]
s_add_u32 m0, s53, 66432
s_nop 0
buffer_load_dwordx4 v4, s[12:15], s41 offen offset:128 lds
M a[184:187],v[16:19],v[40:43],a[184:187]
M a[188:191],v[16:19],v[44:47],a[188:191]
M a[192:195],v[16:19],v[48:51],a[192:195]
TR v[12:13],v1,3072
M a[196:199],v[16:19],v[52:55],a[196:199]
WL 3
TR v[14:15],v1,11264
M a[200:203],v[20:23],v[36:39],a[200:203]
M a[204:207],v[20:23],v[40:43],a[204:207]
s_add_u32 m0, s53, 67328
s_nop 0
buffer_load_dwordx4 v4, s[12:15], s41 offen offset:256 lds
M a[208:211],v[20:23],v[44:47],a[208:211]
M a[212:215],v[20:23],v[48:51],a[212:215]
TR v[16:17],v1,3080
M a[216:219],v[20:23],v[52:55],a[216:219]
WL 3
TR v[18:19],v1,11272
M a[220:223],v[24:27],v[36:39],a[220:223]
M a[224:227],v[24:27],v[40:43],a[224:227]
M a[228:231],v[24:27],v[44:47],a[228:231]
s_add_u32 m0, s53, 68224
s_nop 0
buffer_load_dwordx4 v4, s[12:15], s41 offen offset:384 lds
s_add_u32 s41, s41, 262144
M a[232:235],v[24:27],v[48:51],a[232:235]
TR v[20:21],v1,3584
M a[236:239],v[24:27],v[52:55],a[236:239]
WL 3
TR v[22:23],v1,11776
M a[240:243],v[12:15],v[36:39],a[240:243]
M a[244:247],v[12:15],v[40:43],a[244:247]
M a[248:251],v[12:15],v[44:47],a[248:251]
M a[252:255],v[12:15],v[48:51],a[252:255]
TR v[24:25],v1,3592
M v[192:195],v[12:15],v[52:55],v[192:195]
WL 3
TR v[26:27],v1,11784
M v[196:199],v[16:19],v[36:39],v[196:199]
v_add_u32 v1, 0x4000, v1
M v[200:203],v[16:19],v[40:43],v[200:203]
WV 32
M v[204:207],v[16:19],v[44:47],v[204:207]
s_barrier
M v[208:211],v[16:19],v[48:51],v[208:211]
TR v[12:13],v1,0
M v[212:215],v[16:19],v[52:55],v[212:215]
WL 3
TR v[14:15],v1,8192
M v[216:219],v[20:23],v[36:39],v[216:219]
M v[220:223],v[20:23],v[40:43],v[220:223]
M v[224:227],v[20:23],v[44:47],v[224:227]
M v[228:231],v[20:23],v[48:51],v[228:231]
TR v[16:17],v1,8
M v[232:235],v[20:23],v[52:55],v[232:235]
WL 3
TR v[18:19],v1,8200
M v[236:239],v[24:27],v[36:39],v[236:239]
M v[240:243],v[24:27],v[40:43],v[240:243]
M v[244:247],v[24:27],v[44:47],v[244:247]
M v[248:251],v[24:27],v[48:51],v[248:251]
TR v[20:21],v1,512
M v[252:255],v[24:27],v[52:55],v[252:255]
WL 3
TR v[22:23],v1,8704
M a[0:3],v[12:15],v[56:59],a[0:3]
M a[4:7],v[12:15],v[60:63],a[4:7]
s_add_u32 m0, s53, 81920
s_nop 0
buffer_load_dwordx4 v4, s[12:15], s41 offen offset:0 lds
M a[8:11],v[12:15],v[64:67],a[8:11]
M a[12:15],v[12:15],v[68:71],a[12:15]
TR v[24:25],v1,520
M a[16:19],v[12:15],v[72:75],a[16:19]
WL 3
TR v[26:27],v1,8712
M a[20:23],v[16:19],v[56:59],a[20:23]
M a[24:27],v[16:19],v[60:63],a[24:27]
M a[28:31],v[16:19],v[64:67],a[28:31]
M a[32:35],v[16:19],v[68:71],a[32:35]
TR v[12:13],v1,1024
M a[36:39],v[16:19],v[72:75],a[36:39]
WL 3
TR v[14:15],v1,9216
M a[40:43],v[20:23],v[56:59],a[40:43]
M a[44:47],v[20:23],v[60:63],a[44:47]
M a[48:51],v[20:23],v[64:67],a[48:51]
s_add_u32 m0, s53, 82816
s_nop 0
buffer_load_dwordx4 v4, s[12:15], s41 offen offset:128 lds
M a[52:55],v[20:23],v[68:71],a[52:55]
TR v[16:17],v1,1032
M a[56:59],v[20:23],v[72:75],a[56:59]
WL 3
TR v[18:19],v1,9224
M a[60:63],v[24:27],v[56:59],a[60:63]
WV 28
M a[64:67],v[24:27],v[60:63],a[64:67]
RD v[76:79],v7,8192
M a[68:71],v[24:27],v[64:67],a[68:71]
RD v[96:99],v8,8192
M a[72:75],v[24:27],v[68:71],a[72:75]
TR v[20:21],v1,1536
M a[76:79],v[24:27],v[72:75],a[76:79]
WL 5
TR v[22:23],v1,9728
M a[80:83],v[12:15],v[56:59],a[80:83]
WV 26
M a[84:87],v[12:15],v[60:63],a[84:87]
RD v[80:83],v7,10240
M a[88:91],v[12:15],v[64:67],a[88:91]
RD v[100:103],v8,10240
M a[92:95],v[12:15],v[68:71],a[92:95]
s_add_u32 m0, s53, 83712
TR v[24:25],v1,1544
buffer_load_dwordx4 v4, s[12:15], s41 offen offset:256 lds
M a[96:99],v[12:15],v[72:75],a[96:99]
WL 7
TR v[26:27],v1,9736
M a[100:103],v[16:19],v[56:59],a[100:103]
WV 25
M a[104:107],v[16:19],v[60:63],a[104:107]
RD v[84:87],v7,12288
M a[108:111],v[16:19],v[64:67],a[108:111]
RD v[104:107],v8,12288
M a[112:115],v[16:19],v[68:71],a[112:115]
TR v[12:13],v1,2048
M a[116:119],v[16:19],v[72:75],a[116:119]
WL 7
TR v[14:15],v1,10240
M a[120:123],v[20:23],v[56:59],a[120:123]
WV 15
M a[124:127],v[20:23],v[60:63],a[124:127]
RD v[88:91],v7,14336
M a[128:131],v[20:23],v[64:67],a[128:131]
RD v[108:111],v8,14336
M a[132:135],v[20:23],v[68:71],a[132:135]
TR v[16:17],v1,2056
M a[136:139],v[20:23],v[72:75],a[136:139]
WL 7
TR v[18:19],v1,10248
M a[140:143],v[24:27],v[56:59],a[140:143]
WV 13
M a[144:147],v[24:27],v[60:63],a[144:147]
s_add_u32 m0, s53, 84608
RD v[92:95],v7,0
buffer_load_dwordx4 v4, s[12:15], s41 offen offset:384 lds
s_add_u32 s41, s41, 262144
M a[148:151],v[24:27],v[64:67],a[148:151]
RD v[112:115],v8,0
M a[152:155],v[24:27],v[68:71],a[152:155]
TR v[20:21],v1,2560
M a[156:159],v[24:27],v[72:75],a[156:159]
WL 7
TR v[22:23],v1,10752
M a[160:163],v[12:15],v[56:59],a[160:163]
M a[164:167],v[12:15],v[60:63],a[164:167]
M a[168:171],v[12:15],v[64:67],a[168:171]
M a[172:175],v[12:15],v[68:71],a[172:175]
TR v[24:25],v1,2568
M a[176:179],v[12:15],v[72:75],a[176:179]
WL 5
TR v[26:27],v1,10760
M a[180:183],v[16:19],v[56:59],a[180:183]
M a[184:187],v[16:19],v[60:63],a[184:187]
M a[188:191],v[16:19],v[64:67],a[188:191]
M a[192:195],v[16:19],v[68:71],a[192:195]
s_add_u32 m0, s62, 8192
TR v[12:13],v1,3072
buffer_load_dwordx4 v5, s[8:11], s39 offen lds
M a[196:199],v[16:19],v[72:75],a[196:199]
WL 3
TR v[14:15],v1,11264
M a[200:203],v[20:23],v[56:59],a[200:203]
M a[204:207],v[20:23],v[60:63],a[204:207]
M a[208:211],v[20:23],v[64:67],a[208:211]
s_add_u32 m0, s62, 9216
s_nop 0
buffer_load_dwordx4 v6, s[8:11], s47 offen lds
M a[212:215],v[20:23],v[68:71],a[212:215]
TR v[16:17],v1,3080
M a[216:219],v[20:23],v[72:75],a[216:219]
WL 3
TR v[18:19],v1,11272
M a[220:223],v[24:27],v[56:59],a[220:223]
s_add_u32 m0, s62, 10240
s_nop 0
buffer_load_dwordx4 v5, s[8:11], s40 offen lds
M a[224:227],v[24:27],v[60:63],a[224:227]
M a[228:231],v[24:27],v[64:67],a[228:231]
M a[232:235],v[24:27],v[68:71],a[232:235]
TR v[20:21],v1,3584
M a[236:239],v[24:27],v[72:75],a[236:239]
WL 3
TR v[22:23],v1,11776
M a[240:243],v[12:15],v[56:59],a[240:243]
s_add_u32 m0, s62, 11264
s_nop 0
buffer_load_dwordx4 v6, s[8:11], s48 offen lds
M a[244:247],v[12:15],v[60:63],a[244:247]
M a[248:251],v[12:15],v[64:67],a[248:251]
M a[252:255],v[12:15],v[68:71],a[252:255]
TR v[24:25],v1,3592
M v[192:195],v[12:15],v[72:75],v[192:195]
WL 3
TR v[26:27],v1,11784
M v[196:199],v[16:19],v[56:59],v[196:199]
v_add_u32 v1, 0x4000, v1
M v[200:203],v[16:19],v[60:63],v[200:203]
WV 26
M v[204:207],v[16:19],v[64:67],v[204:207]
s_barrier
M v[208:211],v[16:19],v[68:71],v[208:211]
TR v[12:13],v1,0
M v[212:215],v[16:19],v[72:75],v[212:215]
WL 3
TR v[14:15],v1,8192
M v[216:219],v[20:23],v[56:59],v[216:219]
M v[220:223],v[20:23],v[60:63],v[220:223]
M v[224:227],v[20:23],v[64:67],v[224:227]
M v[228:231],v[20:23],v[68:71],v[228:231]
TR v[16:17],v1,8
M v[232:235],v[20:23],v[72:75],v[232:235]
WL 3
TR v[18:19],v1,8200
M v[236:239],v[24:27],v[56:59],v[236:239]
M v[240:243],v[24:27],v[60:63],v[240:243]
M v[244:247],v[24:27],v[64:67],v[244:247]
M v[248:251],v[24:27],v[68:71],v[248:251]
TR v[20:21],v1,512
M v[252:255],v[24:27],v[72:75],v[252:255]
WL 3
TR v[22:23],v1,8704
M a[0:3],v[12:15],v[76:79],a[0:3]
M a[4:7],v[12:15],v[80:83],a[4:7]
s_add_u32 m0, s62, 12288
v_add_u32 v5, 128, v5
v_add_u32 v6, 128, v6
s_nop 0
buffer_load_dwordx4 v5, s[8:11], s36 offen lds
M a[8:11],v[12:15],v[84:87],a[8:11]
M a[12:15],v[12:15],v[88:91],a[12:15]
TR v[24:25],v1,520
M a[16:19],v[12:15],v[92:95],a[16:19]
WL 3
TR v[26:27],v1,8712
M a[20:23],v[16:19],v[76:79],a[20:23]
M a[24:27],v[16:19],v[80:83],a[24:27]
M a[28:31],v[16:19],v[84:87],a[28:31]
s_add_u32 m0, s62, 13312
s_nop 0
buffer_load_dwordx4 v6, s[8:11], s44 offen lds
M a[32:35],v[16:19],v[88:91],a[32:35]
TR v[12:13],v1,1024
M a[36:39],v[16:19],v[92:95],a[36:39]
WL 3
TR v[14:15],v1,9216
M a[40:43],v[20:23],v[76:79],a[40:43]
M a[44:47],v[20:23],v[80:83],a[44:47]
M a[48:51],v[20:23],v[84:87],a[48:51]
M a[52:55],v[20:23],v[88:91],a[52:55]
s_add_u32 m0, s62, 14336
TR v[16:17],v1,1032
buffer_load_dwordx4 v5, s[8:11], s37 offen lds
M a[56:59],v[20:23],v[92:95],a[56:59]
WL 3
TR v[18:19],v1,9224
M a[60:63],v[24:27],v[76:79],a[60:63]
M a[64:67],v[24:27],v[80:83],a[64:67]
M a[68:71],v[24:27],v[84:87],a[68:71]
M a[72:75],v[24:27],v[88:91],a[72:75]
TR v[20:21],v1,1536
M a[76:79],v[24:27],v[92:95],a[76:79]
WL 3
TR v[22:23],v1,9728
M a[80:83],v[12:15],v[76:79],a[80:83]
s_add_u32 m0, s62, 15360
s_nop 0
buffer_load_dwordx4 v6, s[8:11], s45 offen lds
M a[84:87],v[12:15],v[80:83],a[84:87]
M a[88:91],v[12:15],v[84:87],a[88:91]
M a[92:95],v[12:15],v[88:91],a[92:95]
TR v[24:25],v1,1544
M a[96:99],v[12:15],v[92:95],a[96:99]
WL 3
TR v[26:27],v1,9736
M a[100:103],v[16:19],v[76:79],a[100:103]
M a[104:107],v[16:19],v[80:83],a[104:107]
s_add_u32 m0, s62, 0
s_nop 0
buffer_load_dwordx4 v5, s[8:11], s38 offen lds
M a[108:111],v[16:19],v[84:87],a[108:111]
M a[112:115],v[16:19],v[88:91],a[112:115]
TR v[12:13],v1,2048
M a[116:119],v[16:19],v[92:95],a[116:119]
WL 3
TR v[14:15],v1,10240
M a[120:123],v[20:23],v[76:79],a[120:123]
M a[124:127],v[20:23],v[80:83],a[124:127]
M a[128:131],v[20:23],v[84:87],a[128:131]
s_add_u32 m0, s62, 1024
s_nop 0
buffer_load_dwordx4 v6, s[8:11], s46 offen lds
M a[132:135],v[20:23],v[88:91],a[132:135]
TR v[16:17],v1,2056
M a[136:139],v[20:23],v[92:95],a[136:139]
WL 3
TR v[18:19],v1,10248
M a[140:143],v[24:27],v[76:79],a[140:143]
M a[144:147],v[24:27],v[80:83],a[144:147]
M a[148:151],v[24:27],v[84:87],a[148:151]
M a[152:155],v[24:27],v[88:91],a[152:155]
s_add_u32 m0, s53, 0
TR v[20:21],v1,2560
buffer_load_dwordx4 v4, s[12:15], s41 offen offset:0 lds
M a[156:159],v[24:27],v[92:95],a[156:159]
WL 3
TR v[22:23],v1,10752
M a[160:163],v[12:15],v[76:79],a[160:163]
M a[164:167],v[12:15],v[80:83],a[164:167]
M a[168:171],v[12:15],v[84:87],a[168:171]
M a[172:175],v[12:15],v[88:91],a[172:175]
TR v[24:25],v1,2568
M a[176:179],v[12:15],v[92:95],a[176:179]
WL 3
TR v[26:27],v1,10760
M a[180:183],v[16:19],v[76:79],a[180:183]
s_add_u32 m0, s53, 896
s_nop 0
buffer_load_dwordx4 v4, s[12:15], s41 offen offset:128 lds
M a[184:187],v[16:19],v[80:83],a[184:187]
M a[188:191],v[16:19],v[84:87],a[188:191]
M a[192:195],v[16:19],v[88:91],a[192:195]
TR v[12:13],v1,3072
M a[196:199],v[16:19],v[92:95],a[196:199]
WL 3
TR v[14:15],v1,11264
M a[200:203],v[20:23],v[76:79],a[200:203]
M a[204:207],v[20:23],v[80:83],a[204:207]
s_add_u32 m0, s53, 1792
s_nop 0
buffer_load_dwordx4 v4, s[12:15], s41 offen offset:256 lds
M a[208:211],v[20:23],v[84:87],a[208:211]
M a[212:215],v[20:23],v[88:91],a[212:215]
TR v[16:17],v1,3080
M a[216:219],v[20:23],v[92:95],a[216:219]
WL 3
TR v[18:19],v1,11272
M a[220:223],v[24:27],v[76:79],a[220:223]
M a[224:227],v[24:27],v[80:83],a[224:227]
M a[228:231],v[24:27],v[84:87],a[228:231]
s_add_u32 m0, s53, 2688
s_nop 0
buffer_load_dwordx4 v4, s[12:15], s41 offen offset:384 lds
s_add_u32 s41, s41, 262144
M a[232:235],v[24:27],v[88:91],a[232:235]
TR v[20:21],v1,3584
M a[236:239],v[24:27],v[92:95],a[236:239]
WL 3
TR v[22:23],v1,11776
M a[240:243],v[12:15],v[76:79],a[240:243]
M a[244:247],v[12:15],v[80:83],a[244:247]
M a[248:251],v[12:15],v[84:87],a[248:251]
M a[252:255],v[12:15],v[88:91],a[252:255]
TR v[24:25],v1,3592
M v[192:195],v[12:15],v[92:95],v[192:195]
WL 3
TR v[26:27],v1,11784
M v[196:199],v[16:19],v[76:79],v[196:199]
v_add_u32 v1, 0x4000, v1
M v[200:203],v[16:19],v[80:83],v[200:203]
WV 32
M v[204:207],v[16:19],v[84:87],v[204:207]
s_barrier
M v[208:211],v[16:19],v[88:91],v[208:211]
TR v[12:13],v1,0
M v[212:215],v[16:19],v[92:95],v[212:215]
WL 3
TR v[14:15],v1,8192
M v[216:219],v[20:23],v[76:79],v[216:219]
M v[220:223],v[20:23],v[80:83],v[220:223]
M v[224:227],v[20:23],v[84:87],v[224:227]
M v[228:231],v[20:23],v[88:91],v[228:231]
TR v[16:17],v1,8
M v[232:235],v[20:23],v[92:95],v[232:235]
WL 3
TR v[18:19],v1,8200
M v[236:239],v[24:27],v[76:79],v[236:239]
M v[240:243],v[24:27],v[80:83],v[240:243]
M v[244:247],v[24:27],v[84:87],v[244:247]
M v[248:251],v[24:27],v[88:91],v[248:251]
TR v[20:21],v1,512
M v[252:255],v[24:27],v[92:95],v[252:255]
WL 3
TR v[22:23],v1,8704
M a[0:3],v[12:15],v[96:99],a[0:3]
M a[4:7],v[12:15],v[100:103],a[4:7]
s_add_u32 m0, s53, 16384
s_nop 0
buffer_load_dwordx4 v4, s[12:15], s41 offen offset:0 lds
M a[8:11],v[12:15],v[104:107],a[8:11]
M a[12:15],v[12:15],v[108:111],a[12:15]
TR v[24:25],v1,520
M a[16:19],v[12:15],v[112:115],a[16:19]
WL 3
TR v[26:27],v1,8712
M a[20:23],v[16:19],v[96:99],a[20:23]
M a[24:27],v[16:19],v[100:103],a[24:27]
M a[28:31],v[16:19],v[104:107],a[28:31]
M a[32:35],v[16:19],v[108:111],a[32:35]
TR v[12:13],v1,1024
M a[36:39],v[16:19],v[112:115],a[36:39]
WL 3
TR v[14:15],v1,9216
M a[40:43],v[20:23],v[96:99],a[40:43]
M a[44:47],v[20:23],v[100:103],a[44:47]
M a[48:51],v[20:23],v[104:107],a[48:51]
s_add_u32 m0, s53, 17280
s_nop 0
buffer_load_dwordx4 v4, s[12:15], s41 offen offset:128 lds
M a[52:55],v[20:23],v[108:111],a[52:55]
TR v[16:17],v1,1032
M a[56:59],v[20:23],v[112:115],a[56:59]
WL 3
TR v[18:19],v1,9224
M a[60:63],v[24:27],v[96:99],a[60:63]
WV 28
M a[64:67],v[24:27],v[100:103],a[64:67]
RD v[116:119],v7,2048
M a[68:71],v[24:27],v[104:107],a[68:71]
RD v[136:139],v8,2048
M a[72:75],v[24:27],v[108:111],a[72:75]
TR v[20:21],v1,1536
M a[76:79],v[24:27],v[112:115],a[76:79]
WL 5
TR v[22:23],v1,9728
M a[80:83],v[12:15],v[96:99],a[80:83]
WV 26
M a[84:87],v[12:15],v[100:103],a[84:87]
RD v[120:123],v7,4096
M a[88:91],v[12:15],v[104:107],a[88:91]
RD v[140:143],v8,4096
M a[92:95],v[12:15],v[108:111],a[92:95]
s_add_u32 m0, s53, 18176
TR v[24:25],v1,1544
buffer_load_dwordx4 v4, s[12:15], s41 offen offset:256 lds
M a[96:99],v[12:15],v[112:115],a[96:99]
WL 7
TR v[26:27],v1,9736
M a[100:103],v[16:19],v[96:99],a[100:103]
WV 25
M a[104:107],v[16:19],v[100:103],a[104:107]
RD v[124:127],v7,6144
M a[108:111],v[16:19],v[104:107],a[108:111]
RD v[144:147],v8,6144
M a[112:115],v[16:19],v[108:111],a[112:115]
TR v[12:13],v1,2048
M a[116:119],v[16:19],v[112:115],a[116:119]
WL 7
TR v[14:15],v1,10240
M a[120:123],v[20:23],v[96:99],a[120:123]
WV 15
M a[124:127],v[20:23],v[100:103],a[124:127]
RD v[128:131],v7,8192
M a[128:131],v[20:23],v[104:107],a[128:131]
RD v[148:151],v8,8192
M a[132:135],v[20:23],v[108:111],a[132:135]
TR v[16:17],v1,2056
M a[136:139],v[20:23],v[112:115],a[136:139]
WL 7
TR v[18:19],v1,10248
M a[140:143],v[24:27],v[96:99],a[140:143]
WV 13
M a[144:147],v[24:27],v[100:103],a[144:147]
s_add_u32 m0, s53, 19072
RD v[132:135],v7,10240
buffer_load_dwordx4 v4, s[12:15], s41 offen offset:384 lds
s_add_u32 s41, s41, 262144
M a[148:151],v[24:27],v[104:107],a[148:151]
RD v[152:155],v8,10240
M a[152:155],v[24:27],v[108:111],a[152:155]
TR v[20:21],v1,2560
M a[156:159],v[24:27],v[112:115],a[156:159]
WL 7
TR v[22:23],v1,10752
M a[160:163],v[12:15],v[96:99],a[160:163]
M a[164:167],v[12:15],v[100:103],a[164:167]
M a[168:171],v[12:15],v[104:107],a[168:171]
M a[172:175],v[12:15],v[108:111],a[172:175]
TR v[24:25],v1,2568
M a[176:179],v[12:15],v[112:115],a[176:179]
WL 5
TR v[26:27],v1,10760
M a[180:183],v[16:19],v[96:99],a[180:183]
M a[184:187],v[16:19],v[100:103],a[184:187]
M a[188:191],v[16:19],v[104:107],a[188:191]
M a[192:195],v[16:19],v[108:111],a[192:195]
s_add_u32 m0, s62, 2048
TR v[12:13],v1,3072
buffer_load_dwordx4 v5, s[8:11], s39 offen lds
M a[196:199],v[16:19],v[112:115],a[196:199]
WL 3
TR v[14:15],v1,11264
M a[200:203],v[20:23],v[96:99],a[200:203]
M a[204:207],v[20:23],v[100:103],a[204:207]
M a[208:211],v[20:23],v[104:107],a[208:211]
s_add_u32 m0, s62, 3072
s_nop 0
buffer_load_dwordx4 v6, s[8:11], s47 offen lds
M a[212:215],v[20:23],v[108:111],a[212:215]
TR v[16:17],v1,3080
M a[216:219],v[20:23],v[112:115],a[216:219]
WL 3
TR v[18:19],v1,11272
M a[220:223],v[24:27],v[96:99],a[220:223]
s_add_u32 m0, s62, 4096
s_nop 0
buffer_load_dwordx4 v5, s[8:11], s40 offen lds
M a[224:227],v[24:27],v[100:103],a[224:227]
M a[228:231],v[24:27],v[104:107],a[228:231]
M a[232:235],v[24:27],v[108:111],a[232:235]
TR v[20:21],v1,3584
M a[236:239],v[24:27],v[112:115],a[236:239]
WL 3
TR v[22:23],v1,11776
M a[240:243],v[12:15],v[96:99],a[240:243]
s_add_u32 m0, s62, 5120
s_nop 0
buffer_load_dwordx4 v6, s[8:11], s48 offen lds
M a[244:247],v[12:15],v[100:103],a[244:247]
M a[248:251],v[12:15],v[104:107],a[248:251]
M a[252:255],v[12:15],v[108:111],a[252:255]
TR v[24:25],v1,3592
M v[192:195],v[12:15],v[112:115],v[192:195]
WL 3
TR v[26:27],v1,11784
M v[196:199],v[16:19],v[96:99],v[196:199]
v_add_u32 v1, 0x4000, v1
M v[200:203],v[16:19],v[100:103],v[200:203]
WV 26
M v[204:207],v[16:19],v[104:107],v[204:207]
s_barrier
M v[208:211],v[16:19],v[108:111],v[208:211]
TR v[12:13],v1,0
M v[212:215],v[16:19],v[112:115],v[212:215]
WL 3
TR v[14:15],v1,8192
M v[216:219],v[20:23],v[96:99],v[216:219]
M v[220:223],v[20:23],v[100:103],v[220:223]
M v[224:227],v[20:23],v[104:107],v[224:227]
M v[228:231],v[20:23],v[108:111],v[228:231]
TR v[16:17],v1,8
M v[232:235],v[20:23],v[112:115],v[232:235]
WL 3
TR v[18:19],v1,8200
M v[236:239],v[24:27],v[96:99],v[236:239]
M v[240:243],v[24:27],v[100:103],v[240:243]
M v[244:247],v[24:27],v[104:107],v[244:247]
M v[248:251],v[24:27],v[108:111],v[248:251]
TR v[20:21],v1,512
M v[252:255],v[24:27],v[112:115],v[252:255]
WL 3
TR v[22:23],v1,8704
M a[0:3],v[12:15],v[116:119],a[0:3]
M a[4:7],v[12:15],v[120:123],a[4:7]
s_add_u32 m0, s53, 32768
s_nop 0
buffer_load_dwordx4 v3, s[16:19], s42 offen offset:0 nt lds
M a[8:11],v[12:15],v[124:127],a[8:11]
M a[12:15],v[12:15],v[128:131],a[12:15]
TR v[24:25],v1,520
M a[16:19],v[12:15],v[132:135],a[16:19]
WL 3
TR v[26:27],v1,8712
M a[20:23],v[16:19],v[116:119],a[20:23]
M a[24:27],v[16:19],v[120:123],a[24:27]
M a[28:31],v[16:19],v[124:127],a[28:31]
M a[32:35],v[16:19],v[128:131],a[32:35]
TR v[12:13],v1,1024
M a[36:39],v[16:19],v[132:135],a[36:39]
WL 3
TR v[14:15],v1,9216
M a[40:43],v[20:23],v[116:119],a[40:43]
M a[44:47],v[20:23],v[120:123],a[44:47]
M a[48:51],v[20:23],v[124:127],a[48:51]
M a[52:55],v[20:23],v[128:131],a[52:55]
TR v[16:17],v1,1032
M a[56:59],v[20:23],v[132:135],a[56:59]
WL 3
TR v[18:19],v1,9224
M a[60:63],v[24:27],v[116:119],a[60:63]
M a[64:67],v[24:27],v[120:123],a[64:67]
s_add_u32 m0, s53, 33664
s_nop 0
buffer_load_dwordx4 v3, s[16:19], s42 offen offset:128 nt lds
M a[68:71],v[24:27],v[124:127],a[68:71]
M a[72:75],v[24:27],v[128:131],a[72:75]
TR v[20:21],v1,1536
M a[76:79],v[24:27],v[132:135],a[76:79]
WL 3
TR v[22:23],v1,9728
M a[80:83],v[12:15],v[116:119],a[80:83]
M a[84:87],v[12:15],v[120:123],a[84:87]
M a[88:91],v[12:15],v[124:127],a[88:91]
M a[92:95],v[12:15],v[128:131],a[92:95]
TR v[24:25],v1,1544
M a[96:99],v[12:15],v[132:135],a[96:99]
WL 3
TR v[26:27],v1,9736
M a[100:103],v[16:19],v[116:119],a[100:103]
M a[104:107],v[16:19],v[120:123],a[104:107]
M a[108:111],v[16:19],v[124:127],a[108:111]
M a[112:115],v[16:19],v[128:131],a[112:115]
TR v[12:13],v1,2048
M a[116:119],v[16:19],v[132:135],a[116:119]
WL 3
TR v[14:15],v1,10240
M a[120:123],v[20:23],v[116:119],a[120:123]
M a[124:127],v[20:23],v[120:123],a[124:127]
M a[128:131],v[20:23],v[124:127],a[128:131]
s_add_u32 m0, s53, 34560
s_nop 0
buffer_load_dwordx4 v3, s[16:19], s42 offen offset:256 nt lds
M a[132:135],v[20:23],v[128:131],a[132:135]
TR v[16:17],v1,2056
M a[136:139],v[20:23],v[132:135],a[136:139]
WL 3
TR v[18:19],v1,10248
M a[140:143],v[24:27],v[116:119],a[140:143]
M a[144:147],v[24:27],v[120:123],a[144:147]
M a[148:151],v[24:27],v[124:127],a[148:151]
M a[152:155],v[24:27],v[128:131],a[152:155]
TR v[20:21],v1,2560
M a[156:159],v[24:27],v[132:135],a[156:159]
WL 3
TR v[22:23],v1,10752
M a[160:163],v[12:15],v[116:119],a[160:163]
M a[164:167],v[12:15],v[120:123],a[164:167]
M a[168:171],v[12:15],v[124:127],a[168:171]
M a[172:175],v[12:15],v[128:131],a[172:175]
TR v[24:25],v1,2568
M a[176:179],v[12:15],v[132:135],a[176:179]
WL 3
TR v[26:27],v1,10760
M a[180:183],v[16:19],v[116:119],a[180:183]
M a[184:187],v[16:19],v[120:123],a[184:187]
M a[188:191],v[16:19],v[124:127],a[188:191]
s_add_u32 m0, s53, 35456
s_nop 0
buffer_load_dwordx4 v3, s[16:19], s42 offen offset:384 nt lds
s_add_u32 s42, s42, 16384
M a[192:195],v[16:19],v[128:131],a[192:195]
TR v[12:13],v1,3072
M a[196:199],v[16:19],v[132:135],a[196:199]
WL 3
TR v[14:15],v1,11264
M a[200:203],v[20:23],v[116:119],a[200:203]
M a[204:207],v[20:23],v[120:123],a[204:207]
M a[208:211],v[20:23],v[124:127],a[208:211]
M a[212:215],v[20:23],v[128:131],a[212:215]
TR v[16:17],v1,3080
M a[216:219],v[20:23],v[132:135],a[216:219]
WL 3
TR v[18:19],v1,11272
M a[220:223],v[24:27],v[116:119],a[220:223]
M a[224:227],v[24:27],v[120:123],a[224:227]
M a[228:231],v[24:27],v[124:127],a[228:231]
M a[232:235],v[24:27],v[128:131],a[232:235]
TR v[20:21],v1,3584
M a[236:239],v[24:27],v[132:135],a[236:239]
WL 3
TR v[22:23],v1,11776
M a[240:243],v[12:15],v[116:119],a[240:243]
M a[244:247],v[12:15],v[120:123],a[244:247]
M a[248:251],v[12:15],v[124:127],a[248:251]
M a[252:255],v[12:15],v[128:131],a[252:255]
TR v[24:25],v1,3592
M v[192:195],v[12:15],v[132:135],v[192:195]
WL 3
TR v[26:27],v1,11784
M v[196:199],v[16:19],v[116:119],v[196:199]
v_add_u32 v1, 0x4000, v1
M v[200:203],v[16:19],v[120:123],v[200:203]
WV 26
M v[204:207],v[16:19],v[124:127],v[204:207]
s_barrier
M v[208:211],v[16:19],v[128:131],v[208:211]
TR v[12:13],v1,0
M v[212:215],v[16:19],v[132:135],v[212:215]
WL 3
TR v[14:15],v1,8192
M v[216:219],v[20:23],v[116:119],v[216:219]
M v[220:223],v[20:23],v[120:123],v[220:223]
M v[224:227],v[20:23],v[124:127],v[224:227]
M v[228:231],v[20:23],v[128:131],v[228:231]
TR v[16:17],v1,8
M v[232:235],v[20:23],v[132:135],v[232:235]
WL 3
TR v[18:19],v1,8200
M v[236:239],v[24:27],v[116:119],v[236:239]
M v[240:243],v[24:27],v[120:123],v[240:243]
M v[244:247],v[24:27],v[124:127],v[244:247]
M v[248:251],v[24:27],v[128:131],v[248:251]
TR v[20:21],v1,512
M v[252:255],v[24:27],v[132:135],v[252:255]
WL 3
TR v[22:23],v1,8704
M a[0:3],v[12:15],v[136:139],a[0:3]
M a[4:7],v[12:15],v[140:143],a[4:7]
s_add_u32 m0, s53, 49152
s_nop 0
buffer_load_dwordx4 v3, s[16:19], s42 offen offset:0 nt lds
M a[8:11],v[12:15],v[144:147],a[8:11]
s_mul_i32 s6, s101, 3
M a[12:15],v[12:15],v[148:151],a[12:15]
s_add_u32 s6, s6, s3
TR v[24:25],v1,520
M a[16:19],v[12:15],v[152:155],a[16:19]
WL 3
TR v[26:27],v1,8712
M a[20:23],v[16:19],v[136:139],a[20:23]
s_mul_i32 s4, s6, 8193
M a[24:27],v[16:19],v[140:143],a[24:27]
s_lshr_b32 s4, s4, 16
M a[28:31],v[16:19],v[144:147],a[28:31]
s_mul_i32 s4, s4, 8
M a[32:35],v[16:19],v[148:151],a[32:35]
s_sub_u32 s4, s6, s4
TR v[12:13],v1,1024
M a[36:39],v[16:19],v[152:155],a[36:39]
WL 3
TR v[14:15],v1,9216
M a[40:43],v[20:23],v[136:139],a[40:43]
s_lshr_b32 s5, s4, 2
M a[44:47],v[20:23],v[140:143],a[44:47]
s_lshl_b32 s5, s5, 12
M a[48:51],v[20:23],v[144:147],a[48:51]
s_and_b32 s4, s4, 3
M a[52:55],v[20:23],v[148:151],a[52:55]
s_lshl_b32 s4, s4, 7
TR v[16:17],v1,1032
M a[56:59],v[20:23],v[152:155],a[56:59]
WL 3
TR v[18:19],v1,9224
M a[60:63],v[24:27],v[136:139],a[60:63]
WV 21
M a[64:67],v[24:27],v[140:143],a[64:67]
s_add_u32 m0, s53, 50048
RD v[156:159],v7,12288
buffer_load_dwordx4 v3, s[16:19], s42 offen offset:128 nt lds
M a[68:71],v[24:27],v[144:147],a[68:71]
s_add_u32 s4, s4, s5
RD v[36:39],v8,12288
M a[72:75],v[24:27],v[148:151],a[72:75]
s_add_u32 s100, s4, L1_conv_5-concat_heads__mha_block_cached__mha_block_cached__near_ridge_kernel
TR v[20:21],v1,1536
M a[76:79],v[24:27],v[152:155],a[76:79]
WL 5
TR v[22:23],v1,9728
M a[80:83],v[12:15],v[136:139],a[80:83]
WV 20
buffer_load_dword v190, v3, s[96:99], s100 offen
M a[84:87],v[12:15],v[140:143],a[84:87]
RD v[160:163],v7,14336
M a[88:91],v[12:15],v[144:147],a[88:91]
RD v[40:43],v8,14336
M a[92:95],v[12:15],v[148:151],a[92:95]
TR v[24:25],v1,1544
M a[96:99],v[12:15],v[152:155],a[96:99]
WL 7
TR v[26:27],v1,9736
M a[100:103],v[16:19],v[136:139],a[100:103]
WV 19
M a[104:107],v[16:19],v[140:143],a[104:107]
RD v[164:167],v7,0
M a[108:111],v[16:19],v[144:147],a[108:111]
RD v[44:47],v8,0
M a[112:115],v[16:19],v[148:151],a[112:115]
TR v[12:13],v1,2048
M a[116:119],v[16:19],v[152:155],a[116:119]
WL 7
TR v[14:15],v1,10240
M a[120:123],v[20:23],v[136:139],a[120:123]
WV 9
M a[124:127],v[20:23],v[140:143],a[124:127]
RD v[168:171],v7,2048
M a[128:131],v[20:23],v[144:147],a[128:131]
s_add_u32 m0, s53, 50944
RD v[48:51],v8,2048
buffer_load_dwordx4 v3, s[16:19], s42 offen offset:256 nt lds
M a[132:135],v[20:23],v[148:151],a[132:135]
TR v[16:17],v1,2056
M a[136:139],v[20:23],v[152:155],a[136:139]
WL 7
TR v[18:19],v1,10248
M a[140:143],v[24:27],v[136:139],a[140:143]
WV 8
M a[144:147],v[24:27],v[140:143],a[144:147]
RD v[172:175],v7,4096
M a[148:151],v[24:27],v[144:147],a[148:151]
RD v[52:55],v8,4096
M a[152:155],v[24:27],v[148:151],a[152:155]
TR v[20:21],v1,2560
M a[156:159],v[24:27],v[152:155],a[156:159]
WL 7
TR v[22:23],v1,10752
M a[160:163],v[12:15],v[136:139],a[160:163]
M a[164:167],v[12:15],v[140:143],a[164:167]
M a[168:171],v[12:15],v[144:147],a[168:171]
M a[172:175],v[12:15],v[148:151],a[172:175]
TR v[24:25],v1,2568
M a[176:179],v[12:15],v[152:155],a[176:179]
WL 5
TR v[26:27],v1,10760
M a[180:183],v[16:19],v[136:139],a[180:183]
M a[184:187],v[16:19],v[140:143],a[184:187]
M a[188:191],v[16:19],v[144:147],a[188:191]
s_add_u32 m0, s53, 51840
s_nop 0
buffer_load_dwordx4 v3, s[16:19], s42 offen offset:384 nt lds
s_add_u32 s42, s42, 16384
M a[192:195],v[16:19],v[148:151],a[192:195]
TR v[12:13],v1,3072
M a[196:199],v[16:19],v[152:155],a[196:199]
WL 3
TR v[14:15],v1,11264
M a[200:203],v[20:23],v[136:139],a[200:203]
M a[204:207],v[20:23],v[140:143],a[204:207]
M a[208:211],v[20:23],v[144:147],a[208:211]
M a[212:215],v[20:23],v[148:151],a[212:215]
TR v[16:17],v1,3080
M a[216:219],v[20:23],v[152:155],a[216:219]
WL 3
TR v[18:19],v1,11272
M a[220:223],v[24:27],v[136:139],a[220:223]
M a[224:227],v[24:27],v[140:143],a[224:227]
M a[228:231],v[24:27],v[144:147],a[228:231]
M a[232:235],v[24:27],v[148:151],a[232:235]
TR v[20:21],v1,3584
M a[236:239],v[24:27],v[152:155],a[236:239]
WL 3
TR v[22:23],v1,11776
M a[240:243],v[12:15],v[136:139],a[240:243]
M a[244:247],v[12:15],v[140:143],a[244:247]
M a[248:251],v[12:15],v[144:147],a[248:251]
M a[252:255],v[12:15],v[148:151],a[252:255]
TR v[24:25],v1,3592
M v[192:195],v[12:15],v[152:155],v[192:195]
WL 3
TR v[26:27],v1,11784
M v[196:199],v[16:19],v[136:139],v[196:199]
v_add_u32 v1, 0xfffec000, v1
M v[200:203],v[16:19],v[140:143],v[200:203]
WV 17
M v[204:207],v[16:19],v[144:147],v[204:207]
s_barrier
M v[208:211],v[16:19],v[148:151],v[208:211]
TR v[12:13],v1,0
M v[212:215],v[16:19],v[152:155],v[212:215]
WL 3
TR v[14:15],v1,8192
M v[216:219],v[20:23],v[136:139],v[216:219]
M v[220:223],v[20:23],v[140:143],v[220:223]
M v[224:227],v[20:23],v[144:147],v[224:227]
M v[228:231],v[20:23],v[148:151],v[228:231]
TR v[16:17],v1,8
M v[232:235],v[20:23],v[152:155],v[232:235]
WL 3
TR v[18:19],v1,8200
M v[236:239],v[24:27],v[136:139],v[236:239]
M v[240:243],v[24:27],v[140:143],v[240:243]
M v[244:247],v[24:27],v[144:147],v[244:247]
M v[248:251],v[24:27],v[148:151],v[248:251]
TR v[20:21],v1,512
M v[252:255],v[24:27],v[152:155],v[252:255]
WL 3
TR v[22:23],v1,8704
M a[0:3],v[12:15],v[156:159],a[0:3]
M a[4:7],v[12:15],v[160:163],a[4:7]
s_add_u32 m0, s53, 65536
s_nop 0
buffer_load_dwordx4 v3, s[20:23], s43 offen offset:0 nt lds
M a[8:11],v[12:15],v[164:167],a[8:11]
M a[12:15],v[12:15],v[168:171],a[12:15]
TR v[24:25],v1,520
M a[16:19],v[12:15],v[172:175],a[16:19]
WL 3
TR v[26:27],v1,8712
M a[20:23],v[16:19],v[156:159],a[20:23]
M a[24:27],v[16:19],v[160:163],a[24:27]
M a[28:31],v[16:19],v[164:167],a[28:31]
M a[32:35],v[16:19],v[168:171],a[32:35]
TR v[12:13],v1,1024
M a[36:39],v[16:19],v[172:175],a[36:39]
WL 3
TR v[14:15],v1,9216
M a[40:43],v[20:23],v[156:159],a[40:43]
M a[44:47],v[20:23],v[160:163],a[44:47]
M a[48:51],v[20:23],v[164:167],a[48:51]
M a[52:55],v[20:23],v[168:171],a[52:55]
TR v[16:17],v1,1032
M a[56:59],v[20:23],v[172:175],a[56:59]
WL 3
TR v[18:19],v1,9224
M a[60:63],v[24:27],v[156:159],a[60:63]
M a[64:67],v[24:27],v[160:163],a[64:67]
s_add_u32 m0, s53, 66432
s_nop 0
buffer_load_dwordx4 v3, s[20:23], s43 offen offset:128 nt lds
M a[68:71],v[24:27],v[164:167],a[68:71]
M a[72:75],v[24:27],v[168:171],a[72:75]
TR v[20:21],v1,1536
M a[76:79],v[24:27],v[172:175],a[76:79]
WL 3
TR v[22:23],v1,9728
M a[80:83],v[12:15],v[156:159],a[80:83]
M a[84:87],v[12:15],v[160:163],a[84:87]
M a[88:91],v[12:15],v[164:167],a[88:91]
M a[92:95],v[12:15],v[168:171],a[92:95]
TR v[24:25],v1,1544
M a[96:99],v[12:15],v[172:175],a[96:99]
WL 3
TR v[26:27],v1,9736
M a[100:103],v[16:19],v[156:159],a[100:103]
M a[104:107],v[16:19],v[160:163],a[104:107]
M a[108:111],v[16:19],v[164:167],a[108:111]
M a[112:115],v[16:19],v[168:171],a[112:115]
TR v[12:13],v1,2048
M a[116:119],v[16:19],v[172:175],a[116:119]
WL 3
TR v[14:15],v1,10240
M a[120:123],v[20:23],v[156:159],a[120:123]
M a[124:127],v[20:23],v[160:163],a[124:127]
M a[128:131],v[20:23],v[164:167],a[128:131]
s_add_u32 m0, s53, 67328
s_nop 0
buffer_load_dwordx4 v3, s[20:23], s43 offen offset:256 nt lds
M a[132:135],v[20:23],v[168:171],a[132:135]
TR v[16:17],v1,2056
M a[136:139],v[20:23],v[172:175],a[136:139]
WL 3
TR v[18:19],v1,10248
M a[140:143],v[24:27],v[156:159],a[140:143]
M a[144:147],v[24:27],v[160:163],a[144:147]
M a[148:151],v[24:27],v[164:167],a[148:151]
M a[152:155],v[24:27],v[168:171],a[152:155]
TR v[20:21],v1,2560
M a[156:159],v[24:27],v[172:175],a[156:159]
WL 3
TR v[22:23],v1,10752
M a[160:163],v[12:15],v[156:159],a[160:163]
M a[164:167],v[12:15],v[160:163],a[164:167]
M a[168:171],v[12:15],v[164:167],a[168:171]
M a[172:175],v[12:15],v[168:171],a[172:175]
TR v[24:25],v1,2568
M a[176:179],v[12:15],v[172:175],a[176:179]
WL 3
TR v[26:27],v1,10760
M a[180:183],v[16:19],v[156:159],a[180:183]
M a[184:187],v[16:19],v[160:163],a[184:187]
M a[188:191],v[16:19],v[164:167],a[188:191]
s_add_u32 m0, s53, 68224
s_nop 0
buffer_load_dwordx4 v3, s[20:23], s43 offen offset:384 nt lds
s_add_u32 s43, s43, 16384
M a[192:195],v[16:19],v[168:171],a[192:195]
TR v[12:13],v1,3072
M a[196:199],v[16:19],v[172:175],a[196:199]
WL 3
TR v[14:15],v1,11264
M a[200:203],v[20:23],v[156:159],a[200:203]
M a[204:207],v[20:23],v[160:163],a[204:207]
M a[208:211],v[20:23],v[164:167],a[208:211]
M a[212:215],v[20:23],v[168:171],a[212:215]
TR v[16:17],v1,3080
M a[216:219],v[20:23],v[172:175],a[216:219]
WL 3
TR v[18:19],v1,11272
M a[220:223],v[24:27],v[156:159],a[220:223]
M a[224:227],v[24:27],v[160:163],a[224:227]
M a[228:231],v[24:27],v[164:167],a[228:231]
M a[232:235],v[24:27],v[168:171],a[232:235]
TR v[20:21],v1,3584
M a[236:239],v[24:27],v[172:175],a[236:239]
WL 3
TR v[22:23],v1,11776
M a[240:243],v[12:15],v[156:159],a[240:243]
M a[244:247],v[12:15],v[160:163],a[244:247]
M a[248:251],v[12:15],v[164:167],a[248:251]
M a[252:255],v[12:15],v[168:171],a[252:255]
TR v[24:25],v1,3592
M v[192:195],v[12:15],v[172:175],v[192:195]
WL 3
TR v[26:27],v1,11784
M v[196:199],v[16:19],v[156:159],v[196:199]
v_add_u32 v1, 0x4000, v1
M v[200:203],v[16:19],v[160:163],v[200:203]
WV 17
M v[204:207],v[16:19],v[164:167],v[204:207]
s_barrier
M v[208:211],v[16:19],v[168:171],v[208:211]
TR v[12:13],v1,0
M v[212:215],v[16:19],v[172:175],v[212:215]
WL 3
TR v[14:15],v1,8192
M v[216:219],v[20:23],v[156:159],v[216:219]
M v[220:223],v[20:23],v[160:163],v[220:223]
M v[224:227],v[20:23],v[164:167],v[224:227]
M v[228:231],v[20:23],v[168:171],v[228:231]
TR v[16:17],v1,8
M v[232:235],v[20:23],v[172:175],v[232:235]
WL 3
TR v[18:19],v1,8200
M v[236:239],v[24:27],v[156:159],v[236:239]
M v[240:243],v[24:27],v[160:163],v[240:243]
M v[244:247],v[24:27],v[164:167],v[244:247]
M v[248:251],v[24:27],v[168:171],v[248:251]
TR v[20:21],v1,512
M v[252:255],v[24:27],v[172:175],v[252:255]
WL 3
TR v[22:23],v1,8704
M a[0:3],v[12:15],v[36:39],a[0:3]
M a[4:7],v[12:15],v[40:43],a[4:7]
s_add_u32 m0, s53, 81920
s_nop 0
buffer_load_dwordx4 v3, s[16:19], s42 offen offset:0 nt lds
M a[8:11],v[12:15],v[44:47],a[8:11]
M a[12:15],v[12:15],v[48:51],a[12:15]
TR v[24:25],v1,520
M a[16:19],v[12:15],v[52:55],a[16:19]
WL 3
TR v[26:27],v1,8712
M a[20:23],v[16:19],v[36:39],a[20:23]
M a[24:27],v[16:19],v[40:43],a[24:27]
M a[28:31],v[16:19],v[44:47],a[28:31]
M a[32:35],v[16:19],v[48:51],a[32:35]
TR v[12:13],v1,1024
M a[36:39],v[16:19],v[52:55],a[36:39]
WL 3
TR v[14:15],v1,9216
M a[40:43],v[20:23],v[36:39],a[40:43]
M a[44:47],v[20:23],v[40:43],a[44:47]
M a[48:51],v[20:23],v[44:47],a[48:51]
M a[52:55],v[20:23],v[48:51],a[52:55]
TR v[16:17],v1,1032
M a[56:59],v[20:23],v[52:55],a[56:59]
WL 3
TR v[18:19],v1,9224
M a[60:63],v[24:27],v[36:39],a[60:63]
M a[64:67],v[24:27],v[40:43],a[64:67]
s_add_u32 m0, s53, 82816
s_nop 0
buffer_load_dwordx4 v3, s[16:19], s42 offen offset:128 nt lds
M a[68:71],v[24:27],v[44:47],a[68:71]
M a[72:75],v[24:27],v[48:51],a[72:75]
TR v[20:21],v1,1536
M a[76:79],v[24:27],v[52:55],a[76:79]
WL 3
TR v[22:23],v1,9728
M a[80:83],v[12:15],v[36:39],a[80:83]
M a[84:87],v[12:15],v[40:43],a[84:87]
M a[88:91],v[12:15],v[44:47],a[88:91]
M a[92:95],v[12:15],v[48:51],a[92:95]
TR v[24:25],v1,1544
M a[96:99],v[12:15],v[52:55],a[96:99]
WL 3
TR v[26:27],v1,9736
M a[100:103],v[16:19],v[36:39],a[100:103]
M a[104:107],v[16:19],v[40:43],a[104:107]
M a[108:111],v[16:19],v[44:47],a[108:111]
M a[112:115],v[16:19],v[48:51],a[112:115]
TR v[12:13],v1,2048
M a[116:119],v[16:19],v[52:55],a[116:119]
WL 3
TR v[14:15],v1,10240
M a[120:123],v[20:23],v[36:39],a[120:123]
M a[124:127],v[20:23],v[40:43],a[124:127]
M a[128:131],v[20:23],v[44:47],a[128:131]
s_add_u32 m0, s53, 83712
s_nop 0
buffer_load_dwordx4 v3, s[16:19], s42 offen offset:256 nt lds
M a[132:135],v[20:23],v[48:51],a[132:135]
TR v[16:17],v1,2056
M a[136:139],v[20:23],v[52:55],a[136:139]
WL 3
TR v[18:19],v1,10248
M a[140:143],v[24:27],v[36:39],a[140:143]
M a[144:147],v[24:27],v[40:43],a[144:147]
M a[148:151],v[24:27],v[44:47],a[148:151]
M a[152:155],v[24:27],v[48:51],a[152:155]
TR v[20:21],v1,2560
M a[156:159],v[24:27],v[52:55],a[156:159]
WL 3
TR v[22:23],v1,10752
M a[160:163],v[12:15],v[36:39],a[160:163]
M a[164:167],v[12:15],v[40:43],a[164:167]
M a[168:171],v[12:15],v[44:47],a[168:171]
M a[172:175],v[12:15],v[48:51],a[172:175]
TR v[24:25],v1,2568
M a[176:179],v[12:15],v[52:55],a[176:179]
WL 3
TR v[26:27],v1,10760
M a[180:183],v[16:19],v[36:39],a[180:183]
M a[184:187],v[16:19],v[40:43],a[184:187]
M a[188:191],v[16:19],v[44:47],a[188:191]
s_add_u32 m0, s53, 84608
s_nop 0
buffer_load_dwordx4 v3, s[16:19], s42 offen offset:384 nt lds
s_add_u32 s42, s42, 16384
M a[192:195],v[16:19],v[48:51],a[192:195]
TR v[12:13],v1,3072
M a[196:199],v[16:19],v[52:55],a[196:199]
WL 3
TR v[14:15],v1,11264
M a[200:203],v[20:23],v[36:39],a[200:203]
M a[204:207],v[20:23],v[40:43],a[204:207]
M a[208:211],v[20:23],v[44:47],a[208:211]
M a[212:215],v[20:23],v[48:51],a[212:215]
TR v[16:17],v1,3080
M a[216:219],v[20:23],v[52:55],a[216:219]
WL 3
TR v[18:19],v1,11272
M a[220:223],v[24:27],v[36:39],a[220:223]
M a[224:227],v[24:27],v[40:43],a[224:227]
M a[228:231],v[24:27],v[44:47],a[228:231]
M a[232:235],v[24:27],v[48:51],a[232:235]
TR v[20:21],v1,3584
M a[236:239],v[24:27],v[52:55],a[236:239]
WL 3
TR v[22:23],v1,11776
M a[240:243],v[12:15],v[36:39],a[240:243]
M a[244:247],v[12:15],v[40:43],a[244:247]
M a[248:251],v[12:15],v[44:47],a[248:251]
M a[252:255],v[12:15],v[48:51],a[252:255]
TR v[24:25],v1,3592
M v[192:195],v[12:15],v[52:55],v[192:195]
WL 3
TR v[26:27],v1,11784
M v[196:199],v[16:19],v[36:39],v[196:199]
M v[200:203],v[16:19],v[40:43],v[200:203]
WV 13
M v[204:207],v[16:19],v[44:47],v[204:207]
s_barrier
M v[208:211],v[16:19],v[48:51],v[208:211]
M v[212:215],v[16:19],v[52:55],v[212:215]
WL 2
M v[216:219],v[20:23],v[36:39],v[216:219]
M v[220:223],v[20:23],v[40:43],v[220:223]
M v[224:227],v[20:23],v[44:47],v[224:227]
M v[228:231],v[20:23],v[48:51],v[228:231]
M v[232:235],v[20:23],v[52:55],v[232:235]
WL 0
M v[236:239],v[24:27],v[36:39],v[236:239]
M v[240:243],v[24:27],v[40:43],v[240:243]
M v[244:247],v[24:27],v[44:47],v[244:247]
M v[248:251],v[24:27],v[48:51],v[248:251]
M v[252:255],v[24:27],v[52:55],v[252:255]
WV 10
L1_conv_5:
v_subrev_u32 v36, s62, v2
v_lshrrev_b32 v36, 4, v36
v_lshrrev_b32 v37, 4, v36
v_lshlrev_b32 v10, 5, v37
v_and_b32 v37, 1, v36
v_lshl_add_u32 v10, v37, 4, v10
s_movk_i32 s6, 896
v_bfe_u32 v37, v36, 1, 3
v_mad_u32_u24 v10, v37, s6, v10
s_movk_i32 s7, 7168
v_bfe_u32 v37, v36, 2, 3
v_lshlrev_b32 v11, 5, v37
v_lshrrev_b32 v37, 5, v36
v_mad_u32_u24 v11, v37, s7, v11
v_and_b32 v37, 3, v36
v_lshl_add_u32 v11, v37, 3, v11
s_mul_i32 s6, s3, 1792
s_add_u32 s6, s6, 49152
v_add_u32 v11, s6, v11
v_lshrrev_b32 v37, 5, v36
v_lshlrev_b32 v1, 12, v37
v_bfe_u32 v37, v36, 2, 3
v_lshl_add_u32 v1, v37, 6, v1
v_bfe_u32 v37, v36, 4, 1
v_lshl_add_u32 v1, v37, 5, v1
v_and_b32 v37, 3, v36
v_lshl_add_u32 v1, v37, 3, v1
v_add_u32 v1, 131072, v1
v_xor_b32 v9, 32, v1
s_add_u32 s44, s53, 81920
s_add_u32 s45, s53, 16384
s_sub_u32 s46, s53, 16384
s_add_u32 s61, s53, 49152
s_add_u32 s47, s53, 0
s_add_u32 s48, s53, 32768
s_add_u32 s49, s53, 65536
s_mul_i32 s5, s3, 7168
s_add_u32 m0, s5, 49152
s_nop 0
buffer_load_dwordx4 v10, s[24:27], s5 offen offset:0 lds
s_add_u32 m0, s5, 50048
s_nop 0
buffer_load_dwordx4 v10, s[24:27], s5 offen offset:128 lds
s_add_u32 m0, s5, 50944
s_nop 0
buffer_load_dwordx4 v10, s[24:27], s5 offen offset:256 lds
s_add_u32 m0, s5, 51840
s_nop 0
buffer_load_dwordx4 v10, s[24:27], s5 offen offset:384 lds
s_add_u32 m0, s5, 52736
s_nop 0
buffer_load_dwordx4 v10, s[24:27], s5 offen offset:512 lds
s_add_u32 m0, s5, 53632
s_nop 0
buffer_load_dwordx4 v10, s[24:27], s5 offen offset:640 lds
s_add_u32 m0, s5, 54528
s_nop 0
buffer_load_dwordx4 v10, s[24:27], s5 offen offset:768 lds
v_mov_b32 v4, 0
v_mov_b32 v5, 0
v_mov_b32 v6, 0
v_mov_b32 v7, 0
v_mov_b32 v8, 0
AR v56,a0
AR v57,a1
AR v58,a2
AR v59,a3
PM v[56:57],v[56:57],s[54:55]
PM v[58:59],v[58:59],s[54:55]
AR v60,a20
AR v61,a21
AR v62,a22
AR v63,a23
PM v[60:61],v[60:61],s[54:55]
PM v[62:63],v[62:63],s[54:55]
CV v96,v56,v57
CV v97,v58,v59
CV v98,v60,v61
CV v99,v62,v63
AR v64,a4
AR v65,a5
AR v66,a6
AR v67,a7
PM v[64:65],v[64:65],s[54:55]
PM v[66:67],v[66:67],s[54:55]
AR v68,a24
AR v69,a25
AR v70,a26
AR v71,a27
PM v[68:69],v[68:69],s[54:55]
PM v[70:71],v[70:71],s[54:55]
CV v128,v64,v65
CV v129,v66,v67
CV v130,v68,v69
CV v131,v70,v71
AR v72,a8
AR v73,a9
AR v74,a10
AR v75,a11
PM v[72:73],v[72:73],s[54:55]
PM v[74:75],v[74:75],s[54:55]
AR v76,a28
AR v77,a29
AR v78,a30
AR v79,a31
PM v[76:77],v[76:77],s[54:55]
PM v[78:79],v[78:79],s[54:55]
CV v160,v72,v73
CV v161,v74,v75
CV v162,v76,v77
CV v163,v78,v79
AR v80,a12
AR v81,a13
AR v82,a14
AR v83,a15
PM v[80:81],v[80:81],s[54:55]
PM v[82:83],v[82:83],s[54:55]
AR v84,a32
AR v85,a33
AR v86,a34
AR v87,a35
PM v[84:85],v[84:85],s[54:55]
PM v[86:87],v[86:87],s[54:55]
CV v28,v80,v81
CV v29,v82,v83
CV v30,v84,v85
CV v31,v86,v87
ds_write_b128 v2, v[28:31] offset:0
AR v56,a16
AR v57,a17
AR v58,a18
AR v59,a19
PM v[56:57],v[56:57],s[54:55]
PM v[58:59],v[58:59],s[54:55]
AR v60,a36
AR v61,a37
AR v62,a38
AR v63,a39
PM v[60:61],v[60:61],s[54:55]
PM v[62:63],v[62:63],s[54:55]
CV v32,v56,v57
CV v33,v58,v59
CV v34,v60,v61
CV v35,v62,v63
ds_write_b128 v2, v[32:35] offset:8192
AR v64,a40
AR v65,a41
AR v66,a42
AR v67,a43
PM v[64:65],v[64:65],s[54:55]
PM v[66:67],v[66:67],s[54:55]
AR v68,a60
AR v69,a61
AR v70,a62
AR v71,a63
PM v[68:69],v[68:69],s[54:55]
PM v[70:71],v[70:71],s[54:55]
CV v100,v64,v65
CV v101,v66,v67
CV v102,v68,v69
CV v103,v70,v71
AR v72,a44
AR v73,a45
AR v74,a46
AR v75,a47
PM v[72:73],v[72:73],s[54:55]
PM v[74:75],v[74:75],s[54:55]
AR v76,a64
AR v77,a65
AR v78,a66
AR v79,a67
PM v[76:77],v[76:77],s[54:55]
PM v[78:79],v[78:79],s[54:55]
CV v132,v72,v73
CV v133,v74,v75
CV v134,v76,v77
CV v135,v78,v79
AR v80,a48
AR v81,a49
AR v82,a50
AR v83,a51
PM v[80:81],v[80:81],s[54:55]
PM v[82:83],v[82:83],s[54:55]
AR v84,a68
AR v85,a69
AR v86,a70
AR v87,a71
PM v[84:85],v[84:85],s[54:55]
PM v[86:87],v[86:87],s[54:55]
CV v164,v80,v81
CV v165,v82,v83
CV v166,v84,v85
CV v167,v86,v87
AR v56,a52
AR v57,a53
AR v58,a54
AR v59,a55
PM v[56:57],v[56:57],s[54:55]
PM v[58:59],v[58:59],s[54:55]
AR v60,a72
AR v61,a73
AR v62,a74
AR v63,a75
PM v[60:61],v[60:61],s[54:55]
PM v[62:63],v[62:63],s[54:55]
CV v28,v56,v57
CV v29,v58,v59
CV v30,v60,v61
CV v31,v62,v63
ds_write_b128 v2, v[28:31] offset:1024
AR v64,a56
AR v65,a57
AR v66,a58
AR v67,a59
PM v[64:65],v[64:65],s[54:55]
PM v[66:67],v[66:67],s[54:55]
AR v68,a76
AR v69,a77
AR v70,a78
AR v71,a79
PM v[68:69],v[68:69],s[54:55]
PM v[70:71],v[70:71],s[54:55]
CV v32,v64,v65
CV v33,v66,v67
CV v34,v68,v69
CV v35,v70,v71
ds_write_b128 v2, v[32:35] offset:9216
AR v72,a80
AR v73,a81
AR v74,a82
AR v75,a83
PM v[72:73],v[72:73],s[54:55]
PM v[74:75],v[74:75],s[54:55]
AR v76,a100
AR v77,a101
AR v78,a102
AR v79,a103
PM v[76:77],v[76:77],s[54:55]
PM v[78:79],v[78:79],s[54:55]
CV v104,v72,v73
CV v105,v74,v75
CV v106,v76,v77
CV v107,v78,v79
AR v80,a84
AR v81,a85
AR v82,a86
AR v83,a87
PM v[80:81],v[80:81],s[54:55]
PM v[82:83],v[82:83],s[54:55]
AR v84,a104
AR v85,a105
AR v86,a106
AR v87,a107
PM v[84:85],v[84:85],s[54:55]
PM v[86:87],v[86:87],s[54:55]
CV v136,v80,v81
CV v137,v82,v83
CV v138,v84,v85
CV v139,v86,v87
AR v56,a88
AR v57,a89
AR v58,a90
AR v59,a91
PM v[56:57],v[56:57],s[54:55]
PM v[58:59],v[58:59],s[54:55]
AR v60,a108
AR v61,a109
AR v62,a110
AR v63,a111
PM v[60:61],v[60:61],s[54:55]
PM v[62:63],v[62:63],s[54:55]
CV v168,v56,v57
CV v169,v58,v59
CV v170,v60,v61
CV v171,v62,v63
AR v64,a92
AR v65,a93
AR v66,a94
AR v67,a95
PM v[64:65],v[64:65],s[54:55]
PM v[66:67],v[66:67],s[54:55]
AR v68,a112
AR v69,a113
AR v70,a114
AR v71,a115
PM v[68:69],v[68:69],s[54:55]
PM v[70:71],v[70:71],s[54:55]
CV v28,v64,v65
CV v29,v66,v67
CV v30,v68,v69
CV v31,v70,v71
ds_write_b128 v2, v[28:31] offset:2048
AR v72,a96
AR v73,a97
AR v74,a98
AR v75,a99
PM v[72:73],v[72:73],s[54:55]
PM v[74:75],v[74:75],s[54:55]
AR v76,a116
AR v77,a117
AR v78,a118
AR v79,a119
PM v[76:77],v[76:77],s[54:55]
PM v[78:79],v[78:79],s[54:55]
CV v32,v72,v73
CV v33,v74,v75
CV v34,v76,v77
CV v35,v78,v79
ds_write_b128 v2, v[32:35] offset:10240
AR v80,a120
AR v81,a121
AR v82,a122
AR v83,a123
PM v[80:81],v[80:81],s[54:55]
PM v[82:83],v[82:83],s[54:55]
AR v84,a140
AR v85,a141
AR v86,a142
AR v87,a143
PM v[84:85],v[84:85],s[54:55]
PM v[86:87],v[86:87],s[54:55]
CV v108,v80,v81
CV v109,v82,v83
CV v110,v84,v85
CV v111,v86,v87
AR v56,a124
AR v57,a125
AR v58,a126
AR v59,a127
PM v[56:57],v[56:57],s[54:55]
PM v[58:59],v[58:59],s[54:55]
AR v60,a144
AR v61,a145
AR v62,a146
AR v63,a147
PM v[60:61],v[60:61],s[54:55]
PM v[62:63],v[62:63],s[54:55]
CV v140,v56,v57
CV v141,v58,v59
CV v142,v60,v61
CV v143,v62,v63
AR v64,a128
AR v65,a129
AR v66,a130
AR v67,a131
PM v[64:65],v[64:65],s[54:55]
PM v[66:67],v[66:67],s[54:55]
AR v68,a148
AR v69,a149
AR v70,a150
AR v71,a151
PM v[68:69],v[68:69],s[54:55]
PM v[70:71],v[70:71],s[54:55]
CV v172,v64,v65
CV v173,v66,v67
CV v174,v68,v69
CV v175,v70,v71
AR v72,a132
AR v73,a133
AR v74,a134
AR v75,a135
PM v[72:73],v[72:73],s[54:55]
PM v[74:75],v[74:75],s[54:55]
AR v76,a152
AR v77,a153
AR v78,a154
AR v79,a155
PM v[76:77],v[76:77],s[54:55]
PM v[78:79],v[78:79],s[54:55]
CV v28,v72,v73
CV v29,v74,v75
CV v30,v76,v77
CV v31,v78,v79
ds_write_b128 v2, v[28:31] offset:3072
AR v80,a136
AR v81,a137
AR v82,a138
AR v83,a139
PM v[80:81],v[80:81],s[54:55]
PM v[82:83],v[82:83],s[54:55]
AR v84,a156
AR v85,a157
AR v86,a158
AR v87,a159
PM v[84:85],v[84:85],s[54:55]
PM v[86:87],v[86:87],s[54:55]
CV v32,v80,v81
CV v33,v82,v83
CV v34,v84,v85
CV v35,v86,v87
ds_write_b128 v2, v[32:35] offset:11264
AR v56,a160
AR v57,a161
AR v58,a162
AR v59,a163
PM v[56:57],v[56:57],s[54:55]
PM v[58:59],v[58:59],s[54:55]
AR v60,a180
AR v61,a181
AR v62,a182
AR v63,a183
PM v[60:61],v[60:61],s[54:55]
PM v[62:63],v[62:63],s[54:55]
CV v112,v56,v57
CV v113,v58,v59
CV v114,v60,v61
CV v115,v62,v63
AR v64,a164
AR v65,a165
AR v66,a166
AR v67,a167
PM v[64:65],v[64:65],s[54:55]
PM v[66:67],v[66:67],s[54:55]
AR v68,a184
AR v69,a185
AR v70,a186
AR v71,a187
PM v[68:69],v[68:69],s[54:55]
PM v[70:71],v[70:71],s[54:55]
CV v144,v64,v65
CV v145,v66,v67
CV v146,v68,v69
CV v147,v70,v71
AR v72,a168
AR v73,a169
AR v74,a170
AR v75,a171
PM v[72:73],v[72:73],s[54:55]
PM v[74:75],v[74:75],s[54:55]
AR v76,a188
AR v77,a189
AR v78,a190
AR v79,a191
PM v[76:77],v[76:77],s[54:55]
PM v[78:79],v[78:79],s[54:55]
CV v176,v72,v73
CV v177,v74,v75
CV v178,v76,v77
CV v179,v78,v79
AR v80,a172
AR v81,a173
AR v82,a174
AR v83,a175
PM v[80:81],v[80:81],s[54:55]
PM v[82:83],v[82:83],s[54:55]
AR v84,a192
AR v85,a193
AR v86,a194
AR v87,a195
PM v[84:85],v[84:85],s[54:55]
PM v[86:87],v[86:87],s[54:55]
CV v28,v80,v81
CV v29,v82,v83
CV v30,v84,v85
CV v31,v86,v87
ds_write_b128 v2, v[28:31] offset:4096
AR v56,a176
AR v57,a177
AR v58,a178
AR v59,a179
PM v[56:57],v[56:57],s[54:55]
PM v[58:59],v[58:59],s[54:55]
AR v60,a196
AR v61,a197
AR v62,a198
AR v63,a199
PM v[60:61],v[60:61],s[54:55]
PM v[62:63],v[62:63],s[54:55]
CV v32,v56,v57
CV v33,v58,v59
CV v34,v60,v61
CV v35,v62,v63
ds_write_b128 v2, v[32:35] offset:12288
AR v64,a200
AR v65,a201
AR v66,a202
AR v67,a203
PM v[64:65],v[64:65],s[54:55]
PM v[66:67],v[66:67],s[54:55]
AR v68,a220
AR v69,a221
AR v70,a222
AR v71,a223
PM v[68:69],v[68:69],s[54:55]
PM v[70:71],v[70:71],s[54:55]
CV v116,v64,v65
CV v117,v66,v67
CV v118,v68,v69
CV v119,v70,v71
AR v72,a204
AR v73,a205
AR v74,a206
AR v75,a207
PM v[72:73],v[72:73],s[54:55]
PM v[74:75],v[74:75],s[54:55]
AR v76,a224
AR v77,a225
AR v78,a226
AR v79,a227
PM v[76:77],v[76:77],s[54:55]
PM v[78:79],v[78:79],s[54:55]
CV v148,v72,v73
CV v149,v74,v75
CV v150,v76,v77
CV v151,v78,v79
AR v80,a208
AR v81,a209
AR v82,a210
AR v83,a211
PM v[80:81],v[80:81],s[54:55]
PM v[82:83],v[82:83],s[54:55]
AR v84,a228
AR v85,a229
AR v86,a230
AR v87,a231
PM v[84:85],v[84:85],s[54:55]
PM v[86:87],v[86:87],s[54:55]
CV v180,v80,v81
CV v181,v82,v83
CV v182,v84,v85
CV v183,v86,v87
AR v56,a212
AR v57,a213
AR v58,a214
AR v59,a215
PM v[56:57],v[56:57],s[54:55]
PM v[58:59],v[58:59],s[54:55]
AR v60,a232
AR v61,a233
AR v62,a234
AR v63,a235
PM v[60:61],v[60:61],s[54:55]
PM v[62:63],v[62:63],s[54:55]
CV v28,v56,v57
CV v29,v58,v59
CV v30,v60,v61
CV v31,v62,v63
ds_write_b128 v2, v[28:31] offset:5120
AR v64,a216
AR v65,a217
AR v66,a218
AR v67,a219
PM v[64:65],v[64:65],s[54:55]
PM v[66:67],v[66:67],s[54:55]
AR v68,a236
AR v69,a237
AR v70,a238
AR v71,a239
PM v[68:69],v[68:69],s[54:55]
PM v[70:71],v[70:71],s[54:55]
CV v32,v64,v65
CV v33,v66,v67
CV v34,v68,v69
CV v35,v70,v71
ds_write_b128 v2, v[32:35] offset:13312
AR v72,a240
AR v73,a241
AR v74,a242
AR v75,a243
PM v[72:73],v[72:73],s[54:55]
PM v[74:75],v[74:75],s[54:55]
PM v[76:77],v[196:197],s[54:55]
PM v[78:79],v[198:199],s[54:55]
CV v120,v72,v73
CV v121,v74,v75
CV v122,v76,v77
CV v123,v78,v79
AR v80,a244
AR v81,a245
AR v82,a246
AR v83,a247
PM v[80:81],v[80:81],s[54:55]
PM v[82:83],v[82:83],s[54:55]
PM v[84:85],v[200:201],s[54:55]
PM v[86:87],v[202:203],s[54:55]
CV v152,v80,v81
CV v153,v82,v83
CV v154,v84,v85
CV v155,v86,v87
AR v56,a248
AR v57,a249
AR v58,a250
AR v59,a251
PM v[56:57],v[56:57],s[54:55]
PM v[58:59],v[58:59],s[54:55]
PM v[60:61],v[204:205],s[54:55]
PM v[62:63],v[206:207],s[54:55]
CV v184,v56,v57
CV v185,v58,v59
CV v186,v60,v61
CV v187,v62,v63
AR v64,a252
AR v65,a253
AR v66,a254
AR v67,a255
PM v[64:65],v[64:65],s[54:55]
PM v[66:67],v[66:67],s[54:55]
PM v[68:69],v[208:209],s[54:55]
PM v[70:71],v[210:211],s[54:55]
CV v28,v64,v65
CV v29,v66,v67
CV v30,v68,v69
CV v31,v70,v71
ds_write_b128 v2, v[28:31] offset:6144
PM v[72:73],v[192:193],s[54:55]
PM v[74:75],v[194:195],s[54:55]
PM v[76:77],v[212:213],s[54:55]
PM v[78:79],v[214:215],s[54:55]
CV v32,v72,v73
CV v33,v74,v75
CV v34,v76,v77
CV v35,v78,v79
ds_write_b128 v2, v[32:35] offset:14336
PM v[80:81],v[216:217],s[54:55]
PM v[82:83],v[218:219],s[54:55]
PM v[84:85],v[236:237],s[54:55]
PM v[86:87],v[238:239],s[54:55]
CV v124,v80,v81
CV v125,v82,v83
CV v126,v84,v85
CV v127,v86,v87
PM v[56:57],v[220:221],s[54:55]
PM v[58:59],v[222:223],s[54:55]
PM v[60:61],v[240:241],s[54:55]
PM v[62:63],v[242:243],s[54:55]
CV v156,v56,v57
CV v157,v58,v59
CV v158,v60,v61
CV v159,v62,v63
PM v[64:65],v[224:225],s[54:55]
PM v[66:67],v[226:227],s[54:55]
PM v[68:69],v[244:245],s[54:55]
PM v[70:71],v[246:247],s[54:55]
CV v188,v64,v65
CV v189,v66,v67
CV v190,v68,v69
CV v191,v70,v71
PM v[72:73],v[228:229],s[54:55]
PM v[74:75],v[230:231],s[54:55]
PM v[76:77],v[248:249],s[54:55]
PM v[78:79],v[250:251],s[54:55]
CV v28,v72,v73
CV v29,v74,v75
CV v30,v76,v77
CV v31,v78,v79
ds_write_b128 v2, v[28:31] offset:7168
PM v[80:81],v[232:233],s[54:55]
PM v[82:83],v[234:235],s[54:55]
PM v[84:85],v[252:253],s[54:55]
PM v[86:87],v[254:255],s[54:55]
CV v32,v80,v81
CV v33,v82,v83
CV v34,v84,v85
CV v35,v86,v87
ds_write_b128 v2, v[32:35] offset:15360
WL 0
RD v[12:15],v0,0
RD v[16:19],v0,8192
RD v[20:23],v0,512
RD v[28:31],v2,0
RD v[32:35],v2,8192
WL 4
M v[36:39],v[12:15],v[96:99],0
M v[40:43],v[12:15],v[128:131],0
s_barrier
M v[44:47],v[12:15],v[160:163],0
WL 1
v_subrev_u32 v10, s62, v2
M v[48:51],v[12:15],v[28:31],0
WL 0
RD v[24:27],v0,8704
M v[52:55],v[12:15],v[32:35],0
M v[204:207],v[16:19],v[28:31],0
RD v[28:31],v2,1024
M v[208:211],v[16:19],v[32:35],0
RD v[32:35],v2,9216
M v[192:195],v[16:19],v[96:99],0
M v[196:199],v[16:19],v[128:131],0
s_add_u32 m0, s53, 16384
RD v[12:15],v0,1024
M v[200:203],v[16:19],v[160:163],0
buffer_load_dwordx4 v3, s[16:19], s42 offen offset:0 nt lds
M v[36:39],v[20:23],v[100:103],v[36:39]
M v[40:43],v[20:23],v[132:135],v[40:43]
M v[44:47],v[20:23],v[164:167],v[44:47]
WL 2
M v[48:51],v[20:23],v[28:31],v[48:51]
WL 1
RD v[16:19],v0,9216
M v[52:55],v[20:23],v[32:35],v[52:55]
M v[204:207],v[24:27],v[28:31],v[204:207]
RD v[28:31],v2,2048
M v[208:211],v[24:27],v[32:35],v[208:211]
RD v[32:35],v2,10240
M v[192:195],v[24:27],v[100:103],v[192:195]
M v[196:199],v[24:27],v[132:135],v[196:199]
RD v[20:23],v0,1536
M v[200:203],v[24:27],v[164:167],v[200:203]
WL 4
M v[36:39],v[12:15],v[104:107],v[36:39]
M v[40:43],v[12:15],v[136:139],v[40:43]
M v[44:47],v[12:15],v[168:171],v[44:47]
WL 2
M v[48:51],v[12:15],v[28:31],v[48:51]
WL 1
RD v[24:27],v0,9728
M v[52:55],v[12:15],v[32:35],v[52:55]
M v[204:207],v[16:19],v[28:31],v[204:207]
RD v[28:31],v2,3072
M v[208:211],v[16:19],v[32:35],v[208:211]
s_add_u32 m0, s53, 17280
RD v[32:35],v2,11264
M v[192:195],v[16:19],v[104:107],v[192:195]
buffer_load_dwordx4 v3, s[16:19], s42 offen offset:128 nt lds
M v[196:199],v[16:19],v[136:139],v[196:199]
RD v[12:15],v0,2048
M v[200:203],v[16:19],v[168:171],v[200:203]
WL 4
M v[36:39],v[20:23],v[108:111],v[36:39]
M v[40:43],v[20:23],v[140:143],v[40:43]
M v[44:47],v[20:23],v[172:175],v[44:47]
WL 2
M v[48:51],v[20:23],v[28:31],v[48:51]
WL 1
RD v[16:19],v0,10240
M v[52:55],v[20:23],v[32:35],v[52:55]
M v[204:207],v[24:27],v[28:31],v[204:207]
RD v[28:31],v2,4096
M v[208:211],v[24:27],v[32:35],v[208:211]
RD v[32:35],v2,12288
M v[192:195],v[24:27],v[108:111],v[192:195]
M v[196:199],v[24:27],v[140:143],v[196:199]
s_add_u32 m0, s53, 18176
RD v[20:23],v0,2560
M v[200:203],v[24:27],v[172:175],v[200:203]
WL 4
buffer_load_dwordx4 v3, s[16:19], s42 offen offset:256 nt lds
M v[36:39],v[12:15],v[112:115],v[36:39]
M v[40:43],v[12:15],v[144:147],v[40:43]
M v[44:47],v[12:15],v[176:179],v[44:47]
WL 2
M v[48:51],v[12:15],v[28:31],v[48:51]
WL 1
RD v[24:27],v0,10752
M v[52:55],v[12:15],v[32:35],v[52:55]
M v[204:207],v[16:19],v[28:31],v[204:207]
RD v[28:31],v2,5120
M v[208:211],v[16:19],v[32:35],v[208:211]
RD v[32:35],v2,13312
M v[192:195],v[16:19],v[112:115],v[192:195]
M v[196:199],v[16:19],v[144:147],v[196:199]
RD v[12:15],v0,3072
M v[200:203],v[16:19],v[176:179],v[200:203]
WL 4
M v[36:39],v[20:23],v[116:119],v[36:39]
M v[40:43],v[20:23],v[148:151],v[40:43]
M v[44:47],v[20:23],v[180:183],v[44:47]
WL 2
M v[48:51],v[20:23],v[28:31],v[48:51]
WL 1
RD v[16:19],v0,11264
M v[52:55],v[20:23],v[32:35],v[52:55]
M v[204:207],v[24:27],v[28:31],v[204:207]
RD v[28:31],v2,6144
M v[208:211],v[24:27],v[32:35],v[208:211]
s_add_u32 m0, s53, 19072
RD v[32:35],v2,14336
M v[192:195],v[24:27],v[116:119],v[192:195]
buffer_load_dwordx4 v3, s[16:19], s42 offen offset:384 nt lds
s_add_u32 s42, s42, 16384
M v[196:199],v[24:27],v[148:151],v[196:199]
RD v[20:23],v0,3584
M v[200:203],v[24:27],v[180:183],v[200:203]
WL 4
M v[36:39],v[12:15],v[120:123],v[36:39]
M v[40:43],v[12:15],v[152:155],v[40:43]
M v[44:47],v[12:15],v[184:187],v[44:47]
WL 2
M v[48:51],v[12:15],v[28:31],v[48:51]
WL 1
RD v[24:27],v0,11776
M v[52:55],v[12:15],v[32:35],v[52:55]
M v[204:207],v[16:19],v[28:31],v[204:207]
RD v[28:31],v2,7168
v_add_u32 v0, 0x4000, v0
M v[208:211],v[16:19],v[32:35],v[208:211]
WV 4
RD v[32:35],v2,15360
M v[192:195],v[16:19],v[120:123],v[192:195]
s_barrier
M v[196:199],v[16:19],v[152:155],v[196:199]
RD v[12:15],v0,0
TR v[224:225],v11,0
TR v[226:227],v11,14336
M v[200:203],v[16:19],v[184:187],v[200:203]
WL 6
TR v[228:229],v11,256
TR v[230:231],v11,14592
M v[36:39],v[20:23],v[124:127],v[36:39]
TR v[232:233],v11,512
TR v[234:235],v11,14848
M v[40:43],v[20:23],v[156:159],v[40:43]
TR v[236:237],v11,768
TR v[238:239],v11,15104
M v[44:47],v[20:23],v[188:191],v[44:47]
WL 10
TR v[240:241],v11,1024
TR v[242:243],v11,15360
M v[48:51],v[20:23],v[28:31],v[48:51]
WL 11
RD v[16:19],v0,8192
TR v[244:245],v11,1280
TR v[246:247],v11,15616
M v[52:55],v[20:23],v[32:35],v[52:55]
TR v[248:249],v11,1536
TR v[250:251],v11,15872
M v[204:207],v[24:27],v[28:31],v[204:207]
RD v[28:31],v2,0
M v[208:211],v[24:27],v[32:35],v[208:211]
RD v[32:35],v2,8192
M v[192:195],v[24:27],v[124:127],v[192:195]
v_exp_f32 v36, v36
M v[196:199],v[24:27],v[156:159],v[196:199]
RD v[20:23],v0,512
v_add_f32 v4, v4, v36
M v[200:203],v[24:27],v[188:191],v[200:203]
WL 0
M v[76:79],v[12:15],v[96:99],0
v_exp_f32 v37, v37
M v[80:83],v[12:15],v[128:131],0
s_barrier
v_exp_f32 v38, v38
v_add_f32 v4, v4, v37
M v[84:87],v[12:15],v[160:163],0
v_exp_f32 v39, v39
M v[88:91],v[12:15],v[28:31],0
RD v[24:27],v0,8704
v_exp_f32 v40, v40
M v[92:95],v[12:15],v[32:35],0
v_exp_f32 v41, v41
M v[68:71],v[16:19],v[28:31],0
s_add_u32 s51, s60, 4096
RD v[28:31],v2,1024
v_exp_f32 v42, v42
M v[72:75],v[16:19],v[32:35],0
s_add_u32 m0, s53, 0
RD v[32:35],v2,9216
v_add_f32 v4, v4, v38
M v[56:59],v[16:19],v[96:99],0
buffer_load_dwordx4 v3, s[20:23], s43 offen offset:0 nt lds
v_exp_f32 v43, v43
M v[60:63],v[16:19],v[128:131],0
RD v[12:15],v0,1024
v_add_f32 v4, v4, v39
M v[64:67],v[16:19],v[160:163],0
buffer_store_dwordx4 v[224:227], v10, s[28:31], s60 offen offset:0 sc1
CV v36,v36,v37
CV v37,v38,v39
M v[76:79],v[20:23],v[100:103],v[76:79]
s_add_u32 m0, s53, 896
v_exp_f32 v44, v44
M v[80:83],v[20:23],v[132:135],v[80:83]
buffer_load_dwordx4 v3, s[20:23], s43 offen offset:128 nt lds
v_exp_f32 v45, v45
M v[84:87],v[20:23],v[164:167],v[84:87]
WL 2
buffer_store_dwordx4 v[228:231], v10, s[28:31], s60 offen offset:1024 sc1
v_add_f32 v5, v5, v40
M v[88:91],v[20:23],v[28:31],v[88:91]
WL 1
RD v[16:19],v0,9216
v_exp_f32 v46, v46
M v[92:95],v[20:23],v[32:35],v[92:95]
v_exp_f32 v47, v47
M v[68:71],v[24:27],v[28:31],v[68:71]
RD v[28:31],v2,2048
v_add_f32 v5, v5, v41
v_add_f32 v5, v5, v42
M v[72:75],v[24:27],v[32:35],v[72:75]
s_add_u32 m0, s53, 1792
RD v[32:35],v2,10240
v_add_f32 v5, v5, v43
M v[56:59],v[24:27],v[100:103],v[56:59]
buffer_load_dwordx4 v3, s[20:23], s43 offen offset:256 nt lds
CV v40,v40,v41
CV v41,v42,v43
M v[60:63],v[24:27],v[132:135],v[60:63]
RD v[20:23],v0,1536
v_add_f32 v6, v6, v44
M v[64:67],v[24:27],v[164:167],v[64:67]
WL 4
buffer_store_dwordx4 v[232:235], v10, s[28:31], s60 offen offset:2048 sc1
v_exp_f32 v48, v48
M v[76:79],v[12:15],v[104:107],v[76:79]
v_exp_f32 v49, v49
M v[80:83],v[12:15],v[136:139],v[80:83]
buffer_store_dwordx4 v[236:239], v10, s[28:31], s60 offen offset:3072 sc1
v_exp_f32 v50, v50
M v[84:87],v[12:15],v[168:171],v[84:87]
WL 2
v_exp_f32 v51, v51
M v[88:91],v[12:15],v[28:31],v[88:91]
WL 1
RD v[24:27],v0,9728
v_add_f32 v6, v6, v45
v_add_f32 v6, v6, v46
M v[92:95],v[12:15],v[32:35],v[92:95]
buffer_store_dwordx4 v[240:243], v10, s[28:31], s51 offen offset:0 sc1
v_add_f32 v6, v6, v47
M v[68:71],v[16:19],v[28:31],v[68:71]
RD v[28:31],v2,3072
CV v44,v44,v45
CV v45,v46,v47
M v[72:75],v[16:19],v[32:35],v[72:75]
s_add_u32 m0, s53, 2688
RD v[32:35],v2,11264
v_add_f32 v7, v7, v48
M v[56:59],v[16:19],v[104:107],v[56:59]
buffer_load_dwordx4 v3, s[20:23], s43 offen offset:384 nt lds
v_exp_f32 v52, v52
s_add_u32 s43, s43, 16384
M v[60:63],v[16:19],v[136:139],v[60:63]
RD v[12:15],v0,2048
v_add_f32 v7, v7, v49
M v[64:67],v[16:19],v[168:171],v[64:67]
WL 4
buffer_store_dwordx4 v[244:247], v10, s[28:31], s51 offen offset:1024 sc1
v_exp_f32 v53, v53
M v[76:79],v[20:23],v[108:111],v[76:79]
v_exp_f32 v54, v54
M v[80:83],v[20:23],v[140:143],v[80:83]
s_sub_u32 m0, s53, 16384
v_exp_f32 v55, v55
v_add_f32 v7, v7, v50
M v[84:87],v[20:23],v[172:175],v[84:87]
WL 2
buffer_load_dwordx4 v3, s[16:19], s42 offen offset:0 nt lds
v_add_f32 v7, v7, v51
M v[88:91],v[20:23],v[28:31],v[88:91]
WL 1
RD v[16:19],v0,10240
CV v48,v48,v49
CV v49,v50,v51
M v[92:95],v[20:23],v[32:35],v[92:95]
buffer_store_dwordx4 v[248:251], v10, s[28:31], s51 offen offset:2048 sc1
v_add_f32 v8, v8, v52
M v[68:71],v[24:27],v[28:31],v[68:71]
RD v[28:31],v2,4096
v_exp_f32 v204, v204
M v[72:75],v[24:27],v[32:35],v[72:75]
RD v[32:35],v2,12288
v_mov_b32 v10, 0
M v[56:59],v[24:27],v[108:111],v[56:59]
v_exp_f32 v205, v205
v_add_f32 v8, v8, v53
M v[60:63],v[24:27],v[140:143],v[60:63]
s_sub_u32 m0, s53, 15488
RD v[20:23],v0,2560
v_add_f32 v8, v8, v54
M v[64:67],v[24:27],v[172:175],v[64:67]
WL 4
buffer_load_dwordx4 v3, s[16:19], s42 offen offset:128 nt lds
v_exp_f32 v206, v206
M v[76:79],v[12:15],v[112:115],v[76:79]
v_exp_f32 v207, v207
M v[80:83],v[12:15],v[144:147],v[80:83]
v_add_f32 v8, v8, v55
CV v52,v52,v53
CV v53,v54,v55
M v[84:87],v[12:15],v[176:179],v[84:87]
WL 2
v_exp_f32 v208, v208
M v[88:91],v[12:15],v[28:31],v[88:91]
WL 1
RD v[24:27],v0,10752
v_exp_f32 v209, v209
M v[92:95],v[12:15],v[32:35],v[92:95]
v_exp_f32 v210, v210
M v[68:71],v[16:19],v[28:31],v[68:71]
RD v[28:31],v2,5120
v_exp_f32 v211, v211
M v[72:75],v[16:19],v[32:35],v[72:75]
s_sub_u32 m0, s53, 14592
RD v[32:35],v2,13312
v_add_f32 v7, v7, v204
M v[56:59],v[16:19],v[112:115],v[56:59]
buffer_load_dwordx4 v3, s[16:19], s42 offen offset:256 nt lds
v_add_f32 v7, v7, v205
v_add_f32 v7, v7, v206
M v[60:63],v[16:19],v[144:147],v[60:63]
RD v[12:15],v0,3072
v_add_f32 v7, v7, v207
M v[64:67],v[16:19],v[176:179],v[64:67]
WL 4
CV v50,v204,v205
v_exp_f32 v192, v192
M v[76:79],v[20:23],v[116:119],v[76:79]
v_exp_f32 v193, v193
M v[80:83],v[20:23],v[148:151],v[80:83]
s_sub_u32 m0, s53, 13696
v_exp_f32 v194, v194
CV v51,v206,v207
M v[84:87],v[20:23],v[180:183],v[84:87]
WL 2
buffer_load_dwordx4 v3, s[16:19], s42 offen offset:384 nt lds
v_add_f32 v8, v8, v208
s_add_u32 s42, s42, 16384
M v[88:91],v[20:23],v[28:31],v[88:91]
WL 1
RD v[16:19],v0,11264
v_exp_f32 v195, v195
M v[92:95],v[20:23],v[32:35],v[92:95]
v_add_f32 v8, v8, v209
v_add_f32 v8, v8, v210
M v[68:71],v[24:27],v[28:31],v[68:71]
RD v[28:31],v2,6144
v_add_f32 v8, v8, v211
CV v54,v208,v209
M v[72:75],v[24:27],v[32:35],v[72:75]
RD v[32:35],v2,14336
CV v55,v210,v211
M v[56:59],v[24:27],v[116:119],v[56:59]
v_exp_f32 v196, v196
v_add_f32 v4, v4, v192
M v[60:63],v[24:27],v[148:151],v[60:63]
RD v[20:23],v0,3584
v_add_f32 v4, v4, v193
M v[64:67],v[24:27],v[180:183],v[64:67]
WL 4
v_exp_f32 v197, v197
v_add_f32 v4, v4, v194
M v[76:79],v[12:15],v[120:123],v[76:79]
v_exp_f32 v198, v198
M v[80:83],v[12:15],v[152:155],v[80:83]
v_exp_f32 v199, v199
v_add_f32 v4, v4, v195
M v[84:87],v[12:15],v[184:187],v[84:87]
WL 2
CV v38,v192,v193
CV v39,v194,v195
M v[88:91],v[12:15],v[28:31],v[88:91]
WL 1
RD v[24:27],v0,11776
v_exp_f32 v200, v200
M v[92:95],v[12:15],v[32:35],v[92:95]
v_exp_f32 v201, v201
M v[68:71],v[16:19],v[28:31],v[68:71]
RD v[28:31],v2,7168
v_exp_f32 v202, v202
v_add_u32 v0, 0x8000, v0
M v[72:75],v[16:19],v[32:35],v[72:75]
WV 23
RD v[32:35],v2,15360
v_add_f32 v5, v5, v196
M v[56:59],v[16:19],v[120:123],v[56:59]
s_barrier
v_exp_f32 v203, v203
v_add_f32 v5, v5, v197
M v[60:63],v[16:19],v[152:155],v[60:63]
TR v[12:13],v1,0
v_add_f32 v5, v5, v198
M v[64:67],v[16:19],v[184:187],v[64:67]
WL 4
TR v[14:15],v1,8192
v_add_f32 v5, v5, v199
CV v42,v196,v197
M v[76:79],v[20:23],v[124:127],v[76:79]
s_add_u32 m0, s53, 32768
CV v43,v198,v199
v_add_f32 v6, v6, v200
M v[80:83],v[20:23],v[156:159],v[80:83]
buffer_load_dwordx4 v3, s[20:23], s43 offen offset:0 nt lds
v_add_f32 v6, v6, v201
v_add_f32 v6, v6, v202
M v[84:87],v[20:23],v[188:191],v[84:87]
WL 3
v_add_f32 v6, v6, v203
CV v46,v200,v201
M v[88:91],v[20:23],v[28:31],v[88:91]
WL 2
TR v[16:17],v9,0
CV v47,v202,v203
M v[92:95],v[20:23],v[32:35],v[92:95]
TR v[18:19],v9,8192
M v[68:71],v[24:27],v[28:31],v[68:71]
s_add_u32 m0, s53, 33664
M v[72:75],v[24:27],v[32:35],v[72:75]
buffer_load_dwordx4 v3, s[20:23], s43 offen offset:128 nt lds
M v[56:59],v[24:27],v[124:127],v[56:59]
v_exp_f32 v76, v76
M v[60:63],v[24:27],v[156:159],v[60:63]
TR v[20:21],v1,512
v_add_f32 v4, v4, v76
M v[64:67],v[24:27],v[188:191],v[64:67]
WL 3
TR v[22:23],v1,8704
M a[0:3],v[12:15],v[36:39],0
v_exp_f32 v77, v77
M a[4:7],v[12:15],v[40:43],0
s_add_u32 m0, s53, 34560
v_exp_f32 v78, v78
M a[8:11],v[12:15],v[44:47],0
buffer_load_dwordx4 v3, s[20:23], s43 offen offset:256 nt lds
v_add_f32 v4, v4, v77
M a[12:15],v[12:15],v[48:51],0
TR v[24:25],v9,512
v_add_f32 v4, v4, v78
M a[16:19],v[12:15],v[52:55],0
WL 3
TR v[26:27],v9,8704
CV v76,v76,v77
M a[20:23],v[16:19],v[36:39],0
v_exp_f32 v79, v79
M a[24:27],v[16:19],v[40:43],0
v_exp_f32 v80, v80
M a[28:31],v[16:19],v[44:47],0
v_exp_f32 v81, v81
M a[32:35],v[16:19],v[48:51],0
TR v[12:13],v1,1024
v_add_f32 v4, v4, v79
M a[36:39],v[16:19],v[52:55],0
WL 3
TR v[14:15],v1,9216
CV v77,v78,v79
M a[40:43],v[20:23],v[36:39],0
s_add_u32 m0, s53, 35456
v_exp_f32 v82, v82
M a[44:47],v[20:23],v[40:43],0
buffer_load_dwordx4 v3, s[20:23], s43 offen offset:384 nt lds
v_add_f32 v5, v5, v80
s_add_u32 s43, s43, 16384
M a[48:51],v[20:23],v[44:47],0
v_exp_f32 v83, v83
M a[52:55],v[20:23],v[48:51],0
TR v[16:17],v9,1024
v_add_f32 v5, v5, v81
M a[56:59],v[20:23],v[52:55],0
WL 3
TR v[18:19],v9,9216
v_add_f32 v5, v5, v82
M a[60:63],v[24:27],v[36:39],0
v_exp_f32 v84, v84
M a[64:67],v[24:27],v[40:43],0
v_exp_f32 v85, v85
M a[68:71],v[24:27],v[44:47],0
v_exp_f32 v86, v86
M a[72:75],v[24:27],v[48:51],0
TR v[20:21],v1,1536
v_add_f32 v5, v5, v83
M a[76:79],v[24:27],v[52:55],0
WL 3
TR v[22:23],v1,9728
CV v80,v80,v81
M a[80:83],v[12:15],v[36:39],0
v_exp_f32 v87, v87
M a[84:87],v[12:15],v[40:43],0
v_exp_f32 v88, v88
M a[88:91],v[12:15],v[44:47],0
v_exp_f32 v89, v89
M a[92:95],v[12:15],v[48:51],0
TR v[24:25],v9,1536
CV v81,v82,v83
M a[96:99],v[12:15],v[52:55],0
WL 3
TR v[26:27],v9,9728
v_add_f32 v6, v6, v84
M a[100:103],v[16:19],v[36:39],0
v_exp_f32 v90, v90
M a[104:107],v[16:19],v[40:43],0
v_exp_f32 v91, v91
M a[108:111],v[16:19],v[44:47],0
v_add_f32 v6, v6, v85
v_add_f32 v6, v6, v86
M a[112:115],v[16:19],v[48:51],0
TR v[12:13],v1,2048
v_add_f32 v6, v6, v87
M a[116:119],v[16:19],v[52:55],0
WL 3
TR v[14:15],v1,10240
CV v84,v84,v85
M a[120:123],v[20:23],v[36:39],0
v_exp_f32 v92, v92
M a[124:127],v[20:23],v[40:43],0
v_exp_f32 v93, v93
M a[128:131],v[20:23],v[44:47],0
v_exp_f32 v94, v94
M a[132:135],v[20:23],v[48:51],0
TR v[16:17],v9,2048
CV v85,v86,v87
M a[136:139],v[20:23],v[52:55],0
WL 3
TR v[18:19],v9,10240
v_add_f32 v7, v7, v88
M a[140:143],v[24:27],v[36:39],0
v_exp_f32 v95, v95
M a[144:147],v[24:27],v[40:43],0
v_add_f32 v7, v7, v89
v_add_f32 v7, v7, v90
M a[148:151],v[24:27],v[44:47],0
v_add_f32 v7, v7, v91
CV v88,v88,v89
M a[152:155],v[24:27],v[48:51],0
TR v[20:21],v1,2560
CV v89,v90,v91
M a[156:159],v[24:27],v[52:55],0
WL 3
TR v[22:23],v1,10752
v_add_f32 v8, v8, v92
M a[160:163],v[12:15],v[36:39],0
v_exp_f32 v68, v68
M a[164:167],v[12:15],v[40:43],0
v_exp_f32 v69, v69
M a[168:171],v[12:15],v[44:47],0
v_exp_f32 v70, v70
M a[172:175],v[12:15],v[48:51],0
TR v[24:25],v9,2560
v_add_f32 v8, v8, v93
M a[176:179],v[12:15],v[52:55],0
WL 3
TR v[26:27],v9,10752
v_add_f32 v8, v8, v94
M a[180:183],v[16:19],v[36:39],0
v_exp_f32 v71, v71
M a[184:187],v[16:19],v[40:43],0
v_add_f32 v8, v8, v95
CV v92,v92,v93
M a[188:191],v[16:19],v[44:47],0
v_exp_f32 v72, v72
M a[192:195],v[16:19],v[48:51],0
TR v[12:13],v1,3072
CV v93,v94,v95
M a[196:199],v[16:19],v[52:55],0
WL 3
TR v[14:15],v1,11264
v_add_f32 v7, v7, v68
M a[200:203],v[20:23],v[36:39],0
v_exp_f32 v73, v73
M a[204:207],v[20:23],v[40:43],0
v_exp_f32 v74, v74
M a[208:211],v[20:23],v[44:47],0
v_exp_f32 v75, v75
M a[212:215],v[20:23],v[48:51],0
TR v[16:17],v9,3072
v_add_f32 v7, v7, v69
M a[216:219],v[20:23],v[52:55],0
WL 3
TR v[18:19],v9,11264
v_add_f32 v7, v7, v70
M a[220:223],v[24:27],v[36:39],0
v_add_f32 v7, v7, v71
CV v90,v68,v69
M a[224:227],v[24:27],v[40:43],0
v_exp_f32 v56, v56
M a[228:231],v[24:27],v[44:47],0
v_exp_f32 v57, v57
M a[232:235],v[24:27],v[48:51],0
TR v[20:21],v1,3584
CV v91,v70,v71
M a[236:239],v[24:27],v[52:55],0
WL 3
TR v[22:23],v1,11776
v_add_f32 v8, v8, v72
M a[240:243],v[12:15],v[36:39],0
v_exp_f32 v58, v58
M a[244:247],v[12:15],v[40:43],0
v_exp_f32 v59, v59
M a[248:251],v[12:15],v[44:47],0
v_add_f32 v8, v8, v73
v_add_f32 v8, v8, v74
M a[252:255],v[12:15],v[48:51],0
TR v[24:25],v9,3584
v_add_f32 v8, v8, v75
M v[192:195],v[12:15],v[52:55],0
WL 3
TR v[26:27],v9,11776
CV v94,v72,v73
M v[196:199],v[16:19],v[36:39],0
CV v95,v74,v75
v_add_u32 v1, 0xffff0000, v1
M v[200:203],v[16:19],v[40:43],0
WV 23
v_add_f32 v4, v4, v56
v_add_u32 v9, 0xffff0000, v9
M v[204:207],v[16:19],v[44:47],0
s_barrier
v_exp_f32 v60, v60
M v[208:211],v[16:19],v[48:51],0
RD v[12:15],v0,0
v_add_f32 v4, v4, v57
M v[212:215],v[16:19],v[52:55],0
WL 3
v_exp_f32 v61, v61
M v[216:219],v[20:23],v[36:39],0
RD v[28:31],v2,0
v_add_f32 v4, v4, v58
M v[220:223],v[20:23],v[40:43],0
RD v[32:35],v2,8192
v_add_f32 v4, v4, v59
M v[224:227],v[20:23],v[44:47],0
v_exp_f32 v62, v62
M v[228:231],v[20:23],v[48:51],0
RD v[16:19],v0,8192
CV v78,v56,v57
M v[232:235],v[20:23],v[52:55],0
WL 4
v_exp_f32 v63, v63
M v[236:239],v[24:27],v[36:39],0
v_exp_f32 v64, v64
M v[240:243],v[24:27],v[40:43],0
v_exp_f32 v65, v65
M v[244:247],v[24:27],v[44:47],0
v_exp_f32 v66, v66
M v[248:251],v[24:27],v[48:51],0
RD v[20:23],v0,512
CV v79,v58,v59
M v[252:255],v[24:27],v[52:55],0
v_exp_f32 v67, v67
s_mov_b32 s52, 15
s_lshl_b32 s6, s101, 2
s_add_u32 s6, s6, s3
s_mul_i32 s4, s6, 1639
s_lshr_b32 s4, s4, 16
s_mul_i32 s4, s4, 40
s_sub_u32 s4, s6, s4
s_lshr_b32 s5, s4, 2
s_lshl_b32 s5, s5, 12
s_and_b32 s4, s4, 3
s_lshl_b32 s4, s4, 7
s_add_u32 s4, s4, s5
s_add_u32 s100, s4, L1_post_5-concat_heads__mha_block_cached__mha_block_cached__near_ridge_kernel
L1_loop_5:
WL 4
M v[36:39],v[12:15],v[96:99],0
v_add_f32 v5, v5, v60
v_add_f32 v5, v5, v61
M v[40:43],v[12:15],v[128:131],0
v_add_f32 v5, v5, v62
v_add_f32 v5, v5, v63
M v[44:47],v[12:15],v[160:163],0
WL 3
CV v82,v60,v61
CV v83,v62,v63
M v[48:51],v[12:15],v[28:31],0
WL 2
RD v[24:27],v0,8704
v_add_f32 v6, v6, v64
M v[52:55],v[12:15],v[32:35],0
WL 2
v_add_f32 v6, v6, v65
v_add_f32 v6, v6, v66
M v[68:71],v[16:19],v[28:31],0
RD v[28:31],v2,1024
v_add_f32 v6, v6, v67
M v[72:75],v[16:19],v[32:35],0
RD v[32:35],v2,9216
CV v86,v64,v65
M v[56:59],v[16:19],v[96:99],0
CV v87,v66,v67
M v[60:63],v[16:19],v[128:131],0
s_add_u32 m0, s61, 0
RD v[12:15],v0,1024
M v[64:67],v[16:19],v[160:163],0
WL 4
buffer_load_dwordx4 v3, s[16:19], s42 offen offset:0 nt lds
M v[36:39],v[20:23],v[100:103],v[36:39]
M v[40:43],v[20:23],v[132:135],v[40:43]
M v[44:47],v[20:23],v[164:167],v[44:47]
WL 2
M v[48:51],v[20:23],v[28:31],v[48:51]
WL 1
RD v[16:19],v0,9216
M v[52:55],v[20:23],v[32:35],v[52:55]
M v[68:71],v[24:27],v[28:31],v[68:71]
s_sub_u32 s50, s45, s44
RD v[28:31],v2,2048
M v[72:75],v[24:27],v[32:35],v[72:75]
RD v[32:35],v2,10240
M v[56:59],v[24:27],v[100:103],v[56:59]
M v[60:63],v[24:27],v[132:135],v[60:63]
RD v[20:23],v0,1536
M v[64:67],v[24:27],v[164:167],v[64:67]
WL 4
M v[36:39],v[12:15],v[104:107],v[36:39]
M v[40:43],v[12:15],v[136:139],v[40:43]
M v[44:47],v[12:15],v[168:171],v[44:47]
WL 2
M v[48:51],v[12:15],v[28:31],v[48:51]
WL 1
RD v[24:27],v0,9728
M v[52:55],v[12:15],v[32:35],v[52:55]
M v[68:71],v[16:19],v[28:31],v[68:71]
RD v[28:31],v2,3072
M v[72:75],v[16:19],v[32:35],v[72:75]
s_add_u32 m0, s61, 896
RD v[32:35],v2,11264
M v[56:59],v[16:19],v[104:107],v[56:59]
buffer_load_dwordx4 v3, s[16:19], s42 offen offset:128 nt lds
M v[60:63],v[16:19],v[136:139],v[60:63]
RD v[12:15],v0,2048
M v[64:67],v[16:19],v[168:171],v[64:67]
WL 4
M v[36:39],v[20:23],v[108:111],v[36:39]
M v[40:43],v[20:23],v[140:143],v[40:43]
M v[44:47],v[20:23],v[172:175],v[44:47]
WL 2
M v[48:51],v[20:23],v[28:31],v[48:51]
WL 1
RD v[16:19],v0,10240
M v[52:55],v[20:23],v[32:35],v[52:55]
M v[68:71],v[24:27],v[28:31],v[68:71]
RD v[28:31],v2,4096
M v[72:75],v[24:27],v[32:35],v[72:75]
RD v[32:35],v2,12288
M v[56:59],v[24:27],v[108:111],v[56:59]
M v[60:63],v[24:27],v[140:143],v[60:63]
s_add_u32 m0, s61, 1792
RD v[20:23],v0,2560
M v[64:67],v[24:27],v[172:175],v[64:67]
WL 4
buffer_load_dwordx4 v3, s[16:19], s42 offen offset:256 nt lds
M v[36:39],v[12:15],v[112:115],v[36:39]
M v[40:43],v[12:15],v[144:147],v[40:43]
M v[44:47],v[12:15],v[176:179],v[44:47]
WL 2
M v[48:51],v[12:15],v[28:31],v[48:51]
WL 1
RD v[24:27],v0,10752
M v[52:55],v[12:15],v[32:35],v[52:55]
M v[68:71],v[16:19],v[28:31],v[68:71]
RD v[28:31],v2,5120
M v[72:75],v[16:19],v[32:35],v[72:75]
RD v[32:35],v2,13312
M v[56:59],v[16:19],v[112:115],v[56:59]
M v[60:63],v[16:19],v[144:147],v[60:63]
RD v[12:15],v0,3072
M v[64:67],v[16:19],v[176:179],v[64:67]
WL 4
M v[36:39],v[20:23],v[116:119],v[36:39]
M v[40:43],v[20:23],v[148:151],v[40:43]
M v[44:47],v[20:23],v[180:183],v[44:47]
WL 2
M v[48:51],v[20:23],v[28:31],v[48:51]
WL 1
RD v[16:19],v0,11264
M v[52:55],v[20:23],v[32:35],v[52:55]
M v[68:71],v[24:27],v[28:31],v[68:71]
RD v[28:31],v2,6144
M v[72:75],v[24:27],v[32:35],v[72:75]
s_add_u32 m0, s61, 2688
RD v[32:35],v2,14336
M v[56:59],v[24:27],v[116:119],v[56:59]
buffer_load_dwordx4 v3, s[16:19], s42 offen offset:384 nt lds
s_add_u32 s42, s42, 16384
M v[60:63],v[24:27],v[148:151],v[60:63]
s_mov_b32 s51, s44
RD v[20:23],v0,3584
M v[64:67],v[24:27],v[180:183],v[64:67]
WL 4
M v[36:39],v[12:15],v[120:123],v[36:39]
s_mov_b32 s44, s45
M v[40:43],v[12:15],v[152:155],v[40:43]
s_mov_b32 s45, s46
M v[44:47],v[12:15],v[184:187],v[44:47]
WL 2
M v[48:51],v[12:15],v[28:31],v[48:51]
WL 1
RD v[24:27],v0,11776
M v[52:55],v[12:15],v[32:35],v[52:55]
M v[68:71],v[16:19],v[28:31],v[68:71]
s_mov_b32 s46, s61
RD v[28:31],v2,7168
v_add_u32 v0, s50, v0
M v[72:75],v[16:19],v[32:35],v[72:75]
WV 12
RD v[32:35],v2,15360
M v[56:59],v[16:19],v[120:123],v[56:59]
s_barrier
M v[60:63],v[16:19],v[152:155],v[60:63]
s_mov_b32 s61, s51
TR v[12:13],v1,0
M v[64:67],v[16:19],v[184:187],v[64:67]
WL 4
TR v[14:15],v1,8192
M v[36:39],v[20:23],v[124:127],v[36:39]
s_add_u32 m0, s49, 0
M v[40:43],v[20:23],v[156:159],v[40:43]
buffer_load_dwordx4 v3, s[20:23], s43 offen offset:0 nt lds
M v[44:47],v[20:23],v[188:191],v[44:47]
WL 3
M v[48:51],v[20:23],v[28:31],v[48:51]
WL 2
TR v[16:17],v9,0
M v[52:55],v[20:23],v[32:35],v[52:55]
TR v[18:19],v9,8192
M v[68:71],v[24:27],v[28:31],v[68:71]
s_add_u32 m0, s49, 896
M v[72:75],v[24:27],v[32:35],v[72:75]
buffer_load_dwordx4 v3, s[20:23], s43 offen offset:128 nt lds
M v[56:59],v[24:27],v[124:127],v[56:59]
v_exp_f32 v36, v36
M v[60:63],v[24:27],v[156:159],v[60:63]
TR v[20:21],v1,512
v_add_f32 v4, v4, v36
M v[64:67],v[24:27],v[188:191],v[64:67]
WL 3
TR v[22:23],v1,8704
M a[0:3],v[12:15],v[76:79],a[0:3]
v_exp_f32 v37, v37
M a[4:7],v[12:15],v[80:83],a[4:7]
s_add_u32 m0, s49, 1792
v_exp_f32 v38, v38
M a[8:11],v[12:15],v[84:87],a[8:11]
buffer_load_dwordx4 v3, s[20:23], s43 offen offset:256 nt lds
v_add_f32 v4, v4, v37
M a[12:15],v[12:15],v[88:91],a[12:15]
TR v[24:25],v9,512
v_add_f32 v4, v4, v38
M a[16:19],v[12:15],v[92:95],a[16:19]
WL 3
TR v[26:27],v9,8704
CV v36,v36,v37
M a[20:23],v[16:19],v[76:79],a[20:23]
v_exp_f32 v39, v39
M a[24:27],v[16:19],v[80:83],a[24:27]
v_exp_f32 v40, v40
M a[28:31],v[16:19],v[84:87],a[28:31]
v_exp_f32 v41, v41
M a[32:35],v[16:19],v[88:91],a[32:35]
TR v[12:13],v1,1024
v_add_f32 v4, v4, v39
M a[36:39],v[16:19],v[92:95],a[36:39]
WL 3
TR v[14:15],v1,9216
CV v37,v38,v39
M a[40:43],v[20:23],v[76:79],a[40:43]
s_add_u32 m0, s49, 2688
v_exp_f32 v42, v42
M a[44:47],v[20:23],v[80:83],a[44:47]
s_sub_u32 s50, s48, s47
buffer_load_dwordx4 v3, s[20:23], s43 offen offset:384 nt lds
v_add_f32 v5, v5, v40
s_add_u32 s43, s43, 16384
M a[48:51],v[20:23],v[84:87],a[48:51]
s_mov_b32 s51, s47
v_exp_f32 v43, v43
M a[52:55],v[20:23],v[88:91],a[52:55]
s_mov_b32 s47, s48
TR v[16:17],v9,1024
v_add_f32 v5, v5, v41
M a[56:59],v[20:23],v[92:95],a[56:59]
WL 3
TR v[18:19],v9,9216
v_add_f32 v5, v5, v42
M a[60:63],v[24:27],v[76:79],a[60:63]
s_mov_b32 s48, s49
v_exp_f32 v44, v44
M a[64:67],v[24:27],v[80:83],a[64:67]
s_mov_b32 s49, s51
v_exp_f32 v45, v45
M a[68:71],v[24:27],v[84:87],a[68:71]
v_exp_f32 v46, v46
M a[72:75],v[24:27],v[88:91],a[72:75]
TR v[20:21],v1,1536
v_add_f32 v5, v5, v43
M a[76:79],v[24:27],v[92:95],a[76:79]
WL 3
TR v[22:23],v1,9728
CV v40,v40,v41
M a[80:83],v[12:15],v[76:79],a[80:83]
v_exp_f32 v47, v47
M a[84:87],v[12:15],v[80:83],a[84:87]
v_exp_f32 v48, v48
M a[88:91],v[12:15],v[84:87],a[88:91]
v_exp_f32 v49, v49
M a[92:95],v[12:15],v[88:91],a[92:95]
TR v[24:25],v9,1536
CV v41,v42,v43
M a[96:99],v[12:15],v[92:95],a[96:99]
WL 3
TR v[26:27],v9,9728
v_add_f32 v6, v6, v44
M a[100:103],v[16:19],v[76:79],a[100:103]
v_exp_f32 v50, v50
M a[104:107],v[16:19],v[80:83],a[104:107]
v_exp_f32 v51, v51
M a[108:111],v[16:19],v[84:87],a[108:111]
v_add_f32 v6, v6, v45
v_add_f32 v6, v6, v46
M a[112:115],v[16:19],v[88:91],a[112:115]
TR v[12:13],v1,2048
v_add_f32 v6, v6, v47
M a[116:119],v[16:19],v[92:95],a[116:119]
WL 3
TR v[14:15],v1,10240
CV v44,v44,v45
M a[120:123],v[20:23],v[76:79],a[120:123]
v_exp_f32 v52, v52
M a[124:127],v[20:23],v[80:83],a[124:127]
v_exp_f32 v53, v53
M a[128:131],v[20:23],v[84:87],a[128:131]
v_exp_f32 v54, v54
M a[132:135],v[20:23],v[88:91],a[132:135]
TR v[16:17],v9,2048
CV v45,v46,v47
M a[136:139],v[20:23],v[92:95],a[136:139]
WL 3
TR v[18:19],v9,10240
v_add_f32 v7, v7, v48
M a[140:143],v[24:27],v[76:79],a[140:143]
v_exp_f32 v55, v55
M a[144:147],v[24:27],v[80:83],a[144:147]
v_add_f32 v7, v7, v49
v_add_f32 v7, v7, v50
M a[148:151],v[24:27],v[84:87],a[148:151]
v_add_f32 v7, v7, v51
CV v48,v48,v49
M a[152:155],v[24:27],v[88:91],a[152:155]
TR v[20:21],v1,2560
CV v49,v50,v51
M a[156:159],v[24:27],v[92:95],a[156:159]
WL 3
TR v[22:23],v1,10752
v_add_f32 v8, v8, v52
M a[160:163],v[12:15],v[76:79],a[160:163]
v_exp_f32 v68, v68
M a[164:167],v[12:15],v[80:83],a[164:167]
v_exp_f32 v69, v69
M a[168:171],v[12:15],v[84:87],a[168:171]
v_exp_f32 v70, v70
M a[172:175],v[12:15],v[88:91],a[172:175]
TR v[24:25],v9,2560
v_add_f32 v8, v8, v53
M a[176:179],v[12:15],v[92:95],a[176:179]
WL 3
TR v[26:27],v9,10752
v_add_f32 v8, v8, v54
M a[180:183],v[16:19],v[76:79],a[180:183]
v_exp_f32 v71, v71
M a[184:187],v[16:19],v[80:83],a[184:187]
v_add_f32 v8, v8, v55
CV v52,v52,v53
M a[188:191],v[16:19],v[84:87],a[188:191]
v_exp_f32 v72, v72
M a[192:195],v[16:19],v[88:91],a[192:195]
TR v[12:13],v1,3072
CV v53,v54,v55
M a[196:199],v[16:19],v[92:95],a[196:199]
WL 3
TR v[14:15],v1,11264
v_add_f32 v7, v7, v68
M a[200:203],v[20:23],v[76:79],a[200:203]
v_exp_f32 v73, v73
M a[204:207],v[20:23],v[80:83],a[204:207]
v_exp_f32 v74, v74
M a[208:211],v[20:23],v[84:87],a[208:211]
v_exp_f32 v75, v75
M a[212:215],v[20:23],v[88:91],a[212:215]
TR v[16:17],v9,3072
v_add_f32 v7, v7, v69
M a[216:219],v[20:23],v[92:95],a[216:219]
WL 3
TR v[18:19],v9,11264
v_add_f32 v7, v7, v70
M a[220:223],v[24:27],v[76:79],a[220:223]
v_add_f32 v7, v7, v71
CV v50,v68,v69
M a[224:227],v[24:27],v[80:83],a[224:227]
v_exp_f32 v56, v56
M a[228:231],v[24:27],v[84:87],a[228:231]
v_exp_f32 v57, v57
M a[232:235],v[24:27],v[88:91],a[232:235]
TR v[20:21],v1,3584
CV v51,v70,v71
M a[236:239],v[24:27],v[92:95],a[236:239]
WL 3
TR v[22:23],v1,11776
v_add_f32 v8, v8, v72
M a[240:243],v[12:15],v[76:79],a[240:243]
v_exp_f32 v58, v58
M a[244:247],v[12:15],v[80:83],a[244:247]
v_exp_f32 v59, v59
M a[248:251],v[12:15],v[84:87],a[248:251]
v_add_f32 v8, v8, v73
v_add_f32 v8, v8, v74
M a[252:255],v[12:15],v[88:91],a[252:255]
TR v[24:25],v9,3584
v_add_f32 v8, v8, v75
M v[192:195],v[12:15],v[92:95],v[192:195]
WL 3
TR v[26:27],v9,11776
CV v54,v72,v73
M v[196:199],v[16:19],v[76:79],v[196:199]
CV v55,v74,v75
v_add_u32 v1, s50, v1
M v[200:203],v[16:19],v[80:83],v[200:203]
WV 20
v_add_f32 v4, v4, v56
v_add_u32 v9, s50, v9
M v[204:207],v[16:19],v[84:87],v[204:207]
s_barrier
v_exp_f32 v60, v60
M v[208:211],v[16:19],v[88:91],v[208:211]
RD v[12:15],v0,0
v_add_f32 v4, v4, v57
M v[212:215],v[16:19],v[92:95],v[212:215]
WL 3
v_exp_f32 v61, v61
M v[216:219],v[20:23],v[76:79],v[216:219]
RD v[28:31],v2,0
v_add_f32 v4, v4, v58
M v[220:223],v[20:23],v[80:83],v[220:223]
RD v[32:35],v2,8192
v_add_f32 v4, v4, v59
M v[224:227],v[20:23],v[84:87],v[224:227]
v_exp_f32 v62, v62
M v[228:231],v[20:23],v[88:91],v[228:231]
RD v[16:19],v0,8192
CV v38,v56,v57
M v[232:235],v[20:23],v[92:95],v[232:235]
WL 4
v_exp_f32 v63, v63
M v[236:239],v[24:27],v[76:79],v[236:239]
v_exp_f32 v64, v64
M v[240:243],v[24:27],v[80:83],v[240:243]
v_exp_f32 v65, v65
M v[244:247],v[24:27],v[84:87],v[244:247]
v_exp_f32 v66, v66
M v[248:251],v[24:27],v[88:91],v[248:251]
RD v[20:23],v0,512
CV v39,v58,v59
M v[252:255],v[24:27],v[92:95],v[252:255]
WL 4
v_exp_f32 v67, v67
M v[76:79],v[12:15],v[96:99],0
v_add_f32 v5, v5, v60
v_add_f32 v5, v5, v61
M v[80:83],v[12:15],v[128:131],0
v_add_f32 v5, v5, v62
v_add_f32 v5, v5, v63
M v[84:87],v[12:15],v[160:163],0
WL 3
CV v42,v60,v61
CV v43,v62,v63
M v[88:91],v[12:15],v[28:31],0
WL 2
RD v[24:27],v0,8704
v_add_f32 v6, v6, v64
M v[92:95],v[12:15],v[32:35],0
WL 2
v_add_f32 v6, v6, v65
v_add_f32 v6, v6, v66
M v[68:71],v[16:19],v[28:31],0
RD v[28:31],v2,1024
v_add_f32 v6, v6, v67
M v[72:75],v[16:19],v[32:35],0
RD v[32:35],v2,9216
CV v46,v64,v65
M v[56:59],v[16:19],v[96:99],0
CV v47,v66,v67
M v[60:63],v[16:19],v[128:131],0
s_add_u32 m0, s61, 0
RD v[12:15],v0,1024
M v[64:67],v[16:19],v[160:163],0
WL 4
buffer_load_dwordx4 v3, s[16:19], s42 offen offset:0 nt lds
M v[76:79],v[20:23],v[100:103],v[76:79]
M v[80:83],v[20:23],v[132:135],v[80:83]
M v[84:87],v[20:23],v[164:167],v[84:87]
WL 2
M v[88:91],v[20:23],v[28:31],v[88:91]
WL 1
RD v[16:19],v0,9216
M v[92:95],v[20:23],v[32:35],v[92:95]
M v[68:71],v[24:27],v[28:31],v[68:71]
s_sub_u32 s50, s45, s44
RD v[28:31],v2,2048
M v[72:75],v[24:27],v[32:35],v[72:75]
RD v[32:35],v2,10240
M v[56:59],v[24:27],v[100:103],v[56:59]
M v[60:63],v[24:27],v[132:135],v[60:63]
RD v[20:23],v0,1536
M v[64:67],v[24:27],v[164:167],v[64:67]
WL 4
M v[76:79],v[12:15],v[104:107],v[76:79]
M v[80:83],v[12:15],v[136:139],v[80:83]
M v[84:87],v[12:15],v[168:171],v[84:87]
WL 2
M v[88:91],v[12:15],v[28:31],v[88:91]
WL 1
RD v[24:27],v0,9728
M v[92:95],v[12:15],v[32:35],v[92:95]
M v[68:71],v[16:19],v[28:31],v[68:71]
RD v[28:31],v2,3072
M v[72:75],v[16:19],v[32:35],v[72:75]
s_add_u32 m0, s61, 896
RD v[32:35],v2,11264
M v[56:59],v[16:19],v[104:107],v[56:59]
buffer_load_dwordx4 v3, s[16:19], s42 offen offset:128 nt lds
M v[60:63],v[16:19],v[136:139],v[60:63]
RD v[12:15],v0,2048
M v[64:67],v[16:19],v[168:171],v[64:67]
WL 4
M v[76:79],v[20:23],v[108:111],v[76:79]
M v[80:83],v[20:23],v[140:143],v[80:83]
M v[84:87],v[20:23],v[172:175],v[84:87]
WL 2
M v[88:91],v[20:23],v[28:31],v[88:91]
WL 1
RD v[16:19],v0,10240
M v[92:95],v[20:23],v[32:35],v[92:95]
M v[68:71],v[24:27],v[28:31],v[68:71]
RD v[28:31],v2,4096
M v[72:75],v[24:27],v[32:35],v[72:75]
RD v[32:35],v2,12288
M v[56:59],v[24:27],v[108:111],v[56:59]
M v[60:63],v[24:27],v[140:143],v[60:63]
s_add_u32 m0, s61, 1792
RD v[20:23],v0,2560
M v[64:67],v[24:27],v[172:175],v[64:67]
WL 4
buffer_load_dwordx4 v3, s[16:19], s42 offen offset:256 nt lds
M v[76:79],v[12:15],v[112:115],v[76:79]
M v[80:83],v[12:15],v[144:147],v[80:83]
M v[84:87],v[12:15],v[176:179],v[84:87]
WL 2
M v[88:91],v[12:15],v[28:31],v[88:91]
WL 1
RD v[24:27],v0,10752
M v[92:95],v[12:15],v[32:35],v[92:95]
M v[68:71],v[16:19],v[28:31],v[68:71]
RD v[28:31],v2,5120
M v[72:75],v[16:19],v[32:35],v[72:75]
RD v[32:35],v2,13312
M v[56:59],v[16:19],v[112:115],v[56:59]
M v[60:63],v[16:19],v[144:147],v[60:63]
RD v[12:15],v0,3072
M v[64:67],v[16:19],v[176:179],v[64:67]
WL 4
M v[76:79],v[20:23],v[116:119],v[76:79]
M v[80:83],v[20:23],v[148:151],v[80:83]
M v[84:87],v[20:23],v[180:183],v[84:87]
WL 2
M v[88:91],v[20:23],v[28:31],v[88:91]
WL 1
RD v[16:19],v0,11264
M v[92:95],v[20:23],v[32:35],v[92:95]
M v[68:71],v[24:27],v[28:31],v[68:71]
RD v[28:31],v2,6144
M v[72:75],v[24:27],v[32:35],v[72:75]
s_add_u32 m0, s61, 2688
RD v[32:35],v2,14336
M v[56:59],v[24:27],v[116:119],v[56:59]
buffer_load_dwordx4 v3, s[16:19], s42 offen offset:384 nt lds
s_add_u32 s42, s42, 16384
M v[60:63],v[24:27],v[148:151],v[60:63]
s_mov_b32 s51, s44
RD v[20:23],v0,3584
M v[64:67],v[24:27],v[180:183],v[64:67]
WL 4
M v[76:79],v[12:15],v[120:123],v[76:79]
s_mov_b32 s44, s45
M v[80:83],v[12:15],v[152:155],v[80:83]
s_mov_b32 s45, s46
M v[84:87],v[12:15],v[184:187],v[84:87]
WL 2
M v[88:91],v[12:15],v[28:31],v[88:91]
WL 1
RD v[24:27],v0,11776
M v[92:95],v[12:15],v[32:35],v[92:95]
M v[68:71],v[16:19],v[28:31],v[68:71]
s_mov_b32 s46, s61
RD v[28:31],v2,7168
v_add_u32 v0, s50, v0
M v[72:75],v[16:19],v[32:35],v[72:75]
WV 12
RD v[32:35],v2,15360
M v[56:59],v[16:19],v[120:123],v[56:59]
s_barrier
M v[60:63],v[16:19],v[152:155],v[60:63]
s_mov_b32 s61, s51
TR v[12:13],v1,0
M v[64:67],v[16:19],v[184:187],v[64:67]
WL 4
TR v[14:15],v1,8192
M v[76:79],v[20:23],v[124:127],v[76:79]
s_add_u32 m0, s49, 0
M v[80:83],v[20:23],v[156:159],v[80:83]
buffer_load_dwordx4 v3, s[20:23], s43 offen offset:0 nt lds
M v[84:87],v[20:23],v[188:191],v[84:87]
WL 3
M v[88:91],v[20:23],v[28:31],v[88:91]
WL 2
TR v[16:17],v9,0
M v[92:95],v[20:23],v[32:35],v[92:95]
TR v[18:19],v9,8192
M v[68:71],v[24:27],v[28:31],v[68:71]
s_add_u32 m0, s49, 896
M v[72:75],v[24:27],v[32:35],v[72:75]
buffer_load_dwordx4 v3, s[20:23], s43 offen offset:128 nt lds
M v[56:59],v[24:27],v[124:127],v[56:59]
v_exp_f32 v76, v76
M v[60:63],v[24:27],v[156:159],v[60:63]
TR v[20:21],v1,512
v_add_f32 v4, v4, v76
M v[64:67],v[24:27],v[188:191],v[64:67]
WL 3
TR v[22:23],v1,8704
M a[0:3],v[12:15],v[36:39],a[0:3]
v_exp_f32 v77, v77
M a[4:7],v[12:15],v[40:43],a[4:7]
s_add_u32 m0, s49, 1792
v_exp_f32 v78, v78
M a[8:11],v[12:15],v[44:47],a[8:11]
buffer_load_dwordx4 v3, s[20:23], s43 offen offset:256 nt lds
v_add_f32 v4, v4, v77
M a[12:15],v[12:15],v[48:51],a[12:15]
TR v[24:25],v9,512
v_add_f32 v4, v4, v78
M a[16:19],v[12:15],v[52:55],a[16:19]
WL 3
TR v[26:27],v9,8704
CV v76,v76,v77
M a[20:23],v[16:19],v[36:39],a[20:23]
v_exp_f32 v79, v79
M a[24:27],v[16:19],v[40:43],a[24:27]
v_exp_f32 v80, v80
M a[28:31],v[16:19],v[44:47],a[28:31]
v_exp_f32 v81, v81
M a[32:35],v[16:19],v[48:51],a[32:35]
TR v[12:13],v1,1024
v_add_f32 v4, v4, v79
M a[36:39],v[16:19],v[52:55],a[36:39]
WL 3
TR v[14:15],v1,9216
CV v77,v78,v79
M a[40:43],v[20:23],v[36:39],a[40:43]
s_add_u32 m0, s49, 2688
v_exp_f32 v82, v82
M a[44:47],v[20:23],v[40:43],a[44:47]
s_sub_u32 s50, s48, s47
buffer_load_dwordx4 v3, s[20:23], s43 offen offset:384 nt lds
v_add_f32 v5, v5, v80
s_add_u32 s43, s43, 16384
M a[48:51],v[20:23],v[44:47],a[48:51]
s_mov_b32 s51, s47
v_exp_f32 v83, v83
M a[52:55],v[20:23],v[48:51],a[52:55]
s_mov_b32 s47, s48
TR v[16:17],v9,1024
v_add_f32 v5, v5, v81
M a[56:59],v[20:23],v[52:55],a[56:59]
WL 3
TR v[18:19],v9,9216
v_add_f32 v5, v5, v82
M a[60:63],v[24:27],v[36:39],a[60:63]
s_mov_b32 s48, s49
v_exp_f32 v84, v84
M a[64:67],v[24:27],v[40:43],a[64:67]
s_mov_b32 s49, s51
v_exp_f32 v85, v85
M a[68:71],v[24:27],v[44:47],a[68:71]
v_exp_f32 v86, v86
M a[72:75],v[24:27],v[48:51],a[72:75]
TR v[20:21],v1,1536
v_add_f32 v5, v5, v83
M a[76:79],v[24:27],v[52:55],a[76:79]
WL 3
TR v[22:23],v1,9728
CV v80,v80,v81
M a[80:83],v[12:15],v[36:39],a[80:83]
v_exp_f32 v87, v87
M a[84:87],v[12:15],v[40:43],a[84:87]
v_exp_f32 v88, v88
M a[88:91],v[12:15],v[44:47],a[88:91]
v_exp_f32 v89, v89
M a[92:95],v[12:15],v[48:51],a[92:95]
TR v[24:25],v9,1536
CV v81,v82,v83
M a[96:99],v[12:15],v[52:55],a[96:99]
WL 3
TR v[26:27],v9,9728
v_add_f32 v6, v6, v84
M a[100:103],v[16:19],v[36:39],a[100:103]
v_exp_f32 v90, v90
M a[104:107],v[16:19],v[40:43],a[104:107]
v_exp_f32 v91, v91
M a[108:111],v[16:19],v[44:47],a[108:111]
v_add_f32 v6, v6, v85
v_add_f32 v6, v6, v86
M a[112:115],v[16:19],v[48:51],a[112:115]
TR v[12:13],v1,2048
v_add_f32 v6, v6, v87
M a[116:119],v[16:19],v[52:55],a[116:119]
WL 3
TR v[14:15],v1,10240
CV v84,v84,v85
M a[120:123],v[20:23],v[36:39],a[120:123]
v_exp_f32 v92, v92
M a[124:127],v[20:23],v[40:43],a[124:127]
v_exp_f32 v93, v93
M a[128:131],v[20:23],v[44:47],a[128:131]
v_exp_f32 v94, v94
M a[132:135],v[20:23],v[48:51],a[132:135]
TR v[16:17],v9,2048
CV v85,v86,v87
M a[136:139],v[20:23],v[52:55],a[136:139]
WL 3
TR v[18:19],v9,10240
v_add_f32 v7, v7, v88
M a[140:143],v[24:27],v[36:39],a[140:143]
v_exp_f32 v95, v95
M a[144:147],v[24:27],v[40:43],a[144:147]
v_add_f32 v7, v7, v89
v_add_f32 v7, v7, v90
M a[148:151],v[24:27],v[44:47],a[148:151]
v_add_f32 v7, v7, v91
CV v88,v88,v89
M a[152:155],v[24:27],v[48:51],a[152:155]
TR v[20:21],v1,2560
CV v89,v90,v91
M a[156:159],v[24:27],v[52:55],a[156:159]
WL 3
TR v[22:23],v1,10752
v_add_f32 v8, v8, v92
M a[160:163],v[12:15],v[36:39],a[160:163]
v_exp_f32 v68, v68
M a[164:167],v[12:15],v[40:43],a[164:167]
v_exp_f32 v69, v69
M a[168:171],v[12:15],v[44:47],a[168:171]
v_exp_f32 v70, v70
M a[172:175],v[12:15],v[48:51],a[172:175]
TR v[24:25],v9,2560
v_add_f32 v8, v8, v93
M a[176:179],v[12:15],v[52:55],a[176:179]
WL 3
TR v[26:27],v9,10752
v_add_f32 v8, v8, v94
M a[180:183],v[16:19],v[36:39],a[180:183]
v_exp_f32 v71, v71
M a[184:187],v[16:19],v[40:43],a[184:187]
v_add_f32 v8, v8, v95
CV v92,v92,v93
M a[188:191],v[16:19],v[44:47],a[188:191]
v_exp_f32 v72, v72
M a[192:195],v[16:19],v[48:51],a[192:195]
TR v[12:13],v1,3072
CV v93,v94,v95
M a[196:199],v[16:19],v[52:55],a[196:199]
WL 3
TR v[14:15],v1,11264
v_add_f32 v7, v7, v68
M a[200:203],v[20:23],v[36:39],a[200:203]
v_exp_f32 v73, v73
M a[204:207],v[20:23],v[40:43],a[204:207]
v_exp_f32 v74, v74
M a[208:211],v[20:23],v[44:47],a[208:211]
v_exp_f32 v75, v75
M a[212:215],v[20:23],v[48:51],a[212:215]
TR v[16:17],v9,3072
v_add_f32 v7, v7, v69
M a[216:219],v[20:23],v[52:55],a[216:219]
WL 3
TR v[18:19],v9,11264
v_add_f32 v7, v7, v70
M a[220:223],v[24:27],v[36:39],a[220:223]
v_add_f32 v7, v7, v71
CV v90,v68,v69
M a[224:227],v[24:27],v[40:43],a[224:227]
v_exp_f32 v56, v56
M a[228:231],v[24:27],v[44:47],a[228:231]
v_exp_f32 v57, v57
M a[232:235],v[24:27],v[48:51],a[232:235]
TR v[20:21],v1,3584
CV v91,v70,v71
M a[236:239],v[24:27],v[52:55],a[236:239]
WL 3
TR v[22:23],v1,11776
v_add_f32 v8, v8, v72
M a[240:243],v[12:15],v[36:39],a[240:243]
v_exp_f32 v58, v58
M a[244:247],v[12:15],v[40:43],a[244:247]
v_exp_f32 v59, v59
M a[248:251],v[12:15],v[44:47],a[248:251]
v_add_f32 v8, v8, v73
v_add_f32 v8, v8, v74
M a[252:255],v[12:15],v[48:51],a[252:255]
TR v[24:25],v9,3584
v_add_f32 v8, v8, v75
M v[192:195],v[12:15],v[52:55],v[192:195]
WL 3
TR v[26:27],v9,11776
CV v94,v72,v73
M v[196:199],v[16:19],v[36:39],v[196:199]
CV v95,v74,v75
v_add_u32 v1, s50, v1
M v[200:203],v[16:19],v[40:43],v[200:203]
WV 20
v_add_f32 v4, v4, v56
v_add_u32 v9, s50, v9
M v[204:207],v[16:19],v[44:47],v[204:207]
s_barrier
v_exp_f32 v60, v60
M v[208:211],v[16:19],v[48:51],v[208:211]
RD v[12:15],v0,0
v_add_f32 v4, v4, v57
M v[212:215],v[16:19],v[52:55],v[212:215]
WL 3
v_exp_f32 v61, v61
M v[216:219],v[20:23],v[36:39],v[216:219]
RD v[28:31],v2,0
v_add_f32 v4, v4, v58
M v[220:223],v[20:23],v[40:43],v[220:223]
RD v[32:35],v2,8192
v_add_f32 v4, v4, v59
M v[224:227],v[20:23],v[44:47],v[224:227]
v_exp_f32 v62, v62
M v[228:231],v[20:23],v[48:51],v[228:231]
RD v[16:19],v0,8192
CV v78,v56,v57
M v[232:235],v[20:23],v[52:55],v[232:235]
WL 4
v_exp_f32 v63, v63
M v[236:239],v[24:27],v[36:39],v[236:239]
v_exp_f32 v64, v64
M v[240:243],v[24:27],v[40:43],v[240:243]
v_exp_f32 v65, v65
M v[244:247],v[24:27],v[44:47],v[244:247]
v_exp_f32 v66, v66
M v[248:251],v[24:27],v[48:51],v[248:251]
RD v[20:23],v0,512
CV v79,v58,v59
s_sub_u32 s52, s52, 1
M v[252:255],v[24:27],v[52:55],v[252:255]
v_exp_f32 v67, v67
s_cmp_lg_u32 s52, 0
s_cbranch_scc1 L1_loop_5
s_branch L1_post_5
L1_v4:
s_add_u32 m0, s53, 0
s_nop 0
buffer_load_dwordx4 v4, s[12:15], s41 offen offset:0 lds
s_add_u32 m0, s53, 896
s_nop 0
buffer_load_dwordx4 v4, s[12:15], s41 offen offset:128 lds
s_add_u32 m0, s53, 1792
s_nop 0
buffer_load_dwordx4 v4, s[12:15], s41 offen offset:256 lds
s_add_u32 m0, s53, 2688
s_nop 0
buffer_load_dwordx4 v4, s[12:15], s41 offen offset:384 lds
s_add_u32 s41, s41, 262144
s_add_u32 m0, s62, 0
s_nop 0
buffer_load_dwordx4 v5, s[8:11], s36 offen lds
s_add_u32 m0, s62, 1024
s_nop 0
buffer_load_dwordx4 v6, s[8:11], s44 offen lds
s_add_u32 m0, s62, 2048
s_nop 0
buffer_load_dwordx4 v5, s[8:11], s37 offen lds
s_add_u32 m0, s62, 3072
s_nop 0
buffer_load_dwordx4 v6, s[8:11], s45 offen lds
s_add_u32 m0, s62, 4096
s_nop 0
buffer_load_dwordx4 v5, s[8:11], s38 offen lds
s_add_u32 m0, s62, 5120
s_nop 0
buffer_load_dwordx4 v6, s[8:11], s46 offen lds
s_add_u32 m0, s62, 6144
s_nop 0
buffer_load_dwordx4 v5, s[8:11], s39 offen lds
s_add_u32 m0, s62, 7168
s_nop 0
buffer_load_dwordx4 v6, s[8:11], s47 offen lds
s_lshl_b32 s6, s57, 4
s_add_u32 s6, s6, s56
s_lshl_b32 s6, s6, 19
s_add_u32 s16, s16, s6
s_addc_u32 s17, s17, 0
s_and_b32 s17, s17, 0xffff
s_mov_b32 s18, 524288
s_mov_b32 s19, 0x20000
s_add_u32 s20, s20, s6
s_addc_u32 s21, s21, 0
s_and_b32 s21, s21, 0xffff
s_mov_b32 s22, 524288
s_mov_b32 s23, 0x20000
s_lshl_b32 s6, s56, 3
s_add_u32 s7, s6, s57
s_mul_i32 s6, s7, 28672
s_add_u32 s24, s24, s6
s_addc_u32 s25, s25, 0
s_and_b32 s25, s25, 0xffff
s_mov_b32 s26, 28672
s_mov_b32 s27, 0x20000
s_mul_i32 s6, s58, 3670016
s_add_u32 s6, s6, 41943040
s_add_u32 s28, s28, s6
s_addc_u32 s29, s29, 0
s_and_b32 s29, s29, 0xffff
s_mov_b32 s30, 3670016
s_mov_b32 s31, 0x20000
s_lshl_b32 s6, s3, 7
s_add_u32 s6, s6, s7
s_mul_i32 s60, s6, 7168
s_lshl_b32 s6, s59, 2
s_add_u32 s6, s6, s3
s_mul_i32 s6, s6, 655360
s_add_u32 s32, s32, s6
s_addc_u32 s33, s33, 0
s_and_b32 s33, s33, 0xffff
s_mov_b32 s34, 655360
s_mov_b32 s35, 0x20000
s_mul_i32 s63, s56, 40960
s_add_u32 m0, s53, 16384
s_nop 0
buffer_load_dwordx4 v4, s[12:15], s41 offen offset:0 lds
s_add_u32 m0, s53, 17280
s_nop 0
buffer_load_dwordx4 v4, s[12:15], s41 offen offset:128 lds
s_add_u32 m0, s53, 18176
s_nop 0
buffer_load_dwordx4 v4, s[12:15], s41 offen offset:256 lds
s_add_u32 m0, s53, 19072
s_nop 0
buffer_load_dwordx4 v4, s[12:15], s41 offen offset:384 lds
s_add_u32 s41, s41, 262144
s_add_u32 m0, s62, 8192
v_add_u32 v5, 128, v5
v_add_u32 v6, 128, v6
s_nop 0
buffer_load_dwordx4 v5, s[8:11], s36 offen lds
s_add_u32 m0, s62, 9216
s_nop 0
buffer_load_dwordx4 v6, s[8:11], s44 offen lds
s_add_u32 m0, s62, 10240
s_nop 0
buffer_load_dwordx4 v5, s[8:11], s37 offen lds
s_add_u32 m0, s62, 11264
s_nop 0
buffer_load_dwordx4 v6, s[8:11], s45 offen lds
s_add_u32 m0, s62, 12288
s_nop 0
buffer_load_dwordx4 v5, s[8:11], s38 offen lds
s_add_u32 m0, s62, 13312
s_nop 0
buffer_load_dwordx4 v6, s[8:11], s46 offen lds
s_add_u32 m0, s62, 14336
s_nop 0
buffer_load_dwordx4 v5, s[8:11], s39 offen lds
s_add_u32 m0, s62, 15360
s_nop 0
buffer_load_dwordx4 v6, s[8:11], s47 offen lds
WV 12
s_barrier
TR v[12:13],v1,0
TR v[14:15],v1,8192
TR v[16:17],v1,8
TR v[18:19],v1,8200
TR v[20:21],v1,512
TR v[22:23],v1,8704
RD v[52:55],v7,0
RD v[68:71],v8,0
RD v[56:59],v7,2048
RD v[72:75],v8,2048
RD v[60:63],v7,4096
RD v[76:79],v8,4096
RD v[64:67],v7,6144
RD v[80:83],v8,6144
WL 7
M a[0:3],v[12:15],v[52:55],0
WL 5
M a[4:7],v[12:15],v[56:59],0
WL 3
s_add_u32 m0, s62, 0
v_add_u32 v5, 128, v5
v_add_u32 v6, 128, v6
s_nop 0
buffer_load_dwordx4 v5, s[8:11], s36 offen lds
M a[8:11],v[12:15],v[60:63],0
WL 1
TR v[24:25],v1,520
M a[12:15],v[12:15],v[64:67],0
TR v[26:27],v1,8712
M a[16:19],v[16:19],v[52:55],0
M a[20:23],v[16:19],v[56:59],0
s_add_u32 m0, s62, 1024
s_nop 0
buffer_load_dwordx4 v6, s[8:11], s44 offen lds
M a[24:27],v[16:19],v[60:63],0
TR v[12:13],v1,1024
M a[28:31],v[16:19],v[64:67],0
TR v[14:15],v1,9216
M a[32:35],v[20:23],v[52:55],0
M a[36:39],v[20:23],v[56:59],0
s_add_u32 m0, s62, 2048
s_nop 0
buffer_load_dwordx4 v5, s[8:11], s37 offen lds
M a[40:43],v[20:23],v[60:63],0
TR v[16:17],v1,1032
M a[44:47],v[20:23],v[64:67],0
WL 3
TR v[18:19],v1,9224
M a[48:51],v[24:27],v[52:55],0
M a[52:55],v[24:27],v[56:59],0
s_add_u32 m0, s62, 3072
s_nop 0
buffer_load_dwordx4 v6, s[8:11], s45 offen lds
M a[56:59],v[24:27],v[60:63],0
TR v[20:21],v1,1536
M a[60:63],v[24:27],v[64:67],0
WL 3
TR v[22:23],v1,9728
M a[64:67],v[12:15],v[52:55],0
M a[68:71],v[12:15],v[56:59],0
s_add_u32 m0, s62, 4096
s_nop 0
buffer_load_dwordx4 v5, s[8:11], s38 offen lds
M a[72:75],v[12:15],v[60:63],0
TR v[24:25],v1,1544
M a[76:79],v[12:15],v[64:67],0
WL 3
TR v[26:27],v1,9736
M a[80:83],v[16:19],v[52:55],0
M a[84:87],v[16:19],v[56:59],0
s_add_u32 m0, s62, 5120
s_nop 0
buffer_load_dwordx4 v6, s[8:11], s46 offen lds
M a[88:91],v[16:19],v[60:63],0
TR v[12:13],v1,2048
M a[92:95],v[16:19],v[64:67],0
WL 3
TR v[14:15],v1,10240
M a[96:99],v[20:23],v[52:55],0
M a[100:103],v[20:23],v[56:59],0
s_add_u32 m0, s62, 6144
s_nop 0
buffer_load_dwordx4 v5, s[8:11], s39 offen lds
M a[104:107],v[20:23],v[60:63],0
TR v[16:17],v1,2056
M a[108:111],v[20:23],v[64:67],0
WL 3
TR v[18:19],v1,10248
M a[112:115],v[24:27],v[52:55],0
M a[116:119],v[24:27],v[56:59],0
s_add_u32 m0, s62, 7168
s_nop 0
buffer_load_dwordx4 v6, s[8:11], s47 offen lds
M a[120:123],v[24:27],v[60:63],0
TR v[20:21],v1,2560
M a[124:127],v[24:27],v[64:67],0
WL 3
TR v[22:23],v1,10752
M a[128:131],v[12:15],v[52:55],0
M a[132:135],v[12:15],v[56:59],0
s_add_u32 m0, s53, 32768
s_nop 0
buffer_load_dwordx4 v4, s[12:15], s41 offen offset:0 lds
M a[136:139],v[12:15],v[60:63],0
TR v[24:25],v1,2568
M a[140:143],v[12:15],v[64:67],0
WL 3
TR v[26:27],v1,10760
M a[144:147],v[16:19],v[52:55],0
M a[148:151],v[16:19],v[56:59],0
s_add_u32 m0, s53, 33664
s_nop 0
buffer_load_dwordx4 v4, s[12:15], s41 offen offset:128 lds
M a[152:155],v[16:19],v[60:63],0
TR v[12:13],v1,3072
M a[156:159],v[16:19],v[64:67],0
WL 3
TR v[14:15],v1,11264
M a[160:163],v[20:23],v[52:55],0
M a[164:167],v[20:23],v[56:59],0
s_add_u32 m0, s53, 34560
s_nop 0
buffer_load_dwordx4 v4, s[12:15], s41 offen offset:256 lds
M a[168:171],v[20:23],v[60:63],0
TR v[16:17],v1,3080
M a[172:175],v[20:23],v[64:67],0
WL 3
TR v[18:19],v1,11272
M a[176:179],v[24:27],v[52:55],0
M a[180:183],v[24:27],v[56:59],0
s_add_u32 m0, s53, 35456
s_nop 0
buffer_load_dwordx4 v4, s[12:15], s41 offen offset:384 lds
s_add_u32 s41, s41, 262144
M a[184:187],v[24:27],v[60:63],0
TR v[20:21],v1,3584
M a[188:191],v[24:27],v[64:67],0
WL 3
TR v[22:23],v1,11776
M a[192:195],v[12:15],v[52:55],0
M a[196:199],v[12:15],v[56:59],0
M a[200:203],v[12:15],v[60:63],0
TR v[24:25],v1,3592
M a[204:207],v[12:15],v[64:67],0
WL 3
TR v[26:27],v1,11784
M a[208:211],v[16:19],v[52:55],0
WV 20
v_add_u32 v1, 0x4000, v1
M a[212:215],v[16:19],v[56:59],0
s_barrier
M a[216:219],v[16:19],v[60:63],0
TR v[12:13],v1,0
M a[220:223],v[16:19],v[64:67],0
WL 3
TR v[14:15],v1,8192
M a[224:227],v[20:23],v[52:55],0
M a[228:231],v[20:23],v[56:59],0
M a[232:235],v[20:23],v[60:63],0
TR v[16:17],v1,8
M a[236:239],v[20:23],v[64:67],0
WL 3
TR v[18:19],v1,8200
M a[240:243],v[24:27],v[52:55],0
M a[244:247],v[24:27],v[56:59],0
M a[248:251],v[24:27],v[60:63],0
TR v[20:21],v1,512
M a[252:255],v[24:27],v[64:67],0
WL 3
TR v[22:23],v1,8704
M a[0:3],v[12:15],v[68:71],a[0:3]
M a[4:7],v[12:15],v[72:75],a[4:7]
s_add_u32 m0, s53, 49152
s_nop 0
buffer_load_dwordx4 v4, s[12:15], s41 offen offset:0 lds
M a[8:11],v[12:15],v[76:79],a[8:11]
TR v[24:25],v1,520
M a[12:15],v[12:15],v[80:83],a[12:15]
WL 3
TR v[26:27],v1,8712
M a[16:19],v[16:19],v[68:71],a[16:19]
M a[20:23],v[16:19],v[72:75],a[20:23]
M a[24:27],v[16:19],v[76:79],a[24:27]
TR v[12:13],v1,1024
M a[28:31],v[16:19],v[80:83],a[28:31]
WL 3
TR v[14:15],v1,9216
M a[32:35],v[20:23],v[68:71],a[32:35]
M a[36:39],v[20:23],v[72:75],a[36:39]
M a[40:43],v[20:23],v[76:79],a[40:43]
TR v[16:17],v1,1032
M a[44:47],v[20:23],v[80:83],a[44:47]
WL 3
TR v[18:19],v1,9224
M a[48:51],v[24:27],v[68:71],a[48:51]
WV 19
M a[52:55],v[24:27],v[72:75],a[52:55]
s_add_u32 m0, s53, 50048
RD v[84:87],v7,8192
buffer_load_dwordx4 v4, s[12:15], s41 offen offset:128 lds
M a[56:59],v[24:27],v[76:79],a[56:59]
TR v[20:21],v1,1536
M a[60:63],v[24:27],v[80:83],a[60:63]
WL 4
TR v[22:23],v1,9728
M a[64:67],v[12:15],v[68:71],a[64:67]
RD v[100:103],v8,8192
M a[68:71],v[12:15],v[72:75],a[68:71]
M a[72:75],v[12:15],v[76:79],a[72:75]
TR v[24:25],v1,1544
M a[76:79],v[12:15],v[80:83],a[76:79]
WL 5
TR v[26:27],v1,9736
M a[80:83],v[16:19],v[68:71],a[80:83]
WV 18
M a[84:87],v[16:19],v[72:75],a[84:87]
RD v[88:91],v7,10240
M a[88:91],v[16:19],v[76:79],a[88:91]
TR v[12:13],v1,2048
M a[92:95],v[16:19],v[80:83],a[92:95]
WL 5
TR v[14:15],v1,10240
M a[96:99],v[20:23],v[68:71],a[96:99]
RD v[104:107],v8,10240
M a[100:103],v[20:23],v[72:75],a[100:103]
s_add_u32 m0, s53, 50944
s_nop 0
buffer_load_dwordx4 v4, s[12:15], s41 offen offset:256 lds
M a[104:107],v[20:23],v[76:79],a[104:107]
TR v[16:17],v1,2056
M a[108:111],v[20:23],v[80:83],a[108:111]
WL 5
TR v[18:19],v1,10248
M a[112:115],v[24:27],v[68:71],a[112:115]
WV 17
M a[116:119],v[24:27],v[72:75],a[116:119]
RD v[92:95],v7,12288
M a[120:123],v[24:27],v[76:79],a[120:123]
TR v[20:21],v1,2560
M a[124:127],v[24:27],v[80:83],a[124:127]
WL 5
TR v[22:23],v1,10752
M a[128:131],v[12:15],v[68:71],a[128:131]
RD v[108:111],v8,12288
M a[132:135],v[12:15],v[72:75],a[132:135]
M a[136:139],v[12:15],v[76:79],a[136:139]
TR v[24:25],v1,2568
M a[140:143],v[12:15],v[80:83],a[140:143]
WL 5
TR v[26:27],v1,10760
M a[144:147],v[16:19],v[68:71],a[144:147]
WV 15
M a[148:151],v[16:19],v[72:75],a[148:151]
s_add_u32 m0, s53, 51840
RD v[96:99],v7,14336
buffer_load_dwordx4 v4, s[12:15], s41 offen offset:384 lds
s_add_u32 s41, s41, 262144
M a[152:155],v[16:19],v[76:79],a[152:155]
TR v[12:13],v1,3072
M a[156:159],v[16:19],v[80:83],a[156:159]
WL 5
TR v[14:15],v1,11264
M a[160:163],v[20:23],v[68:71],a[160:163]
RD v[112:115],v8,14336
M a[164:167],v[20:23],v[72:75],a[164:167]
M a[168:171],v[20:23],v[76:79],a[168:171]
TR v[16:17],v1,3080
M a[172:175],v[20:23],v[80:83],a[172:175]
WL 5
TR v[18:19],v1,11272
M a[176:179],v[24:27],v[68:71],a[176:179]
M a[180:183],v[24:27],v[72:75],a[180:183]
M a[184:187],v[24:27],v[76:79],a[184:187]
TR v[20:21],v1,3584
M a[188:191],v[24:27],v[80:83],a[188:191]
WL 4
TR v[22:23],v1,11776
M a[192:195],v[12:15],v[68:71],a[192:195]
M a[196:199],v[12:15],v[72:75],a[196:199]
M a[200:203],v[12:15],v[76:79],a[200:203]
TR v[24:25],v1,3592
M a[204:207],v[12:15],v[80:83],a[204:207]
WL 3
TR v[26:27],v1,11784
M a[208:211],v[16:19],v[68:71],a[208:211]
WV 4
v_add_u32 v1, 0x4000, v1
M a[212:215],v[16:19],v[72:75],a[212:215]
s_barrier
M a[216:219],v[16:19],v[76:79],a[216:219]
TR v[12:13],v1,0
M a[220:223],v[16:19],v[80:83],a[220:223]
WL 3
TR v[14:15],v1,8192
M a[224:227],v[20:23],v[68:71],a[224:227]
M a[228:231],v[20:23],v[72:75],a[228:231]
M a[232:235],v[20:23],v[76:79],a[232:235]
TR v[16:17],v1,8
M a[236:239],v[20:23],v[80:83],a[236:239]
WL 3
TR v[18:19],v1,8200
M a[240:243],v[24:27],v[68:71],a[240:243]
M a[244:247],v[24:27],v[72:75],a[244:247]
M a[248:251],v[24:27],v[76:79],a[248:251]
TR v[20:21],v1,512
M a[252:255],v[24:27],v[80:83],a[252:255]
WL 3
TR v[22:23],v1,8704
M a[0:3],v[12:15],v[84:87],a[0:3]
M a[4:7],v[12:15],v[88:91],a[4:7]
s_add_u32 m0, s62, 8192
v_add_u32 v5, 128, v5
v_add_u32 v6, 128, v6
s_nop 0
buffer_load_dwordx4 v5, s[8:11], s36 offen lds
M a[8:11],v[12:15],v[92:95],a[8:11]
TR v[24:25],v1,520
M a[12:15],v[12:15],v[96:99],a[12:15]
WL 3
TR v[26:27],v1,8712
M a[16:19],v[16:19],v[84:87],a[16:19]
s_add_u32 m0, s62, 9216
s_nop 0
buffer_load_dwordx4 v6, s[8:11], s44 offen lds
M a[20:23],v[16:19],v[88:91],a[20:23]
M a[24:27],v[16:19],v[92:95],a[24:27]
s_add_u32 m0, s62, 10240
TR v[12:13],v1,1024
buffer_load_dwordx4 v5, s[8:11], s37 offen lds
M a[28:31],v[16:19],v[96:99],a[28:31]
WL 3
TR v[14:15],v1,9216
M a[32:35],v[20:23],v[84:87],a[32:35]
M a[36:39],v[20:23],v[88:91],a[36:39]
M a[40:43],v[20:23],v[92:95],a[40:43]
s_add_u32 m0, s62, 11264
TR v[16:17],v1,1032
buffer_load_dwordx4 v6, s[8:11], s45 offen lds
M a[44:47],v[20:23],v[96:99],a[44:47]
WL 3
TR v[18:19],v1,9224
M a[48:51],v[24:27],v[84:87],a[48:51]
M a[52:55],v[24:27],v[88:91],a[52:55]
s_add_u32 m0, s62, 12288
s_nop 0
buffer_load_dwordx4 v5, s[8:11], s38 offen lds
M a[56:59],v[24:27],v[92:95],a[56:59]
TR v[20:21],v1,1536
M a[60:63],v[24:27],v[96:99],a[60:63]
WL 3
TR v[22:23],v1,9728
M a[64:67],v[12:15],v[84:87],a[64:67]
s_add_u32 m0, s62, 13312
s_nop 0
buffer_load_dwordx4 v6, s[8:11], s46 offen lds
M a[68:71],v[12:15],v[88:91],a[68:71]
M a[72:75],v[12:15],v[92:95],a[72:75]
s_add_u32 m0, s62, 14336
TR v[24:25],v1,1544
buffer_load_dwordx4 v5, s[8:11], s39 offen lds
M a[76:79],v[12:15],v[96:99],a[76:79]
WL 3
TR v[26:27],v1,9736
M a[80:83],v[16:19],v[84:87],a[80:83]
M a[84:87],v[16:19],v[88:91],a[84:87]
M a[88:91],v[16:19],v[92:95],a[88:91]
s_add_u32 m0, s62, 15360
TR v[12:13],v1,2048
buffer_load_dwordx4 v6, s[8:11], s47 offen lds
M a[92:95],v[16:19],v[96:99],a[92:95]
WL 3
TR v[14:15],v1,10240
M a[96:99],v[20:23],v[84:87],a[96:99]
M a[100:103],v[20:23],v[88:91],a[100:103]
s_add_u32 m0, s53, 65536
s_nop 0
buffer_load_dwordx4 v4, s[12:15], s41 offen offset:0 lds
M a[104:107],v[20:23],v[92:95],a[104:107]
TR v[16:17],v1,2056
M a[108:111],v[20:23],v[96:99],a[108:111]
WL 3
TR v[18:19],v1,10248
M a[112:115],v[24:27],v[84:87],a[112:115]
s_add_u32 m0, s53, 66432
s_nop 0
buffer_load_dwordx4 v4, s[12:15], s41 offen offset:128 lds
M a[116:119],v[24:27],v[88:91],a[116:119]
M a[120:123],v[24:27],v[92:95],a[120:123]
s_add_u32 m0, s53, 67328
TR v[20:21],v1,2560
buffer_load_dwordx4 v4, s[12:15], s41 offen offset:256 lds
M a[124:127],v[24:27],v[96:99],a[124:127]
WL 3
TR v[22:23],v1,10752
M a[128:131],v[12:15],v[84:87],a[128:131]
M a[132:135],v[12:15],v[88:91],a[132:135]
M a[136:139],v[12:15],v[92:95],a[136:139]
s_add_u32 m0, s53, 68224
TR v[24:25],v1,2568
buffer_load_dwordx4 v4, s[12:15], s41 offen offset:384 lds
s_add_u32 s41, s41, 262144
M a[140:143],v[12:15],v[96:99],a[140:143]
WL 3
TR v[26:27],v1,10760
M a[144:147],v[16:19],v[84:87],a[144:147]
M a[148:151],v[16:19],v[88:91],a[148:151]
s_add_u32 m0, s53, 81920
s_nop 0
buffer_load_dwordx4 v4, s[12:15], s41 offen offset:0 lds
M a[152:155],v[16:19],v[92:95],a[152:155]
TR v[12:13],v1,3072
M a[156:159],v[16:19],v[96:99],a[156:159]
WL 3
TR v[14:15],v1,11264
M a[160:163],v[20:23],v[84:87],a[160:163]
s_add_u32 m0, s53, 82816
s_nop 0
buffer_load_dwordx4 v4, s[12:15], s41 offen offset:128 lds
M a[164:167],v[20:23],v[88:91],a[164:167]
M a[168:171],v[20:23],v[92:95],a[168:171]
s_add_u32 m0, s53, 83712
TR v[16:17],v1,3080
buffer_load_dwordx4 v4, s[12:15], s41 offen offset:256 lds
M a[172:175],v[20:23],v[96:99],a[172:175]
WL 3
TR v[18:19],v1,11272
M a[176:179],v[24:27],v[84:87],a[176:179]
M a[180:183],v[24:27],v[88:91],a[180:183]
M a[184:187],v[24:27],v[92:95],a[184:187]
s_add_u32 m0, s53, 84608
TR v[20:21],v1,3584
buffer_load_dwordx4 v4, s[12:15], s41 offen offset:384 lds
s_add_u32 s41, s41, 262144
M a[188:191],v[24:27],v[96:99],a[188:191]
WL 3
TR v[22:23],v1,11776
M a[192:195],v[12:15],v[84:87],a[192:195]
M a[196:199],v[12:15],v[88:91],a[196:199]
M a[200:203],v[12:15],v[92:95],a[200:203]
TR v[24:25],v1,3592
M a[204:207],v[12:15],v[96:99],a[204:207]
WL 3
TR v[26:27],v1,11784
M a[208:211],v[16:19],v[84:87],a[208:211]
WV 16
v_add_u32 v1, 0x4000, v1
M a[212:215],v[16:19],v[88:91],a[212:215]
s_barrier
M a[216:219],v[16:19],v[92:95],a[216:219]
TR v[12:13],v1,0
M a[220:223],v[16:19],v[96:99],a[220:223]
WL 3
TR v[14:15],v1,8192
M a[224:227],v[20:23],v[84:87],a[224:227]
M a[228:231],v[20:23],v[88:91],a[228:231]
M a[232:235],v[20:23],v[92:95],a[232:235]
TR v[16:17],v1,8
M a[236:239],v[20:23],v[96:99],a[236:239]
WL 3
TR v[18:19],v1,8200
M a[240:243],v[24:27],v[84:87],a[240:243]
M a[244:247],v[24:27],v[88:91],a[244:247]
M a[248:251],v[24:27],v[92:95],a[248:251]
TR v[20:21],v1,512
M a[252:255],v[24:27],v[96:99],a[252:255]
WL 3
TR v[22:23],v1,8704
M a[0:3],v[12:15],v[100:103],a[0:3]
M a[4:7],v[12:15],v[104:107],a[4:7]
s_add_u32 m0, s53, 0
s_nop 0
buffer_load_dwordx4 v4, s[12:15], s41 offen offset:0 lds
M a[8:11],v[12:15],v[108:111],a[8:11]
TR v[24:25],v1,520
M a[12:15],v[12:15],v[112:115],a[12:15]
WL 3
TR v[26:27],v1,8712
M a[16:19],v[16:19],v[100:103],a[16:19]
M a[20:23],v[16:19],v[104:107],a[20:23]
M a[24:27],v[16:19],v[108:111],a[24:27]
s_add_u32 m0, s53, 896
TR v[12:13],v1,1024
buffer_load_dwordx4 v4, s[12:15], s41 offen offset:128 lds
M a[28:31],v[16:19],v[112:115],a[28:31]
WL 3
TR v[14:15],v1,9216
M a[32:35],v[20:23],v[100:103],a[32:35]
M a[36:39],v[20:23],v[104:107],a[36:39]
M a[40:43],v[20:23],v[108:111],a[40:43]
TR v[16:17],v1,1032
M a[44:47],v[20:23],v[112:115],a[44:47]
WL 3
TR v[18:19],v1,9224
M a[48:51],v[24:27],v[100:103],a[48:51]
WV 32
M a[52:55],v[24:27],v[104:107],a[52:55]
s_add_u32 m0, s53, 1792
RD v[116:119],v7,0
buffer_load_dwordx4 v4, s[12:15], s41 offen offset:256 lds
M a[56:59],v[24:27],v[108:111],a[56:59]
TR v[20:21],v1,1536
M a[60:63],v[24:27],v[112:115],a[60:63]
WL 4
TR v[22:23],v1,9728
M a[64:67],v[12:15],v[100:103],a[64:67]
RD v[132:135],v8,0
M a[68:71],v[12:15],v[104:107],a[68:71]
M a[72:75],v[12:15],v[108:111],a[72:75]
s_add_u32 m0, s53, 2688
TR v[24:25],v1,1544
buffer_load_dwordx4 v4, s[12:15], s41 offen offset:384 lds
s_add_u32 s41, s41, 262144
M a[76:79],v[12:15],v[112:115],a[76:79]
WL 5
TR v[26:27],v1,9736
M a[80:83],v[16:19],v[100:103],a[80:83]
WV 32
M a[84:87],v[16:19],v[104:107],a[84:87]
RD v[120:123],v7,2048
M a[88:91],v[16:19],v[108:111],a[88:91]
TR v[12:13],v1,2048
M a[92:95],v[16:19],v[112:115],a[92:95]
WL 5
TR v[14:15],v1,10240
M a[96:99],v[20:23],v[100:103],a[96:99]
RD v[136:139],v8,2048
M a[100:103],v[20:23],v[104:107],a[100:103]
s_add_u32 m0, s53, 16384
s_nop 0
buffer_load_dwordx4 v4, s[12:15], s41 offen offset:0 lds
M a[104:107],v[20:23],v[108:111],a[104:107]
TR v[16:17],v1,2056
M a[108:111],v[20:23],v[112:115],a[108:111]
WL 5
TR v[18:19],v1,10248
M a[112:115],v[24:27],v[100:103],a[112:115]
WV 31
M a[116:119],v[24:27],v[104:107],a[116:119]
RD v[124:127],v7,4096
M a[120:123],v[24:27],v[108:111],a[120:123]
s_add_u32 m0, s53, 17280
TR v[20:21],v1,2560
buffer_load_dwordx4 v4, s[12:15], s41 offen offset:128 lds
M a[124:127],v[24:27],v[112:115],a[124:127]
WL 5
TR v[22:23],v1,10752
M a[128:131],v[12:15],v[100:103],a[128:131]
RD v[140:143],v8,4096
M a[132:135],v[12:15],v[104:107],a[132:135]
M a[136:139],v[12:15],v[108:111],a[136:139]
TR v[24:25],v1,2568
M a[140:143],v[12:15],v[112:115],a[140:143]
WL 5
TR v[26:27],v1,10760
M a[144:147],v[16:19],v[100:103],a[144:147]
WV 30
M a[148:151],v[16:19],v[104:107],a[148:151]
s_add_u32 m0, s53, 18176
RD v[128:131],v7,6144
buffer_load_dwordx4 v4, s[12:15], s41 offen offset:256 lds
M a[152:155],v[16:19],v[108:111],a[152:155]
TR v[12:13],v1,3072
M a[156:159],v[16:19],v[112:115],a[156:159]
WL 5
TR v[14:15],v1,11264
M a[160:163],v[20:23],v[100:103],a[160:163]
RD v[144:147],v8,6144
M a[164:167],v[20:23],v[104:107],a[164:167]
M a[168:171],v[20:23],v[108:111],a[168:171]
s_add_u32 m0, s53, 19072
TR v[16:17],v1,3080
buffer_load_dwordx4 v4, s[12:15], s41 offen offset:384 lds
s_add_u32 s41, s41, 262144
M a[172:175],v[20:23],v[112:115],a[172:175]
WL 5
TR v[18:19],v1,11272
M a[176:179],v[24:27],v[100:103],a[176:179]
M a[180:183],v[24:27],v[104:107],a[180:183]
M a[184:187],v[24:27],v[108:111],a[184:187]
TR v[20:21],v1,3584
M a[188:191],v[24:27],v[112:115],a[188:191]
WL 4
TR v[22:23],v1,11776
M a[192:195],v[12:15],v[100:103],a[192:195]
M a[196:199],v[12:15],v[104:107],a[196:199]
M a[200:203],v[12:15],v[108:111],a[200:203]
TR v[24:25],v1,3592
M a[204:207],v[12:15],v[112:115],a[204:207]
WL 3
TR v[26:27],v1,11784
M a[208:211],v[16:19],v[100:103],a[208:211]
WV 12
v_add_u32 v1, 0x4000, v1
M a[212:215],v[16:19],v[104:107],a[212:215]
s_barrier
M a[216:219],v[16:19],v[108:111],a[216:219]
TR v[12:13],v1,0
M a[220:223],v[16:19],v[112:115],a[220:223]
WL 3
TR v[14:15],v1,8192
M a[224:227],v[20:23],v[100:103],a[224:227]
M a[228:231],v[20:23],v[104:107],a[228:231]
M a[232:235],v[20:23],v[108:111],a[232:235]
TR v[16:17],v1,8
M a[236:239],v[20:23],v[112:115],a[236:239]
WL 3
TR v[18:19],v1,8200
M a[240:243],v[24:27],v[100:103],a[240:243]
M a[244:247],v[24:27],v[104:107],a[244:247]
M a[248:251],v[24:27],v[108:111],a[248:251]
TR v[20:21],v1,512
M a[252:255],v[24:27],v[112:115],a[252:255]
WL 3
TR v[22:23],v1,8704
M a[0:3],v[12:15],v[116:119],a[0:3]
M a[4:7],v[12:15],v[120:123],a[4:7]
s_add_u32 m0, s62, 0
v_add_u32 v5, 128, v5
v_add_u32 v6, 128, v6
s_nop 0
buffer_load_dwordx4 v5, s[8:11], s36 offen lds
M a[8:11],v[12:15],v[124:127],a[8:11]
TR v[24:25],v1,520
M a[12:15],v[12:15],v[128:131],a[12:15]
WL 3
TR v[26:27],v1,8712
M a[16:19],v[16:19],v[116:119],a[16:19]
M a[20:23],v[16:19],v[120:123],a[20:23]
s_add_u32 m0, s62, 1024
s_nop 0
buffer_load_dwordx4 v6, s[8:11], s44 offen lds
M a[24:27],v[16:19],v[124:127],a[24:27]
TR v[12:13],v1,1024
M a[28:31],v[16:19],v[128:131],a[28:31]
WL 3
TR v[14:15],v1,9216
M a[32:35],v[20:23],v[116:119],a[32:35]
M a[36:39],v[20:23],v[120:123],a[36:39]
s_add_u32 m0, s62, 2048
s_nop 0
buffer_load_dwordx4 v5, s[8:11], s37 offen lds
M a[40:43],v[20:23],v[124:127],a[40:43]
TR v[16:17],v1,1032
M a[44:47],v[20:23],v[128:131],a[44:47]
WL 3
TR v[18:19],v1,9224
M a[48:51],v[24:27],v[116:119],a[48:51]
M a[52:55],v[24:27],v[120:123],a[52:55]
s_add_u32 m0, s62, 3072
s_nop 0
buffer_load_dwordx4 v6, s[8:11], s45 offen lds
M a[56:59],v[24:27],v[124:127],a[56:59]
TR v[20:21],v1,1536
M a[60:63],v[24:27],v[128:131],a[60:63]
WL 3
TR v[22:23],v1,9728
M a[64:67],v[12:15],v[116:119],a[64:67]
M a[68:71],v[12:15],v[120:123],a[68:71]
s_add_u32 m0, s62, 4096
s_nop 0
buffer_load_dwordx4 v5, s[8:11], s38 offen lds
M a[72:75],v[12:15],v[124:127],a[72:75]
TR v[24:25],v1,1544
M a[76:79],v[12:15],v[128:131],a[76:79]
WL 3
TR v[26:27],v1,9736
M a[80:83],v[16:19],v[116:119],a[80:83]
M a[84:87],v[16:19],v[120:123],a[84:87]
s_add_u32 m0, s62, 5120
s_nop 0
buffer_load_dwordx4 v6, s[8:11], s46 offen lds
M a[88:91],v[16:19],v[124:127],a[88:91]
TR v[12:13],v1,2048
M a[92:95],v[16:19],v[128:131],a[92:95]
WL 3
TR v[14:15],v1,10240
M a[96:99],v[20:23],v[116:119],a[96:99]
M a[100:103],v[20:23],v[120:123],a[100:103]
s_add_u32 m0, s62, 6144
s_nop 0
buffer_load_dwordx4 v5, s[8:11], s39 offen lds
M a[104:107],v[20:23],v[124:127],a[104:107]
TR v[16:17],v1,2056
M a[108:111],v[20:23],v[128:131],a[108:111]
WL 3
TR v[18:19],v1,10248
M a[112:115],v[24:27],v[116:119],a[112:115]
M a[116:119],v[24:27],v[120:123],a[116:119]
s_add_u32 m0, s62, 7168
s_nop 0
buffer_load_dwordx4 v6, s[8:11], s47 offen lds
M a[120:123],v[24:27],v[124:127],a[120:123]
TR v[20:21],v1,2560
M a[124:127],v[24:27],v[128:131],a[124:127]
WL 3
TR v[22:23],v1,10752
M a[128:131],v[12:15],v[116:119],a[128:131]
M a[132:135],v[12:15],v[120:123],a[132:135]
s_add_u32 m0, s53, 32768
s_nop 0
buffer_load_dwordx4 v4, s[12:15], s41 offen offset:0 lds
M a[136:139],v[12:15],v[124:127],a[136:139]
TR v[24:25],v1,2568
M a[140:143],v[12:15],v[128:131],a[140:143]
WL 3
TR v[26:27],v1,10760
M a[144:147],v[16:19],v[116:119],a[144:147]
M a[148:151],v[16:19],v[120:123],a[148:151]
s_add_u32 m0, s53, 33664
s_nop 0
buffer_load_dwordx4 v4, s[12:15], s41 offen offset:128 lds
M a[152:155],v[16:19],v[124:127],a[152:155]
TR v[12:13],v1,3072
M a[156:159],v[16:19],v[128:131],a[156:159]
WL 3
TR v[14:15],v1,11264
M a[160:163],v[20:23],v[116:119],a[160:163]
M a[164:167],v[20:23],v[120:123],a[164:167]
s_add_u32 m0, s53, 34560
s_nop 0
buffer_load_dwordx4 v4, s[12:15], s41 offen offset:256 lds
M a[168:171],v[20:23],v[124:127],a[168:171]
TR v[16:17],v1,3080
M a[172:175],v[20:23],v[128:131],a[172:175]
WL 3
TR v[18:19],v1,11272
M a[176:179],v[24:27],v[116:119],a[176:179]
M a[180:183],v[24:27],v[120:123],a[180:183]
s_add_u32 m0, s53, 35456
s_nop 0
buffer_load_dwordx4 v4, s[12:15], s41 offen offset:384 lds
s_add_u32 s41, s41, 262144
M a[184:187],v[24:27],v[124:127],a[184:187]
TR v[20:21],v1,3584
M a[188:191],v[24:27],v[128:131],a[188:191]
WL 3
TR v[22:23],v1,11776
M a[192:195],v[12:15],v[116:119],a[192:195]
M a[196:199],v[12:15],v[120:123],a[196:199]
M a[200:203],v[12:15],v[124:127],a[200:203]
TR v[24:25],v1,3592
M a[204:207],v[12:15],v[128:131],a[204:207]
WL 3
TR v[26:27],v1,11784
M a[208:211],v[16:19],v[116:119],a[208:211]
WV 20
v_add_u32 v1, 0x4000, v1
M a[212:215],v[16:19],v[120:123],a[212:215]
s_barrier
M a[216:219],v[16:19],v[124:127],a[216:219]
TR v[12:13],v1,0
M a[220:223],v[16:19],v[128:131],a[220:223]
WL 3
TR v[14:15],v1,8192
M a[224:227],v[20:23],v[116:119],a[224:227]
M a[228:231],v[20:23],v[120:123],a[228:231]
M a[232:235],v[20:23],v[124:127],a[232:235]
TR v[16:17],v1,8
M a[236:239],v[20:23],v[128:131],a[236:239]
WL 3
TR v[18:19],v1,8200
M a[240:243],v[24:27],v[116:119],a[240:243]
M a[244:247],v[24:27],v[120:123],a[244:247]
M a[248:251],v[24:27],v[124:127],a[248:251]
TR v[20:21],v1,512
M a[252:255],v[24:27],v[128:131],a[252:255]
WL 3
TR v[22:23],v1,8704
M a[0:3],v[12:15],v[132:135],a[0:3]
M a[4:7],v[12:15],v[136:139],a[4:7]
s_add_u32 m0, s53, 49152
s_nop 0
buffer_load_dwordx4 v4, s[12:15], s41 offen offset:0 lds
M a[8:11],v[12:15],v[140:143],a[8:11]
TR v[24:25],v1,520
M a[12:15],v[12:15],v[144:147],a[12:15]
WL 3
TR v[26:27],v1,8712
M a[16:19],v[16:19],v[132:135],a[16:19]
M a[20:23],v[16:19],v[136:139],a[20:23]
M a[24:27],v[16:19],v[140:143],a[24:27]
TR v[12:13],v1,1024
M a[28:31],v[16:19],v[144:147],a[28:31]
WL 3
TR v[14:15],v1,9216
M a[32:35],v[20:23],v[132:135],a[32:35]
M a[36:39],v[20:23],v[136:139],a[36:39]
M a[40:43],v[20:23],v[140:143],a[40:43]
TR v[16:17],v1,1032
M a[44:47],v[20:23],v[144:147],a[44:47]
WL 3
TR v[18:19],v1,9224
M a[48:51],v[24:27],v[132:135],a[48:51]
WV 35
M a[52:55],v[24:27],v[136:139],a[52:55]
s_add_u32 m0, s53, 50048
RD v[36:39],v7,8192
buffer_load_dwordx4 v4, s[12:15], s41 offen offset:128 lds
M a[56:59],v[24:27],v[140:143],a[56:59]
TR v[20:21],v1,1536
M a[60:63],v[24:27],v[144:147],a[60:63]
WL 4
TR v[22:23],v1,9728
M a[64:67],v[12:15],v[132:135],a[64:67]
RD v[52:55],v8,8192
M a[68:71],v[12:15],v[136:139],a[68:71]
M a[72:75],v[12:15],v[140:143],a[72:75]
TR v[24:25],v1,1544
M a[76:79],v[12:15],v[144:147],a[76:79]
WL 5
TR v[26:27],v1,9736
M a[80:83],v[16:19],v[132:135],a[80:83]
WV 34
M a[84:87],v[16:19],v[136:139],a[84:87]
RD v[40:43],v7,10240
M a[88:91],v[16:19],v[140:143],a[88:91]
TR v[12:13],v1,2048
M a[92:95],v[16:19],v[144:147],a[92:95]
WL 5
TR v[14:15],v1,10240
M a[96:99],v[20:23],v[132:135],a[96:99]
RD v[56:59],v8,10240
M a[100:103],v[20:23],v[136:139],a[100:103]
s_add_u32 m0, s53, 50944
s_nop 0
buffer_load_dwordx4 v4, s[12:15], s41 offen offset:256 lds
M a[104:107],v[20:23],v[140:143],a[104:107]
TR v[16:17],v1,2056
M a[108:111],v[20:23],v[144:147],a[108:111]
WL 5
TR v[18:19],v1,10248
M a[112:115],v[24:27],v[132:135],a[112:115]
WV 33
M a[116:119],v[24:27],v[136:139],a[116:119]
RD v[44:47],v7,12288
M a[120:123],v[24:27],v[140:143],a[120:123]
TR v[20:21],v1,2560
M a[124:127],v[24:27],v[144:147],a[124:127]
WL 5
TR v[22:23],v1,10752
M a[128:131],v[12:15],v[132:135],a[128:131]
RD v[60:63],v8,12288
M a[132:135],v[12:15],v[136:139],a[132:135]
M a[136:139],v[12:15],v[140:143],a[136:139]
TR v[24:25],v1,2568
M a[140:143],v[12:15],v[144:147],a[140:143]
WL 5
TR v[26:27],v1,10760
M a[144:147],v[16:19],v[132:135],a[144:147]
WV 31
M a[148:151],v[16:19],v[136:139],a[148:151]
s_add_u32 m0, s53, 51840
RD v[48:51],v7,14336
buffer_load_dwordx4 v4, s[12:15], s41 offen offset:384 lds
s_add_u32 s41, s41, 262144
M a[152:155],v[16:19],v[140:143],a[152:155]
TR v[12:13],v1,3072
M a[156:159],v[16:19],v[144:147],a[156:159]
WL 5
TR v[14:15],v1,11264
M a[160:163],v[20:23],v[132:135],a[160:163]
RD v[64:67],v8,14336
M a[164:167],v[20:23],v[136:139],a[164:167]
M a[168:171],v[20:23],v[140:143],a[168:171]
TR v[16:17],v1,3080
M a[172:175],v[20:23],v[144:147],a[172:175]
WL 5
TR v[18:19],v1,11272
M a[176:179],v[24:27],v[132:135],a[176:179]
M a[180:183],v[24:27],v[136:139],a[180:183]
M a[184:187],v[24:27],v[140:143],a[184:187]
TR v[20:21],v1,3584
M a[188:191],v[24:27],v[144:147],a[188:191]
WL 4
TR v[22:23],v1,11776
M a[192:195],v[12:15],v[132:135],a[192:195]
M a[196:199],v[12:15],v[136:139],a[196:199]
M a[200:203],v[12:15],v[140:143],a[200:203]
TR v[24:25],v1,3592
M a[204:207],v[12:15],v[144:147],a[204:207]
WL 3
TR v[26:27],v1,11784
M a[208:211],v[16:19],v[132:135],a[208:211]
WV 20
v_add_u32 v1, 0xfffec000, v1
M a[212:215],v[16:19],v[136:139],a[212:215]
s_barrier
M a[216:219],v[16:19],v[140:143],a[216:219]
TR v[12:13],v1,0
M a[220:223],v[16:19],v[144:147],a[220:223]
WL 3
TR v[14:15],v1,8192
M a[224:227],v[20:23],v[132:135],a[224:227]
M a[228:231],v[20:23],v[136:139],a[228:231]
M a[232:235],v[20:23],v[140:143],a[232:235]
TR v[16:17],v1,8
M a[236:239],v[20:23],v[144:147],a[236:239]
WL 3
TR v[18:19],v1,8200
M a[240:243],v[24:27],v[132:135],a[240:243]
M a[244:247],v[24:27],v[136:139],a[244:247]
M a[248:251],v[24:27],v[140:143],a[248:251]
TR v[20:21],v1,512
M a[252:255],v[24:27],v[144:147],a[252:255]
WL 3
TR v[22:23],v1,8704
L1_qp_4:
M a[0:3],v[12:15],v[36:39],a[0:3]
M a[4:7],v[12:15],v[40:43],a[4:7]
s_add_u32 m0, s62, 8192
v_add_u32 v5, 128, v5
v_add_u32 v6, 128, v6
s_nop 0
buffer_load_dwordx4 v5, s[8:11], s36 offen lds
M a[8:11],v[12:15],v[44:47],a[8:11]
TR v[24:25],v1,520
M a[12:15],v[12:15],v[48:51],a[12:15]
WL 3
TR v[26:27],v1,8712
M a[16:19],v[16:19],v[36:39],a[16:19]
M a[20:23],v[16:19],v[40:43],a[20:23]
s_add_u32 m0, s62, 9216
s_nop 0
buffer_load_dwordx4 v6, s[8:11], s44 offen lds
M a[24:27],v[16:19],v[44:47],a[24:27]
TR v[12:13],v1,1024
M a[28:31],v[16:19],v[48:51],a[28:31]
WL 3
TR v[14:15],v1,9216
M a[32:35],v[20:23],v[36:39],a[32:35]
M a[36:39],v[20:23],v[40:43],a[36:39]
s_add_u32 m0, s62, 10240
s_nop 0
buffer_load_dwordx4 v5, s[8:11], s37 offen lds
M a[40:43],v[20:23],v[44:47],a[40:43]
TR v[16:17],v1,1032
M a[44:47],v[20:23],v[48:51],a[44:47]
WL 3
TR v[18:19],v1,9224
M a[48:51],v[24:27],v[36:39],a[48:51]
M a[52:55],v[24:27],v[40:43],a[52:55]
s_add_u32 m0, s62, 11264
s_nop 0
buffer_load_dwordx4 v6, s[8:11], s45 offen lds
M a[56:59],v[24:27],v[44:47],a[56:59]
TR v[20:21],v1,1536
M a[60:63],v[24:27],v[48:51],a[60:63]
WL 3
TR v[22:23],v1,9728
M a[64:67],v[12:15],v[36:39],a[64:67]
M a[68:71],v[12:15],v[40:43],a[68:71]
s_add_u32 m0, s62, 12288
s_nop 0
buffer_load_dwordx4 v5, s[8:11], s38 offen lds
M a[72:75],v[12:15],v[44:47],a[72:75]
TR v[24:25],v1,1544
M a[76:79],v[12:15],v[48:51],a[76:79]
WL 3
TR v[26:27],v1,9736
M a[80:83],v[16:19],v[36:39],a[80:83]
M a[84:87],v[16:19],v[40:43],a[84:87]
s_add_u32 m0, s62, 13312
s_nop 0
buffer_load_dwordx4 v6, s[8:11], s46 offen lds
M a[88:91],v[16:19],v[44:47],a[88:91]
TR v[12:13],v1,2048
M a[92:95],v[16:19],v[48:51],a[92:95]
WL 3
TR v[14:15],v1,10240
M a[96:99],v[20:23],v[36:39],a[96:99]
M a[100:103],v[20:23],v[40:43],a[100:103]
s_add_u32 m0, s62, 14336
s_nop 0
buffer_load_dwordx4 v5, s[8:11], s39 offen lds
M a[104:107],v[20:23],v[44:47],a[104:107]
TR v[16:17],v1,2056
M a[108:111],v[20:23],v[48:51],a[108:111]
WL 3
TR v[18:19],v1,10248
M a[112:115],v[24:27],v[36:39],a[112:115]
M a[116:119],v[24:27],v[40:43],a[116:119]
s_add_u32 m0, s62, 15360
s_nop 0
buffer_load_dwordx4 v6, s[8:11], s47 offen lds
M a[120:123],v[24:27],v[44:47],a[120:123]
TR v[20:21],v1,2560
M a[124:127],v[24:27],v[48:51],a[124:127]
WL 3
TR v[22:23],v1,10752
M a[128:131],v[12:15],v[36:39],a[128:131]
M a[132:135],v[12:15],v[40:43],a[132:135]
s_add_u32 m0, s53, 65536
s_nop 0
buffer_load_dwordx4 v4, s[12:15], s41 offen offset:0 lds
M a[136:139],v[12:15],v[44:47],a[136:139]
TR v[24:25],v1,2568
M a[140:143],v[12:15],v[48:51],a[140:143]
WL 3
TR v[26:27],v1,10760
M a[144:147],v[16:19],v[36:39],a[144:147]
M a[148:151],v[16:19],v[40:43],a[148:151]
s_add_u32 m0, s53, 66432
s_nop 0
buffer_load_dwordx4 v4, s[12:15], s41 offen offset:128 lds
M a[152:155],v[16:19],v[44:47],a[152:155]
TR v[12:13],v1,3072
M a[156:159],v[16:19],v[48:51],a[156:159]
WL 3
TR v[14:15],v1,11264
M a[160:163],v[20:23],v[36:39],a[160:163]
M a[164:167],v[20:23],v[40:43],a[164:167]
s_add_u32 m0, s53, 67328
s_nop 0
buffer_load_dwordx4 v4, s[12:15], s41 offen offset:256 lds
M a[168:171],v[20:23],v[44:47],a[168:171]
TR v[16:17],v1,3080
M a[172:175],v[20:23],v[48:51],a[172:175]
WL 3
TR v[18:19],v1,11272
M a[176:179],v[24:27],v[36:39],a[176:179]
M a[180:183],v[24:27],v[40:43],a[180:183]
s_add_u32 m0, s53, 68224
s_nop 0
buffer_load_dwordx4 v4, s[12:15], s41 offen offset:384 lds
s_add_u32 s41, s41, 262144
M a[184:187],v[24:27],v[44:47],a[184:187]
TR v[20:21],v1,3584
M a[188:191],v[24:27],v[48:51],a[188:191]
WL 3
TR v[22:23],v1,11776
M a[192:195],v[12:15],v[36:39],a[192:195]
M a[196:199],v[12:15],v[40:43],a[196:199]
M a[200:203],v[12:15],v[44:47],a[200:203]
TR v[24:25],v1,3592
M a[204:207],v[12:15],v[48:51],a[204:207]
WL 3
TR v[26:27],v1,11784
M a[208:211],v[16:19],v[36:39],a[208:211]
WV 28
v_add_u32 v1, 0x4000, v1
M a[212:215],v[16:19],v[40:43],a[212:215]
s_barrier
M a[216:219],v[16:19],v[44:47],a[216:219]
TR v[12:13],v1,0
M a[220:223],v[16:19],v[48:51],a[220:223]
WL 3
TR v[14:15],v1,8192
M a[224:227],v[20:23],v[36:39],a[224:227]
M a[228:231],v[20:23],v[40:43],a[228:231]
M a[232:235],v[20:23],v[44:47],a[232:235]
TR v[16:17],v1,8
M a[236:239],v[20:23],v[48:51],a[236:239]
WL 3
TR v[18:19],v1,8200
M a[240:243],v[24:27],v[36:39],a[240:243]
M a[244:247],v[24:27],v[40:43],a[244:247]
M a[248:251],v[24:27],v[44:47],a[248:251]
TR v[20:21],v1,512
M a[252:255],v[24:27],v[48:51],a[252:255]
WL 3
TR v[22:23],v1,8704
M a[0:3],v[12:15],v[52:55],a[0:3]
M a[4:7],v[12:15],v[56:59],a[4:7]
s_add_u32 m0, s53, 81920
s_nop 0
buffer_load_dwordx4 v4, s[12:15], s41 offen offset:0 lds
M a[8:11],v[12:15],v[60:63],a[8:11]
TR v[24:25],v1,520
M a[12:15],v[12:15],v[64:67],a[12:15]
WL 3
TR v[26:27],v1,8712
M a[16:19],v[16:19],v[52:55],a[16:19]
M a[20:23],v[16:19],v[56:59],a[20:23]
M a[24:27],v[16:19],v[60:63],a[24:27]
TR v[12:13],v1,1024
M a[28:31],v[16:19],v[64:67],a[28:31]
WL 3
TR v[14:15],v1,9216
M a[32:35],v[20:23],v[52:55],a[32:35]
M a[36:39],v[20:23],v[56:59],a[36:39]
M a[40:43],v[20:23],v[60:63],a[40:43]
TR v[16:17],v1,1032
M a[44:47],v[20:23],v[64:67],a[44:47]
WL 3
TR v[18:19],v1,9224
M a[48:51],v[24:27],v[52:55],a[48:51]
WV 27
M a[52:55],v[24:27],v[56:59],a[52:55]
s_add_u32 m0, s53, 82816
RD v[68:71],v7,0
buffer_load_dwordx4 v4, s[12:15], s41 offen offset:128 lds
M a[56:59],v[24:27],v[60:63],a[56:59]
TR v[20:21],v1,1536
M a[60:63],v[24:27],v[64:67],a[60:63]
WL 4
TR v[22:23],v1,9728
M a[64:67],v[12:15],v[52:55],a[64:67]
RD v[84:87],v8,0
M a[68:71],v[12:15],v[56:59],a[68:71]
M a[72:75],v[12:15],v[60:63],a[72:75]
TR v[24:25],v1,1544
M a[76:79],v[12:15],v[64:67],a[76:79]
WL 5
TR v[26:27],v1,9736
M a[80:83],v[16:19],v[52:55],a[80:83]
WV 26
M a[84:87],v[16:19],v[56:59],a[84:87]
RD v[72:75],v7,2048
M a[88:91],v[16:19],v[60:63],a[88:91]
TR v[12:13],v1,2048
M a[92:95],v[16:19],v[64:67],a[92:95]
WL 5
TR v[14:15],v1,10240
M a[96:99],v[20:23],v[52:55],a[96:99]
RD v[88:91],v8,2048
M a[100:103],v[20:23],v[56:59],a[100:103]
s_add_u32 m0, s53, 83712
s_nop 0
buffer_load_dwordx4 v4, s[12:15], s41 offen offset:256 lds
M a[104:107],v[20:23],v[60:63],a[104:107]
TR v[16:17],v1,2056
M a[108:111],v[20:23],v[64:67],a[108:111]
WL 5
TR v[18:19],v1,10248
M a[112:115],v[24:27],v[52:55],a[112:115]
WV 25
M a[116:119],v[24:27],v[56:59],a[116:119]
RD v[76:79],v7,4096
M a[120:123],v[24:27],v[60:63],a[120:123]
TR v[20:21],v1,2560
M a[124:127],v[24:27],v[64:67],a[124:127]
WL 5
TR v[22:23],v1,10752
M a[128:131],v[12:15],v[52:55],a[128:131]
RD v[92:95],v8,4096
M a[132:135],v[12:15],v[56:59],a[132:135]
M a[136:139],v[12:15],v[60:63],a[136:139]
TR v[24:25],v1,2568
M a[140:143],v[12:15],v[64:67],a[140:143]
WL 5
TR v[26:27],v1,10760
M a[144:147],v[16:19],v[52:55],a[144:147]
WV 23
M a[148:151],v[16:19],v[56:59],a[148:151]
s_add_u32 m0, s53, 84608
RD v[80:83],v7,6144
buffer_load_dwordx4 v4, s[12:15], s41 offen offset:384 lds
s_add_u32 s41, s41, 262144
M a[152:155],v[16:19],v[60:63],a[152:155]
TR v[12:13],v1,3072
M a[156:159],v[16:19],v[64:67],a[156:159]
WL 5
TR v[14:15],v1,11264
M a[160:163],v[20:23],v[52:55],a[160:163]
RD v[96:99],v8,6144
M a[164:167],v[20:23],v[56:59],a[164:167]
M a[168:171],v[20:23],v[60:63],a[168:171]
TR v[16:17],v1,3080
M a[172:175],v[20:23],v[64:67],a[172:175]
WL 5
TR v[18:19],v1,11272
M a[176:179],v[24:27],v[52:55],a[176:179]
M a[180:183],v[24:27],v[56:59],a[180:183]
M a[184:187],v[24:27],v[60:63],a[184:187]
TR v[20:21],v1,3584
M a[188:191],v[24:27],v[64:67],a[188:191]
WL 4
TR v[22:23],v1,11776
M a[192:195],v[12:15],v[52:55],a[192:195]
M a[196:199],v[12:15],v[56:59],a[196:199]
M a[200:203],v[12:15],v[60:63],a[200:203]
TR v[24:25],v1,3592
M a[204:207],v[12:15],v[64:67],a[204:207]
WL 3
TR v[26:27],v1,11784
M a[208:211],v[16:19],v[52:55],a[208:211]
WV 20
v_add_u32 v1, 0x4000, v1
M a[212:215],v[16:19],v[56:59],a[212:215]
s_barrier
M a[216:219],v[16:19],v[60:63],a[216:219]
TR v[12:13],v1,0
M a[220:223],v[16:19],v[64:67],a[220:223]
WL 3
TR v[14:15],v1,8192
M a[224:227],v[20:23],v[52:55],a[224:227]
M a[228:231],v[20:23],v[56:59],a[228:231]
M a[232:235],v[20:23],v[60:63],a[232:235]
TR v[16:17],v1,8
M a[236:239],v[20:23],v[64:67],a[236:239]
WL 3
TR v[18:19],v1,8200
M a[240:243],v[24:27],v[52:55],a[240:243]
M a[244:247],v[24:27],v[56:59],a[244:247]
M a[248:251],v[24:27],v[60:63],a[248:251]
TR v[20:21],v1,512
M a[252:255],v[24:27],v[64:67],a[252:255]
WL 3
TR v[22:23],v1,8704
M a[0:3],v[12:15],v[68:71],a[0:3]
M a[4:7],v[12:15],v[72:75],a[4:7]
s_add_u32 m0, s62, 0
v_add_u32 v5, 128, v5
v_add_u32 v6, 128, v6
s_nop 0
buffer_load_dwordx4 v5, s[8:11], s36 offen lds
M a[8:11],v[12:15],v[76:79],a[8:11]
TR v[24:25],v1,520
M a[12:15],v[12:15],v[80:83],a[12:15]
WL 3
TR v[26:27],v1,8712
M a[16:19],v[16:19],v[68:71],a[16:19]
M a[20:23],v[16:19],v[72:75],a[20:23]
s_add_u32 m0, s62, 1024
s_nop 0
buffer_load_dwordx4 v6, s[8:11], s44 offen lds
M a[24:27],v[16:19],v[76:79],a[24:27]
TR v[12:13],v1,1024
M a[28:31],v[16:19],v[80:83],a[28:31]
WL 3
TR v[14:15],v1,9216
M a[32:35],v[20:23],v[68:71],a[32:35]
M a[36:39],v[20:23],v[72:75],a[36:39]
s_add_u32 m0, s62, 2048
s_nop 0
buffer_load_dwordx4 v5, s[8:11], s37 offen lds
M a[40:43],v[20:23],v[76:79],a[40:43]
TR v[16:17],v1,1032
M a[44:47],v[20:23],v[80:83],a[44:47]
WL 3
TR v[18:19],v1,9224
M a[48:51],v[24:27],v[68:71],a[48:51]
M a[52:55],v[24:27],v[72:75],a[52:55]
s_add_u32 m0, s62, 3072
s_nop 0
buffer_load_dwordx4 v6, s[8:11], s45 offen lds
M a[56:59],v[24:27],v[76:79],a[56:59]
TR v[20:21],v1,1536
M a[60:63],v[24:27],v[80:83],a[60:63]
WL 3
TR v[22:23],v1,9728
M a[64:67],v[12:15],v[68:71],a[64:67]
M a[68:71],v[12:15],v[72:75],a[68:71]
s_add_u32 m0, s62, 4096
s_nop 0
buffer_load_dwordx4 v5, s[8:11], s38 offen lds
M a[72:75],v[12:15],v[76:79],a[72:75]
TR v[24:25],v1,1544
M a[76:79],v[12:15],v[80:83],a[76:79]
WL 3
TR v[26:27],v1,9736
M a[80:83],v[16:19],v[68:71],a[80:83]
M a[84:87],v[16:19],v[72:75],a[84:87]
s_add_u32 m0, s62, 5120
s_nop 0
buffer_load_dwordx4 v6, s[8:11], s46 offen lds
M a[88:91],v[16:19],v[76:79],a[88:91]
TR v[12:13],v1,2048
M a[92:95],v[16:19],v[80:83],a[92:95]
WL 3
TR v[14:15],v1,10240
M a[96:99],v[20:23],v[68:71],a[96:99]
M a[100:103],v[20:23],v[72:75],a[100:103]
s_add_u32 m0, s62, 6144
s_nop 0
buffer_load_dwordx4 v5, s[8:11], s39 offen lds
M a[104:107],v[20:23],v[76:79],a[104:107]
TR v[16:17],v1,2056
M a[108:111],v[20:23],v[80:83],a[108:111]
WL 3
TR v[18:19],v1,10248
M a[112:115],v[24:27],v[68:71],a[112:115]
M a[116:119],v[24:27],v[72:75],a[116:119]
s_add_u32 m0, s62, 7168
s_nop 0
buffer_load_dwordx4 v6, s[8:11], s47 offen lds
M a[120:123],v[24:27],v[76:79],a[120:123]
TR v[20:21],v1,2560
M a[124:127],v[24:27],v[80:83],a[124:127]
WL 3
TR v[22:23],v1,10752
M a[128:131],v[12:15],v[68:71],a[128:131]
M a[132:135],v[12:15],v[72:75],a[132:135]
s_add_u32 m0, s53, 0
s_nop 0
buffer_load_dwordx4 v4, s[12:15], s41 offen offset:0 lds
M a[136:139],v[12:15],v[76:79],a[136:139]
TR v[24:25],v1,2568
M a[140:143],v[12:15],v[80:83],a[140:143]
WL 3
TR v[26:27],v1,10760
M a[144:147],v[16:19],v[68:71],a[144:147]
M a[148:151],v[16:19],v[72:75],a[148:151]
s_add_u32 m0, s53, 896
s_nop 0
buffer_load_dwordx4 v4, s[12:15], s41 offen offset:128 lds
M a[152:155],v[16:19],v[76:79],a[152:155]
TR v[12:13],v1,3072
M a[156:159],v[16:19],v[80:83],a[156:159]
WL 3
TR v[14:15],v1,11264
M a[160:163],v[20:23],v[68:71],a[160:163]
M a[164:167],v[20:23],v[72:75],a[164:167]
s_add_u32 m0, s53, 1792
s_nop 0
buffer_load_dwordx4 v4, s[12:15], s41 offen offset:256 lds
M a[168:171],v[20:23],v[76:79],a[168:171]
TR v[16:17],v1,3080
M a[172:175],v[20:23],v[80:83],a[172:175]
WL 3
TR v[18:19],v1,11272
M a[176:179],v[24:27],v[68:71],a[176:179]
M a[180:183],v[24:27],v[72:75],a[180:183]
s_add_u32 m0, s53, 2688
s_nop 0
buffer_load_dwordx4 v4, s[12:15], s41 offen offset:384 lds
s_add_u32 s41, s41, 262144
M a[184:187],v[24:27],v[76:79],a[184:187]
TR v[20:21],v1,3584
M a[188:191],v[24:27],v[80:83],a[188:191]
WL 3
TR v[22:23],v1,11776
M a[192:195],v[12:15],v[68:71],a[192:195]
M a[196:199],v[12:15],v[72:75],a[196:199]
M a[200:203],v[12:15],v[76:79],a[200:203]
TR v[24:25],v1,3592
M a[204:207],v[12:15],v[80:83],a[204:207]
WL 3
TR v[26:27],v1,11784
M a[208:211],v[16:19],v[68:71],a[208:211]
WV 28
v_add_u32 v1, 0x4000, v1
M a[212:215],v[16:19],v[72:75],a[212:215]
s_barrier
M a[216:219],v[16:19],v[76:79],a[216:219]
TR v[12:13],v1,0
M a[220:223],v[16:19],v[80:83],a[220:223]
WL 3
TR v[14:15],v1,8192
M a[224:227],v[20:23],v[68:71],a[224:227]
M a[228:231],v[20:23],v[72:75],a[228:231]
M a[232:235],v[20:23],v[76:79],a[232:235]
TR v[16:17],v1,8
M a[236:239],v[20:23],v[80:83],a[236:239]
WL 3
TR v[18:19],v1,8200
M a[240:243],v[24:27],v[68:71],a[240:243]
M a[244:247],v[24:27],v[72:75],a[244:247]
M a[248:251],v[24:27],v[76:79],a[248:251]
TR v[20:21],v1,512
M a[252:255],v[24:27],v[80:83],a[252:255]
WL 3
TR v[22:23],v1,8704
M a[0:3],v[12:15],v[84:87],a[0:3]
M a[4:7],v[12:15],v[88:91],a[4:7]
s_add_u32 m0, s53, 16384
s_nop 0
buffer_load_dwordx4 v4, s[12:15], s41 offen offset:0 lds
M a[8:11],v[12:15],v[92:95],a[8:11]
TR v[24:25],v1,520
M a[12:15],v[12:15],v[96:99],a[12:15]
WL 3
TR v[26:27],v1,8712
M a[16:19],v[16:19],v[84:87],a[16:19]
M a[20:23],v[16:19],v[88:91],a[20:23]
M a[24:27],v[16:19],v[92:95],a[24:27]
TR v[12:13],v1,1024
M a[28:31],v[16:19],v[96:99],a[28:31]
WL 3
TR v[14:15],v1,9216
M a[32:35],v[20:23],v[84:87],a[32:35]
M a[36:39],v[20:23],v[88:91],a[36:39]
M a[40:43],v[20:23],v[92:95],a[40:43]
TR v[16:17],v1,1032
M a[44:47],v[20:23],v[96:99],a[44:47]
WL 3
TR v[18:19],v1,9224
M a[48:51],v[24:27],v[84:87],a[48:51]
WV 27
M a[52:55],v[24:27],v[88:91],a[52:55]
s_add_u32 m0, s53, 17280
RD v[100:103],v7,8192
buffer_load_dwordx4 v4, s[12:15], s41 offen offset:128 lds
M a[56:59],v[24:27],v[92:95],a[56:59]
TR v[20:21],v1,1536
M a[60:63],v[24:27],v[96:99],a[60:63]
WL 4
TR v[22:23],v1,9728
M a[64:67],v[12:15],v[84:87],a[64:67]
RD v[116:119],v8,8192
M a[68:71],v[12:15],v[88:91],a[68:71]
M a[72:75],v[12:15],v[92:95],a[72:75]
TR v[24:25],v1,1544
M a[76:79],v[12:15],v[96:99],a[76:79]
WL 5
TR v[26:27],v1,9736
M a[80:83],v[16:19],v[84:87],a[80:83]
WV 26
M a[84:87],v[16:19],v[88:91],a[84:87]
RD v[104:107],v7,10240
M a[88:91],v[16:19],v[92:95],a[88:91]
TR v[12:13],v1,2048
M a[92:95],v[16:19],v[96:99],a[92:95]
WL 5
TR v[14:15],v1,10240
M a[96:99],v[20:23],v[84:87],a[96:99]
RD v[120:123],v8,10240
M a[100:103],v[20:23],v[88:91],a[100:103]
s_add_u32 m0, s53, 18176
s_nop 0
buffer_load_dwordx4 v4, s[12:15], s41 offen offset:256 lds
M a[104:107],v[20:23],v[92:95],a[104:107]
TR v[16:17],v1,2056
M a[108:111],v[20:23],v[96:99],a[108:111]
WL 5
TR v[18:19],v1,10248
M a[112:115],v[24:27],v[84:87],a[112:115]
WV 25
M a[116:119],v[24:27],v[88:91],a[116:119]
RD v[108:111],v7,12288
M a[120:123],v[24:27],v[92:95],a[120:123]
TR v[20:21],v1,2560
M a[124:127],v[24:27],v[96:99],a[124:127]
WL 5
TR v[22:23],v1,10752
M a[128:131],v[12:15],v[84:87],a[128:131]
RD v[124:127],v8,12288
M a[132:135],v[12:15],v[88:91],a[132:135]
M a[136:139],v[12:15],v[92:95],a[136:139]
TR v[24:25],v1,2568
M a[140:143],v[12:15],v[96:99],a[140:143]
WL 5
TR v[26:27],v1,10760
M a[144:147],v[16:19],v[84:87],a[144:147]
WV 23
M a[148:151],v[16:19],v[88:91],a[148:151]
s_add_u32 m0, s53, 19072
RD v[112:115],v7,14336
buffer_load_dwordx4 v4, s[12:15], s41 offen offset:384 lds
s_add_u32 s41, s41, 262144
M a[152:155],v[16:19],v[92:95],a[152:155]
TR v[12:13],v1,3072
M a[156:159],v[16:19],v[96:99],a[156:159]
WL 5
TR v[14:15],v1,11264
M a[160:163],v[20:23],v[84:87],a[160:163]
RD v[128:131],v8,14336
M a[164:167],v[20:23],v[88:91],a[164:167]
M a[168:171],v[20:23],v[92:95],a[168:171]
TR v[16:17],v1,3080
M a[172:175],v[20:23],v[96:99],a[172:175]
WL 5
TR v[18:19],v1,11272
M a[176:179],v[24:27],v[84:87],a[176:179]
M a[180:183],v[24:27],v[88:91],a[180:183]
M a[184:187],v[24:27],v[92:95],a[184:187]
TR v[20:21],v1,3584
M a[188:191],v[24:27],v[96:99],a[188:191]
WL 4
TR v[22:23],v1,11776
M a[192:195],v[12:15],v[84:87],a[192:195]
M a[196:199],v[12:15],v[88:91],a[196:199]
M a[200:203],v[12:15],v[92:95],a[200:203]
TR v[24:25],v1,3592
M a[204:207],v[12:15],v[96:99],a[204:207]
WL 3
TR v[26:27],v1,11784
M a[208:211],v[16:19],v[84:87],a[208:211]
WV 20
v_add_u32 v1, 0x4000, v1
M a[212:215],v[16:19],v[88:91],a[212:215]
s_barrier
M a[216:219],v[16:19],v[92:95],a[216:219]
TR v[12:13],v1,0
M a[220:223],v[16:19],v[96:99],a[220:223]
WL 3
TR v[14:15],v1,8192
M a[224:227],v[20:23],v[84:87],a[224:227]
M a[228:231],v[20:23],v[88:91],a[228:231]
M a[232:235],v[20:23],v[92:95],a[232:235]
TR v[16:17],v1,8
M a[236:239],v[20:23],v[96:99],a[236:239]
WL 3
TR v[18:19],v1,8200
M a[240:243],v[24:27],v[84:87],a[240:243]
M a[244:247],v[24:27],v[88:91],a[244:247]
M a[248:251],v[24:27],v[92:95],a[248:251]
TR v[20:21],v1,512
M a[252:255],v[24:27],v[96:99],a[252:255]
WL 3
TR v[22:23],v1,8704
M a[0:3],v[12:15],v[100:103],a[0:3]
M a[4:7],v[12:15],v[104:107],a[4:7]
s_add_u32 m0, s53, 32768
s_nop 0
buffer_load_dwordx4 v3, s[16:19], s42 offen offset:0 nt lds
M a[8:11],v[12:15],v[108:111],a[8:11]
TR v[24:25],v1,520
M a[12:15],v[12:15],v[112:115],a[12:15]
WL 3
TR v[26:27],v1,8712
M a[16:19],v[16:19],v[100:103],a[16:19]
M a[20:23],v[16:19],v[104:107],a[20:23]
M a[24:27],v[16:19],v[108:111],a[24:27]
TR v[12:13],v1,1024
M a[28:31],v[16:19],v[112:115],a[28:31]
WL 3
TR v[14:15],v1,9216
M a[32:35],v[20:23],v[100:103],a[32:35]
M a[36:39],v[20:23],v[104:107],a[36:39]
M a[40:43],v[20:23],v[108:111],a[40:43]
TR v[16:17],v1,1032
M a[44:47],v[20:23],v[112:115],a[44:47]
WL 3
TR v[18:19],v1,9224
M a[48:51],v[24:27],v[100:103],a[48:51]
M a[52:55],v[24:27],v[104:107],a[52:55]
s_add_u32 m0, s53, 33664
s_nop 0
buffer_load_dwordx4 v3, s[16:19], s42 offen offset:128 nt lds
M a[56:59],v[24:27],v[108:111],a[56:59]
TR v[20:21],v1,1536
M a[60:63],v[24:27],v[112:115],a[60:63]
WL 3
TR v[22:23],v1,9728
M a[64:67],v[12:15],v[100:103],a[64:67]
M a[68:71],v[12:15],v[104:107],a[68:71]
M a[72:75],v[12:15],v[108:111],a[72:75]
TR v[24:25],v1,1544
M a[76:79],v[12:15],v[112:115],a[76:79]
WL 3
TR v[26:27],v1,9736
M a[80:83],v[16:19],v[100:103],a[80:83]
M a[84:87],v[16:19],v[104:107],a[84:87]
M a[88:91],v[16:19],v[108:111],a[88:91]
TR v[12:13],v1,2048
M a[92:95],v[16:19],v[112:115],a[92:95]
WL 3
TR v[14:15],v1,10240
M a[96:99],v[20:23],v[100:103],a[96:99]
M a[100:103],v[20:23],v[104:107],a[100:103]
s_add_u32 m0, s53, 34560
s_nop 0
buffer_load_dwordx4 v3, s[16:19], s42 offen offset:256 nt lds
M a[104:107],v[20:23],v[108:111],a[104:107]
TR v[16:17],v1,2056
M a[108:111],v[20:23],v[112:115],a[108:111]
WL 3
TR v[18:19],v1,10248
M a[112:115],v[24:27],v[100:103],a[112:115]
M a[116:119],v[24:27],v[104:107],a[116:119]
M a[120:123],v[24:27],v[108:111],a[120:123]
TR v[20:21],v1,2560
M a[124:127],v[24:27],v[112:115],a[124:127]
WL 3
TR v[22:23],v1,10752
M a[128:131],v[12:15],v[100:103],a[128:131]
M a[132:135],v[12:15],v[104:107],a[132:135]
M a[136:139],v[12:15],v[108:111],a[136:139]
TR v[24:25],v1,2568
M a[140:143],v[12:15],v[112:115],a[140:143]
WL 3
TR v[26:27],v1,10760
M a[144:147],v[16:19],v[100:103],a[144:147]
M a[148:151],v[16:19],v[104:107],a[148:151]
s_add_u32 m0, s53, 35456
s_nop 0
buffer_load_dwordx4 v3, s[16:19], s42 offen offset:384 nt lds
s_add_u32 s42, s42, 16384
M a[152:155],v[16:19],v[108:111],a[152:155]
TR v[12:13],v1,3072
M a[156:159],v[16:19],v[112:115],a[156:159]
WL 3
TR v[14:15],v1,11264
M a[160:163],v[20:23],v[100:103],a[160:163]
M a[164:167],v[20:23],v[104:107],a[164:167]
M a[168:171],v[20:23],v[108:111],a[168:171]
TR v[16:17],v1,3080
M a[172:175],v[20:23],v[112:115],a[172:175]
WL 3
TR v[18:19],v1,11272
M a[176:179],v[24:27],v[100:103],a[176:179]
M a[180:183],v[24:27],v[104:107],a[180:183]
M a[184:187],v[24:27],v[108:111],a[184:187]
TR v[20:21],v1,3584
M a[188:191],v[24:27],v[112:115],a[188:191]
WL 3
TR v[22:23],v1,11776
M a[192:195],v[12:15],v[100:103],a[192:195]
M a[196:199],v[12:15],v[104:107],a[196:199]
M a[200:203],v[12:15],v[108:111],a[200:203]
TR v[24:25],v1,3592
M a[204:207],v[12:15],v[112:115],a[204:207]
WL 3
TR v[26:27],v1,11784
M a[208:211],v[16:19],v[100:103],a[208:211]
WV 20
v_add_u32 v1, 0x4000, v1
M a[212:215],v[16:19],v[104:107],a[212:215]
s_barrier
M a[216:219],v[16:19],v[108:111],a[216:219]
TR v[12:13],v1,0
M a[220:223],v[16:19],v[112:115],a[220:223]
WL 3
TR v[14:15],v1,8192
M a[224:227],v[20:23],v[100:103],a[224:227]
M a[228:231],v[20:23],v[104:107],a[228:231]
M a[232:235],v[20:23],v[108:111],a[232:235]
TR v[16:17],v1,8
M a[236:239],v[20:23],v[112:115],a[236:239]
WL 3
TR v[18:19],v1,8200
M a[240:243],v[24:27],v[100:103],a[240:243]
M a[244:247],v[24:27],v[104:107],a[244:247]
M a[248:251],v[24:27],v[108:111],a[248:251]
TR v[20:21],v1,512
M a[252:255],v[24:27],v[112:115],a[252:255]
WL 3
TR v[22:23],v1,8704
M a[0:3],v[12:15],v[116:119],a[0:3]
M a[4:7],v[12:15],v[120:123],a[4:7]
s_add_u32 m0, s53, 49152
s_nop 0
buffer_load_dwordx4 v3, s[16:19], s42 offen offset:0 nt lds
M a[8:11],v[12:15],v[124:127],a[8:11]
s_mul_i32 s6, s101, 1
TR v[24:25],v1,520
M a[12:15],v[12:15],v[128:131],a[12:15]
WL 3
TR v[26:27],v1,8712
M a[16:19],v[16:19],v[116:119],a[16:19]
s_nop 0
M a[20:23],v[16:19],v[120:123],a[20:23]
s_mul_i32 s4, s6, 8193
M a[24:27],v[16:19],v[124:127],a[24:27]
s_lshr_b32 s4, s4, 16
TR v[12:13],v1,1024
M a[28:31],v[16:19],v[128:131],a[28:31]
WL 3
TR v[14:15],v1,9216
M a[32:35],v[20:23],v[116:119],a[32:35]
s_mul_i32 s4, s4, 8
M a[36:39],v[20:23],v[120:123],a[36:39]
s_sub_u32 s4, s6, s4
M a[40:43],v[20:23],v[124:127],a[40:43]
s_lshr_b32 s5, s4, 2
TR v[16:17],v1,1032
M a[44:47],v[20:23],v[128:131],a[44:47]
WL 3
TR v[18:19],v1,9224
M a[48:51],v[24:27],v[116:119],a[48:51]
WV 19
M a[52:55],v[24:27],v[120:123],a[52:55]
s_add_u32 m0, s53, 50048
RD v[132:135],v7,0
buffer_load_dwordx4 v3, s[16:19], s42 offen offset:128 nt lds
M a[56:59],v[24:27],v[124:127],a[56:59]
s_lshl_b32 s5, s5, 12
TR v[20:21],v1,1536
M a[60:63],v[24:27],v[128:131],a[60:63]
WL 4
TR v[22:23],v1,9728
M a[64:67],v[12:15],v[116:119],a[64:67]
s_and_b32 s4, s4, 3
RD v[36:39],v8,0
M a[68:71],v[12:15],v[120:123],a[68:71]
s_lshl_b32 s4, s4, 7
M a[72:75],v[12:15],v[124:127],a[72:75]
s_add_u32 s4, s4, s5
TR v[24:25],v1,1544
M a[76:79],v[12:15],v[128:131],a[76:79]
WL 5
TR v[26:27],v1,9736
M a[80:83],v[16:19],v[116:119],a[80:83]
WV 18
M a[84:87],v[16:19],v[120:123],a[84:87]
s_add_u32 s100, s4, L1_conv_4-concat_heads__mha_block_cached__mha_block_cached__near_ridge_kernel
RD v[136:139],v7,2048
M a[88:91],v[16:19],v[124:127],a[88:91]
TR v[12:13],v1,2048
M a[92:95],v[16:19],v[128:131],a[92:95]
WL 5
TR v[14:15],v1,10240
M a[96:99],v[20:23],v[116:119],a[96:99]
RD v[40:43],v8,2048
M a[100:103],v[20:23],v[120:123],a[100:103]
s_add_u32 m0, s53, 50944
s_nop 0
buffer_load_dwordx4 v3, s[16:19], s42 offen offset:256 nt lds
M a[104:107],v[20:23],v[124:127],a[104:107]
TR v[16:17],v1,2056
M a[108:111],v[20:23],v[128:131],a[108:111]
WL 5
TR v[18:19],v1,10248
M a[112:115],v[24:27],v[116:119],a[112:115]
WV 17
buffer_load_dword v190, v3, s[96:99], s100 offen
M a[116:119],v[24:27],v[120:123],a[116:119]
RD v[140:143],v7,4096
M a[120:123],v[24:27],v[124:127],a[120:123]
TR v[20:21],v1,2560
M a[124:127],v[24:27],v[128:131],a[124:127]
WL 5
TR v[22:23],v1,10752
M a[128:131],v[12:15],v[116:119],a[128:131]
RD v[44:47],v8,4096
M a[132:135],v[12:15],v[120:123],a[132:135]
M a[136:139],v[12:15],v[124:127],a[136:139]
TR v[24:25],v1,2568
M a[140:143],v[12:15],v[128:131],a[140:143]
WL 5
TR v[26:27],v1,10760
M a[144:147],v[16:19],v[116:119],a[144:147]
WV 16
M a[148:151],v[16:19],v[120:123],a[148:151]
s_add_u32 m0, s53, 51840
RD v[144:147],v7,6144
buffer_load_dwordx4 v3, s[16:19], s42 offen offset:384 nt lds
s_add_u32 s42, s42, 16384
M a[152:155],v[16:19],v[124:127],a[152:155]
TR v[12:13],v1,3072
M a[156:159],v[16:19],v[128:131],a[156:159]
WL 5
TR v[14:15],v1,11264
M a[160:163],v[20:23],v[116:119],a[160:163]
RD v[48:51],v8,6144
M a[164:167],v[20:23],v[120:123],a[164:167]
M a[168:171],v[20:23],v[124:127],a[168:171]
TR v[16:17],v1,3080
M a[172:175],v[20:23],v[128:131],a[172:175]
WL 5
TR v[18:19],v1,11272
M a[176:179],v[24:27],v[116:119],a[176:179]
M a[180:183],v[24:27],v[120:123],a[180:183]
M a[184:187],v[24:27],v[124:127],a[184:187]
TR v[20:21],v1,3584
M a[188:191],v[24:27],v[128:131],a[188:191]
WL 4
TR v[22:23],v1,11776
M a[192:195],v[12:15],v[116:119],a[192:195]
M a[196:199],v[12:15],v[120:123],a[196:199]
M a[200:203],v[12:15],v[124:127],a[200:203]
TR v[24:25],v1,3592
M a[204:207],v[12:15],v[128:131],a[204:207]
WL 3
TR v[26:27],v1,11784
M a[208:211],v[16:19],v[116:119],a[208:211]
WV 13
v_add_u32 v1, 0xfffec000, v1
M a[212:215],v[16:19],v[120:123],a[212:215]
s_barrier
M a[216:219],v[16:19],v[124:127],a[216:219]
TR v[12:13],v1,0
M a[220:223],v[16:19],v[128:131],a[220:223]
WL 3
TR v[14:15],v1,8192
M a[224:227],v[20:23],v[116:119],a[224:227]
M a[228:231],v[20:23],v[120:123],a[228:231]
M a[232:235],v[20:23],v[124:127],a[232:235]
TR v[16:17],v1,8
M a[236:239],v[20:23],v[128:131],a[236:239]
WL 3
TR v[18:19],v1,8200
M a[240:243],v[24:27],v[116:119],a[240:243]
M a[244:247],v[24:27],v[120:123],a[244:247]
M a[248:251],v[24:27],v[124:127],a[248:251]
TR v[20:21],v1,512
M a[252:255],v[24:27],v[128:131],a[252:255]
WL 3
TR v[22:23],v1,8704
M a[0:3],v[12:15],v[132:135],a[0:3]
M a[4:7],v[12:15],v[136:139],a[4:7]
s_add_u32 m0, s53, 65536
s_nop 0
buffer_load_dwordx4 v3, s[20:23], s43 offen offset:0 nt lds
M a[8:11],v[12:15],v[140:143],a[8:11]
TR v[24:25],v1,520
M a[12:15],v[12:15],v[144:147],a[12:15]
WL 3
TR v[26:27],v1,8712
M a[16:19],v[16:19],v[132:135],a[16:19]
M a[20:23],v[16:19],v[136:139],a[20:23]
M a[24:27],v[16:19],v[140:143],a[24:27]
TR v[12:13],v1,1024
M a[28:31],v[16:19],v[144:147],a[28:31]
WL 3
TR v[14:15],v1,9216
M a[32:35],v[20:23],v[132:135],a[32:35]
M a[36:39],v[20:23],v[136:139],a[36:39]
M a[40:43],v[20:23],v[140:143],a[40:43]
TR v[16:17],v1,1032
M a[44:47],v[20:23],v[144:147],a[44:47]
WL 3
TR v[18:19],v1,9224
M a[48:51],v[24:27],v[132:135],a[48:51]
M a[52:55],v[24:27],v[136:139],a[52:55]
s_add_u32 m0, s53, 66432
s_nop 0
buffer_load_dwordx4 v3, s[20:23], s43 offen offset:128 nt lds
M a[56:59],v[24:27],v[140:143],a[56:59]
TR v[20:21],v1,1536
M a[60:63],v[24:27],v[144:147],a[60:63]
WL 3
TR v[22:23],v1,9728
M a[64:67],v[12:15],v[132:135],a[64:67]
M a[68:71],v[12:15],v[136:139],a[68:71]
M a[72:75],v[12:15],v[140:143],a[72:75]
TR v[24:25],v1,1544
M a[76:79],v[12:15],v[144:147],a[76:79]
WL 3
TR v[26:27],v1,9736
M a[80:83],v[16:19],v[132:135],a[80:83]
M a[84:87],v[16:19],v[136:139],a[84:87]
M a[88:91],v[16:19],v[140:143],a[88:91]
TR v[12:13],v1,2048
M a[92:95],v[16:19],v[144:147],a[92:95]
WL 3
TR v[14:15],v1,10240
M a[96:99],v[20:23],v[132:135],a[96:99]
M a[100:103],v[20:23],v[136:139],a[100:103]
s_add_u32 m0, s53, 67328
s_nop 0
buffer_load_dwordx4 v3, s[20:23], s43 offen offset:256 nt lds
M a[104:107],v[20:23],v[140:143],a[104:107]
TR v[16:17],v1,2056
M a[108:111],v[20:23],v[144:147],a[108:111]
WL 3
TR v[18:19],v1,10248
M a[112:115],v[24:27],v[132:135],a[112:115]
M a[116:119],v[24:27],v[136:139],a[116:119]
M a[120:123],v[24:27],v[140:143],a[120:123]
TR v[20:21],v1,2560
M a[124:127],v[24:27],v[144:147],a[124:127]
WL 3
TR v[22:23],v1,10752
M a[128:131],v[12:15],v[132:135],a[128:131]
M a[132:135],v[12:15],v[136:139],a[132:135]
M a[136:139],v[12:15],v[140:143],a[136:139]
TR v[24:25],v1,2568
M a[140:143],v[12:15],v[144:147],a[140:143]
WL 3
TR v[26:27],v1,10760
M a[144:147],v[16:19],v[132:135],a[144:147]
M a[148:151],v[16:19],v[136:139],a[148:151]
s_add_u32 m0, s53, 68224
s_nop 0
buffer_load_dwordx4 v3, s[20:23], s43 offen offset:384 nt lds
s_add_u32 s43, s43, 16384
M a[152:155],v[16:19],v[140:143],a[152:155]
TR v[12:13],v1,3072
M a[156:159],v[16:19],v[144:147],a[156:159]
WL 3
TR v[14:15],v1,11264
M a[160:163],v[20:23],v[132:135],a[160:163]
M a[164:167],v[20:23],v[136:139],a[164:167]
M a[168:171],v[20:23],v[140:143],a[168:171]
TR v[16:17],v1,3080
M a[172:175],v[20:23],v[144:147],a[172:175]
WL 3
TR v[18:19],v1,11272
M a[176:179],v[24:27],v[132:135],a[176:179]
M a[180:183],v[24:27],v[136:139],a[180:183]
M a[184:187],v[24:27],v[140:143],a[184:187]
TR v[20:21],v1,3584
M a[188:191],v[24:27],v[144:147],a[188:191]
WL 3
TR v[22:23],v1,11776
M a[192:195],v[12:15],v[132:135],a[192:195]
M a[196:199],v[12:15],v[136:139],a[196:199]
M a[200:203],v[12:15],v[140:143],a[200:203]
TR v[24:25],v1,3592
M a[204:207],v[12:15],v[144:147],a[204:207]
WL 3
TR v[26:27],v1,11784
M a[208:211],v[16:19],v[132:135],a[208:211]
WV 13
v_add_u32 v1, 0x4000, v1
M a[212:215],v[16:19],v[136:139],a[212:215]
s_barrier
M a[216:219],v[16:19],v[140:143],a[216:219]
TR v[12:13],v1,0
M a[220:223],v[16:19],v[144:147],a[220:223]
WL 3
TR v[14:15],v1,8192
M a[224:227],v[20:23],v[132:135],a[224:227]
M a[228:231],v[20:23],v[136:139],a[228:231]
M a[232:235],v[20:23],v[140:143],a[232:235]
TR v[16:17],v1,8
M a[236:239],v[20:23],v[144:147],a[236:239]
WL 3
TR v[18:19],v1,8200
M a[240:243],v[24:27],v[132:135],a[240:243]
M a[244:247],v[24:27],v[136:139],a[244:247]
M a[248:251],v[24:27],v[140:143],a[248:251]
TR v[20:21],v1,512
M a[252:255],v[24:27],v[144:147],a[252:255]
WL 3
TR v[22:23],v1,8704
M a[0:3],v[12:15],v[36:39],a[0:3]
M a[4:7],v[12:15],v[40:43],a[4:7]
s_add_u32 m0, s53, 81920
s_nop 0
buffer_load_dwordx4 v3, s[16:19], s42 offen offset:0 nt lds
M a[8:11],v[12:15],v[44:47],a[8:11]
TR v[24:25],v1,520
M a[12:15],v[12:15],v[48:51],a[12:15]
WL 3
TR v[26:27],v1,8712
M a[16:19],v[16:19],v[36:39],a[16:19]
M a[20:23],v[16:19],v[40:43],a[20:23]
M a[24:27],v[16:19],v[44:47],a[24:27]
TR v[12:13],v1,1024
M a[28:31],v[16:19],v[48:51],a[28:31]
WL 3
TR v[14:15],v1,9216
M a[32:35],v[20:23],v[36:39],a[32:35]
M a[36:39],v[20:23],v[40:43],a[36:39]
M a[40:43],v[20:23],v[44:47],a[40:43]
TR v[16:17],v1,1032
M a[44:47],v[20:23],v[48:51],a[44:47]
WL 3
TR v[18:19],v1,9224
M a[48:51],v[24:27],v[36:39],a[48:51]
M a[52:55],v[24:27],v[40:43],a[52:55]
s_add_u32 m0, s53, 82816
s_nop 0
buffer_load_dwordx4 v3, s[16:19], s42 offen offset:128 nt lds
M a[56:59],v[24:27],v[44:47],a[56:59]
TR v[20:21],v1,1536
M a[60:63],v[24:27],v[48:51],a[60:63]
WL 3
TR v[22:23],v1,9728
M a[64:67],v[12:15],v[36:39],a[64:67]
M a[68:71],v[12:15],v[40:43],a[68:71]
M a[72:75],v[12:15],v[44:47],a[72:75]
TR v[24:25],v1,1544
M a[76:79],v[12:15],v[48:51],a[76:79]
WL 3
TR v[26:27],v1,9736
M a[80:83],v[16:19],v[36:39],a[80:83]
M a[84:87],v[16:19],v[40:43],a[84:87]
M a[88:91],v[16:19],v[44:47],a[88:91]
TR v[12:13],v1,2048
M a[92:95],v[16:19],v[48:51],a[92:95]
WL 3
TR v[14:15],v1,10240
M a[96:99],v[20:23],v[36:39],a[96:99]
M a[100:103],v[20:23],v[40:43],a[100:103]
s_add_u32 m0, s53, 83712
s_nop 0
buffer_load_dwordx4 v3, s[16:19], s42 offen offset:256 nt lds
M a[104:107],v[20:23],v[44:47],a[104:107]
TR v[16:17],v1,2056
M a[108:111],v[20:23],v[48:51],a[108:111]
WL 3
TR v[18:19],v1,10248
M a[112:115],v[24:27],v[36:39],a[112:115]
M a[116:119],v[24:27],v[40:43],a[116:119]
M a[120:123],v[24:27],v[44:47],a[120:123]
TR v[20:21],v1,2560
M a[124:127],v[24:27],v[48:51],a[124:127]
WL 3
TR v[22:23],v1,10752
M a[128:131],v[12:15],v[36:39],a[128:131]
M a[132:135],v[12:15],v[40:43],a[132:135]
M a[136:139],v[12:15],v[44:47],a[136:139]
TR v[24:25],v1,2568
M a[140:143],v[12:15],v[48:51],a[140:143]
WL 3
TR v[26:27],v1,10760
M a[144:147],v[16:19],v[36:39],a[144:147]
M a[148:151],v[16:19],v[40:43],a[148:151]
s_add_u32 m0, s53, 84608
s_nop 0
buffer_load_dwordx4 v3, s[16:19], s42 offen offset:384 nt lds
s_add_u32 s42, s42, 16384
M a[152:155],v[16:19],v[44:47],a[152:155]
TR v[12:13],v1,3072
M a[156:159],v[16:19],v[48:51],a[156:159]
WL 3
TR v[14:15],v1,11264
M a[160:163],v[20:23],v[36:39],a[160:163]
M a[164:167],v[20:23],v[40:43],a[164:167]
M a[168:171],v[20:23],v[44:47],a[168:171]
TR v[16:17],v1,3080
M a[172:175],v[20:23],v[48:51],a[172:175]
WL 3
TR v[18:19],v1,11272
M a[176:179],v[24:27],v[36:39],a[176:179]
M a[180:183],v[24:27],v[40:43],a[180:183]
M a[184:187],v[24:27],v[44:47],a[184:187]
TR v[20:21],v1,3584
M a[188:191],v[24:27],v[48:51],a[188:191]
WL 3
TR v[22:23],v1,11776
M a[192:195],v[12:15],v[36:39],a[192:195]
M a[196:199],v[12:15],v[40:43],a[196:199]
M a[200:203],v[12:15],v[44:47],a[200:203]
TR v[24:25],v1,3592
M a[204:207],v[12:15],v[48:51],a[204:207]
WL 3
TR v[26:27],v1,11784
M a[208:211],v[16:19],v[36:39],a[208:211]
WV 13
M a[212:215],v[16:19],v[40:43],a[212:215]
s_barrier
M a[216:219],v[16:19],v[44:47],a[216:219]
M a[220:223],v[16:19],v[48:51],a[220:223]
WL 2
M a[224:227],v[20:23],v[36:39],a[224:227]
M a[228:231],v[20:23],v[40:43],a[228:231]
M a[232:235],v[20:23],v[44:47],a[232:235]
M a[236:239],v[20:23],v[48:51],a[236:239]
WL 0
M a[240:243],v[24:27],v[36:39],a[240:243]
M a[244:247],v[24:27],v[40:43],a[244:247]
M a[248:251],v[24:27],v[44:47],a[248:251]
M a[252:255],v[24:27],v[48:51],a[252:255]
WV 9
L1_conv_4:
v_subrev_u32 v36, s62, v2
v_lshrrev_b32 v36, 4, v36
v_lshrrev_b32 v37, 4, v36
v_lshlrev_b32 v10, 5, v37
v_and_b32 v37, 1, v36
v_lshl_add_u32 v10, v37, 4, v10
s_movk_i32 s6, 896
v_bfe_u32 v37, v36, 1, 3
v_mad_u32_u24 v10, v37, s6, v10
s_movk_i32 s7, 7168
v_bfe_u32 v37, v36, 2, 3
v_lshlrev_b32 v11, 5, v37
v_lshrrev_b32 v37, 5, v36
v_mad_u32_u24 v11, v37, s7, v11
v_and_b32 v37, 3, v36
v_lshl_add_u32 v11, v37, 3, v11
s_mul_i32 s6, s3, 1792
s_add_u32 s6, s6, 49152
v_add_u32 v11, s6, v11
v_lshrrev_b32 v37, 5, v36
v_lshlrev_b32 v1, 12, v37
v_bfe_u32 v37, v36, 2, 3
v_lshl_add_u32 v1, v37, 6, v1
v_bfe_u32 v37, v36, 4, 1
v_lshl_add_u32 v1, v37, 5, v1
v_and_b32 v37, 3, v36
v_lshl_add_u32 v1, v37, 3, v1
v_add_u32 v1, 131072, v1
v_xor_b32 v9, 32, v1
s_add_u32 s44, s53, 81920
s_add_u32 s45, s53, 16384
s_sub_u32 s46, s53, 16384
s_add_u32 s61, s53, 49152
s_add_u32 s47, s53, 0
s_add_u32 s48, s53, 32768
s_add_u32 s49, s53, 65536
s_mul_i32 s5, s3, 7168
s_add_u32 m0, s5, 49152
s_nop 0
buffer_load_dwordx4 v10, s[24:27], s5 offen offset:0 lds
s_add_u32 m0, s5, 50048
s_nop 0
buffer_load_dwordx4 v10, s[24:27], s5 offen offset:128 lds
s_add_u32 m0, s5, 50944
s_nop 0
buffer_load_dwordx4 v10, s[24:27], s5 offen offset:256 lds
s_add_u32 m0, s5, 51840
s_nop 0
buffer_load_dwordx4 v10, s[24:27], s5 offen offset:384 lds
s_add_u32 m0, s5, 52736
s_nop 0
buffer_load_dwordx4 v10, s[24:27], s5 offen offset:512 lds
s_add_u32 m0, s5, 53632
s_nop 0
buffer_load_dwordx4 v10, s[24:27], s5 offen offset:640 lds
s_add_u32 m0, s5, 54528
s_nop 0
buffer_load_dwordx4 v10, s[24:27], s5 offen offset:768 lds
v_mov_b32 v4, 0
v_mov_b32 v5, 0
v_mov_b32 v6, 0
v_mov_b32 v7, 0
AR v56,a0
AR v57,a1
AR v58,a2
AR v59,a3
PM v[56:57],v[56:57],s[54:55]
PM v[58:59],v[58:59],s[54:55]
AR v60,a16
AR v61,a17
AR v62,a18
AR v63,a19
PM v[60:61],v[60:61],s[54:55]
PM v[62:63],v[62:63],s[54:55]
CV v96,v56,v57
CV v97,v58,v59
CV v98,v60,v61
CV v99,v62,v63
AR v64,a4
AR v65,a5
AR v66,a6
AR v67,a7
PM v[64:65],v[64:65],s[54:55]
PM v[66:67],v[66:67],s[54:55]
AR v68,a20
AR v69,a21
AR v70,a22
AR v71,a23
PM v[68:69],v[68:69],s[54:55]
PM v[70:71],v[70:71],s[54:55]
CV v128,v64,v65
CV v129,v66,v67
CV v130,v68,v69
CV v131,v70,v71
AR v72,a8
AR v73,a9
AR v74,a10
AR v75,a11
PM v[72:73],v[72:73],s[54:55]
PM v[74:75],v[74:75],s[54:55]
AR v76,a24
AR v77,a25
AR v78,a26
AR v79,a27
PM v[76:77],v[76:77],s[54:55]
PM v[78:79],v[78:79],s[54:55]
CV v160,v72,v73
CV v161,v74,v75
CV v162,v76,v77
CV v163,v78,v79
AR v80,a12
AR v81,a13
AR v82,a14
AR v83,a15
PM v[80:81],v[80:81],s[54:55]
PM v[82:83],v[82:83],s[54:55]
AR v84,a28
AR v85,a29
AR v86,a30
AR v87,a31
PM v[84:85],v[84:85],s[54:55]
PM v[86:87],v[86:87],s[54:55]
CV v192,v80,v81
CV v193,v82,v83
CV v194,v84,v85
CV v195,v86,v87
AR v56,a32
AR v57,a33
AR v58,a34
AR v59,a35
PM v[56:57],v[56:57],s[54:55]
PM v[58:59],v[58:59],s[54:55]
AR v60,a48
AR v61,a49
AR v62,a50
AR v63,a51
PM v[60:61],v[60:61],s[54:55]
PM v[62:63],v[62:63],s[54:55]
CV v100,v56,v57
CV v101,v58,v59
CV v102,v60,v61
CV v103,v62,v63
AR v64,a36
AR v65,a37
AR v66,a38
AR v67,a39
PM v[64:65],v[64:65],s[54:55]
PM v[66:67],v[66:67],s[54:55]
AR v68,a52
AR v69,a53
AR v70,a54
AR v71,a55
PM v[68:69],v[68:69],s[54:55]
PM v[70:71],v[70:71],s[54:55]
CV v132,v64,v65
CV v133,v66,v67
CV v134,v68,v69
CV v135,v70,v71
AR v72,a40
AR v73,a41
AR v74,a42
AR v75,a43
PM v[72:73],v[72:73],s[54:55]
PM v[74:75],v[74:75],s[54:55]
AR v76,a56
AR v77,a57
AR v78,a58
AR v79,a59
PM v[76:77],v[76:77],s[54:55]
PM v[78:79],v[78:79],s[54:55]
CV v164,v72,v73
CV v165,v74,v75
CV v166,v76,v77
CV v167,v78,v79
AR v80,a44
AR v81,a45
AR v82,a46
AR v83,a47
PM v[80:81],v[80:81],s[54:55]
PM v[82:83],v[82:83],s[54:55]
AR v84,a60
AR v85,a61
AR v86,a62
AR v87,a63
PM v[84:85],v[84:85],s[54:55]
PM v[86:87],v[86:87],s[54:55]
CV v196,v80,v81
CV v197,v82,v83
CV v198,v84,v85
CV v199,v86,v87
AR v56,a64
AR v57,a65
AR v58,a66
AR v59,a67
PM v[56:57],v[56:57],s[54:55]
PM v[58:59],v[58:59],s[54:55]
AR v60,a80
AR v61,a81
AR v62,a82
AR v63,a83
PM v[60:61],v[60:61],s[54:55]
PM v[62:63],v[62:63],s[54:55]
CV v104,v56,v57
CV v105,v58,v59
CV v106,v60,v61
CV v107,v62,v63
AR v64,a68
AR v65,a69
AR v66,a70
AR v67,a71
PM v[64:65],v[64:65],s[54:55]
PM v[66:67],v[66:67],s[54:55]
AR v68,a84
AR v69,a85
AR v70,a86
AR v71,a87
PM v[68:69],v[68:69],s[54:55]
PM v[70:71],v[70:71],s[54:55]
CV v136,v64,v65
CV v137,v66,v67
CV v138,v68,v69
CV v139,v70,v71
AR v72,a72
AR v73,a73
AR v74,a74
AR v75,a75
PM v[72:73],v[72:73],s[54:55]
PM v[74:75],v[74:75],s[54:55]
AR v76,a88
AR v77,a89
AR v78,a90
AR v79,a91
PM v[76:77],v[76:77],s[54:55]
PM v[78:79],v[78:79],s[54:55]
CV v168,v72,v73
CV v169,v74,v75
CV v170,v76,v77
CV v171,v78,v79
AR v80,a76
AR v81,a77
AR v82,a78
AR v83,a79
PM v[80:81],v[80:81],s[54:55]
PM v[82:83],v[82:83],s[54:55]
AR v84,a92
AR v85,a93
AR v86,a94
AR v87,a95
PM v[84:85],v[84:85],s[54:55]
PM v[86:87],v[86:87],s[54:55]
CV v200,v80,v81
CV v201,v82,v83
CV v202,v84,v85
CV v203,v86,v87
AR v56,a96
AR v57,a97
AR v58,a98
AR v59,a99
PM v[56:57],v[56:57],s[54:55]
PM v[58:59],v[58:59],s[54:55]
AR v60,a112
AR v61,a113
AR v62,a114
AR v63,a115
PM v[60:61],v[60:61],s[54:55]
PM v[62:63],v[62:63],s[54:55]
CV v108,v56,v57
CV v109,v58,v59
CV v110,v60,v61
CV v111,v62,v63
AR v64,a100
AR v65,a101
AR v66,a102
AR v67,a103
PM v[64:65],v[64:65],s[54:55]
PM v[66:67],v[66:67],s[54:55]
AR v68,a116
AR v69,a117
AR v70,a118
AR v71,a119
PM v[68:69],v[68:69],s[54:55]
PM v[70:71],v[70:71],s[54:55]
CV v140,v64,v65
CV v141,v66,v67
CV v142,v68,v69
CV v143,v70,v71
AR v72,a104
AR v73,a105
AR v74,a106
AR v75,a107
PM v[72:73],v[72:73],s[54:55]
PM v[74:75],v[74:75],s[54:55]
AR v76,a120
AR v77,a121
AR v78,a122
AR v79,a123
PM v[76:77],v[76:77],s[54:55]
PM v[78:79],v[78:79],s[54:55]
CV v172,v72,v73
CV v173,v74,v75
CV v174,v76,v77
CV v175,v78,v79
AR v80,a108
AR v81,a109
AR v82,a110
AR v83,a111
PM v[80:81],v[80:81],s[54:55]
PM v[82:83],v[82:83],s[54:55]
AR v84,a124
AR v85,a125
AR v86,a126
AR v87,a127
PM v[84:85],v[84:85],s[54:55]
PM v[86:87],v[86:87],s[54:55]
CV v204,v80,v81
CV v205,v82,v83
CV v206,v84,v85
CV v207,v86,v87
AR v56,a128
AR v57,a129
AR v58,a130
AR v59,a131
PM v[56:57],v[56:57],s[54:55]
PM v[58:59],v[58:59],s[54:55]
AR v60,a144
AR v61,a145
AR v62,a146
AR v63,a147
PM v[60:61],v[60:61],s[54:55]
PM v[62:63],v[62:63],s[54:55]
CV v112,v56,v57
CV v113,v58,v59
CV v114,v60,v61
CV v115,v62,v63
AR v64,a132
AR v65,a133
AR v66,a134
AR v67,a135
PM v[64:65],v[64:65],s[54:55]
PM v[66:67],v[66:67],s[54:55]
AR v68,a148
AR v69,a149
AR v70,a150
AR v71,a151
PM v[68:69],v[68:69],s[54:55]
PM v[70:71],v[70:71],s[54:55]
CV v144,v64,v65
CV v145,v66,v67
CV v146,v68,v69
CV v147,v70,v71
AR v72,a136
AR v73,a137
AR v74,a138
AR v75,a139
PM v[72:73],v[72:73],s[54:55]
PM v[74:75],v[74:75],s[54:55]
AR v76,a152
AR v77,a153
AR v78,a154
AR v79,a155
PM v[76:77],v[76:77],s[54:55]
PM v[78:79],v[78:79],s[54:55]
CV v176,v72,v73
CV v177,v74,v75
CV v178,v76,v77
CV v179,v78,v79
AR v80,a140
AR v81,a141
AR v82,a142
AR v83,a143
PM v[80:81],v[80:81],s[54:55]
PM v[82:83],v[82:83],s[54:55]
AR v84,a156
AR v85,a157
AR v86,a158
AR v87,a159
PM v[84:85],v[84:85],s[54:55]
PM v[86:87],v[86:87],s[54:55]
CV v208,v80,v81
CV v209,v82,v83
CV v210,v84,v85
CV v211,v86,v87
AR v56,a160
AR v57,a161
AR v58,a162
AR v59,a163
PM v[56:57],v[56:57],s[54:55]
PM v[58:59],v[58:59],s[54:55]
AR v60,a176
AR v61,a177
AR v62,a178
AR v63,a179
PM v[60:61],v[60:61],s[54:55]
PM v[62:63],v[62:63],s[54:55]
CV v116,v56,v57
CV v117,v58,v59
CV v118,v60,v61
CV v119,v62,v63
AR v64,a164
AR v65,a165
AR v66,a166
AR v67,a167
PM v[64:65],v[64:65],s[54:55]
PM v[66:67],v[66:67],s[54:55]
AR v68,a180
AR v69,a181
AR v70,a182
AR v71,a183
PM v[68:69],v[68:69],s[54:55]
PM v[70:71],v[70:71],s[54:55]
CV v148,v64,v65
CV v149,v66,v67
CV v150,v68,v69
CV v151,v70,v71
AR v72,a168
AR v73,a169
AR v74,a170
AR v75,a171
PM v[72:73],v[72:73],s[54:55]
PM v[74:75],v[74:75],s[54:55]
AR v76,a184
AR v77,a185
AR v78,a186
AR v79,a187
PM v[76:77],v[76:77],s[54:55]
PM v[78:79],v[78:79],s[54:55]
CV v180,v72,v73
CV v181,v74,v75
CV v182,v76,v77
CV v183,v78,v79
AR v80,a172
AR v81,a173
AR v82,a174
AR v83,a175
PM v[80:81],v[80:81],s[54:55]
PM v[82:83],v[82:83],s[54:55]
AR v84,a188
AR v85,a189
AR v86,a190
AR v87,a191
PM v[84:85],v[84:85],s[54:55]
PM v[86:87],v[86:87],s[54:55]
CV v212,v80,v81
CV v213,v82,v83
CV v214,v84,v85
CV v215,v86,v87
AR v56,a192
AR v57,a193
AR v58,a194
AR v59,a195
PM v[56:57],v[56:57],s[54:55]
PM v[58:59],v[58:59],s[54:55]
AR v60,a208
AR v61,a209
AR v62,a210
AR v63,a211
PM v[60:61],v[60:61],s[54:55]
PM v[62:63],v[62:63],s[54:55]
CV v120,v56,v57
CV v121,v58,v59
CV v122,v60,v61
CV v123,v62,v63
AR v64,a196
AR v65,a197
AR v66,a198
AR v67,a199
PM v[64:65],v[64:65],s[54:55]
PM v[66:67],v[66:67],s[54:55]
AR v68,a212
AR v69,a213
AR v70,a214
AR v71,a215
PM v[68:69],v[68:69],s[54:55]
PM v[70:71],v[70:71],s[54:55]
CV v152,v64,v65
CV v153,v66,v67
CV v154,v68,v69
CV v155,v70,v71
AR v72,a200
AR v73,a201
AR v74,a202
AR v75,a203
PM v[72:73],v[72:73],s[54:55]
PM v[74:75],v[74:75],s[54:55]
AR v76,a216
AR v77,a217
AR v78,a218
AR v79,a219
PM v[76:77],v[76:77],s[54:55]
PM v[78:79],v[78:79],s[54:55]
CV v184,v72,v73
CV v185,v74,v75
CV v186,v76,v77
CV v187,v78,v79
AR v80,a204
AR v81,a205
AR v82,a206
AR v83,a207
PM v[80:81],v[80:81],s[54:55]
PM v[82:83],v[82:83],s[54:55]
AR v84,a220
AR v85,a221
AR v86,a222
AR v87,a223
PM v[84:85],v[84:85],s[54:55]
PM v[86:87],v[86:87],s[54:55]
CV v216,v80,v81
CV v217,v82,v83
CV v218,v84,v85
CV v219,v86,v87
AR v56,a224
AR v57,a225
AR v58,a226
AR v59,a227
PM v[56:57],v[56:57],s[54:55]
PM v[58:59],v[58:59],s[54:55]
AR v60,a240
AR v61,a241
AR v62,a242
AR v63,a243
PM v[60:61],v[60:61],s[54:55]
PM v[62:63],v[62:63],s[54:55]
CV v124,v56,v57
CV v125,v58,v59
CV v126,v60,v61
CV v127,v62,v63
AR v64,a228
AR v65,a229
AR v66,a230
AR v67,a231
PM v[64:65],v[64:65],s[54:55]
PM v[66:67],v[66:67],s[54:55]
AR v68,a244
AR v69,a245
AR v70,a246
AR v71,a247
PM v[68:69],v[68:69],s[54:55]
PM v[70:71],v[70:71],s[54:55]
CV v156,v64,v65
CV v157,v66,v67
CV v158,v68,v69
CV v159,v70,v71
AR v72,a232
AR v73,a233
AR v74,a234
AR v75,a235
PM v[72:73],v[72:73],s[54:55]
PM v[74:75],v[74:75],s[54:55]
AR v76,a248
AR v77,a249
AR v78,a250
AR v79,a251
PM v[76:77],v[76:77],s[54:55]
PM v[78:79],v[78:79],s[54:55]
CV v188,v72,v73
CV v189,v74,v75
CV v190,v76,v77
CV v191,v78,v79
AR v80,a236
AR v81,a237
AR v82,a238
AR v83,a239
PM v[80:81],v[80:81],s[54:55]
PM v[82:83],v[82:83],s[54:55]
AR v84,a252
AR v85,a253
AR v86,a254
AR v87,a255
PM v[84:85],v[84:85],s[54:55]
PM v[86:87],v[86:87],s[54:55]
CV v220,v80,v81
CV v221,v82,v83
CV v222,v84,v85
CV v223,v86,v87
WL 0
RD v[12:15],v0,0
RD v[16:19],v0,8192
RD v[20:23],v0,512
WL 2
M v[36:39],v[12:15],v[96:99],0
M v[40:43],v[12:15],v[128:131],0
s_barrier
M v[44:47],v[12:15],v[160:163],0
RD v[24:27],v0,8704
v_subrev_u32 v10, s62, v2
M v[48:51],v[12:15],v[192:195],0
WL 2
M v[52:55],v[16:19],v[96:99],0
M v[72:75],v[16:19],v[128:131],0
M v[92:95],v[16:19],v[160:163],0
s_add_u32 m0, s53, 16384
RD v[12:15],v0,1024
M v[252:255],v[16:19],v[192:195],0
WL 2
buffer_load_dwordx4 v3, s[16:19], s42 offen offset:0 nt lds
M v[36:39],v[20:23],v[100:103],v[36:39]
M v[40:43],v[20:23],v[132:135],v[40:43]
M v[44:47],v[20:23],v[164:167],v[44:47]
RD v[16:19],v0,9216
M v[48:51],v[20:23],v[196:199],v[48:51]
WL 2
M v[52:55],v[24:27],v[100:103],v[52:55]
M v[72:75],v[24:27],v[132:135],v[72:75]
M v[92:95],v[24:27],v[164:167],v[92:95]
RD v[20:23],v0,1536
M v[252:255],v[24:27],v[196:199],v[252:255]
WL 2
M v[36:39],v[12:15],v[104:107],v[36:39]
M v[40:43],v[12:15],v[136:139],v[40:43]
M v[44:47],v[12:15],v[168:171],v[44:47]
s_add_u32 m0, s53, 17280
RD v[24:27],v0,9728
M v[48:51],v[12:15],v[200:203],v[48:51]
WL 2
buffer_load_dwordx4 v3, s[16:19], s42 offen offset:128 nt lds
M v[52:55],v[16:19],v[104:107],v[52:55]
M v[72:75],v[16:19],v[136:139],v[72:75]
M v[92:95],v[16:19],v[168:171],v[92:95]
RD v[12:15],v0,2048
M v[252:255],v[16:19],v[200:203],v[252:255]
WL 2
M v[36:39],v[20:23],v[108:111],v[36:39]
M v[40:43],v[20:23],v[140:143],v[40:43]
M v[44:47],v[20:23],v[172:175],v[44:47]
RD v[16:19],v0,10240
M v[48:51],v[20:23],v[204:207],v[48:51]
WL 2
M v[52:55],v[24:27],v[108:111],v[52:55]
M v[72:75],v[24:27],v[140:143],v[72:75]
M v[92:95],v[24:27],v[172:175],v[92:95]
s_add_u32 m0, s53, 18176
RD v[20:23],v0,2560
M v[252:255],v[24:27],v[204:207],v[252:255]
WL 2
buffer_load_dwordx4 v3, s[16:19], s42 offen offset:256 nt lds
M v[36:39],v[12:15],v[112:115],v[36:39]
M v[40:43],v[12:15],v[144:147],v[40:43]
M v[44:47],v[12:15],v[176:179],v[44:47]
RD v[24:27],v0,10752
M v[48:51],v[12:15],v[208:211],v[48:51]
WL 2
M v[52:55],v[16:19],v[112:115],v[52:55]
M v[72:75],v[16:19],v[144:147],v[72:75]
M v[92:95],v[16:19],v[176:179],v[92:95]
RD v[12:15],v0,3072
M v[252:255],v[16:19],v[208:211],v[252:255]
WL 2
M v[36:39],v[20:23],v[116:119],v[36:39]
M v[40:43],v[20:23],v[148:151],v[40:43]
M v[44:47],v[20:23],v[180:183],v[44:47]
s_add_u32 m0, s53, 19072
RD v[16:19],v0,11264
M v[48:51],v[20:23],v[212:215],v[48:51]
WL 2
buffer_load_dwordx4 v3, s[16:19], s42 offen offset:384 nt lds
s_add_u32 s42, s42, 16384
M v[52:55],v[24:27],v[116:119],v[52:55]
M v[72:75],v[24:27],v[148:151],v[72:75]
M v[92:95],v[24:27],v[180:183],v[92:95]
RD v[20:23],v0,3584
M v[252:255],v[24:27],v[212:215],v[252:255]
WL 2
M v[36:39],v[12:15],v[120:123],v[36:39]
M v[40:43],v[12:15],v[152:155],v[40:43]
M v[44:47],v[12:15],v[184:187],v[44:47]
RD v[24:27],v0,11776
M v[48:51],v[12:15],v[216:219],v[48:51]
WL 2
M v[52:55],v[16:19],v[120:123],v[52:55]
WV 4
v_add_u32 v0, 0x4000, v0
M v[72:75],v[16:19],v[152:155],v[72:75]
s_barrier
M v[92:95],v[16:19],v[184:187],v[92:95]
RD v[12:15],v0,0
TR v[224:225],v11,0
TR v[226:227],v11,14336
M v[252:255],v[16:19],v[216:219],v[252:255]
WL 4
TR v[228:229],v11,256
TR v[230:231],v11,14592
M v[36:39],v[20:23],v[124:127],v[36:39]
TR v[232:233],v11,512
TR v[234:235],v11,14848
M v[40:43],v[20:23],v[156:159],v[40:43]
TR v[236:237],v11,768
TR v[238:239],v11,15104
M v[44:47],v[20:23],v[188:191],v[44:47]
RD v[16:19],v0,8192
TR v[240:241],v11,1024
TR v[242:243],v11,15360
M v[48:51],v[20:23],v[220:223],v[48:51]
WL 12
TR v[244:245],v11,1280
TR v[246:247],v11,15616
M v[52:55],v[24:27],v[124:127],v[52:55]
TR v[248:249],v11,1536
TR v[250:251],v11,15872
M v[72:75],v[24:27],v[156:159],v[72:75]
M v[92:95],v[24:27],v[188:191],v[92:95]
RD v[20:23],v0,512
v_exp_f32 v36, v36
M v[252:255],v[24:27],v[220:223],v[252:255]
v_exp_f32 v37, v37
WL 0
M v[76:79],v[12:15],v[96:99],0
v_exp_f32 v38, v38
M v[80:83],v[12:15],v[128:131],0
s_barrier
v_exp_f32 v39, v39
v_add_f32 v4, v4, v36
M v[84:87],v[12:15],v[160:163],0
s_add_u32 s51, s60, 4096
RD v[24:27],v0,8704
v_add_f32 v4, v4, v37
M v[88:91],v[12:15],v[192:195],0
v_exp_f32 v40, v40
v_add_f32 v4, v4, v38
M v[56:59],v[16:19],v[96:99],0
s_add_u32 m0, s53, 0
v_exp_f32 v41, v41
M v[60:63],v[16:19],v[128:131],0
buffer_load_dwordx4 v3, s[20:23], s43 offen offset:0 nt lds
v_exp_f32 v42, v42
M v[64:67],v[16:19],v[160:163],0
RD v[12:15],v0,1024
v_add_f32 v4, v4, v39
M v[68:71],v[16:19],v[192:195],0
buffer_store_dwordx4 v[224:227], v10, s[28:31], s60 offen offset:0 sc1
v_exp_f32 v43, v43
M v[76:79],v[20:23],v[100:103],v[76:79]
s_add_u32 m0, s53, 896
CV v36,v36,v37
CV v37,v38,v39
M v[80:83],v[20:23],v[132:135],v[80:83]
buffer_load_dwordx4 v3, s[20:23], s43 offen offset:128 nt lds
v_exp_f32 v44, v44
M v[84:87],v[20:23],v[164:167],v[84:87]
RD v[16:19],v0,9216
v_add_f32 v5, v5, v40
M v[88:91],v[20:23],v[196:199],v[88:91]
WL 2
buffer_store_dwordx4 v[228:231], v10, s[28:31], s60 offen offset:1024 sc1
v_exp_f32 v45, v45
M v[56:59],v[24:27],v[100:103],v[56:59]
v_exp_f32 v46, v46
M v[60:63],v[24:27],v[132:135],v[60:63]
buffer_store_dwordx4 v[232:235], v10, s[28:31], s60 offen offset:2048 sc1
v_exp_f32 v47, v47
M v[64:67],v[24:27],v[164:167],v[64:67]
s_add_u32 m0, s53, 1792
RD v[20:23],v0,1536
v_add_f32 v5, v5, v41
M v[68:71],v[24:27],v[196:199],v[68:71]
WL 2
buffer_load_dwordx4 v3, s[20:23], s43 offen offset:256 nt lds
v_add_f32 v5, v5, v42
v_add_f32 v5, v5, v43
M v[76:79],v[12:15],v[104:107],v[76:79]
buffer_store_dwordx4 v[236:239], v10, s[28:31], s60 offen offset:3072 sc1
CV v40,v40,v41
M v[80:83],v[12:15],v[136:139],v[80:83]
v_exp_f32 v48, v48
CV v41,v42,v43
M v[84:87],v[12:15],v[168:171],v[84:87]
s_add_u32 m0, s53, 2688
RD v[24:27],v0,9728
v_add_f32 v6, v6, v44
M v[88:91],v[12:15],v[200:203],v[88:91]
WL 2
buffer_load_dwordx4 v3, s[20:23], s43 offen offset:384 nt lds
v_exp_f32 v49, v49
s_add_u32 s43, s43, 16384
M v[56:59],v[16:19],v[104:107],v[56:59]
buffer_store_dwordx4 v[240:243], v10, s[28:31], s51 offen offset:0 sc1
v_add_f32 v6, v6, v45
M v[60:63],v[16:19],v[136:139],v[60:63]
v_exp_f32 v50, v50
v_add_f32 v6, v6, v46
M v[64:67],v[16:19],v[168:171],v[64:67]
RD v[12:15],v0,2048
v_add_f32 v6, v6, v47
M v[68:71],v[16:19],v[200:203],v[68:71]
WL 2
buffer_store_dwordx4 v[244:247], v10, s[28:31], s51 offen offset:1024 sc1
v_exp_f32 v51, v51
M v[76:79],v[20:23],v[108:111],v[76:79]
s_sub_u32 m0, s53, 16384
CV v44,v44,v45
CV v45,v46,v47
M v[80:83],v[20:23],v[140:143],v[80:83]
buffer_load_dwordx4 v3, s[16:19], s42 offen offset:0 nt lds
v_exp_f32 v52, v52
M v[84:87],v[20:23],v[172:175],v[84:87]
RD v[16:19],v0,10240
v_add_f32 v7, v7, v48
M v[88:91],v[20:23],v[204:207],v[88:91]
WL 2
buffer_store_dwordx4 v[248:251], v10, s[28:31], s51 offen offset:2048 sc1
v_exp_f32 v53, v53
M v[56:59],v[24:27],v[108:111],v[56:59]
v_exp_f32 v54, v54
M v[60:63],v[24:27],v[140:143],v[60:63]
v_mov_b32 v10, 0
v_exp_f32 v55, v55
M v[64:67],v[24:27],v[172:175],v[64:67]
s_sub_u32 m0, s53, 15488
RD v[20:23],v0,2560
v_add_f32 v7, v7, v49
M v[68:71],v[24:27],v[204:207],v[68:71]
WL 2
buffer_load_dwordx4 v3, s[16:19], s42 offen offset:128 nt lds
v_add_f32 v7, v7, v50
v_add_f32 v7, v7, v51
M v[76:79],v[12:15],v[112:115],v[76:79]
CV v48,v48,v49
CV v49,v50,v51
M v[80:83],v[12:15],v[144:147],v[80:83]
v_exp_f32 v72, v72
v_add_f32 v4, v4, v52
M v[84:87],v[12:15],v[176:179],v[84:87]
s_sub_u32 m0, s53, 14592
RD v[24:27],v0,10752
v_add_f32 v4, v4, v53
M v[88:91],v[12:15],v[208:211],v[88:91]
WL 2
buffer_load_dwordx4 v3, s[16:19], s42 offen offset:256 nt lds
v_exp_f32 v73, v73
M v[56:59],v[16:19],v[112:115],v[56:59]
v_exp_f32 v74, v74
M v[60:63],v[16:19],v[144:147],v[60:63]
v_exp_f32 v75, v75
v_add_f32 v4, v4, v54
M v[64:67],v[16:19],v[176:179],v[64:67]
RD v[12:15],v0,3072
v_add_f32 v4, v4, v55
M v[68:71],v[16:19],v[208:211],v[68:71]
WL 2
CV v38,v52,v53
v_exp_f32 v92, v92
M v[76:79],v[20:23],v[116:119],v[76:79]
s_sub_u32 m0, s53, 13696
v_exp_f32 v93, v93
M v[80:83],v[20:23],v[148:151],v[80:83]
buffer_load_dwordx4 v3, s[16:19], s42 offen offset:384 nt lds
v_exp_f32 v94, v94
s_add_u32 s42, s42, 16384
M v[84:87],v[20:23],v[180:183],v[84:87]
RD v[16:19],v0,11264
CV v39,v54,v55
M v[88:91],v[20:23],v[212:215],v[88:91]
WL 2
v_exp_f32 v95, v95
v_add_f32 v5, v5, v72
M v[56:59],v[24:27],v[116:119],v[56:59]
v_add_f32 v5, v5, v73
v_add_f32 v5, v5, v74
M v[60:63],v[24:27],v[148:151],v[60:63]
v_add_f32 v5, v5, v75
CV v42,v72,v73
CV v43,v74,v75
M v[64:67],v[24:27],v[180:183],v[64:67]
RD v[20:23],v0,3584
v_add_f32 v6, v6, v92
M v[68:71],v[24:27],v[212:215],v[68:71]
WL 2
v_exp_f32 v252, v252
v_add_f32 v6, v6, v93
M v[76:79],v[12:15],v[120:123],v[76:79]
v_exp_f32 v253, v253
M v[80:83],v[12:15],v[152:155],v[80:83]
v_exp_f32 v254, v254
v_add_f32 v6, v6, v94
M v[84:87],v[12:15],v[184:187],v[84:87]
RD v[24:27],v0,11776
v_add_f32 v6, v6, v95
M v[88:91],v[12:15],v[216:219],v[88:91]
WL 2
v_exp_f32 v255, v255
CV v46,v92,v93
M v[56:59],v[16:19],v[120:123],v[56:59]
WV 23
CV v47,v94,v95
v_add_f32 v7, v7, v252
v_add_u32 v0, 0x8000, v0
M v[60:63],v[16:19],v[152:155],v[60:63]
s_barrier
v_add_f32 v7, v7, v253
v_add_f32 v7, v7, v254
v_add_f32 v7, v7, v255
M v[64:67],v[16:19],v[184:187],v[64:67]
TR v[12:13],v1,0
CV v50,v252,v253
M v[68:71],v[16:19],v[216:219],v[68:71]
WL 2
TR v[14:15],v1,8192
CV v51,v254,v255
M v[76:79],v[20:23],v[124:127],v[76:79]
s_add_u32 m0, s53, 32768
M v[80:83],v[20:23],v[156:159],v[80:83]
buffer_load_dwordx4 v3, s[20:23], s43 offen offset:0 nt lds
M v[84:87],v[20:23],v[188:191],v[84:87]
TR v[16:17],v9,0
M v[88:91],v[20:23],v[220:223],v[88:91]
WL 3
TR v[18:19],v9,8192
M v[56:59],v[24:27],v[124:127],v[56:59]
s_add_u32 m0, s53, 33664
M v[60:63],v[24:27],v[156:159],v[60:63]
buffer_load_dwordx4 v3, s[20:23], s43 offen offset:128 nt lds
M v[64:67],v[24:27],v[188:191],v[64:67]
TR v[20:21],v1,512
v_exp_f32 v76, v76
M v[68:71],v[24:27],v[220:223],v[68:71]
WL 3
TR v[22:23],v1,8704
v_exp_f32 v77, v77
M a[0:3],v[12:15],v[36:39],0
v_exp_f32 v78, v78
v_add_f32 v4, v4, v76
M a[4:7],v[12:15],v[40:43],0
v_exp_f32 v79, v79
v_add_f32 v4, v4, v77
M a[8:11],v[12:15],v[44:47],0
TR v[24:25],v9,512
v_exp_f32 v80, v80
M a[12:15],v[12:15],v[48:51],0
WL 3
TR v[26:27],v9,8704
v_exp_f32 v81, v81
M a[16:19],v[16:19],v[36:39],0
s_add_u32 m0, s53, 34560
v_add_f32 v4, v4, v78
v_exp_f32 v82, v82
M a[20:23],v[16:19],v[40:43],0
buffer_load_dwordx4 v3, s[20:23], s43 offen offset:256 nt lds
v_exp_f32 v83, v83
M a[24:27],v[16:19],v[44:47],0
TR v[12:13],v1,1024
v_add_f32 v4, v4, v79
CV v76,v76,v77
M a[28:31],v[16:19],v[48:51],0
WL 3
TR v[14:15],v1,9216
v_exp_f32 v84, v84
M a[32:35],v[20:23],v[36:39],0
s_add_u32 m0, s53, 35456
CV v77,v78,v79
v_exp_f32 v85, v85
M a[36:39],v[20:23],v[40:43],0
buffer_load_dwordx4 v3, s[20:23], s43 offen offset:384 nt lds
v_exp_f32 v86, v86
s_add_u32 s43, s43, 16384
M a[40:43],v[20:23],v[44:47],0
TR v[16:17],v9,1024
v_exp_f32 v87, v87
M a[44:47],v[20:23],v[48:51],0
WL 3
TR v[18:19],v9,9216
v_add_f32 v5, v5, v80
v_add_f32 v5, v5, v81
M a[48:51],v[24:27],v[36:39],0
v_add_f32 v5, v5, v82
v_add_f32 v5, v5, v83
CV v80,v80,v81
M a[52:55],v[24:27],v[40:43],0
CV v81,v82,v83
v_exp_f32 v88, v88
M a[56:59],v[24:27],v[44:47],0
TR v[20:21],v1,1536
v_exp_f32 v89, v89
M a[60:63],v[24:27],v[48:51],0
WL 3
TR v[22:23],v1,9728
v_exp_f32 v90, v90
M a[64:67],v[12:15],v[36:39],0
v_add_f32 v6, v6, v84
v_exp_f32 v91, v91
M a[68:71],v[12:15],v[40:43],0
v_add_f32 v6, v6, v85
v_add_f32 v6, v6, v86
v_add_f32 v6, v6, v87
M a[72:75],v[12:15],v[44:47],0
TR v[24:25],v9,1536
CV v84,v84,v85
CV v85,v86,v87
M a[76:79],v[12:15],v[48:51],0
WL 3
TR v[26:27],v9,9728
v_exp_f32 v56, v56
M a[80:83],v[16:19],v[36:39],0
v_add_f32 v7, v7, v88
v_exp_f32 v57, v57
M a[84:87],v[16:19],v[40:43],0
v_add_f32 v7, v7, v89
v_exp_f32 v58, v58
M a[88:91],v[16:19],v[44:47],0
TR v[12:13],v1,2048
v_exp_f32 v59, v59
M a[92:95],v[16:19],v[48:51],0
WL 3
TR v[14:15],v1,10240
v_add_f32 v7, v7, v90
v_add_f32 v7, v7, v91
M a[96:99],v[20:23],v[36:39],0
CV v88,v88,v89
v_exp_f32 v60, v60
M a[100:103],v[20:23],v[40:43],0
CV v89,v90,v91
v_exp_f32 v61, v61
M a[104:107],v[20:23],v[44:47],0
TR v[16:17],v9,2048
v_exp_f32 v62, v62
M a[108:111],v[20:23],v[48:51],0
WL 3
TR v[18:19],v9,10240
v_exp_f32 v63, v63
M a[112:115],v[24:27],v[36:39],0
v_add_f32 v4, v4, v56
v_add_f32 v4, v4, v57
v_add_f32 v4, v4, v58
M a[116:119],v[24:27],v[40:43],0
v_add_f32 v4, v4, v59
CV v78,v56,v57
CV v79,v58,v59
M a[120:123],v[24:27],v[44:47],0
TR v[20:21],v1,2560
v_exp_f32 v64, v64
M a[124:127],v[24:27],v[48:51],0
WL 3
TR v[22:23],v1,10752
v_exp_f32 v65, v65
M a[128:131],v[12:15],v[36:39],0
v_add_f32 v5, v5, v60
v_exp_f32 v66, v66
M a[132:135],v[12:15],v[40:43],0
v_add_f32 v5, v5, v61
v_exp_f32 v67, v67
M a[136:139],v[12:15],v[44:47],0
TR v[24:25],v9,2560
v_add_f32 v5, v5, v62
v_add_f32 v5, v5, v63
M a[140:143],v[12:15],v[48:51],0
WL 3
TR v[26:27],v9,10752
CV v82,v60,v61
CV v83,v62,v63
M a[144:147],v[16:19],v[36:39],0
v_add_f32 v6, v6, v64
v_exp_f32 v68, v68
M a[148:151],v[16:19],v[40:43],0
v_add_f32 v6, v6, v65
v_exp_f32 v69, v69
M a[152:155],v[16:19],v[44:47],0
TR v[12:13],v1,3072
v_exp_f32 v70, v70
M a[156:159],v[16:19],v[48:51],0
WL 3
TR v[14:15],v1,11264
v_exp_f32 v71, v71
M a[160:163],v[20:23],v[36:39],0
v_add_f32 v6, v6, v66
v_add_f32 v6, v6, v67
CV v86,v64,v65
M a[164:167],v[20:23],v[40:43],0
CV v87,v66,v67
v_add_f32 v7, v7, v68
v_add_f32 v7, v7, v69
M a[168:171],v[20:23],v[44:47],0
TR v[16:17],v9,3072
v_add_f32 v7, v7, v70
v_add_f32 v7, v7, v71
M a[172:175],v[20:23],v[48:51],0
WL 3
TR v[18:19],v9,11264
CV v90,v68,v69
CV v91,v70,v71
M a[176:179],v[24:27],v[36:39],0
M a[180:183],v[24:27],v[40:43],0
M a[184:187],v[24:27],v[44:47],0
TR v[20:21],v1,3584
M a[188:191],v[24:27],v[48:51],0
WL 3
TR v[22:23],v1,11776
M a[192:195],v[12:15],v[36:39],0
M a[196:199],v[12:15],v[40:43],0
M a[200:203],v[12:15],v[44:47],0
TR v[24:25],v9,3584
M a[204:207],v[12:15],v[48:51],0
WL 3
TR v[26:27],v9,11776
M a[208:211],v[16:19],v[36:39],0
WV 23
v_add_u32 v1, 0xffff0000, v1
M a[212:215],v[16:19],v[40:43],0
s_barrier
v_add_u32 v9, 0xffff0000, v9
M a[216:219],v[16:19],v[44:47],0
RD v[12:15],v0,0
M a[220:223],v[16:19],v[48:51],0
WL 3
M a[224:227],v[20:23],v[36:39],0
M a[228:231],v[20:23],v[40:43],0
M a[232:235],v[20:23],v[44:47],0
RD v[16:19],v0,8192
M a[236:239],v[20:23],v[48:51],0
WL 2
M a[240:243],v[24:27],v[36:39],0
M a[244:247],v[24:27],v[40:43],0
M a[248:251],v[24:27],v[44:47],0
RD v[20:23],v0,512
M a[252:255],v[24:27],v[48:51],0
s_mov_b32 s52, 15
s_lshl_b32 s6, s101, 2
s_add_u32 s6, s6, s3
s_mul_i32 s4, s6, 1639
s_lshr_b32 s4, s4, 16
s_mul_i32 s4, s4, 40
s_sub_u32 s4, s6, s4
s_lshr_b32 s5, s4, 2
s_lshl_b32 s5, s5, 12
s_and_b32 s4, s4, 3
s_lshl_b32 s4, s4, 7
s_add_u32 s4, s4, s5
s_add_u32 s100, s4, L1_post_5-concat_heads__mha_block_cached__mha_block_cached__near_ridge_kernel
L1_loop_4:
WL 2
M v[36:39],v[12:15],v[96:99],0
M v[40:43],v[12:15],v[128:131],0
M v[44:47],v[12:15],v[160:163],0
RD v[24:27],v0,8704
M v[48:51],v[12:15],v[192:195],0
WL 2
M v[56:59],v[16:19],v[96:99],0
M v[60:63],v[16:19],v[128:131],0
M v[64:67],v[16:19],v[160:163],0
s_add_u32 m0, s61, 0
RD v[12:15],v0,1024
M v[68:71],v[16:19],v[192:195],0
WL 2
buffer_load_dwordx4 v3, s[16:19], s42 offen offset:0 nt lds
M v[36:39],v[20:23],v[100:103],v[36:39]
M v[40:43],v[20:23],v[132:135],v[40:43]
M v[44:47],v[20:23],v[164:167],v[44:47]
RD v[16:19],v0,9216
M v[48:51],v[20:23],v[196:199],v[48:51]
WL 2
M v[56:59],v[24:27],v[100:103],v[56:59]
s_sub_u32 s50, s45, s44
M v[60:63],v[24:27],v[132:135],v[60:63]
M v[64:67],v[24:27],v[164:167],v[64:67]
RD v[20:23],v0,1536
M v[68:71],v[24:27],v[196:199],v[68:71]
WL 2
M v[36:39],v[12:15],v[104:107],v[36:39]
M v[40:43],v[12:15],v[136:139],v[40:43]
M v[44:47],v[12:15],v[168:171],v[44:47]
s_add_u32 m0, s61, 896
RD v[24:27],v0,9728
M v[48:51],v[12:15],v[200:203],v[48:51]
WL 2
buffer_load_dwordx4 v3, s[16:19], s42 offen offset:128 nt lds
M v[56:59],v[16:19],v[104:107],v[56:59]
M v[60:63],v[16:19],v[136:139],v[60:63]
M v[64:67],v[16:19],v[168:171],v[64:67]
RD v[12:15],v0,2048
M v[68:71],v[16:19],v[200:203],v[68:71]
WL 2
M v[36:39],v[20:23],v[108:111],v[36:39]
M v[40:43],v[20:23],v[140:143],v[40:43]
M v[44:47],v[20:23],v[172:175],v[44:47]
RD v[16:19],v0,10240
M v[48:51],v[20:23],v[204:207],v[48:51]
WL 2
M v[56:59],v[24:27],v[108:111],v[56:59]
M v[60:63],v[24:27],v[140:143],v[60:63]
M v[64:67],v[24:27],v[172:175],v[64:67]
s_add_u32 m0, s61, 1792
RD v[20:23],v0,2560
M v[68:71],v[24:27],v[204:207],v[68:71]
WL 2
buffer_load_dwordx4 v3, s[16:19], s42 offen offset:256 nt lds
M v[36:39],v[12:15],v[112:115],v[36:39]
M v[40:43],v[12:15],v[144:147],v[40:43]
M v[44:47],v[12:15],v[176:179],v[44:47]
RD v[24:27],v0,10752
M v[48:51],v[12:15],v[208:211],v[48:51]
WL 2
M v[56:59],v[16:19],v[112:115],v[56:59]
M v[60:63],v[16:19],v[144:147],v[60:63]
M v[64:67],v[16:19],v[176:179],v[64:67]
RD v[12:15],v0,3072
M v[68:71],v[16:19],v[208:211],v[68:71]
WL 2
M v[36:39],v[20:23],v[116:119],v[36:39]
M v[40:43],v[20:23],v[148:151],v[40:43]
M v[44:47],v[20:23],v[180:183],v[44:47]
s_add_u32 m0, s61, 2688
RD v[16:19],v0,11264
M v[48:51],v[20:23],v[212:215],v[48:51]
WL 2
buffer_load_dwordx4 v3, s[16:19], s42 offen offset:384 nt lds
s_add_u32 s42, s42, 16384
M v[56:59],v[24:27],v[116:119],v[56:59]
s_mov_b32 s51, s44
M v[60:63],v[24:27],v[148:151],v[60:63]
s_mov_b32 s44, s45
M v[64:67],v[24:27],v[180:183],v[64:67]
s_mov_b32 s45, s46
RD v[20:23],v0,3584
M v[68:71],v[24:27],v[212:215],v[68:71]
WL 2
M v[36:39],v[12:15],v[120:123],v[36:39]
s_mov_b32 s46, s61
M v[40:43],v[12:15],v[152:155],v[40:43]
s_mov_b32 s61, s51
M v[44:47],v[12:15],v[184:187],v[44:47]
RD v[24:27],v0,11776
M v[48:51],v[12:15],v[216:219],v[48:51]
WL 2
M v[56:59],v[16:19],v[120:123],v[56:59]
WV 12
v_add_u32 v0, s50, v0
M v[60:63],v[16:19],v[152:155],v[60:63]
s_barrier
M v[64:67],v[16:19],v[184:187],v[64:67]
TR v[12:13],v1,0
M v[68:71],v[16:19],v[216:219],v[68:71]
WL 2
TR v[14:15],v1,8192
M v[36:39],v[20:23],v[124:127],v[36:39]
s_add_u32 m0, s49, 0
M v[40:43],v[20:23],v[156:159],v[40:43]
buffer_load_dwordx4 v3, s[20:23], s43 offen offset:0 nt lds
M v[44:47],v[20:23],v[188:191],v[44:47]
TR v[16:17],v9,0
M v[48:51],v[20:23],v[220:223],v[48:51]
WL 3
TR v[18:19],v9,8192
M v[56:59],v[24:27],v[124:127],v[56:59]
s_add_u32 m0, s49, 896
M v[60:63],v[24:27],v[156:159],v[60:63]
buffer_load_dwordx4 v3, s[20:23], s43 offen offset:128 nt lds
M v[64:67],v[24:27],v[188:191],v[64:67]
TR v[20:21],v1,512
v_exp_f32 v36, v36
M v[68:71],v[24:27],v[220:223],v[68:71]
WL 3
TR v[22:23],v1,8704
v_exp_f32 v37, v37
M a[0:3],v[12:15],v[76:79],a[0:3]
v_exp_f32 v38, v38
v_add_f32 v4, v4, v36
M a[4:7],v[12:15],v[80:83],a[4:7]
v_exp_f32 v39, v39
v_add_f32 v4, v4, v37
M a[8:11],v[12:15],v[84:87],a[8:11]
TR v[24:25],v9,512
v_exp_f32 v40, v40
M a[12:15],v[12:15],v[88:91],a[12:15]
WL 3
TR v[26:27],v9,8704
v_exp_f32 v41, v41
M a[16:19],v[16:19],v[76:79],a[16:19]
s_add_u32 m0, s49, 1792
v_add_f32 v4, v4, v38
v_exp_f32 v42, v42
M a[20:23],v[16:19],v[80:83],a[20:23]
buffer_load_dwordx4 v3, s[20:23], s43 offen offset:256 nt lds
v_exp_f32 v43, v43
M a[24:27],v[16:19],v[84:87],a[24:27]
TR v[12:13],v1,1024
v_add_f32 v4, v4, v39
CV v36,v36,v37
M a[28:31],v[16:19],v[88:91],a[28:31]
WL 3
TR v[14:15],v1,9216
v_exp_f32 v44, v44
M a[32:35],v[20:23],v[76:79],a[32:35]
s_add_u32 m0, s49, 2688
CV v37,v38,v39
v_exp_f32 v45, v45
M a[36:39],v[20:23],v[80:83],a[36:39]
buffer_load_dwordx4 v3, s[20:23], s43 offen offset:384 nt lds
v_exp_f32 v46, v46
s_add_u32 s43, s43, 16384
M a[40:43],v[20:23],v[84:87],a[40:43]
s_sub_u32 s50, s48, s47
TR v[16:17],v9,1024
v_exp_f32 v47, v47
M a[44:47],v[20:23],v[88:91],a[44:47]
WL 3
TR v[18:19],v9,9216
v_add_f32 v5, v5, v40
v_add_f32 v5, v5, v41
M a[48:51],v[24:27],v[76:79],a[48:51]
s_mov_b32 s51, s47
v_add_f32 v5, v5, v42
v_add_f32 v5, v5, v43
CV v40,v40,v41
M a[52:55],v[24:27],v[80:83],a[52:55]
s_mov_b32 s47, s48
CV v41,v42,v43
v_exp_f32 v48, v48
M a[56:59],v[24:27],v[84:87],a[56:59]
s_mov_b32 s48, s49
TR v[20:21],v1,1536
v_exp_f32 v49, v49
M a[60:63],v[24:27],v[88:91],a[60:63]
WL 3
TR v[22:23],v1,9728
v_exp_f32 v50, v50
M a[64:67],v[12:15],v[76:79],a[64:67]
s_mov_b32 s49, s51
v_add_f32 v6, v6, v44
v_exp_f32 v51, v51
M a[68:71],v[12:15],v[80:83],a[68:71]
v_add_f32 v6, v6, v45
v_add_f32 v6, v6, v46
v_add_f32 v6, v6, v47
M a[72:75],v[12:15],v[84:87],a[72:75]
TR v[24:25],v9,1536
CV v44,v44,v45
CV v45,v46,v47
M a[76:79],v[12:15],v[88:91],a[76:79]
WL 3
TR v[26:27],v9,9728
v_exp_f32 v56, v56
M a[80:83],v[16:19],v[76:79],a[80:83]
v_add_f32 v7, v7, v48
v_exp_f32 v57, v57
M a[84:87],v[16:19],v[80:83],a[84:87]
v_add_f32 v7, v7, v49
v_exp_f32 v58, v58
M a[88:91],v[16:19],v[84:87],a[88:91]
TR v[12:13],v1,2048
v_exp_f32 v59, v59
M a[92:95],v[16:19],v[88:91],a[92:95]
WL 3
TR v[14:15],v1,10240
v_add_f32 v7, v7, v50
v_add_f32 v7, v7, v51
M a[96:99],v[20:23],v[76:79],a[96:99]
CV v48,v48,v49
v_exp_f32 v60, v60
M a[100:103],v[20:23],v[80:83],a[100:103]
CV v49,v50,v51
v_exp_f32 v61, v61
M a[104:107],v[20:23],v[84:87],a[104:107]
TR v[16:17],v9,2048
v_exp_f32 v62, v62
M a[108:111],v[20:23],v[88:91],a[108:111]
WL 3
TR v[18:19],v9,10240
v_exp_f32 v63, v63
M a[112:115],v[24:27],v[76:79],a[112:115]
v_add_f32 v4, v4, v56
v_add_f32 v4, v4, v57
v_add_f32 v4, v4, v58
M a[116:119],v[24:27],v[80:83],a[116:119]
v_add_f32 v4, v4, v59
CV v38,v56,v57
CV v39,v58,v59
M a[120:123],v[24:27],v[84:87],a[120:123]
TR v[20:21],v1,2560
v_exp_f32 v64, v64
M a[124:127],v[24:27],v[88:91],a[124:127]
WL 3
TR v[22:23],v1,10752
v_exp_f32 v65, v65
M a[128:131],v[12:15],v[76:79],a[128:131]
v_add_f32 v5, v5, v60
v_exp_f32 v66, v66
M a[132:135],v[12:15],v[80:83],a[132:135]
v_add_f32 v5, v5, v61
v_exp_f32 v67, v67
M a[136:139],v[12:15],v[84:87],a[136:139]
TR v[24:25],v9,2560
v_add_f32 v5, v5, v62
v_add_f32 v5, v5, v63
M a[140:143],v[12:15],v[88:91],a[140:143]
WL 3
TR v[26:27],v9,10752
CV v42,v60,v61
CV v43,v62,v63
M a[144:147],v[16:19],v[76:79],a[144:147]
v_add_f32 v6, v6, v64
v_exp_f32 v68, v68
M a[148:151],v[16:19],v[80:83],a[148:151]
v_add_f32 v6, v6, v65
v_exp_f32 v69, v69
M a[152:155],v[16:19],v[84:87],a[152:155]
TR v[12:13],v1,3072
v_exp_f32 v70, v70
M a[156:159],v[16:19],v[88:91],a[156:159]
WL 3
TR v[14:15],v1,11264
v_exp_f32 v71, v71
M a[160:163],v[20:23],v[76:79],a[160:163]
v_add_f32 v6, v6, v66
v_add_f32 v6, v6, v67
CV v46,v64,v65
M a[164:167],v[20:23],v[80:83],a[164:167]
CV v47,v66,v67
v_add_f32 v7, v7, v68
v_add_f32 v7, v7, v69
M a[168:171],v[20:23],v[84:87],a[168:171]
TR v[16:17],v9,3072
v_add_f32 v7, v7, v70
v_add_f32 v7, v7, v71
M a[172:175],v[20:23],v[88:91],a[172:175]
WL 3
TR v[18:19],v9,11264
CV v50,v68,v69
CV v51,v70,v71
M a[176:179],v[24:27],v[76:79],a[176:179]
M a[180:183],v[24:27],v[80:83],a[180:183]
M a[184:187],v[24:27],v[84:87],a[184:187]
TR v[20:21],v1,3584
M a[188:191],v[24:27],v[88:91],a[188:191]
WL 3
TR v[22:23],v1,11776
M a[192:195],v[12:15],v[76:79],a[192:195]
M a[196:199],v[12:15],v[80:83],a[196:199]
M a[200:203],v[12:15],v[84:87],a[200:203]
TR v[24:25],v9,3584
M a[204:207],v[12:15],v[88:91],a[204:207]
WL 3
TR v[26:27],v9,11776
M a[208:211],v[16:19],v[76:79],a[208:211]
WV 20
v_add_u32 v1, s50, v1
M a[212:215],v[16:19],v[80:83],a[212:215]
s_barrier
v_add_u32 v9, s50, v9
M a[216:219],v[16:19],v[84:87],a[216:219]
RD v[12:15],v0,0
M a[220:223],v[16:19],v[88:91],a[220:223]
WL 3
M a[224:227],v[20:23],v[76:79],a[224:227]
M a[228:231],v[20:23],v[80:83],a[228:231]
M a[232:235],v[20:23],v[84:87],a[232:235]
RD v[16:19],v0,8192
M a[236:239],v[20:23],v[88:91],a[236:239]
WL 2
M a[240:243],v[24:27],v[76:79],a[240:243]
M a[244:247],v[24:27],v[80:83],a[244:247]
M a[248:251],v[24:27],v[84:87],a[248:251]
RD v[20:23],v0,512
M a[252:255],v[24:27],v[88:91],a[252:255]
WL 2
M v[76:79],v[12:15],v[96:99],0
M v[80:83],v[12:15],v[128:131],0
M v[84:87],v[12:15],v[160:163],0
RD v[24:27],v0,8704
M v[88:91],v[12:15],v[192:195],0
WL 2
M v[56:59],v[16:19],v[96:99],0
M v[60:63],v[16:19],v[128:131],0
M v[64:67],v[16:19],v[160:163],0
s_add_u32 m0, s61, 0
RD v[12:15],v0,1024
M v[68:71],v[16:19],v[192:195],0
WL 2
buffer_load_dwordx4 v3, s[16:19], s42 offen offset:0 nt lds
M v[76:79],v[20:23],v[100:103],v[76:79]
M v[80:83],v[20:23],v[132:135],v[80:83]
M v[84:87],v[20:23],v[164:167],v[84:87]
RD v[16:19],v0,9216
M v[88:91],v[20:23],v[196:199],v[88:91]
WL 2
M v[56:59],v[24:27],v[100:103],v[56:59]
s_sub_u32 s50, s45, s44
M v[60:63],v[24:27],v[132:135],v[60:63]
M v[64:67],v[24:27],v[164:167],v[64:67]
RD v[20:23],v0,1536
M v[68:71],v[24:27],v[196:199],v[68:71]
WL 2
M v[76:79],v[12:15],v[104:107],v[76:79]
M v[80:83],v[12:15],v[136:139],v[80:83]
M v[84:87],v[12:15],v[168:171],v[84:87]
s_add_u32 m0, s61, 896
RD v[24:27],v0,9728
M v[88:91],v[12:15],v[200:203],v[88:91]
WL 2
buffer_load_dwordx4 v3, s[16:19], s42 offen offset:128 nt lds
M v[56:59],v[16:19],v[104:107],v[56:59]
M v[60:63],v[16:19],v[136:139],v[60:63]
M v[64:67],v[16:19],v[168:171],v[64:67]
RD v[12:15],v0,2048
M v[68:71],v[16:19],v[200:203],v[68:71]
WL 2
M v[76:79],v[20:23],v[108:111],v[76:79]
M v[80:83],v[20:23],v[140:143],v[80:83]
M v[84:87],v[20:23],v[172:175],v[84:87]
RD v[16:19],v0,10240
M v[88:91],v[20:23],v[204:207],v[88:91]
WL 2
M v[56:59],v[24:27],v[108:111],v[56:59]
M v[60:63],v[24:27],v[140:143],v[60:63]
M v[64:67],v[24:27],v[172:175],v[64:67]
s_add_u32 m0, s61, 1792
RD v[20:23],v0,2560
M v[68:71],v[24:27],v[204:207],v[68:71]
WL 2
buffer_load_dwordx4 v3, s[16:19], s42 offen offset:256 nt lds
M v[76:79],v[12:15],v[112:115],v[76:79]
M v[80:83],v[12:15],v[144:147],v[80:83]
M v[84:87],v[12:15],v[176:179],v[84:87]
RD v[24:27],v0,10752
M v[88:91],v[12:15],v[208:211],v[88:91]
WL 2
M v[56:59],v[16:19],v[112:115],v[56:59]
M v[60:63],v[16:19],v[144:147],v[60:63]
M v[64:67],v[16:19],v[176:179],v[64:67]
RD v[12:15],v0,3072
M v[68:71],v[16:19],v[208:211],v[68:71]
WL 2
M v[76:79],v[20:23],v[116:119],v[76:79]
M v[80:83],v[20:23],v[148:151],v[80:83]
M v[84:87],v[20:23],v[180:183],v[84:87]
s_add_u32 m0, s61, 2688
RD v[16:19],v0,11264
M v[88:91],v[20:23],v[212:215],v[88:91]
WL 2
buffer_load_dwordx4 v3, s[16:19], s42 offen offset:384 nt lds
s_add_u32 s42, s42, 16384
M v[56:59],v[24:27],v[116:119],v[56:59]
s_mov_b32 s51, s44
M v[60:63],v[24:27],v[148:151],v[60:63]
s_mov_b32 s44, s45
M v[64:67],v[24:27],v[180:183],v[64:67]
s_mov_b32 s45, s46
RD v[20:23],v0,3584
M v[68:71],v[24:27],v[212:215],v[68:71]
WL 2
M v[76:79],v[12:15],v[120:123],v[76:79]
s_mov_b32 s46, s61
M v[80:83],v[12:15],v[152:155],v[80:83]
s_mov_b32 s61, s51
M v[84:87],v[12:15],v[184:187],v[84:87]
RD v[24:27],v0,11776
M v[88:91],v[12:15],v[216:219],v[88:91]
WL 2
M v[56:59],v[16:19],v[120:123],v[56:59]
WV 12
v_add_u32 v0, s50, v0
M v[60:63],v[16:19],v[152:155],v[60:63]
s_barrier
M v[64:67],v[16:19],v[184:187],v[64:67]
TR v[12:13],v1,0
M v[68:71],v[16:19],v[216:219],v[68:71]
WL 2
TR v[14:15],v1,8192
M v[76:79],v[20:23],v[124:127],v[76:79]
s_add_u32 m0, s49, 0
M v[80:83],v[20:23],v[156:159],v[80:83]
buffer_load_dwordx4 v3, s[20:23], s43 offen offset:0 nt lds
M v[84:87],v[20:23],v[188:191],v[84:87]
TR v[16:17],v9,0
M v[88:91],v[20:23],v[220:223],v[88:91]
WL 3
TR v[18:19],v9,8192
M v[56:59],v[24:27],v[124:127],v[56:59]
s_add_u32 m0, s49, 896
M v[60:63],v[24:27],v[156:159],v[60:63]
buffer_load_dwordx4 v3, s[20:23], s43 offen offset:128 nt lds
M v[64:67],v[24:27],v[188:191],v[64:67]
TR v[20:21],v1,512
v_exp_f32 v76, v76
M v[68:71],v[24:27],v[220:223],v[68:71]
WL 3
TR v[22:23],v1,8704
v_exp_f32 v77, v77
M a[0:3],v[12:15],v[36:39],a[0:3]
v_exp_f32 v78, v78
v_add_f32 v4, v4, v76
M a[4:7],v[12:15],v[40:43],a[4:7]
v_exp_f32 v79, v79
v_add_f32 v4, v4, v77
M a[8:11],v[12:15],v[44:47],a[8:11]
TR v[24:25],v9,512
v_exp_f32 v80, v80
M a[12:15],v[12:15],v[48:51],a[12:15]
WL 3
TR v[26:27],v9,8704
v_exp_f32 v81, v81
M a[16:19],v[16:19],v[36:39],a[16:19]
s_add_u32 m0, s49, 1792
v_add_f32 v4, v4, v78
v_exp_f32 v82, v82
M a[20:23],v[16:19],v[40:43],a[20:23]
buffer_load_dwordx4 v3, s[20:23], s43 offen offset:256 nt lds
v_exp_f32 v83, v83
M a[24:27],v[16:19],v[44:47],a[24:27]
TR v[12:13],v1,1024
v_add_f32 v4, v4, v79
CV v76,v76,v77
M a[28:31],v[16:19],v[48:51],a[28:31]
WL 3
TR v[14:15],v1,9216
v_exp_f32 v84, v84
M a[32:35],v[20:23],v[36:39],a[32:35]
s_add_u32 m0, s49, 2688
CV v77,v78,v79
v_exp_f32 v85, v85
M a[36:39],v[20:23],v[40:43],a[36:39]
buffer_load_dwordx4 v3, s[20:23], s43 offen offset:384 nt lds
v_exp_f32 v86, v86
s_add_u32 s43, s43, 16384
M a[40:43],v[20:23],v[44:47],a[40:43]
s_sub_u32 s50, s48, s47
TR v[16:17],v9,1024
v_exp_f32 v87, v87
M a[44:47],v[20:23],v[48:51],a[44:47]
WL 3
TR v[18:19],v9,9216
v_add_f32 v5, v5, v80
v_add_f32 v5, v5, v81
M a[48:51],v[24:27],v[36:39],a[48:51]
s_mov_b32 s51, s47
v_add_f32 v5, v5, v82
v_add_f32 v5, v5, v83
CV v80,v80,v81
M a[52:55],v[24:27],v[40:43],a[52:55]
s_mov_b32 s47, s48
CV v81,v82,v83
v_exp_f32 v88, v88
M a[56:59],v[24:27],v[44:47],a[56:59]
s_mov_b32 s48, s49
TR v[20:21],v1,1536
v_exp_f32 v89, v89
M a[60:63],v[24:27],v[48:51],a[60:63]
WL 3
TR v[22:23],v1,9728
v_exp_f32 v90, v90
M a[64:67],v[12:15],v[36:39],a[64:67]
s_mov_b32 s49, s51
v_add_f32 v6, v6, v84
v_exp_f32 v91, v91
M a[68:71],v[12:15],v[40:43],a[68:71]
v_add_f32 v6, v6, v85
v_add_f32 v6, v6, v86
v_add_f32 v6, v6, v87
M a[72:75],v[12:15],v[44:47],a[72:75]
TR v[24:25],v9,1536
CV v84,v84,v85
CV v85,v86,v87
M a[76:79],v[12:15],v[48:51],a[76:79]
WL 3
TR v[26:27],v9,9728
v_exp_f32 v56, v56
M a[80:83],v[16:19],v[36:39],a[80:83]
v_add_f32 v7, v7, v88
v_exp_f32 v57, v57
M a[84:87],v[16:19],v[40:43],a[84:87]
v_add_f32 v7, v7, v89
v_exp_f32 v58, v58
M a[88:91],v[16:19],v[44:47],a[88:91]
TR v[12:13],v1,2048
v_exp_f32 v59, v59
M a[92:95],v[16:19],v[48:51],a[92:95]
WL 3
TR v[14:15],v1,10240
v_add_f32 v7, v7, v90
v_add_f32 v7, v7, v91
M a[96:99],v[20:23],v[36:39],a[96:99]
CV v88,v88,v89
v_exp_f32 v60, v60
M a[100:103],v[20:23],v[40:43],a[100:103]
CV v89,v90,v91
v_exp_f32 v61, v61
M a[104:107],v[20:23],v[44:47],a[104:107]
TR v[16:17],v9,2048
v_exp_f32 v62, v62
M a[108:111],v[20:23],v[48:51],a[108:111]
WL 3
TR v[18:19],v9,10240
v_exp_f32 v63, v63
M a[112:115],v[24:27],v[36:39],a[112:115]
v_add_f32 v4, v4, v56
v_add_f32 v4, v4, v57
v_add_f32 v4, v4, v58
M a[116:119],v[24:27],v[40:43],a[116:119]
v_add_f32 v4, v4, v59
CV v78,v56,v57
CV v79,v58,v59
M a[120:123],v[24:27],v[44:47],a[120:123]
TR v[20:21],v1,2560
v_exp_f32 v64, v64
M a[124:127],v[24:27],v[48:51],a[124:127]
WL 3
TR v[22:23],v1,10752
v_exp_f32 v65, v65
M a[128:131],v[12:15],v[36:39],a[128:131]
v_add_f32 v5, v5, v60
v_exp_f32 v66, v66
M a[132:135],v[12:15],v[40:43],a[132:135]
v_add_f32 v5, v5, v61
v_exp_f32 v67, v67
M a[136:139],v[12:15],v[44:47],a[136:139]
TR v[24:25],v9,2560
v_add_f32 v5, v5, v62
v_add_f32 v5, v5, v63
M a[140:143],v[12:15],v[48:51],a[140:143]
WL 3
TR v[26:27],v9,10752
CV v82,v60,v61
CV v83,v62,v63
M a[144:147],v[16:19],v[36:39],a[144:147]
v_add_f32 v6, v6, v64
v_exp_f32 v68, v68
M a[148:151],v[16:19],v[40:43],a[148:151]
v_add_f32 v6, v6, v65
v_exp_f32 v69, v69
M a[152:155],v[16:19],v[44:47],a[152:155]
TR v[12:13],v1,3072
v_exp_f32 v70, v70
M a[156:159],v[16:19],v[48:51],a[156:159]
WL 3
TR v[14:15],v1,11264
v_exp_f32 v71, v71
M a[160:163],v[20:23],v[36:39],a[160:163]
v_add_f32 v6, v6, v66
v_add_f32 v6, v6, v67
CV v86,v64,v65
M a[164:167],v[20:23],v[40:43],a[164:167]
CV v87,v66,v67
v_add_f32 v7, v7, v68
v_add_f32 v7, v7, v69
M a[168:171],v[20:23],v[44:47],a[168:171]
TR v[16:17],v9,3072
v_add_f32 v7, v7, v70
v_add_f32 v7, v7, v71
M a[172:175],v[20:23],v[48:51],a[172:175]
WL 3
TR v[18:19],v9,11264
CV v90,v68,v69
CV v91,v70,v71
M a[176:179],v[24:27],v[36:39],a[176:179]
M a[180:183],v[24:27],v[40:43],a[180:183]
M a[184:187],v[24:27],v[44:47],a[184:187]
TR v[20:21],v1,3584
M a[188:191],v[24:27],v[48:51],a[188:191]
WL 3
TR v[22:23],v1,11776
M a[192:195],v[12:15],v[36:39],a[192:195]
M a[196:199],v[12:15],v[40:43],a[196:199]
M a[200:203],v[12:15],v[44:47],a[200:203]
TR v[24:25],v9,3584
M a[204:207],v[12:15],v[48:51],a[204:207]
WL 3
TR v[26:27],v9,11776
M a[208:211],v[16:19],v[36:39],a[208:211]
WV 20
v_add_u32 v1, s50, v1
M a[212:215],v[16:19],v[40:43],a[212:215]
s_barrier
v_add_u32 v9, s50, v9
M a[216:219],v[16:19],v[44:47],a[216:219]
RD v[12:15],v0,0
M a[220:223],v[16:19],v[48:51],a[220:223]
WL 3
M a[224:227],v[20:23],v[36:39],a[224:227]
M a[228:231],v[20:23],v[40:43],a[228:231]
M a[232:235],v[20:23],v[44:47],a[232:235]
RD v[16:19],v0,8192
M a[236:239],v[20:23],v[48:51],a[236:239]
WL 2
M a[240:243],v[24:27],v[36:39],a[240:243]
M a[244:247],v[24:27],v[40:43],a[244:247]
M a[248:251],v[24:27],v[44:47],a[248:251]
RD v[20:23],v0,512
s_sub_u32 s52, s52, 1
M a[252:255],v[24:27],v[48:51],a[252:255]
s_cmp_lg_u32 s52, 0
s_cbranch_scc1 L1_loop_4
s_branch L1_post_4
L1_post_5:
WV 0
s_barrier
v_mov_b32 v11, 0
s_cmp_lg_u32 s3, 0
s_cbranch_scc1 L1_wof_5
s_lshl_b32 s4, s58, 2
s_mov_b64 s[6:7], exec
s_mov_b64 exec, 1
v_mov_b32 v11, 1
buffer_atomic_add v11, v10, s[64:67], s4 offen offset:128
s_mov_b64 exec, s[6:7]
L1_wof_5:
TR v[12:13],v1,0
TR v[14:15],v1,8192
TR v[16:17],v9,0
TR v[18:19],v9,8192
TR v[20:21],v1,512
TR v[22:23],v1,8704
buffer_load_dword v0, v3, s[96:99], s100 offen
v_add_f32 v5, v5, v60
v_add_f32 v5, v5, v61
v_add_f32 v5, v5, v62
v_add_f32 v5, v5, v63
CV v82,v60,v61
CV v83,v62,v63
v_add_f32 v6, v6, v64
v_add_f32 v6, v6, v65
v_add_f32 v6, v6, v66
v_add_f32 v6, v6, v67
CV v86,v64,v65
CV v87,v66,v67
s_lshl_b32 s51, s58, 2
buffer_load_dword v11, v10, s[64:67], s51 offen offset:128 sc1
v_mov_b32 v56, v4
v_mov_b32 v57, v4
v_mov_b32 v58, v5
v_mov_b32 v59, v5
v_mov_b32 v60, v6
v_mov_b32 v61, v6
v_mov_b32 v62, v7
v_mov_b32 v63, v7
v_mov_b32 v64, v8
v_mov_b32 v65, v8
s_nop 1
v_permlane32_swap_b32 v56, v57
v_permlane32_swap_b32 v58, v59
v_permlane32_swap_b32 v60, v61
v_permlane32_swap_b32 v62, v63
v_permlane32_swap_b32 v64, v65
s_nop 1
v_add_f32 v4, v56, v57
v_add_f32 v5, v58, v59
v_add_f32 v6, v60, v61
v_add_f32 v7, v62, v63
v_add_f32 v8, v64, v65
v_mov_b32 v56, v4
v_mov_b32 v57, v4
v_mov_b32 v58, v5
v_mov_b32 v59, v5
v_mov_b32 v60, v6
v_mov_b32 v61, v6
v_mov_b32 v62, v7
v_mov_b32 v63, v7
v_mov_b32 v64, v8
v_mov_b32 v65, v8
s_nop 1
v_permlane16_swap_b32 v56, v57
v_permlane16_swap_b32 v58, v59
v_permlane16_swap_b32 v60, v61
v_permlane16_swap_b32 v62, v63
v_permlane16_swap_b32 v64, v65
s_nop 1
v_add_f32 v4, v56, v57
v_add_f32 v5, v58, v59
v_add_f32 v6, v60, v61
v_add_f32 v7, v62, v63
v_add_f32 v8, v64, v65
s_mov_b32 s4, 0x2b800000
s_mov_b32 s5, 0x53800000
s_mov_b64 s[6:7], -1
v_cmp_le_f32 vcc, s4, v4
s_nop 1
s_and_b64 s[6:7], s[6:7], vcc
v_cmp_ge_f32 vcc, s5, v4
s_nop 1
s_and_b64 s[6:7], s[6:7], vcc
v_cmp_le_f32 vcc, s4, v5
s_nop 1
s_and_b64 s[6:7], s[6:7], vcc
v_cmp_ge_f32 vcc, s5, v5
s_nop 1
s_and_b64 s[6:7], s[6:7], vcc
v_cmp_le_f32 vcc, s4, v6
s_nop 1
s_and_b64 s[6:7], s[6:7], vcc
v_cmp_ge_f32 vcc, s5, v6
s_nop 1
s_and_b64 s[6:7], s[6:7], vcc
v_cmp_le_f32 vcc, s4, v7
s_nop 1
s_and_b64 s[6:7], s[6:7], vcc
v_cmp_ge_f32 vcc, s5, v7
s_nop 1
s_and_b64 s[6:7], s[6:7], vcc
v_cmp_le_f32 vcc, s4, v8
s_nop 1
s_and_b64 s[6:7], s[6:7], vcc
v_cmp_ge_f32 vcc, s5, v8
s_nop 1
s_and_b64 s[6:7], s[6:7], vcc
s_cmp_eq_u64 s[6:7], -1
s_cselect_b32 s60, 0, 1
v_subrev_u32 v10, s62, v2
v_rcp_f32 v4, v4
v_rcp_f32 v5, v5
v_rcp_f32 v6, v6
v_rcp_f32 v7, v7
v_rcp_f32 v8, v8
TR v[24:25],v9,512
TR v[26:27],v9,8704
WL 10
v_mov_b32 v32, 0
s_mov_b32 s4, 0x7fff7fff
WL 6
M a[0:3],v[12:15],v[76:79],a[0:3]
M a[4:7],v[12:15],v[80:83],a[4:7]
M a[8:11],v[12:15],v[84:87],a[8:11]
M a[12:15],v[12:15],v[88:91],a[12:15]
M a[16:19],v[12:15],v[92:95],a[16:19]
WL 4
M a[20:23],v[16:19],v[76:79],a[20:23]
M a[24:27],v[16:19],v[80:83],a[24:27]
M a[28:31],v[16:19],v[84:87],a[28:31]
M a[32:35],v[16:19],v[88:91],a[32:35]
M a[36:39],v[16:19],v[92:95],a[36:39]
WL 2
TR v[12:13],v1,1024
TR v[14:15],v1,9216
TR v[16:17],v9,1024
TR v[18:19],v9,9216
M a[40:43],v[20:23],v[76:79],a[40:43]
M a[44:47],v[20:23],v[80:83],a[44:47]
M a[48:51],v[20:23],v[84:87],a[48:51]
M a[52:55],v[20:23],v[88:91],a[52:55]
M a[56:59],v[20:23],v[92:95],a[56:59]
WL 4
M a[60:63],v[24:27],v[76:79],a[60:63]
M a[64:67],v[24:27],v[80:83],a[64:67]
M a[68:71],v[24:27],v[84:87],a[68:71]
M a[72:75],v[24:27],v[88:91],a[72:75]
M a[76:79],v[24:27],v[92:95],a[76:79]
WL 2
TR v[20:21],v1,1536
TR v[22:23],v1,9728
TR v[24:25],v9,1536
TR v[26:27],v9,9728
s_add_u32 s51, s63, 0
s_add_u32 s50, s63, 4096
AR v36,a0
AR v37,a1
AR v38,a2
AR v39,a3
v_pk_mul_f32 v[36:37], v[36:37], v[4:5] op_sel_hi:[1,0]
v_pk_mul_f32 v[38:39], v[38:39], v[4:5] op_sel_hi:[1,0]
AR v40,a20
AR v41,a21
AR v42,a22
AR v43,a23
v_pk_mul_f32 v[40:41], v[40:41], v[4:5] op_sel_hi:[1,0]
v_pk_mul_f32 v[42:43], v[42:43], v[4:5] op_sel_hi:[1,0]
CV v64,v36,v37
CV v65,v38,v39
CV v66,v40,v41
CV v67,v42,v43
buffer_store_dwordx4 v[64:67], v10, s[32:35], s51 offen offset:0 sc1
v_and_b32 v36, s4, v64
v_and_b32 v37, s4, v65
v_and_b32 v38, s4, v66
v_and_b32 v39, s4, v67
v_pk_max_u16 v32, v32, v36
v_pk_max_u16 v32, v32, v37
v_pk_max_u16 v32, v32, v38
v_pk_max_u16 v32, v32, v39
AR v44,a4
AR v45,a5
AR v46,a6
AR v47,a7
v_pk_mul_f32 v[44:45], v[44:45], v[4:5] op_sel:[0,1] op_sel_hi:[1,1]
v_pk_mul_f32 v[46:47], v[46:47], v[4:5] op_sel:[0,1] op_sel_hi:[1,1]
AR v48,a24
AR v49,a25
AR v50,a26
AR v51,a27
v_pk_mul_f32 v[48:49], v[48:49], v[4:5] op_sel:[0,1] op_sel_hi:[1,1]
v_pk_mul_f32 v[50:51], v[50:51], v[4:5] op_sel:[0,1] op_sel_hi:[1,1]
CV v68,v44,v45
CV v69,v46,v47
CV v70,v48,v49
CV v71,v50,v51
buffer_store_dwordx4 v[68:71], v10, s[32:35], s51 offen offset:1024 sc1
v_and_b32 v44, s4, v68
v_and_b32 v45, s4, v69
v_and_b32 v46, s4, v70
v_and_b32 v47, s4, v71
v_pk_max_u16 v32, v32, v44
v_pk_max_u16 v32, v32, v45
v_pk_max_u16 v32, v32, v46
v_pk_max_u16 v32, v32, v47
AR v56,a8
AR v57,a9
AR v58,a10
AR v59,a11
v_pk_mul_f32 v[56:57], v[56:57], v[6:7] op_sel_hi:[1,0]
v_pk_mul_f32 v[58:59], v[58:59], v[6:7] op_sel_hi:[1,0]
AR v60,a28
AR v61,a29
AR v62,a30
AR v63,a31
v_pk_mul_f32 v[60:61], v[60:61], v[6:7] op_sel_hi:[1,0]
v_pk_mul_f32 v[62:63], v[62:63], v[6:7] op_sel_hi:[1,0]
CV v72,v56,v57
CV v73,v58,v59
CV v74,v60,v61
CV v75,v62,v63
buffer_store_dwordx4 v[72:75], v10, s[32:35], s51 offen offset:2048 sc1
v_and_b32 v56, s4, v72
v_and_b32 v57, s4, v73
v_and_b32 v58, s4, v74
v_and_b32 v59, s4, v75
v_pk_max_u16 v32, v32, v56
v_pk_max_u16 v32, v32, v57
v_pk_max_u16 v32, v32, v58
v_pk_max_u16 v32, v32, v59
AR v36,a12
AR v37,a13
AR v38,a14
AR v39,a15
v_pk_mul_f32 v[36:37], v[36:37], v[6:7] op_sel:[0,1] op_sel_hi:[1,1]
v_pk_mul_f32 v[38:39], v[38:39], v[6:7] op_sel:[0,1] op_sel_hi:[1,1]
AR v40,a32
AR v41,a33
AR v42,a34
AR v43,a35
v_pk_mul_f32 v[40:41], v[40:41], v[6:7] op_sel:[0,1] op_sel_hi:[1,1]
v_pk_mul_f32 v[42:43], v[42:43], v[6:7] op_sel:[0,1] op_sel_hi:[1,1]
CV v52,v36,v37
CV v53,v38,v39
CV v54,v40,v41
CV v55,v42,v43
buffer_store_dwordx4 v[52:55], v10, s[32:35], s51 offen offset:3072 sc1
v_and_b32 v36, s4, v52
v_and_b32 v37, s4, v53
v_and_b32 v38, s4, v54
v_and_b32 v39, s4, v55
v_pk_max_u16 v32, v32, v36
v_pk_max_u16 v32, v32, v37
v_pk_max_u16 v32, v32, v38
v_pk_max_u16 v32, v32, v39
AR v44,a16
AR v45,a17
AR v46,a18
AR v47,a19
v_pk_mul_f32 v[44:45], v[44:45], v[8:9] op_sel_hi:[1,0]
v_pk_mul_f32 v[46:47], v[46:47], v[8:9] op_sel_hi:[1,0]
AR v48,a36
AR v49,a37
AR v50,a38
AR v51,a39
v_pk_mul_f32 v[48:49], v[48:49], v[8:9] op_sel_hi:[1,0]
v_pk_mul_f32 v[50:51], v[50:51], v[8:9] op_sel_hi:[1,0]
CV v28,v44,v45
CV v29,v46,v47
CV v30,v48,v49
CV v31,v50,v51
buffer_store_dwordx4 v[28:31], v10, s[32:35], s50 offen offset:0 sc1
v_and_b32 v44, s4, v28
v_and_b32 v45, s4, v29
v_and_b32 v46, s4, v30
v_and_b32 v47, s4, v31
v_pk_max_u16 v32, v32, v44
v_pk_max_u16 v32, v32, v45
v_pk_max_u16 v32, v32, v46
v_pk_max_u16 v32, v32, v47
M a[80:83],v[12:15],v[76:79],a[80:83]
M a[84:87],v[12:15],v[80:83],a[84:87]
M a[88:91],v[12:15],v[84:87],a[88:91]
M a[92:95],v[12:15],v[88:91],a[92:95]
M a[96:99],v[12:15],v[92:95],a[96:99]
WL 4
M a[100:103],v[16:19],v[76:79],a[100:103]
M a[104:107],v[16:19],v[80:83],a[104:107]
M a[108:111],v[16:19],v[84:87],a[108:111]
M a[112:115],v[16:19],v[88:91],a[112:115]
M a[116:119],v[16:19],v[92:95],a[116:119]
WL 2
TR v[12:13],v1,2048
TR v[14:15],v1,10240
TR v[16:17],v9,2048
TR v[18:19],v9,10240
s_add_u32 s51, s63, 5120
s_add_u32 s50, s63, 9216
AR v56,a40
AR v57,a41
AR v58,a42
AR v59,a43
v_pk_mul_f32 v[56:57], v[56:57], v[4:5] op_sel_hi:[1,0]
v_pk_mul_f32 v[58:59], v[58:59], v[4:5] op_sel_hi:[1,0]
AR v60,a60
AR v61,a61
AR v62,a62
AR v63,a63
v_pk_mul_f32 v[60:61], v[60:61], v[4:5] op_sel_hi:[1,0]
v_pk_mul_f32 v[62:63], v[62:63], v[4:5] op_sel_hi:[1,0]
CV v64,v56,v57
CV v65,v58,v59
CV v66,v60,v61
CV v67,v62,v63
buffer_store_dwordx4 v[64:67], v10, s[32:35], s51 offen offset:0 sc1
v_and_b32 v56, s4, v64
v_and_b32 v57, s4, v65
v_and_b32 v58, s4, v66
v_and_b32 v59, s4, v67
v_pk_max_u16 v32, v32, v56
v_pk_max_u16 v32, v32, v57
v_pk_max_u16 v32, v32, v58
v_pk_max_u16 v32, v32, v59
AR v36,a44
AR v37,a45
AR v38,a46
AR v39,a47
v_pk_mul_f32 v[36:37], v[36:37], v[4:5] op_sel:[0,1] op_sel_hi:[1,1]
v_pk_mul_f32 v[38:39], v[38:39], v[4:5] op_sel:[0,1] op_sel_hi:[1,1]
AR v40,a64
AR v41,a65
AR v42,a66
AR v43,a67
v_pk_mul_f32 v[40:41], v[40:41], v[4:5] op_sel:[0,1] op_sel_hi:[1,1]
v_pk_mul_f32 v[42:43], v[42:43], v[4:5] op_sel:[0,1] op_sel_hi:[1,1]
CV v68,v36,v37
CV v69,v38,v39
CV v70,v40,v41
CV v71,v42,v43
buffer_store_dwordx4 v[68:71], v10, s[32:35], s51 offen offset:1024 sc1
v_and_b32 v36, s4, v68
v_and_b32 v37, s4, v69
v_and_b32 v38, s4, v70
v_and_b32 v39, s4, v71
v_pk_max_u16 v32, v32, v36
v_pk_max_u16 v32, v32, v37
v_pk_max_u16 v32, v32, v38
v_pk_max_u16 v32, v32, v39
AR v44,a48
AR v45,a49
AR v46,a50
AR v47,a51
v_pk_mul_f32 v[44:45], v[44:45], v[6:7] op_sel_hi:[1,0]
v_pk_mul_f32 v[46:47], v[46:47], v[6:7] op_sel_hi:[1,0]
AR v48,a68
AR v49,a69
AR v50,a70
AR v51,a71
v_pk_mul_f32 v[48:49], v[48:49], v[6:7] op_sel_hi:[1,0]
v_pk_mul_f32 v[50:51], v[50:51], v[6:7] op_sel_hi:[1,0]
CV v72,v44,v45
CV v73,v46,v47
CV v74,v48,v49
CV v75,v50,v51
buffer_store_dwordx4 v[72:75], v10, s[32:35], s51 offen offset:2048 sc1
v_and_b32 v44, s4, v72
v_and_b32 v45, s4, v73
v_and_b32 v46, s4, v74
v_and_b32 v47, s4, v75
v_pk_max_u16 v32, v32, v44
v_pk_max_u16 v32, v32, v45
v_pk_max_u16 v32, v32, v46
v_pk_max_u16 v32, v32, v47
AR v56,a52
AR v57,a53
AR v58,a54
AR v59,a55
v_pk_mul_f32 v[56:57], v[56:57], v[6:7] op_sel:[0,1] op_sel_hi:[1,1]
v_pk_mul_f32 v[58:59], v[58:59], v[6:7] op_sel:[0,1] op_sel_hi:[1,1]
AR v60,a72
AR v61,a73
AR v62,a74
AR v63,a75
v_pk_mul_f32 v[60:61], v[60:61], v[6:7] op_sel:[0,1] op_sel_hi:[1,1]
v_pk_mul_f32 v[62:63], v[62:63], v[6:7] op_sel:[0,1] op_sel_hi:[1,1]
CV v52,v56,v57
CV v53,v58,v59
CV v54,v60,v61
CV v55,v62,v63
buffer_store_dwordx4 v[52:55], v10, s[32:35], s51 offen offset:3072 sc1
v_and_b32 v56, s4, v52
v_and_b32 v57, s4, v53
v_and_b32 v58, s4, v54
v_and_b32 v59, s4, v55
v_pk_max_u16 v32, v32, v56
v_pk_max_u16 v32, v32, v57
v_pk_max_u16 v32, v32, v58
v_pk_max_u16 v32, v32, v59
AR v36,a56
AR v37,a57
AR v38,a58
AR v39,a59
v_pk_mul_f32 v[36:37], v[36:37], v[8:9] op_sel_hi:[1,0]
v_pk_mul_f32 v[38:39], v[38:39], v[8:9] op_sel_hi:[1,0]
AR v40,a76
AR v41,a77
AR v42,a78
AR v43,a79
v_pk_mul_f32 v[40:41], v[40:41], v[8:9] op_sel_hi:[1,0]
v_pk_mul_f32 v[42:43], v[42:43], v[8:9] op_sel_hi:[1,0]
CV v28,v36,v37
CV v29,v38,v39
CV v30,v40,v41
CV v31,v42,v43
buffer_store_dwordx4 v[28:31], v10, s[32:35], s50 offen offset:0 sc1
v_and_b32 v36, s4, v28
v_and_b32 v37, s4, v29
v_and_b32 v38, s4, v30
v_and_b32 v39, s4, v31
v_pk_max_u16 v32, v32, v36
v_pk_max_u16 v32, v32, v37
v_pk_max_u16 v32, v32, v38
v_pk_max_u16 v32, v32, v39
M a[120:123],v[20:23],v[76:79],a[120:123]
M a[124:127],v[20:23],v[80:83],a[124:127]
M a[128:131],v[20:23],v[84:87],a[128:131]
M a[132:135],v[20:23],v[88:91],a[132:135]
M a[136:139],v[20:23],v[92:95],a[136:139]
WL 4
M a[140:143],v[24:27],v[76:79],a[140:143]
M a[144:147],v[24:27],v[80:83],a[144:147]
M a[148:151],v[24:27],v[84:87],a[148:151]
M a[152:155],v[24:27],v[88:91],a[152:155]
M a[156:159],v[24:27],v[92:95],a[156:159]
WL 2
TR v[20:21],v1,2560
TR v[22:23],v1,10752
TR v[24:25],v9,2560
TR v[26:27],v9,10752
s_add_u32 s51, s63, 10240
s_add_u32 s50, s63, 14336
AR v44,a80
AR v45,a81
AR v46,a82
AR v47,a83
v_pk_mul_f32 v[44:45], v[44:45], v[4:5] op_sel_hi:[1,0]
v_pk_mul_f32 v[46:47], v[46:47], v[4:5] op_sel_hi:[1,0]
AR v48,a100
AR v49,a101
AR v50,a102
AR v51,a103
v_pk_mul_f32 v[48:49], v[48:49], v[4:5] op_sel_hi:[1,0]
v_pk_mul_f32 v[50:51], v[50:51], v[4:5] op_sel_hi:[1,0]
CV v64,v44,v45
CV v65,v46,v47
CV v66,v48,v49
CV v67,v50,v51
buffer_store_dwordx4 v[64:67], v10, s[32:35], s51 offen offset:0 sc1
v_and_b32 v44, s4, v64
v_and_b32 v45, s4, v65
v_and_b32 v46, s4, v66
v_and_b32 v47, s4, v67
v_pk_max_u16 v32, v32, v44
v_pk_max_u16 v32, v32, v45
v_pk_max_u16 v32, v32, v46
v_pk_max_u16 v32, v32, v47
AR v56,a84
AR v57,a85
AR v58,a86
AR v59,a87
v_pk_mul_f32 v[56:57], v[56:57], v[4:5] op_sel:[0,1] op_sel_hi:[1,1]
v_pk_mul_f32 v[58:59], v[58:59], v[4:5] op_sel:[0,1] op_sel_hi:[1,1]
AR v60,a104
AR v61,a105
AR v62,a106
AR v63,a107
v_pk_mul_f32 v[60:61], v[60:61], v[4:5] op_sel:[0,1] op_sel_hi:[1,1]
v_pk_mul_f32 v[62:63], v[62:63], v[4:5] op_sel:[0,1] op_sel_hi:[1,1]
CV v68,v56,v57
CV v69,v58,v59
CV v70,v60,v61
CV v71,v62,v63
buffer_store_dwordx4 v[68:71], v10, s[32:35], s51 offen offset:1024 sc1
v_and_b32 v56, s4, v68
v_and_b32 v57, s4, v69
v_and_b32 v58, s4, v70
v_and_b32 v59, s4, v71
v_pk_max_u16 v32, v32, v56
v_pk_max_u16 v32, v32, v57
v_pk_max_u16 v32, v32, v58
v_pk_max_u16 v32, v32, v59
AR v36,a88
AR v37,a89
AR v38,a90
AR v39,a91
v_pk_mul_f32 v[36:37], v[36:37], v[6:7] op_sel_hi:[1,0]
v_pk_mul_f32 v[38:39], v[38:39], v[6:7] op_sel_hi:[1,0]
AR v40,a108
AR v41,a109
AR v42,a110
AR v43,a111
v_pk_mul_f32 v[40:41], v[40:41], v[6:7] op_sel_hi:[1,0]
v_pk_mul_f32 v[42:43], v[42:43], v[6:7] op_sel_hi:[1,0]
CV v72,v36,v37
CV v73,v38,v39
CV v74,v40,v41
CV v75,v42,v43
buffer_store_dwordx4 v[72:75], v10, s[32:35], s51 offen offset:2048 sc1
v_and_b32 v36, s4, v72
v_and_b32 v37, s4, v73
v_and_b32 v38, s4, v74
v_and_b32 v39, s4, v75
v_pk_max_u16 v32, v32, v36
v_pk_max_u16 v32, v32, v37
v_pk_max_u16 v32, v32, v38
v_pk_max_u16 v32, v32, v39
AR v44,a92
AR v45,a93
AR v46,a94
AR v47,a95
v_pk_mul_f32 v[44:45], v[44:45], v[6:7] op_sel:[0,1] op_sel_hi:[1,1]
v_pk_mul_f32 v[46:47], v[46:47], v[6:7] op_sel:[0,1] op_sel_hi:[1,1]
AR v48,a112
AR v49,a113
AR v50,a114
AR v51,a115
v_pk_mul_f32 v[48:49], v[48:49], v[6:7] op_sel:[0,1] op_sel_hi:[1,1]
v_pk_mul_f32 v[50:51], v[50:51], v[6:7] op_sel:[0,1] op_sel_hi:[1,1]
CV v52,v44,v45
CV v53,v46,v47
CV v54,v48,v49
CV v55,v50,v51
buffer_store_dwordx4 v[52:55], v10, s[32:35], s51 offen offset:3072 sc1
v_and_b32 v44, s4, v52
v_and_b32 v45, s4, v53
v_and_b32 v46, s4, v54
v_and_b32 v47, s4, v55
v_pk_max_u16 v32, v32, v44
v_pk_max_u16 v32, v32, v45
v_pk_max_u16 v32, v32, v46
v_pk_max_u16 v32, v32, v47
AR v56,a96
AR v57,a97
AR v58,a98
AR v59,a99
v_pk_mul_f32 v[56:57], v[56:57], v[8:9] op_sel_hi:[1,0]
v_pk_mul_f32 v[58:59], v[58:59], v[8:9] op_sel_hi:[1,0]
AR v60,a116
AR v61,a117
AR v62,a118
AR v63,a119
v_pk_mul_f32 v[60:61], v[60:61], v[8:9] op_sel_hi:[1,0]
v_pk_mul_f32 v[62:63], v[62:63], v[8:9] op_sel_hi:[1,0]
CV v28,v56,v57
CV v29,v58,v59
CV v30,v60,v61
CV v31,v62,v63
buffer_store_dwordx4 v[28:31], v10, s[32:35], s50 offen offset:0 sc1
v_and_b32 v56, s4, v28
v_and_b32 v57, s4, v29
v_and_b32 v58, s4, v30
v_and_b32 v59, s4, v31
v_pk_max_u16 v32, v32, v56
v_pk_max_u16 v32, v32, v57
v_pk_max_u16 v32, v32, v58
v_pk_max_u16 v32, v32, v59
M a[160:163],v[12:15],v[76:79],a[160:163]
M a[164:167],v[12:15],v[80:83],a[164:167]
M a[168:171],v[12:15],v[84:87],a[168:171]
M a[172:175],v[12:15],v[88:91],a[172:175]
M a[176:179],v[12:15],v[92:95],a[176:179]
WL 4
M a[180:183],v[16:19],v[76:79],a[180:183]
M a[184:187],v[16:19],v[80:83],a[184:187]
M a[188:191],v[16:19],v[84:87],a[188:191]
M a[192:195],v[16:19],v[88:91],a[192:195]
M a[196:199],v[16:19],v[92:95],a[196:199]
WL 2
TR v[12:13],v1,3072
TR v[14:15],v1,11264
TR v[16:17],v9,3072
TR v[18:19],v9,11264
s_add_u32 s51, s63, 15360
s_add_u32 s50, s63, 19456
AR v36,a120
AR v37,a121
AR v38,a122
AR v39,a123
v_pk_mul_f32 v[36:37], v[36:37], v[4:5] op_sel_hi:[1,0]
v_pk_mul_f32 v[38:39], v[38:39], v[4:5] op_sel_hi:[1,0]
AR v40,a140
AR v41,a141
AR v42,a142
AR v43,a143
v_pk_mul_f32 v[40:41], v[40:41], v[4:5] op_sel_hi:[1,0]
v_pk_mul_f32 v[42:43], v[42:43], v[4:5] op_sel_hi:[1,0]
CV v64,v36,v37
CV v65,v38,v39
CV v66,v40,v41
CV v67,v42,v43
buffer_store_dwordx4 v[64:67], v10, s[32:35], s51 offen offset:0 sc1
v_and_b32 v36, s4, v64
v_and_b32 v37, s4, v65
v_and_b32 v38, s4, v66
v_and_b32 v39, s4, v67
v_pk_max_u16 v32, v32, v36
v_pk_max_u16 v32, v32, v37
v_pk_max_u16 v32, v32, v38
v_pk_max_u16 v32, v32, v39
AR v44,a124
AR v45,a125
AR v46,a126
AR v47,a127
v_pk_mul_f32 v[44:45], v[44:45], v[4:5] op_sel:[0,1] op_sel_hi:[1,1]
v_pk_mul_f32 v[46:47], v[46:47], v[4:5] op_sel:[0,1] op_sel_hi:[1,1]
AR v48,a144
AR v49,a145
AR v50,a146
AR v51,a147
v_pk_mul_f32 v[48:49], v[48:49], v[4:5] op_sel:[0,1] op_sel_hi:[1,1]
v_pk_mul_f32 v[50:51], v[50:51], v[4:5] op_sel:[0,1] op_sel_hi:[1,1]
CV v68,v44,v45
CV v69,v46,v47
CV v70,v48,v49
CV v71,v50,v51
buffer_store_dwordx4 v[68:71], v10, s[32:35], s51 offen offset:1024 sc1
v_and_b32 v44, s4, v68
v_and_b32 v45, s4, v69
v_and_b32 v46, s4, v70
v_and_b32 v47, s4, v71
v_pk_max_u16 v32, v32, v44
v_pk_max_u16 v32, v32, v45
v_pk_max_u16 v32, v32, v46
v_pk_max_u16 v32, v32, v47
AR v56,a128
AR v57,a129
AR v58,a130
AR v59,a131
v_pk_mul_f32 v[56:57], v[56:57], v[6:7] op_sel_hi:[1,0]
v_pk_mul_f32 v[58:59], v[58:59], v[6:7] op_sel_hi:[1,0]
AR v60,a148
AR v61,a149
AR v62,a150
AR v63,a151
v_pk_mul_f32 v[60:61], v[60:61], v[6:7] op_sel_hi:[1,0]
v_pk_mul_f32 v[62:63], v[62:63], v[6:7] op_sel_hi:[1,0]
CV v72,v56,v57
CV v73,v58,v59
CV v74,v60,v61
CV v75,v62,v63
buffer_store_dwordx4 v[72:75], v10, s[32:35], s51 offen offset:2048 sc1
v_and_b32 v56, s4, v72
v_and_b32 v57, s4, v73
v_and_b32 v58, s4, v74
v_and_b32 v59, s4, v75
v_pk_max_u16 v32, v32, v56
v_pk_max_u16 v32, v32, v57
v_pk_max_u16 v32, v32, v58
v_pk_max_u16 v32, v32, v59
AR v36,a132
AR v37,a133
AR v38,a134
AR v39,a135
v_pk_mul_f32 v[36:37], v[36:37], v[6:7] op_sel:[0,1] op_sel_hi:[1,1]
v_pk_mul_f32 v[38:39], v[38:39], v[6:7] op_sel:[0,1] op_sel_hi:[1,1]
AR v40,a152
AR v41,a153
AR v42,a154
AR v43,a155
v_pk_mul_f32 v[40:41], v[40:41], v[6:7] op_sel:[0,1] op_sel_hi:[1,1]
v_pk_mul_f32 v[42:43], v[42:43], v[6:7] op_sel:[0,1] op_sel_hi:[1,1]
CV v52,v36,v37
CV v53,v38,v39
CV v54,v40,v41
CV v55,v42,v43
buffer_store_dwordx4 v[52:55], v10, s[32:35], s51 offen offset:3072 sc1
v_and_b32 v36, s4, v52
v_and_b32 v37, s4, v53
v_and_b32 v38, s4, v54
v_and_b32 v39, s4, v55
v_pk_max_u16 v32, v32, v36
v_pk_max_u16 v32, v32, v37
v_pk_max_u16 v32, v32, v38
v_pk_max_u16 v32, v32, v39
AR v44,a136
AR v45,a137
AR v46,a138
AR v47,a139
v_pk_mul_f32 v[44:45], v[44:45], v[8:9] op_sel_hi:[1,0]
v_pk_mul_f32 v[46:47], v[46:47], v[8:9] op_sel_hi:[1,0]
AR v48,a156
AR v49,a157
AR v50,a158
AR v51,a159
v_pk_mul_f32 v[48:49], v[48:49], v[8:9] op_sel_hi:[1,0]
v_pk_mul_f32 v[50:51], v[50:51], v[8:9] op_sel_hi:[1,0]
CV v28,v44,v45
CV v29,v46,v47
CV v30,v48,v49
CV v31,v50,v51
buffer_store_dwordx4 v[28:31], v10, s[32:35], s50 offen offset:0 sc1
v_and_b32 v44, s4, v28
v_and_b32 v45, s4, v29
v_and_b32 v46, s4, v30
v_and_b32 v47, s4, v31
v_pk_max_u16 v32, v32, v44
v_pk_max_u16 v32, v32, v45
v_pk_max_u16 v32, v32, v46
v_pk_max_u16 v32, v32, v47
M a[200:203],v[20:23],v[76:79],a[200:203]
M a[204:207],v[20:23],v[80:83],a[204:207]
M a[208:211],v[20:23],v[84:87],a[208:211]
M a[212:215],v[20:23],v[88:91],a[212:215]
M a[216:219],v[20:23],v[92:95],a[216:219]
WL 4
M a[220:223],v[24:27],v[76:79],a[220:223]
M a[224:227],v[24:27],v[80:83],a[224:227]
M a[228:231],v[24:27],v[84:87],a[228:231]
M a[232:235],v[24:27],v[88:91],a[232:235]
M a[236:239],v[24:27],v[92:95],a[236:239]
WL 2
TR v[20:21],v1,3584
TR v[22:23],v1,11776
TR v[24:25],v9,3584
TR v[26:27],v9,11776
s_add_u32 s51, s63, 20480
s_add_u32 s50, s63, 24576
AR v56,a160
AR v57,a161
AR v58,a162
AR v59,a163
v_pk_mul_f32 v[56:57], v[56:57], v[4:5] op_sel_hi:[1,0]
v_pk_mul_f32 v[58:59], v[58:59], v[4:5] op_sel_hi:[1,0]
AR v60,a180
AR v61,a181
AR v62,a182
AR v63,a183
v_pk_mul_f32 v[60:61], v[60:61], v[4:5] op_sel_hi:[1,0]
v_pk_mul_f32 v[62:63], v[62:63], v[4:5] op_sel_hi:[1,0]
CV v64,v56,v57
CV v65,v58,v59
CV v66,v60,v61
CV v67,v62,v63
buffer_store_dwordx4 v[64:67], v10, s[32:35], s51 offen offset:0 sc1
v_and_b32 v56, s4, v64
v_and_b32 v57, s4, v65
v_and_b32 v58, s4, v66
v_and_b32 v59, s4, v67
v_pk_max_u16 v32, v32, v56
v_pk_max_u16 v32, v32, v57
v_pk_max_u16 v32, v32, v58
v_pk_max_u16 v32, v32, v59
AR v36,a164
AR v37,a165
AR v38,a166
AR v39,a167
v_pk_mul_f32 v[36:37], v[36:37], v[4:5] op_sel:[0,1] op_sel_hi:[1,1]
v_pk_mul_f32 v[38:39], v[38:39], v[4:5] op_sel:[0,1] op_sel_hi:[1,1]
AR v40,a184
AR v41,a185
AR v42,a186
AR v43,a187
v_pk_mul_f32 v[40:41], v[40:41], v[4:5] op_sel:[0,1] op_sel_hi:[1,1]
v_pk_mul_f32 v[42:43], v[42:43], v[4:5] op_sel:[0,1] op_sel_hi:[1,1]
CV v68,v36,v37
CV v69,v38,v39
CV v70,v40,v41
CV v71,v42,v43
buffer_store_dwordx4 v[68:71], v10, s[32:35], s51 offen offset:1024 sc1
v_and_b32 v36, s4, v68
v_and_b32 v37, s4, v69
v_and_b32 v38, s4, v70
v_and_b32 v39, s4, v71
v_pk_max_u16 v32, v32, v36
v_pk_max_u16 v32, v32, v37
v_pk_max_u16 v32, v32, v38
v_pk_max_u16 v32, v32, v39
AR v44,a168
AR v45,a169
AR v46,a170
AR v47,a171
v_pk_mul_f32 v[44:45], v[44:45], v[6:7] op_sel_hi:[1,0]
v_pk_mul_f32 v[46:47], v[46:47], v[6:7] op_sel_hi:[1,0]
AR v48,a188
AR v49,a189
AR v50,a190
AR v51,a191
v_pk_mul_f32 v[48:49], v[48:49], v[6:7] op_sel_hi:[1,0]
v_pk_mul_f32 v[50:51], v[50:51], v[6:7] op_sel_hi:[1,0]
CV v72,v44,v45
CV v73,v46,v47
CV v74,v48,v49
CV v75,v50,v51
buffer_store_dwordx4 v[72:75], v10, s[32:35], s51 offen offset:2048 sc1
v_and_b32 v44, s4, v72
v_and_b32 v45, s4, v73
v_and_b32 v46, s4, v74
v_and_b32 v47, s4, v75
v_pk_max_u16 v32, v32, v44
v_pk_max_u16 v32, v32, v45
v_pk_max_u16 v32, v32, v46
v_pk_max_u16 v32, v32, v47
AR v56,a172
AR v57,a173
AR v58,a174
AR v59,a175
v_pk_mul_f32 v[56:57], v[56:57], v[6:7] op_sel:[0,1] op_sel_hi:[1,1]
v_pk_mul_f32 v[58:59], v[58:59], v[6:7] op_sel:[0,1] op_sel_hi:[1,1]
AR v60,a192
AR v61,a193
AR v62,a194
AR v63,a195
v_pk_mul_f32 v[60:61], v[60:61], v[6:7] op_sel:[0,1] op_sel_hi:[1,1]
v_pk_mul_f32 v[62:63], v[62:63], v[6:7] op_sel:[0,1] op_sel_hi:[1,1]
CV v52,v56,v57
CV v53,v58,v59
CV v54,v60,v61
CV v55,v62,v63
buffer_store_dwordx4 v[52:55], v10, s[32:35], s51 offen offset:3072 sc1
v_and_b32 v56, s4, v52
v_and_b32 v57, s4, v53
v_and_b32 v58, s4, v54
v_and_b32 v59, s4, v55
v_pk_max_u16 v32, v32, v56
v_pk_max_u16 v32, v32, v57
v_pk_max_u16 v32, v32, v58
v_pk_max_u16 v32, v32, v59
AR v36,a176
AR v37,a177
AR v38,a178
AR v39,a179
v_pk_mul_f32 v[36:37], v[36:37], v[8:9] op_sel_hi:[1,0]
v_pk_mul_f32 v[38:39], v[38:39], v[8:9] op_sel_hi:[1,0]
AR v40,a196
AR v41,a197
AR v42,a198
AR v43,a199
v_pk_mul_f32 v[40:41], v[40:41], v[8:9] op_sel_hi:[1,0]
v_pk_mul_f32 v[42:43], v[42:43], v[8:9] op_sel_hi:[1,0]
CV v28,v36,v37
CV v29,v38,v39
CV v30,v40,v41
CV v31,v42,v43
buffer_store_dwordx4 v[28:31], v10, s[32:35], s50 offen offset:0 sc1
v_and_b32 v36, s4, v28
v_and_b32 v37, s4, v29
v_and_b32 v38, s4, v30
v_and_b32 v39, s4, v31
v_pk_max_u16 v32, v32, v36
v_pk_max_u16 v32, v32, v37
v_pk_max_u16 v32, v32, v38
v_pk_max_u16 v32, v32, v39
M a[240:243],v[12:15],v[76:79],a[240:243]
M a[244:247],v[12:15],v[80:83],a[244:247]
M a[248:251],v[12:15],v[84:87],a[248:251]
M a[252:255],v[12:15],v[88:91],a[252:255]
M v[192:195],v[12:15],v[92:95],v[192:195]
WL 4
M v[196:199],v[16:19],v[76:79],v[196:199]
M v[200:203],v[16:19],v[80:83],v[200:203]
M v[204:207],v[16:19],v[84:87],v[204:207]
M v[208:211],v[16:19],v[88:91],v[208:211]
M v[212:215],v[16:19],v[92:95],v[212:215]
WL 2
s_add_u32 s51, s63, 25600
s_add_u32 s50, s63, 29696
AR v44,a200
AR v45,a201
AR v46,a202
AR v47,a203
v_pk_mul_f32 v[44:45], v[44:45], v[4:5] op_sel_hi:[1,0]
v_pk_mul_f32 v[46:47], v[46:47], v[4:5] op_sel_hi:[1,0]
AR v48,a220
AR v49,a221
AR v50,a222
AR v51,a223
v_pk_mul_f32 v[48:49], v[48:49], v[4:5] op_sel_hi:[1,0]
v_pk_mul_f32 v[50:51], v[50:51], v[4:5] op_sel_hi:[1,0]
CV v64,v44,v45
CV v65,v46,v47
CV v66,v48,v49
CV v67,v50,v51
buffer_store_dwordx4 v[64:67], v10, s[32:35], s51 offen offset:0 sc1
v_and_b32 v44, s4, v64
v_and_b32 v45, s4, v65
v_and_b32 v46, s4, v66
v_and_b32 v47, s4, v67
v_pk_max_u16 v32, v32, v44
v_pk_max_u16 v32, v32, v45
v_pk_max_u16 v32, v32, v46
v_pk_max_u16 v32, v32, v47
AR v56,a204
AR v57,a205
AR v58,a206
AR v59,a207
v_pk_mul_f32 v[56:57], v[56:57], v[4:5] op_sel:[0,1] op_sel_hi:[1,1]
v_pk_mul_f32 v[58:59], v[58:59], v[4:5] op_sel:[0,1] op_sel_hi:[1,1]
AR v60,a224
AR v61,a225
AR v62,a226
AR v63,a227
v_pk_mul_f32 v[60:61], v[60:61], v[4:5] op_sel:[0,1] op_sel_hi:[1,1]
v_pk_mul_f32 v[62:63], v[62:63], v[4:5] op_sel:[0,1] op_sel_hi:[1,1]
CV v68,v56,v57
CV v69,v58,v59
CV v70,v60,v61
CV v71,v62,v63
buffer_store_dwordx4 v[68:71], v10, s[32:35], s51 offen offset:1024 sc1
v_and_b32 v56, s4, v68
v_and_b32 v57, s4, v69
v_and_b32 v58, s4, v70
v_and_b32 v59, s4, v71
v_pk_max_u16 v32, v32, v56
v_pk_max_u16 v32, v32, v57
v_pk_max_u16 v32, v32, v58
v_pk_max_u16 v32, v32, v59
AR v36,a208
AR v37,a209
AR v38,a210
AR v39,a211
v_pk_mul_f32 v[36:37], v[36:37], v[6:7] op_sel_hi:[1,0]
v_pk_mul_f32 v[38:39], v[38:39], v[6:7] op_sel_hi:[1,0]
AR v40,a228
AR v41,a229
AR v42,a230
AR v43,a231
v_pk_mul_f32 v[40:41], v[40:41], v[6:7] op_sel_hi:[1,0]
v_pk_mul_f32 v[42:43], v[42:43], v[6:7] op_sel_hi:[1,0]
CV v72,v36,v37
CV v73,v38,v39
CV v74,v40,v41
CV v75,v42,v43
buffer_store_dwordx4 v[72:75], v10, s[32:35], s51 offen offset:2048 sc1
v_and_b32 v36, s4, v72
v_and_b32 v37, s4, v73
v_and_b32 v38, s4, v74
v_and_b32 v39, s4, v75
v_pk_max_u16 v32, v32, v36
v_pk_max_u16 v32, v32, v37
v_pk_max_u16 v32, v32, v38
v_pk_max_u16 v32, v32, v39
AR v44,a212
AR v45,a213
AR v46,a214
AR v47,a215
v_pk_mul_f32 v[44:45], v[44:45], v[6:7] op_sel:[0,1] op_sel_hi:[1,1]
v_pk_mul_f32 v[46:47], v[46:47], v[6:7] op_sel:[0,1] op_sel_hi:[1,1]
AR v48,a232
AR v49,a233
AR v50,a234
AR v51,a235
v_pk_mul_f32 v[48:49], v[48:49], v[6:7] op_sel:[0,1] op_sel_hi:[1,1]
v_pk_mul_f32 v[50:51], v[50:51], v[6:7] op_sel:[0,1] op_sel_hi:[1,1]
CV v52,v44,v45
CV v53,v46,v47
CV v54,v48,v49
CV v55,v50,v51
buffer_store_dwordx4 v[52:55], v10, s[32:35], s51 offen offset:3072 sc1
v_and_b32 v44, s4, v52
v_and_b32 v45, s4, v53
v_and_b32 v46, s4, v54
v_and_b32 v47, s4, v55
v_pk_max_u16 v32, v32, v44
v_pk_max_u16 v32, v32, v45
v_pk_max_u16 v32, v32, v46
v_pk_max_u16 v32, v32, v47
AR v56,a216
AR v57,a217
AR v58,a218
AR v59,a219
v_pk_mul_f32 v[56:57], v[56:57], v[8:9] op_sel_hi:[1,0]
v_pk_mul_f32 v[58:59], v[58:59], v[8:9] op_sel_hi:[1,0]
AR v60,a236
AR v61,a237
AR v62,a238
AR v63,a239
v_pk_mul_f32 v[60:61], v[60:61], v[8:9] op_sel_hi:[1,0]
v_pk_mul_f32 v[62:63], v[62:63], v[8:9] op_sel_hi:[1,0]
CV v28,v56,v57
CV v29,v58,v59
CV v30,v60,v61
CV v31,v62,v63
buffer_store_dwordx4 v[28:31], v10, s[32:35], s50 offen offset:0 sc1
v_and_b32 v56, s4, v28
v_and_b32 v57, s4, v29
v_and_b32 v58, s4, v30
v_and_b32 v59, s4, v31
v_pk_max_u16 v32, v32, v56
v_pk_max_u16 v32, v32, v57
v_pk_max_u16 v32, v32, v58
v_pk_max_u16 v32, v32, v59
M v[216:219],v[20:23],v[76:79],v[216:219]
M v[220:223],v[20:23],v[80:83],v[220:223]
M v[224:227],v[20:23],v[84:87],v[224:227]
M v[228:231],v[20:23],v[88:91],v[228:231]
M v[232:235],v[20:23],v[92:95],v[232:235]
WL 0
M v[236:239],v[24:27],v[76:79],v[236:239]
M v[240:243],v[24:27],v[80:83],v[240:243]
M v[244:247],v[24:27],v[84:87],v[244:247]
M v[248:251],v[24:27],v[88:91],v[248:251]
M v[252:255],v[24:27],v[92:95],v[252:255]
s_add_u32 s51, s63, 30720
s_add_u32 s50, s63, 34816
AR v36,a240
AR v37,a241
AR v38,a242
AR v39,a243
v_pk_mul_f32 v[36:37], v[36:37], v[4:5] op_sel_hi:[1,0]
v_pk_mul_f32 v[38:39], v[38:39], v[4:5] op_sel_hi:[1,0]
v_pk_mul_f32 v[40:41], v[196:197], v[4:5] op_sel_hi:[1,0]
v_pk_mul_f32 v[42:43], v[198:199], v[4:5] op_sel_hi:[1,0]
CV v64,v36,v37
CV v65,v38,v39
CV v66,v40,v41
CV v67,v42,v43
buffer_store_dwordx4 v[64:67], v10, s[32:35], s51 offen offset:0 sc1
v_and_b32 v36, s4, v64
v_and_b32 v37, s4, v65
v_and_b32 v38, s4, v66
v_and_b32 v39, s4, v67
v_pk_max_u16 v32, v32, v36
v_pk_max_u16 v32, v32, v37
v_pk_max_u16 v32, v32, v38
v_pk_max_u16 v32, v32, v39
AR v44,a244
AR v45,a245
AR v46,a246
AR v47,a247
v_pk_mul_f32 v[44:45], v[44:45], v[4:5] op_sel:[0,1] op_sel_hi:[1,1]
v_pk_mul_f32 v[46:47], v[46:47], v[4:5] op_sel:[0,1] op_sel_hi:[1,1]
v_pk_mul_f32 v[48:49], v[200:201], v[4:5] op_sel:[0,1] op_sel_hi:[1,1]
v_pk_mul_f32 v[50:51], v[202:203], v[4:5] op_sel:[0,1] op_sel_hi:[1,1]
CV v68,v44,v45
CV v69,v46,v47
CV v70,v48,v49
CV v71,v50,v51
buffer_store_dwordx4 v[68:71], v10, s[32:35], s51 offen offset:1024 sc1
v_and_b32 v44, s4, v68
v_and_b32 v45, s4, v69
v_and_b32 v46, s4, v70
v_and_b32 v47, s4, v71
v_pk_max_u16 v32, v32, v44
v_pk_max_u16 v32, v32, v45
v_pk_max_u16 v32, v32, v46
v_pk_max_u16 v32, v32, v47
AR v56,a248
AR v57,a249
AR v58,a250
AR v59,a251
v_pk_mul_f32 v[56:57], v[56:57], v[6:7] op_sel_hi:[1,0]
v_pk_mul_f32 v[58:59], v[58:59], v[6:7] op_sel_hi:[1,0]
v_pk_mul_f32 v[60:61], v[204:205], v[6:7] op_sel_hi:[1,0]
v_pk_mul_f32 v[62:63], v[206:207], v[6:7] op_sel_hi:[1,0]
CV v72,v56,v57
CV v73,v58,v59
CV v74,v60,v61
CV v75,v62,v63
buffer_store_dwordx4 v[72:75], v10, s[32:35], s51 offen offset:2048 sc1
v_and_b32 v56, s4, v72
v_and_b32 v57, s4, v73
v_and_b32 v58, s4, v74
v_and_b32 v59, s4, v75
v_pk_max_u16 v32, v32, v56
v_pk_max_u16 v32, v32, v57
v_pk_max_u16 v32, v32, v58
v_pk_max_u16 v32, v32, v59
AR v36,a252
AR v37,a253
AR v38,a254
AR v39,a255
v_pk_mul_f32 v[36:37], v[36:37], v[6:7] op_sel:[0,1] op_sel_hi:[1,1]
v_pk_mul_f32 v[38:39], v[38:39], v[6:7] op_sel:[0,1] op_sel_hi:[1,1]
v_pk_mul_f32 v[40:41], v[208:209], v[6:7] op_sel:[0,1] op_sel_hi:[1,1]
v_pk_mul_f32 v[42:43], v[210:211], v[6:7] op_sel:[0,1] op_sel_hi:[1,1]
CV v52,v36,v37
CV v53,v38,v39
CV v54,v40,v41
CV v55,v42,v43
buffer_store_dwordx4 v[52:55], v10, s[32:35], s51 offen offset:3072 sc1
v_and_b32 v36, s4, v52
v_and_b32 v37, s4, v53
v_and_b32 v38, s4, v54
v_and_b32 v39, s4, v55
v_pk_max_u16 v32, v32, v36
v_pk_max_u16 v32, v32, v37
v_pk_max_u16 v32, v32, v38
v_pk_max_u16 v32, v32, v39
v_pk_mul_f32 v[44:45], v[192:193], v[8:9] op_sel_hi:[1,0]
v_pk_mul_f32 v[46:47], v[194:195], v[8:9] op_sel_hi:[1,0]
v_pk_mul_f32 v[48:49], v[212:213], v[8:9] op_sel_hi:[1,0]
v_pk_mul_f32 v[50:51], v[214:215], v[8:9] op_sel_hi:[1,0]
CV v28,v44,v45
CV v29,v46,v47
CV v30,v48,v49
CV v31,v50,v51
buffer_store_dwordx4 v[28:31], v10, s[32:35], s50 offen offset:0 sc1
v_and_b32 v44, s4, v28
v_and_b32 v45, s4, v29
v_and_b32 v46, s4, v30
v_and_b32 v47, s4, v31
v_pk_max_u16 v32, v32, v44
v_pk_max_u16 v32, v32, v45
v_pk_max_u16 v32, v32, v46
v_pk_max_u16 v32, v32, v47
s_nop 7
s_add_u32 s51, s63, 35840
s_add_u32 s50, s63, 39936
v_pk_mul_f32 v[56:57], v[216:217], v[4:5] op_sel_hi:[1,0]
v_pk_mul_f32 v[58:59], v[218:219], v[4:5] op_sel_hi:[1,0]
v_pk_mul_f32 v[60:61], v[236:237], v[4:5] op_sel_hi:[1,0]
v_pk_mul_f32 v[62:63], v[238:239], v[4:5] op_sel_hi:[1,0]
CV v64,v56,v57
CV v65,v58,v59
CV v66,v60,v61
CV v67,v62,v63
buffer_store_dwordx4 v[64:67], v10, s[32:35], s51 offen offset:0 sc1
v_and_b32 v56, s4, v64
v_and_b32 v57, s4, v65
v_and_b32 v58, s4, v66
v_and_b32 v59, s4, v67
v_pk_max_u16 v32, v32, v56
v_pk_max_u16 v32, v32, v57
v_pk_max_u16 v32, v32, v58
v_pk_max_u16 v32, v32, v59
v_pk_mul_f32 v[36:37], v[220:221], v[4:5] op_sel:[0,1] op_sel_hi:[1,1]
v_pk_mul_f32 v[38:39], v[222:223], v[4:5] op_sel:[0,1] op_sel_hi:[1,1]
v_pk_mul_f32 v[40:41], v[240:241], v[4:5] op_sel:[0,1] op_sel_hi:[1,1]
v_pk_mul_f32 v[42:43], v[242:243], v[4:5] op_sel:[0,1] op_sel_hi:[1,1]
CV v68,v36,v37
CV v69,v38,v39
CV v70,v40,v41
CV v71,v42,v43
buffer_store_dwordx4 v[68:71], v10, s[32:35], s51 offen offset:1024 sc1
v_and_b32 v36, s4, v68
v_and_b32 v37, s4, v69
v_and_b32 v38, s4, v70
v_and_b32 v39, s4, v71
v_pk_max_u16 v32, v32, v36
v_pk_max_u16 v32, v32, v37
v_pk_max_u16 v32, v32, v38
v_pk_max_u16 v32, v32, v39
v_pk_mul_f32 v[44:45], v[224:225], v[6:7] op_sel_hi:[1,0]
v_pk_mul_f32 v[46:47], v[226:227], v[6:7] op_sel_hi:[1,0]
v_pk_mul_f32 v[48:49], v[244:245], v[6:7] op_sel_hi:[1,0]
v_pk_mul_f32 v[50:51], v[246:247], v[6:7] op_sel_hi:[1,0]
CV v72,v44,v45
CV v73,v46,v47
CV v74,v48,v49
CV v75,v50,v51
buffer_store_dwordx4 v[72:75], v10, s[32:35], s51 offen offset:2048 sc1
v_and_b32 v44, s4, v72
v_and_b32 v45, s4, v73
v_and_b32 v46, s4, v74
v_and_b32 v47, s4, v75
v_pk_max_u16 v32, v32, v44
v_pk_max_u16 v32, v32, v45
v_pk_max_u16 v32, v32, v46
v_pk_max_u16 v32, v32, v47
v_pk_mul_f32 v[56:57], v[228:229], v[6:7] op_sel:[0,1] op_sel_hi:[1,1]
v_pk_mul_f32 v[58:59], v[230:231], v[6:7] op_sel:[0,1] op_sel_hi:[1,1]
v_pk_mul_f32 v[60:61], v[248:249], v[6:7] op_sel:[0,1] op_sel_hi:[1,1]
v_pk_mul_f32 v[62:63], v[250:251], v[6:7] op_sel:[0,1] op_sel_hi:[1,1]
CV v52,v56,v57
CV v53,v58,v59
CV v54,v60,v61
CV v55,v62,v63
buffer_store_dwordx4 v[52:55], v10, s[32:35], s51 offen offset:3072 sc1
v_and_b32 v56, s4, v52
v_and_b32 v57, s4, v53
v_and_b32 v58, s4, v54
v_and_b32 v59, s4, v55
v_pk_max_u16 v32, v32, v56
v_pk_max_u16 v32, v32, v57
v_pk_max_u16 v32, v32, v58
v_pk_max_u16 v32, v32, v59
v_pk_mul_f32 v[36:37], v[232:233], v[8:9] op_sel_hi:[1,0]
v_pk_mul_f32 v[38:39], v[234:235], v[8:9] op_sel_hi:[1,0]
v_pk_mul_f32 v[40:41], v[252:253], v[8:9] op_sel_hi:[1,0]
v_pk_mul_f32 v[42:43], v[254:255], v[8:9] op_sel_hi:[1,0]
CV v28,v36,v37
CV v29,v38,v39
CV v30,v40,v41
CV v31,v42,v43
buffer_store_dwordx4 v[28:31], v10, s[32:35], s50 offen offset:0 sc1
v_and_b32 v36, s4, v28
v_and_b32 v37, s4, v29
v_and_b32 v38, s4, v30
v_and_b32 v39, s4, v31
v_pk_max_u16 v32, v32, v36
v_pk_max_u16 v32, v32, v37
v_pk_max_u16 v32, v32, v38
v_pk_max_u16 v32, v32, v39
v_lshrrev_b32 v36, 16, v32
v_and_b32 v32, 0xffff, v32
v_max_u32 v32, v32, v36
s_movk_i32 s4, 0x7f80
v_cmp_le_u32 vcc, s4, v32
s_nop 1
s_cmp_lg_u64 vcc, 0
s_cselect_b32 s4, 1, 0
s_or_b32 s60, s60, s4
s_lshl_b32 s5, s3, 2
s_add_u32 s5, s5, 81920
v_mov_b32 v56, s5
v_mov_b32 v57, s60
v_mov_b32 v58, 81920
ds_write_b32 v56, v57
WL 0
s_barrier
ds_read_b128 v[60:63], v58
WL 0
v_or_b32 v60, v60, v61
v_or_b32 v62, v62, v63
v_or_b32 v60, v60, v62
s_nop 0
v_readfirstlane_b32 s4, v60
s_nop 3
s_cmp_lg_u32 s4, 0
s_cbranch_scc1 L1_slow_5
s_branch L2_join
L1_norm_5:
v_subrev_u32 v10, s62, v2
v_rcp_f32 v4, v4
v_rcp_f32 v5, v5
v_rcp_f32 v6, v6
v_rcp_f32 v7, v7
v_rcp_f32 v8, v8
s_nop 0
v_mov_b32 v76, v4
v_mov_b32 v77, v4
v_mov_b32 v78, v5
v_mov_b32 v79, v5
v_mov_b32 v80, v6
v_mov_b32 v81, v6
v_mov_b32 v82, v7
v_mov_b32 v83, v7
v_mov_b32 v84, v8
v_mov_b32 v85, v8
s_add_u32 s51, s63, 0
s_add_u32 s50, s63, 4096
AR v96,a0
AR v97,a1
AR v98,a2
AR v99,a3
PM v[96:97],v[96:97],v[76:77]
PM v[98:99],v[98:99],v[76:77]
AR v100,a20
AR v101,a21
AR v102,a22
AR v103,a23
PM v[100:101],v[100:101],v[76:77]
PM v[102:103],v[102:103],v[76:77]
CV v128,v96,v97
CV v129,v98,v99
CV v130,v100,v101
CV v131,v102,v103
buffer_store_dwordx4 v[128:131], v10, s[32:35], s51 offen offset:0 sc1
AR v104,a4
AR v105,a5
AR v106,a6
AR v107,a7
PM v[104:105],v[104:105],v[78:79]
PM v[106:107],v[106:107],v[78:79]
AR v108,a24
AR v109,a25
AR v110,a26
AR v111,a27
PM v[108:109],v[108:109],v[78:79]
PM v[110:111],v[110:111],v[78:79]
CV v132,v104,v105
CV v133,v106,v107
CV v134,v108,v109
CV v135,v110,v111
buffer_store_dwordx4 v[132:135], v10, s[32:35], s51 offen offset:1024 sc1
AR v112,a8
AR v113,a9
AR v114,a10
AR v115,a11
PM v[112:113],v[112:113],v[80:81]
PM v[114:115],v[114:115],v[80:81]
AR v116,a28
AR v117,a29
AR v118,a30
AR v119,a31
PM v[116:117],v[116:117],v[80:81]
PM v[118:119],v[118:119],v[80:81]
CV v136,v112,v113
CV v137,v114,v115
CV v138,v116,v117
CV v139,v118,v119
buffer_store_dwordx4 v[136:139], v10, s[32:35], s51 offen offset:2048 sc1
AR v120,a12
AR v121,a13
AR v122,a14
AR v123,a15
PM v[120:121],v[120:121],v[82:83]
PM v[122:123],v[122:123],v[82:83]
AR v124,a32
AR v125,a33
AR v126,a34
AR v127,a35
PM v[124:125],v[124:125],v[82:83]
PM v[126:127],v[126:127],v[82:83]
CV v140,v120,v121
CV v141,v122,v123
CV v142,v124,v125
CV v143,v126,v127
buffer_store_dwordx4 v[140:143], v10, s[32:35], s51 offen offset:3072 sc1
AR v96,a16
AR v97,a17
AR v98,a18
AR v99,a19
PM v[96:97],v[96:97],v[84:85]
PM v[98:99],v[98:99],v[84:85]
AR v100,a36
AR v101,a37
AR v102,a38
AR v103,a39
PM v[100:101],v[100:101],v[84:85]
PM v[102:103],v[102:103],v[84:85]
CV v144,v96,v97
CV v145,v98,v99
CV v146,v100,v101
CV v147,v102,v103
buffer_store_dwordx4 v[144:147], v10, s[32:35], s50 offen offset:0 sc1
s_add_u32 s51, s63, 5120
s_add_u32 s50, s63, 9216
AR v104,a40
AR v105,a41
AR v106,a42
AR v107,a43
PM v[104:105],v[104:105],v[76:77]
PM v[106:107],v[106:107],v[76:77]
AR v108,a60
AR v109,a61
AR v110,a62
AR v111,a63
PM v[108:109],v[108:109],v[76:77]
PM v[110:111],v[110:111],v[76:77]
CV v148,v104,v105
CV v149,v106,v107
CV v150,v108,v109
CV v151,v110,v111
buffer_store_dwordx4 v[148:151], v10, s[32:35], s51 offen offset:0 sc1
AR v112,a44
AR v113,a45
AR v114,a46
AR v115,a47
PM v[112:113],v[112:113],v[78:79]
PM v[114:115],v[114:115],v[78:79]
AR v116,a64
AR v117,a65
AR v118,a66
AR v119,a67
PM v[116:117],v[116:117],v[78:79]
PM v[118:119],v[118:119],v[78:79]
CV v128,v112,v113
CV v129,v114,v115
CV v130,v116,v117
CV v131,v118,v119
buffer_store_dwordx4 v[128:131], v10, s[32:35], s51 offen offset:1024 sc1
AR v120,a48
AR v121,a49
AR v122,a50
AR v123,a51
PM v[120:121],v[120:121],v[80:81]
PM v[122:123],v[122:123],v[80:81]
AR v124,a68
AR v125,a69
AR v126,a70
AR v127,a71
PM v[124:125],v[124:125],v[80:81]
PM v[126:127],v[126:127],v[80:81]
CV v132,v120,v121
CV v133,v122,v123
CV v134,v124,v125
CV v135,v126,v127
buffer_store_dwordx4 v[132:135], v10, s[32:35], s51 offen offset:2048 sc1
AR v96,a52
AR v97,a53
AR v98,a54
AR v99,a55
PM v[96:97],v[96:97],v[82:83]
PM v[98:99],v[98:99],v[82:83]
AR v100,a72
AR v101,a73
AR v102,a74
AR v103,a75
PM v[100:101],v[100:101],v[82:83]
PM v[102:103],v[102:103],v[82:83]
CV v136,v96,v97
CV v137,v98,v99
CV v138,v100,v101
CV v139,v102,v103
buffer_store_dwordx4 v[136:139], v10, s[32:35], s51 offen offset:3072 sc1
AR v104,a56
AR v105,a57
AR v106,a58
AR v107,a59
PM v[104:105],v[104:105],v[84:85]
PM v[106:107],v[106:107],v[84:85]
AR v108,a76
AR v109,a77
AR v110,a78
AR v111,a79
PM v[108:109],v[108:109],v[84:85]
PM v[110:111],v[110:111],v[84:85]
CV v140,v104,v105
CV v141,v106,v107
CV v142,v108,v109
CV v143,v110,v111
buffer_store_dwordx4 v[140:143], v10, s[32:35], s50 offen offset:0 sc1
s_add_u32 s51, s63, 10240
s_add_u32 s50, s63, 14336
AR v112,a80
AR v113,a81
AR v114,a82
AR v115,a83
PM v[112:113],v[112:113],v[76:77]
PM v[114:115],v[114:115],v[76:77]
AR v116,a100
AR v117,a101
AR v118,a102
AR v119,a103
PM v[116:117],v[116:117],v[76:77]
PM v[118:119],v[118:119],v[76:77]
CV v144,v112,v113
CV v145,v114,v115
CV v146,v116,v117
CV v147,v118,v119
buffer_store_dwordx4 v[144:147], v10, s[32:35], s51 offen offset:0 sc1
AR v120,a84
AR v121,a85
AR v122,a86
AR v123,a87
PM v[120:121],v[120:121],v[78:79]
PM v[122:123],v[122:123],v[78:79]
AR v124,a104
AR v125,a105
AR v126,a106
AR v127,a107
PM v[124:125],v[124:125],v[78:79]
PM v[126:127],v[126:127],v[78:79]
CV v148,v120,v121
CV v149,v122,v123
CV v150,v124,v125
CV v151,v126,v127
buffer_store_dwordx4 v[148:151], v10, s[32:35], s51 offen offset:1024 sc1
AR v96,a88
AR v97,a89
AR v98,a90
AR v99,a91
PM v[96:97],v[96:97],v[80:81]
PM v[98:99],v[98:99],v[80:81]
AR v100,a108
AR v101,a109
AR v102,a110
AR v103,a111
PM v[100:101],v[100:101],v[80:81]
PM v[102:103],v[102:103],v[80:81]
CV v128,v96,v97
CV v129,v98,v99
CV v130,v100,v101
CV v131,v102,v103
buffer_store_dwordx4 v[128:131], v10, s[32:35], s51 offen offset:2048 sc1
AR v104,a92
AR v105,a93
AR v106,a94
AR v107,a95
PM v[104:105],v[104:105],v[82:83]
PM v[106:107],v[106:107],v[82:83]
AR v108,a112
AR v109,a113
AR v110,a114
AR v111,a115
PM v[108:109],v[108:109],v[82:83]
PM v[110:111],v[110:111],v[82:83]
CV v132,v104,v105
CV v133,v106,v107
CV v134,v108,v109
CV v135,v110,v111
buffer_store_dwordx4 v[132:135], v10, s[32:35], s51 offen offset:3072 sc1
AR v112,a96
AR v113,a97
AR v114,a98
AR v115,a99
PM v[112:113],v[112:113],v[84:85]
PM v[114:115],v[114:115],v[84:85]
AR v116,a116
AR v117,a117
AR v118,a118
AR v119,a119
PM v[116:117],v[116:117],v[84:85]
PM v[118:119],v[118:119],v[84:85]
CV v136,v112,v113
CV v137,v114,v115
CV v138,v116,v117
CV v139,v118,v119
buffer_store_dwordx4 v[136:139], v10, s[32:35], s50 offen offset:0 sc1
s_add_u32 s51, s63, 15360
s_add_u32 s50, s63, 19456
AR v120,a120
AR v121,a121
AR v122,a122
AR v123,a123
PM v[120:121],v[120:121],v[76:77]
PM v[122:123],v[122:123],v[76:77]
AR v124,a140
AR v125,a141
AR v126,a142
AR v127,a143
PM v[124:125],v[124:125],v[76:77]
PM v[126:127],v[126:127],v[76:77]
CV v140,v120,v121
CV v141,v122,v123
CV v142,v124,v125
CV v143,v126,v127
buffer_store_dwordx4 v[140:143], v10, s[32:35], s51 offen offset:0 sc1
AR v96,a124
AR v97,a125
AR v98,a126
AR v99,a127
PM v[96:97],v[96:97],v[78:79]
PM v[98:99],v[98:99],v[78:79]
AR v100,a144
AR v101,a145
AR v102,a146
AR v103,a147
PM v[100:101],v[100:101],v[78:79]
PM v[102:103],v[102:103],v[78:79]
CV v144,v96,v97
CV v145,v98,v99
CV v146,v100,v101
CV v147,v102,v103
buffer_store_dwordx4 v[144:147], v10, s[32:35], s51 offen offset:1024 sc1
AR v104,a128
AR v105,a129
AR v106,a130
AR v107,a131
PM v[104:105],v[104:105],v[80:81]
PM v[106:107],v[106:107],v[80:81]
AR v108,a148
AR v109,a149
AR v110,a150
AR v111,a151
PM v[108:109],v[108:109],v[80:81]
PM v[110:111],v[110:111],v[80:81]
CV v148,v104,v105
CV v149,v106,v107
CV v150,v108,v109
CV v151,v110,v111
buffer_store_dwordx4 v[148:151], v10, s[32:35], s51 offen offset:2048 sc1
AR v112,a132
AR v113,a133
AR v114,a134
AR v115,a135
PM v[112:113],v[112:113],v[82:83]
PM v[114:115],v[114:115],v[82:83]
AR v116,a152
AR v117,a153
AR v118,a154
AR v119,a155
PM v[116:117],v[116:117],v[82:83]
PM v[118:119],v[118:119],v[82:83]
CV v128,v112,v113
CV v129,v114,v115
CV v130,v116,v117
CV v131,v118,v119
buffer_store_dwordx4 v[128:131], v10, s[32:35], s51 offen offset:3072 sc1
AR v120,a136
AR v121,a137
AR v122,a138
AR v123,a139
PM v[120:121],v[120:121],v[84:85]
PM v[122:123],v[122:123],v[84:85]
AR v124,a156
AR v125,a157
AR v126,a158
AR v127,a159
PM v[124:125],v[124:125],v[84:85]
PM v[126:127],v[126:127],v[84:85]
CV v132,v120,v121
CV v133,v122,v123
CV v134,v124,v125
CV v135,v126,v127
buffer_store_dwordx4 v[132:135], v10, s[32:35], s50 offen offset:0 sc1
s_add_u32 s51, s63, 20480
s_add_u32 s50, s63, 24576
AR v96,a160
AR v97,a161
AR v98,a162
AR v99,a163
PM v[96:97],v[96:97],v[76:77]
PM v[98:99],v[98:99],v[76:77]
AR v100,a180
AR v101,a181
AR v102,a182
AR v103,a183
PM v[100:101],v[100:101],v[76:77]
PM v[102:103],v[102:103],v[76:77]
CV v136,v96,v97
CV v137,v98,v99
CV v138,v100,v101
CV v139,v102,v103
buffer_store_dwordx4 v[136:139], v10, s[32:35], s51 offen offset:0 sc1
AR v104,a164
AR v105,a165
AR v106,a166
AR v107,a167
PM v[104:105],v[104:105],v[78:79]
PM v[106:107],v[106:107],v[78:79]
AR v108,a184
AR v109,a185
AR v110,a186
AR v111,a187
PM v[108:109],v[108:109],v[78:79]
PM v[110:111],v[110:111],v[78:79]
CV v140,v104,v105
CV v141,v106,v107
CV v142,v108,v109
CV v143,v110,v111
buffer_store_dwordx4 v[140:143], v10, s[32:35], s51 offen offset:1024 sc1
AR v112,a168
AR v113,a169
AR v114,a170
AR v115,a171
PM v[112:113],v[112:113],v[80:81]
PM v[114:115],v[114:115],v[80:81]
AR v116,a188
AR v117,a189
AR v118,a190
AR v119,a191
PM v[116:117],v[116:117],v[80:81]
PM v[118:119],v[118:119],v[80:81]
CV v144,v112,v113
CV v145,v114,v115
CV v146,v116,v117
CV v147,v118,v119
buffer_store_dwordx4 v[144:147], v10, s[32:35], s51 offen offset:2048 sc1
AR v120,a172
AR v121,a173
AR v122,a174
AR v123,a175
PM v[120:121],v[120:121],v[82:83]
PM v[122:123],v[122:123],v[82:83]
AR v124,a192
AR v125,a193
AR v126,a194
AR v127,a195
PM v[124:125],v[124:125],v[82:83]
PM v[126:127],v[126:127],v[82:83]
CV v148,v120,v121
CV v149,v122,v123
CV v150,v124,v125
CV v151,v126,v127
buffer_store_dwordx4 v[148:151], v10, s[32:35], s51 offen offset:3072 sc1
AR v96,a176
AR v97,a177
AR v98,a178
AR v99,a179
PM v[96:97],v[96:97],v[84:85]
PM v[98:99],v[98:99],v[84:85]
AR v100,a196
AR v101,a197
AR v102,a198
AR v103,a199
PM v[100:101],v[100:101],v[84:85]
PM v[102:103],v[102:103],v[84:85]
CV v128,v96,v97
CV v129,v98,v99
CV v130,v100,v101
CV v131,v102,v103
buffer_store_dwordx4 v[128:131], v10, s[32:35], s50 offen offset:0 sc1
s_add_u32 s51, s63, 25600
s_add_u32 s50, s63, 29696
AR v104,a200
AR v105,a201
AR v106,a202
AR v107,a203
PM v[104:105],v[104:105],v[76:77]
PM v[106:107],v[106:107],v[76:77]
AR v108,a220
AR v109,a221
AR v110,a222
AR v111,a223
PM v[108:109],v[108:109],v[76:77]
PM v[110:111],v[110:111],v[76:77]
CV v132,v104,v105
CV v133,v106,v107
CV v134,v108,v109
CV v135,v110,v111
buffer_store_dwordx4 v[132:135], v10, s[32:35], s51 offen offset:0 sc1
AR v112,a204
AR v113,a205
AR v114,a206
AR v115,a207
PM v[112:113],v[112:113],v[78:79]
PM v[114:115],v[114:115],v[78:79]
AR v116,a224
AR v117,a225
AR v118,a226
AR v119,a227
PM v[116:117],v[116:117],v[78:79]
PM v[118:119],v[118:119],v[78:79]
CV v136,v112,v113
CV v137,v114,v115
CV v138,v116,v117
CV v139,v118,v119
buffer_store_dwordx4 v[136:139], v10, s[32:35], s51 offen offset:1024 sc1
AR v120,a208
AR v121,a209
AR v122,a210
AR v123,a211
PM v[120:121],v[120:121],v[80:81]
PM v[122:123],v[122:123],v[80:81]
AR v124,a228
AR v125,a229
AR v126,a230
AR v127,a231
PM v[124:125],v[124:125],v[80:81]
PM v[126:127],v[126:127],v[80:81]
CV v140,v120,v121
CV v141,v122,v123
CV v142,v124,v125
CV v143,v126,v127
buffer_store_dwordx4 v[140:143], v10, s[32:35], s51 offen offset:2048 sc1
AR v96,a212
AR v97,a213
AR v98,a214
AR v99,a215
PM v[96:97],v[96:97],v[82:83]
PM v[98:99],v[98:99],v[82:83]
AR v100,a232
AR v101,a233
AR v102,a234
AR v103,a235
PM v[100:101],v[100:101],v[82:83]
PM v[102:103],v[102:103],v[82:83]
CV v144,v96,v97
CV v145,v98,v99
CV v146,v100,v101
CV v147,v102,v103
buffer_store_dwordx4 v[144:147], v10, s[32:35], s51 offen offset:3072 sc1
AR v104,a216
AR v105,a217
AR v106,a218
AR v107,a219
PM v[104:105],v[104:105],v[84:85]
PM v[106:107],v[106:107],v[84:85]
AR v108,a236
AR v109,a237
AR v110,a238
AR v111,a239
PM v[108:109],v[108:109],v[84:85]
PM v[110:111],v[110:111],v[84:85]
CV v148,v104,v105
CV v149,v106,v107
CV v150,v108,v109
CV v151,v110,v111
buffer_store_dwordx4 v[148:151], v10, s[32:35], s50 offen offset:0 sc1
s_add_u32 s51, s63, 30720
s_add_u32 s50, s63, 34816
AR v112,a240
AR v113,a241
AR v114,a242
AR v115,a243
PM v[112:113],v[112:113],v[76:77]
PM v[114:115],v[114:115],v[76:77]
PM v[116:117],v[196:197],v[76:77]
PM v[118:119],v[198:199],v[76:77]
CV v128,v112,v113
CV v129,v114,v115
CV v130,v116,v117
CV v131,v118,v119
buffer_store_dwordx4 v[128:131], v10, s[32:35], s51 offen offset:0 sc1
AR v120,a244
AR v121,a245
AR v122,a246
AR v123,a247
PM v[120:121],v[120:121],v[78:79]
PM v[122:123],v[122:123],v[78:79]
PM v[124:125],v[200:201],v[78:79]
PM v[126:127],v[202:203],v[78:79]
CV v132,v120,v121
CV v133,v122,v123
CV v134,v124,v125
CV v135,v126,v127
buffer_store_dwordx4 v[132:135], v10, s[32:35], s51 offen offset:1024 sc1
AR v96,a248
AR v97,a249
AR v98,a250
AR v99,a251
PM v[96:97],v[96:97],v[80:81]
PM v[98:99],v[98:99],v[80:81]
PM v[100:101],v[204:205],v[80:81]
PM v[102:103],v[206:207],v[80:81]
CV v136,v96,v97
CV v137,v98,v99
CV v138,v100,v101
CV v139,v102,v103
buffer_store_dwordx4 v[136:139], v10, s[32:35], s51 offen offset:2048 sc1
AR v104,a252
AR v105,a253
AR v106,a254
AR v107,a255
PM v[104:105],v[104:105],v[82:83]
PM v[106:107],v[106:107],v[82:83]
PM v[108:109],v[208:209],v[82:83]
PM v[110:111],v[210:211],v[82:83]
CV v140,v104,v105
CV v141,v106,v107
CV v142,v108,v109
CV v143,v110,v111
buffer_store_dwordx4 v[140:143], v10, s[32:35], s51 offen offset:3072 sc1
PM v[112:113],v[192:193],v[84:85]
PM v[114:115],v[194:195],v[84:85]
PM v[116:117],v[212:213],v[84:85]
PM v[118:119],v[214:215],v[84:85]
CV v144,v112,v113
CV v145,v114,v115
CV v146,v116,v117
CV v147,v118,v119
buffer_store_dwordx4 v[144:147], v10, s[32:35], s50 offen offset:0 sc1
s_add_u32 s51, s63, 35840
s_add_u32 s50, s63, 39936
PM v[120:121],v[216:217],v[76:77]
PM v[122:123],v[218:219],v[76:77]
PM v[124:125],v[236:237],v[76:77]
PM v[126:127],v[238:239],v[76:77]
CV v148,v120,v121
CV v149,v122,v123
CV v150,v124,v125
CV v151,v126,v127
buffer_store_dwordx4 v[148:151], v10, s[32:35], s51 offen offset:0 sc1
PM v[96:97],v[220:221],v[78:79]
PM v[98:99],v[222:223],v[78:79]
PM v[100:101],v[240:241],v[78:79]
PM v[102:103],v[242:243],v[78:79]
CV v128,v96,v97
CV v129,v98,v99
CV v130,v100,v101
CV v131,v102,v103
buffer_store_dwordx4 v[128:131], v10, s[32:35], s51 offen offset:1024 sc1
PM v[104:105],v[224:225],v[80:81]
PM v[106:107],v[226:227],v[80:81]
PM v[108:109],v[244:245],v[80:81]
PM v[110:111],v[246:247],v[80:81]
CV v132,v104,v105
CV v133,v106,v107
CV v134,v108,v109
CV v135,v110,v111
buffer_store_dwordx4 v[132:135], v10, s[32:35], s51 offen offset:2048 sc1
PM v[112:113],v[228:229],v[82:83]
PM v[114:115],v[230:231],v[82:83]
PM v[116:117],v[248:249],v[82:83]
PM v[118:119],v[250:251],v[82:83]
CV v136,v112,v113
CV v137,v114,v115
CV v138,v116,v117
CV v139,v118,v119
buffer_store_dwordx4 v[136:139], v10, s[32:35], s51 offen offset:3072 sc1
PM v[120:121],v[232:233],v[84:85]
PM v[122:123],v[234:235],v[84:85]
PM v[124:125],v[252:253],v[84:85]
PM v[126:127],v[254:255],v[84:85]
CV v140,v120,v121
CV v141,v122,v123
CV v142,v124,v125
CV v143,v126,v127
buffer_store_dwordx4 v[140:143], v10, s[32:35], s50 offen offset:0 sc1
s_branch L2_join
L1_post_4:
WV 0
s_barrier
v_mov_b32 v11, 0
s_cmp_lg_u32 s3, 0
s_cbranch_scc1 L1_wof_4
s_lshl_b32 s4, s58, 2
s_mov_b64 s[6:7], exec
s_mov_b64 exec, 1
v_mov_b32 v11, 1
buffer_atomic_add v11, v10, s[64:67], s4 offen offset:128
s_mov_b64 exec, s[6:7]
L1_wof_4:
TR v[12:13],v1,0
TR v[14:15],v1,8192
TR v[16:17],v9,0
TR v[18:19],v9,8192
TR v[20:21],v1,512
TR v[22:23],v1,8704
buffer_load_dword v0, v3, s[96:99], s100 offen
s_lshl_b32 s51, s58, 2
buffer_load_dword v11, v10, s[64:67], s51 offen offset:128 sc1
v_mov_b32 v56, v4
v_mov_b32 v57, v4
v_mov_b32 v58, v5
v_mov_b32 v59, v5
v_mov_b32 v60, v6
v_mov_b32 v61, v6
v_mov_b32 v62, v7
v_mov_b32 v63, v7
s_nop 1
v_permlane32_swap_b32 v56, v57
v_permlane32_swap_b32 v58, v59
v_permlane32_swap_b32 v60, v61
v_permlane32_swap_b32 v62, v63
s_nop 1
v_add_f32 v4, v56, v57
v_add_f32 v5, v58, v59
v_add_f32 v6, v60, v61
v_add_f32 v7, v62, v63
v_mov_b32 v56, v4
v_mov_b32 v57, v4
v_mov_b32 v58, v5
v_mov_b32 v59, v5
v_mov_b32 v60, v6
v_mov_b32 v61, v6
v_mov_b32 v62, v7
v_mov_b32 v63, v7
s_nop 1
v_permlane16_swap_b32 v56, v57
v_permlane16_swap_b32 v58, v59
v_permlane16_swap_b32 v60, v61
v_permlane16_swap_b32 v62, v63
s_nop 1
v_add_f32 v4, v56, v57
v_add_f32 v5, v58, v59
v_add_f32 v6, v60, v61
v_add_f32 v7, v62, v63
s_mov_b32 s4, 0x2b800000
s_mov_b32 s5, 0x53800000
s_mov_b64 s[6:7], -1
v_cmp_le_f32 vcc, s4, v4
s_nop 1
s_and_b64 s[6:7], s[6:7], vcc
v_cmp_ge_f32 vcc, s5, v4
s_nop 1
s_and_b64 s[6:7], s[6:7], vcc
v_cmp_le_f32 vcc, s4, v5
s_nop 1
s_and_b64 s[6:7], s[6:7], vcc
v_cmp_ge_f32 vcc, s5, v5
s_nop 1
s_and_b64 s[6:7], s[6:7], vcc
v_cmp_le_f32 vcc, s4, v6
s_nop 1
s_and_b64 s[6:7], s[6:7], vcc
v_cmp_ge_f32 vcc, s5, v6
s_nop 1
s_and_b64 s[6:7], s[6:7], vcc
v_cmp_le_f32 vcc, s4, v7
s_nop 1
s_and_b64 s[6:7], s[6:7], vcc
v_cmp_ge_f32 vcc, s5, v7
s_nop 1
s_and_b64 s[6:7], s[6:7], vcc
s_cmp_eq_u64 s[6:7], -1
s_cselect_b32 s60, 0, 1
v_subrev_u32 v10, s62, v2
v_rcp_f32 v4, v4
v_rcp_f32 v5, v5
v_rcp_f32 v6, v6
v_rcp_f32 v7, v7
TR v[24:25],v9,512
TR v[26:27],v9,8704
v_mov_b32 v32, 0
s_mov_b32 s4, 0x7fff7fff
WL 6
M a[0:3],v[12:15],v[76:79],a[0:3]
M a[4:7],v[12:15],v[80:83],a[4:7]
M a[8:11],v[12:15],v[84:87],a[8:11]
M a[12:15],v[12:15],v[88:91],a[12:15]
WL 4
M a[16:19],v[16:19],v[76:79],a[16:19]
M a[20:23],v[16:19],v[80:83],a[20:23]
M a[24:27],v[16:19],v[84:87],a[24:27]
M a[28:31],v[16:19],v[88:91],a[28:31]
WL 2
TR v[12:13],v1,1024
TR v[14:15],v1,9216
TR v[16:17],v9,1024
TR v[18:19],v9,9216
M a[32:35],v[20:23],v[76:79],a[32:35]
M a[36:39],v[20:23],v[80:83],a[36:39]
M a[40:43],v[20:23],v[84:87],a[40:43]
M a[44:47],v[20:23],v[88:91],a[44:47]
WL 4
M a[48:51],v[24:27],v[76:79],a[48:51]
M a[52:55],v[24:27],v[80:83],a[52:55]
M a[56:59],v[24:27],v[84:87],a[56:59]
M a[60:63],v[24:27],v[88:91],a[60:63]
WL 2
TR v[20:21],v1,1536
TR v[22:23],v1,9728
TR v[24:25],v9,1536
TR v[26:27],v9,9728
s_add_u32 s51, s63, 0
s_add_u32 s50, s63, 4096
AR v36,a0
AR v37,a1
AR v38,a2
AR v39,a3
v_pk_mul_f32 v[36:37], v[36:37], v[4:5] op_sel_hi:[1,0]
v_pk_mul_f32 v[38:39], v[38:39], v[4:5] op_sel_hi:[1,0]
AR v40,a16
AR v41,a17
AR v42,a18
AR v43,a19
v_pk_mul_f32 v[40:41], v[40:41], v[4:5] op_sel_hi:[1,0]
v_pk_mul_f32 v[42:43], v[42:43], v[4:5] op_sel_hi:[1,0]
CV v64,v36,v37
CV v65,v38,v39
CV v66,v40,v41
CV v67,v42,v43
buffer_store_dwordx4 v[64:67], v10, s[32:35], s51 offen offset:0 sc1
v_and_b32 v36, s4, v64
v_and_b32 v37, s4, v65
v_and_b32 v38, s4, v66
v_and_b32 v39, s4, v67
v_pk_max_u16 v32, v32, v36
v_pk_max_u16 v32, v32, v37
v_pk_max_u16 v32, v32, v38
v_pk_max_u16 v32, v32, v39
AR v44,a4
AR v45,a5
AR v46,a6
AR v47,a7
v_pk_mul_f32 v[44:45], v[44:45], v[4:5] op_sel:[0,1] op_sel_hi:[1,1]
v_pk_mul_f32 v[46:47], v[46:47], v[4:5] op_sel:[0,1] op_sel_hi:[1,1]
AR v48,a20
AR v49,a21
AR v50,a22
AR v51,a23
v_pk_mul_f32 v[48:49], v[48:49], v[4:5] op_sel:[0,1] op_sel_hi:[1,1]
v_pk_mul_f32 v[50:51], v[50:51], v[4:5] op_sel:[0,1] op_sel_hi:[1,1]
CV v68,v44,v45
CV v69,v46,v47
CV v70,v48,v49
CV v71,v50,v51
buffer_store_dwordx4 v[68:71], v10, s[32:35], s51 offen offset:1024 sc1
v_and_b32 v44, s4, v68
v_and_b32 v45, s4, v69
v_and_b32 v46, s4, v70
v_and_b32 v47, s4, v71
v_pk_max_u16 v32, v32, v44
v_pk_max_u16 v32, v32, v45
v_pk_max_u16 v32, v32, v46
v_pk_max_u16 v32, v32, v47
AR v56,a8
AR v57,a9
AR v58,a10
AR v59,a11
v_pk_mul_f32 v[56:57], v[56:57], v[6:7] op_sel_hi:[1,0]
v_pk_mul_f32 v[58:59], v[58:59], v[6:7] op_sel_hi:[1,0]
AR v60,a24
AR v61,a25
AR v62,a26
AR v63,a27
v_pk_mul_f32 v[60:61], v[60:61], v[6:7] op_sel_hi:[1,0]
v_pk_mul_f32 v[62:63], v[62:63], v[6:7] op_sel_hi:[1,0]
CV v72,v56,v57
CV v73,v58,v59
CV v74,v60,v61
CV v75,v62,v63
buffer_store_dwordx4 v[72:75], v10, s[32:35], s51 offen offset:2048 sc1
v_and_b32 v56, s4, v72
v_and_b32 v57, s4, v73
v_and_b32 v58, s4, v74
v_and_b32 v59, s4, v75
v_pk_max_u16 v32, v32, v56
v_pk_max_u16 v32, v32, v57
v_pk_max_u16 v32, v32, v58
v_pk_max_u16 v32, v32, v59
AR v36,a12
AR v37,a13
AR v38,a14
AR v39,a15
v_pk_mul_f32 v[36:37], v[36:37], v[6:7] op_sel:[0,1] op_sel_hi:[1,1]
v_pk_mul_f32 v[38:39], v[38:39], v[6:7] op_sel:[0,1] op_sel_hi:[1,1]
AR v40,a28
AR v41,a29
AR v42,a30
AR v43,a31
v_pk_mul_f32 v[40:41], v[40:41], v[6:7] op_sel:[0,1] op_sel_hi:[1,1]
v_pk_mul_f32 v[42:43], v[42:43], v[6:7] op_sel:[0,1] op_sel_hi:[1,1]
CV v52,v36,v37
CV v53,v38,v39
CV v54,v40,v41
CV v55,v42,v43
buffer_store_dwordx4 v[52:55], v10, s[32:35], s51 offen offset:3072 sc1
v_and_b32 v36, s4, v52
v_and_b32 v37, s4, v53
v_and_b32 v38, s4, v54
v_and_b32 v39, s4, v55
v_pk_max_u16 v32, v32, v36
v_pk_max_u16 v32, v32, v37
v_pk_max_u16 v32, v32, v38
v_pk_max_u16 v32, v32, v39
M a[64:67],v[12:15],v[76:79],a[64:67]
M a[68:71],v[12:15],v[80:83],a[68:71]
M a[72:75],v[12:15],v[84:87],a[72:75]
M a[76:79],v[12:15],v[88:91],a[76:79]
WL 4
M a[80:83],v[16:19],v[76:79],a[80:83]
M a[84:87],v[16:19],v[80:83],a[84:87]
M a[88:91],v[16:19],v[84:87],a[88:91]
M a[92:95],v[16:19],v[88:91],a[92:95]
WL 2
TR v[12:13],v1,2048
TR v[14:15],v1,10240
TR v[16:17],v9,2048
TR v[18:19],v9,10240
s_add_u32 s51, s63, 5120
s_add_u32 s50, s63, 9216
AR v44,a32
AR v45,a33
AR v46,a34
AR v47,a35
v_pk_mul_f32 v[44:45], v[44:45], v[4:5] op_sel_hi:[1,0]
v_pk_mul_f32 v[46:47], v[46:47], v[4:5] op_sel_hi:[1,0]
AR v48,a48
AR v49,a49
AR v50,a50
AR v51,a51
v_pk_mul_f32 v[48:49], v[48:49], v[4:5] op_sel_hi:[1,0]
v_pk_mul_f32 v[50:51], v[50:51], v[4:5] op_sel_hi:[1,0]
CV v28,v44,v45
CV v29,v46,v47
CV v30,v48,v49
CV v31,v50,v51
buffer_store_dwordx4 v[28:31], v10, s[32:35], s51 offen offset:0 sc1
v_and_b32 v44, s4, v28
v_and_b32 v45, s4, v29
v_and_b32 v46, s4, v30
v_and_b32 v47, s4, v31
v_pk_max_u16 v32, v32, v44
v_pk_max_u16 v32, v32, v45
v_pk_max_u16 v32, v32, v46
v_pk_max_u16 v32, v32, v47
AR v56,a36
AR v57,a37
AR v58,a38
AR v59,a39
v_pk_mul_f32 v[56:57], v[56:57], v[4:5] op_sel:[0,1] op_sel_hi:[1,1]
v_pk_mul_f32 v[58:59], v[58:59], v[4:5] op_sel:[0,1] op_sel_hi:[1,1]
AR v60,a52
AR v61,a53
AR v62,a54
AR v63,a55
v_pk_mul_f32 v[60:61], v[60:61], v[4:5] op_sel:[0,1] op_sel_hi:[1,1]
v_pk_mul_f32 v[62:63], v[62:63], v[4:5] op_sel:[0,1] op_sel_hi:[1,1]
CV v64,v56,v57
CV v65,v58,v59
CV v66,v60,v61
CV v67,v62,v63
buffer_store_dwordx4 v[64:67], v10, s[32:35], s51 offen offset:1024 sc1
v_and_b32 v56, s4, v64
v_and_b32 v57, s4, v65
v_and_b32 v58, s4, v66
v_and_b32 v59, s4, v67
v_pk_max_u16 v32, v32, v56
v_pk_max_u16 v32, v32, v57
v_pk_max_u16 v32, v32, v58
v_pk_max_u16 v32, v32, v59
AR v36,a40
AR v37,a41
AR v38,a42
AR v39,a43
v_pk_mul_f32 v[36:37], v[36:37], v[6:7] op_sel_hi:[1,0]
v_pk_mul_f32 v[38:39], v[38:39], v[6:7] op_sel_hi:[1,0]
AR v40,a56
AR v41,a57
AR v42,a58
AR v43,a59
v_pk_mul_f32 v[40:41], v[40:41], v[6:7] op_sel_hi:[1,0]
v_pk_mul_f32 v[42:43], v[42:43], v[6:7] op_sel_hi:[1,0]
CV v68,v36,v37
CV v69,v38,v39
CV v70,v40,v41
CV v71,v42,v43
buffer_store_dwordx4 v[68:71], v10, s[32:35], s51 offen offset:2048 sc1
v_and_b32 v36, s4, v68
v_and_b32 v37, s4, v69
v_and_b32 v38, s4, v70
v_and_b32 v39, s4, v71
v_pk_max_u16 v32, v32, v36
v_pk_max_u16 v32, v32, v37
v_pk_max_u16 v32, v32, v38
v_pk_max_u16 v32, v32, v39
AR v44,a44
AR v45,a45
AR v46,a46
AR v47,a47
v_pk_mul_f32 v[44:45], v[44:45], v[6:7] op_sel:[0,1] op_sel_hi:[1,1]
v_pk_mul_f32 v[46:47], v[46:47], v[6:7] op_sel:[0,1] op_sel_hi:[1,1]
AR v48,a60
AR v49,a61
AR v50,a62
AR v51,a63
v_pk_mul_f32 v[48:49], v[48:49], v[6:7] op_sel:[0,1] op_sel_hi:[1,1]
v_pk_mul_f32 v[50:51], v[50:51], v[6:7] op_sel:[0,1] op_sel_hi:[1,1]
CV v72,v44,v45
CV v73,v46,v47
CV v74,v48,v49
CV v75,v50,v51
buffer_store_dwordx4 v[72:75], v10, s[32:35], s51 offen offset:3072 sc1
v_and_b32 v44, s4, v72
v_and_b32 v45, s4, v73
v_and_b32 v46, s4, v74
v_and_b32 v47, s4, v75
v_pk_max_u16 v32, v32, v44
v_pk_max_u16 v32, v32, v45
v_pk_max_u16 v32, v32, v46
v_pk_max_u16 v32, v32, v47
M a[96:99],v[20:23],v[76:79],a[96:99]
M a[100:103],v[20:23],v[80:83],a[100:103]
M a[104:107],v[20:23],v[84:87],a[104:107]
M a[108:111],v[20:23],v[88:91],a[108:111]
WL 4
M a[112:115],v[24:27],v[76:79],a[112:115]
M a[116:119],v[24:27],v[80:83],a[116:119]
M a[120:123],v[24:27],v[84:87],a[120:123]
M a[124:127],v[24:27],v[88:91],a[124:127]
WL 2
TR v[20:21],v1,2560
TR v[22:23],v1,10752
TR v[24:25],v9,2560
TR v[26:27],v9,10752
s_add_u32 s51, s63, 10240
s_add_u32 s50, s63, 14336
AR v56,a64
AR v57,a65
AR v58,a66
AR v59,a67
v_pk_mul_f32 v[56:57], v[56:57], v[4:5] op_sel_hi:[1,0]
v_pk_mul_f32 v[58:59], v[58:59], v[4:5] op_sel_hi:[1,0]
AR v60,a80
AR v61,a81
AR v62,a82
AR v63,a83
v_pk_mul_f32 v[60:61], v[60:61], v[4:5] op_sel_hi:[1,0]
v_pk_mul_f32 v[62:63], v[62:63], v[4:5] op_sel_hi:[1,0]
CV v52,v56,v57
CV v53,v58,v59
CV v54,v60,v61
CV v55,v62,v63
buffer_store_dwordx4 v[52:55], v10, s[32:35], s51 offen offset:0 sc1
v_and_b32 v56, s4, v52
v_and_b32 v57, s4, v53
v_and_b32 v58, s4, v54
v_and_b32 v59, s4, v55
v_pk_max_u16 v32, v32, v56
v_pk_max_u16 v32, v32, v57
v_pk_max_u16 v32, v32, v58
v_pk_max_u16 v32, v32, v59
AR v36,a68
AR v37,a69
AR v38,a70
AR v39,a71
v_pk_mul_f32 v[36:37], v[36:37], v[4:5] op_sel:[0,1] op_sel_hi:[1,1]
v_pk_mul_f32 v[38:39], v[38:39], v[4:5] op_sel:[0,1] op_sel_hi:[1,1]
AR v40,a84
AR v41,a85
AR v42,a86
AR v43,a87
v_pk_mul_f32 v[40:41], v[40:41], v[4:5] op_sel:[0,1] op_sel_hi:[1,1]
v_pk_mul_f32 v[42:43], v[42:43], v[4:5] op_sel:[0,1] op_sel_hi:[1,1]
CV v28,v36,v37
CV v29,v38,v39
CV v30,v40,v41
CV v31,v42,v43
buffer_store_dwordx4 v[28:31], v10, s[32:35], s51 offen offset:1024 sc1
v_and_b32 v36, s4, v28
v_and_b32 v37, s4, v29
v_and_b32 v38, s4, v30
v_and_b32 v39, s4, v31
v_pk_max_u16 v32, v32, v36
v_pk_max_u16 v32, v32, v37
v_pk_max_u16 v32, v32, v38
v_pk_max_u16 v32, v32, v39
AR v44,a72
AR v45,a73
AR v46,a74
AR v47,a75
v_pk_mul_f32 v[44:45], v[44:45], v[6:7] op_sel_hi:[1,0]
v_pk_mul_f32 v[46:47], v[46:47], v[6:7] op_sel_hi:[1,0]
AR v48,a88
AR v49,a89
AR v50,a90
AR v51,a91
v_pk_mul_f32 v[48:49], v[48:49], v[6:7] op_sel_hi:[1,0]
v_pk_mul_f32 v[50:51], v[50:51], v[6:7] op_sel_hi:[1,0]
CV v64,v44,v45
CV v65,v46,v47
CV v66,v48,v49
CV v67,v50,v51
buffer_store_dwordx4 v[64:67], v10, s[32:35], s51 offen offset:2048 sc1
v_and_b32 v44, s4, v64
v_and_b32 v45, s4, v65
v_and_b32 v46, s4, v66
v_and_b32 v47, s4, v67
v_pk_max_u16 v32, v32, v44
v_pk_max_u16 v32, v32, v45
v_pk_max_u16 v32, v32, v46
v_pk_max_u16 v32, v32, v47
AR v56,a76
AR v57,a77
AR v58,a78
AR v59,a79
v_pk_mul_f32 v[56:57], v[56:57], v[6:7] op_sel:[0,1] op_sel_hi:[1,1]
v_pk_mul_f32 v[58:59], v[58:59], v[6:7] op_sel:[0,1] op_sel_hi:[1,1]
AR v60,a92
AR v61,a93
AR v62,a94
AR v63,a95
v_pk_mul_f32 v[60:61], v[60:61], v[6:7] op_sel:[0,1] op_sel_hi:[1,1]
v_pk_mul_f32 v[62:63], v[62:63], v[6:7] op_sel:[0,1] op_sel_hi:[1,1]
CV v68,v56,v57
CV v69,v58,v59
CV v70,v60,v61
CV v71,v62,v63
buffer_store_dwordx4 v[68:71], v10, s[32:35], s51 offen offset:3072 sc1
v_and_b32 v56, s4, v68
v_and_b32 v57, s4, v69
v_and_b32 v58, s4, v70
v_and_b32 v59, s4, v71
v_pk_max_u16 v32, v32, v56
v_pk_max_u16 v32, v32, v57
v_pk_max_u16 v32, v32, v58
v_pk_max_u16 v32, v32, v59
M a[128:131],v[12:15],v[76:79],a[128:131]
M a[132:135],v[12:15],v[80:83],a[132:135]
M a[136:139],v[12:15],v[84:87],a[136:139]
M a[140:143],v[12:15],v[88:91],a[140:143]
WL 4
M a[144:147],v[16:19],v[76:79],a[144:147]
M a[148:151],v[16:19],v[80:83],a[148:151]
M a[152:155],v[16:19],v[84:87],a[152:155]
M a[156:159],v[16:19],v[88:91],a[156:159]
WL 2
TR v[12:13],v1,3072
TR v[14:15],v1,11264
TR v[16:17],v9,3072
TR v[18:19],v9,11264
s_add_u32 s51, s63, 15360
s_add_u32 s50, s63, 19456
AR v36,a96
AR v37,a97
AR v38,a98
AR v39,a99
v_pk_mul_f32 v[36:37], v[36:37], v[4:5] op_sel_hi:[1,0]
v_pk_mul_f32 v[38:39], v[38:39], v[4:5] op_sel_hi:[1,0]
AR v40,a112
AR v41,a113
AR v42,a114
AR v43,a115
v_pk_mul_f32 v[40:41], v[40:41], v[4:5] op_sel_hi:[1,0]
v_pk_mul_f32 v[42:43], v[42:43], v[4:5] op_sel_hi:[1,0]
CV v72,v36,v37
CV v73,v38,v39
CV v74,v40,v41
CV v75,v42,v43
buffer_store_dwordx4 v[72:75], v10, s[32:35], s51 offen offset:0 sc1
v_and_b32 v36, s4, v72
v_and_b32 v37, s4, v73
v_and_b32 v38, s4, v74
v_and_b32 v39, s4, v75
v_pk_max_u16 v32, v32, v36
v_pk_max_u16 v32, v32, v37
v_pk_max_u16 v32, v32, v38
v_pk_max_u16 v32, v32, v39
AR v44,a100
AR v45,a101
AR v46,a102
AR v47,a103
v_pk_mul_f32 v[44:45], v[44:45], v[4:5] op_sel:[0,1] op_sel_hi:[1,1]
v_pk_mul_f32 v[46:47], v[46:47], v[4:5] op_sel:[0,1] op_sel_hi:[1,1]
AR v48,a116
AR v49,a117
AR v50,a118
AR v51,a119
v_pk_mul_f32 v[48:49], v[48:49], v[4:5] op_sel:[0,1] op_sel_hi:[1,1]
v_pk_mul_f32 v[50:51], v[50:51], v[4:5] op_sel:[0,1] op_sel_hi:[1,1]
CV v52,v44,v45
CV v53,v46,v47
CV v54,v48,v49
CV v55,v50,v51
buffer_store_dwordx4 v[52:55], v10, s[32:35], s51 offen offset:1024 sc1
v_and_b32 v44, s4, v52
v_and_b32 v45, s4, v53
v_and_b32 v46, s4, v54
v_and_b32 v47, s4, v55
v_pk_max_u16 v32, v32, v44
v_pk_max_u16 v32, v32, v45
v_pk_max_u16 v32, v32, v46
v_pk_max_u16 v32, v32, v47
AR v56,a104
AR v57,a105
AR v58,a106
AR v59,a107
v_pk_mul_f32 v[56:57], v[56:57], v[6:7] op_sel_hi:[1,0]
v_pk_mul_f32 v[58:59], v[58:59], v[6:7] op_sel_hi:[1,0]
AR v60,a120
AR v61,a121
AR v62,a122
AR v63,a123
v_pk_mul_f32 v[60:61], v[60:61], v[6:7] op_sel_hi:[1,0]
v_pk_mul_f32 v[62:63], v[62:63], v[6:7] op_sel_hi:[1,0]
CV v28,v56,v57
CV v29,v58,v59
CV v30,v60,v61
CV v31,v62,v63
buffer_store_dwordx4 v[28:31], v10, s[32:35], s51 offen offset:2048 sc1
v_and_b32 v56, s4, v28
v_and_b32 v57, s4, v29
v_and_b32 v58, s4, v30
v_and_b32 v59, s4, v31
v_pk_max_u16 v32, v32, v56
v_pk_max_u16 v32, v32, v57
v_pk_max_u16 v32, v32, v58
v_pk_max_u16 v32, v32, v59
AR v36,a108
AR v37,a109
AR v38,a110
AR v39,a111
v_pk_mul_f32 v[36:37], v[36:37], v[6:7] op_sel:[0,1] op_sel_hi:[1,1]
v_pk_mul_f32 v[38:39], v[38:39], v[6:7] op_sel:[0,1] op_sel_hi:[1,1]
AR v40,a124
AR v41,a125
AR v42,a126
AR v43,a127
v_pk_mul_f32 v[40:41], v[40:41], v[6:7] op_sel:[0,1] op_sel_hi:[1,1]
v_pk_mul_f32 v[42:43], v[42:43], v[6:7] op_sel:[0,1] op_sel_hi:[1,1]
CV v64,v36,v37
CV v65,v38,v39
CV v66,v40,v41
CV v67,v42,v43
buffer_store_dwordx4 v[64:67], v10, s[32:35], s51 offen offset:3072 sc1
v_and_b32 v36, s4, v64
v_and_b32 v37, s4, v65
v_and_b32 v38, s4, v66
v_and_b32 v39, s4, v67
v_pk_max_u16 v32, v32, v36
v_pk_max_u16 v32, v32, v37
v_pk_max_u16 v32, v32, v38
v_pk_max_u16 v32, v32, v39
M a[160:163],v[20:23],v[76:79],a[160:163]
M a[164:167],v[20:23],v[80:83],a[164:167]
M a[168:171],v[20:23],v[84:87],a[168:171]
M a[172:175],v[20:23],v[88:91],a[172:175]
WL 4
M a[176:179],v[24:27],v[76:79],a[176:179]
M a[180:183],v[24:27],v[80:83],a[180:183]
M a[184:187],v[24:27],v[84:87],a[184:187]
M a[188:191],v[24:27],v[88:91],a[188:191]
WL 2
TR v[20:21],v1,3584
TR v[22:23],v1,11776
TR v[24:25],v9,3584
TR v[26:27],v9,11776
s_add_u32 s51, s63, 20480
s_add_u32 s50, s63, 24576
AR v44,a128
AR v45,a129
AR v46,a130
AR v47,a131
v_pk_mul_f32 v[44:45], v[44:45], v[4:5] op_sel_hi:[1,0]
v_pk_mul_f32 v[46:47], v[46:47], v[4:5] op_sel_hi:[1,0]
AR v48,a144
AR v49,a145
AR v50,a146
AR v51,a147
v_pk_mul_f32 v[48:49], v[48:49], v[4:5] op_sel_hi:[1,0]
v_pk_mul_f32 v[50:51], v[50:51], v[4:5] op_sel_hi:[1,0]
CV v68,v44,v45
CV v69,v46,v47
CV v70,v48,v49
CV v71,v50,v51
buffer_store_dwordx4 v[68:71], v10, s[32:35], s51 offen offset:0 sc1
v_and_b32 v44, s4, v68
v_and_b32 v45, s4, v69
v_and_b32 v46, s4, v70
v_and_b32 v47, s4, v71
v_pk_max_u16 v32, v32, v44
v_pk_max_u16 v32, v32, v45
v_pk_max_u16 v32, v32, v46
v_pk_max_u16 v32, v32, v47
AR v56,a132
AR v57,a133
AR v58,a134
AR v59,a135
v_pk_mul_f32 v[56:57], v[56:57], v[4:5] op_sel:[0,1] op_sel_hi:[1,1]
v_pk_mul_f32 v[58:59], v[58:59], v[4:5] op_sel:[0,1] op_sel_hi:[1,1]
AR v60,a148
AR v61,a149
AR v62,a150
AR v63,a151
v_pk_mul_f32 v[60:61], v[60:61], v[4:5] op_sel:[0,1] op_sel_hi:[1,1]
v_pk_mul_f32 v[62:63], v[62:63], v[4:5] op_sel:[0,1] op_sel_hi:[1,1]
CV v72,v56,v57
CV v73,v58,v59
CV v74,v60,v61
CV v75,v62,v63
buffer_store_dwordx4 v[72:75], v10, s[32:35], s51 offen offset:1024 sc1
v_and_b32 v56, s4, v72
v_and_b32 v57, s4, v73
v_and_b32 v58, s4, v74
v_and_b32 v59, s4, v75
v_pk_max_u16 v32, v32, v56
v_pk_max_u16 v32, v32, v57
v_pk_max_u16 v32, v32, v58
v_pk_max_u16 v32, v32, v59
AR v36,a136
AR v37,a137
AR v38,a138
AR v39,a139
v_pk_mul_f32 v[36:37], v[36:37], v[6:7] op_sel_hi:[1,0]
v_pk_mul_f32 v[38:39], v[38:39], v[6:7] op_sel_hi:[1,0]
AR v40,a152
AR v41,a153
AR v42,a154
AR v43,a155
v_pk_mul_f32 v[40:41], v[40:41], v[6:7] op_sel_hi:[1,0]
v_pk_mul_f32 v[42:43], v[42:43], v[6:7] op_sel_hi:[1,0]
CV v52,v36,v37
CV v53,v38,v39
CV v54,v40,v41
CV v55,v42,v43
buffer_store_dwordx4 v[52:55], v10, s[32:35], s51 offen offset:2048 sc1
v_and_b32 v36, s4, v52
v_and_b32 v37, s4, v53
v_and_b32 v38, s4, v54
v_and_b32 v39, s4, v55
v_pk_max_u16 v32, v32, v36
v_pk_max_u16 v32, v32, v37
v_pk_max_u16 v32, v32, v38
v_pk_max_u16 v32, v32, v39
AR v44,a140
AR v45,a141
AR v46,a142
AR v47,a143
v_pk_mul_f32 v[44:45], v[44:45], v[6:7] op_sel:[0,1] op_sel_hi:[1,1]
v_pk_mul_f32 v[46:47], v[46:47], v[6:7] op_sel:[0,1] op_sel_hi:[1,1]
AR v48,a156
AR v49,a157
AR v50,a158
AR v51,a159
v_pk_mul_f32 v[48:49], v[48:49], v[6:7] op_sel:[0,1] op_sel_hi:[1,1]
v_pk_mul_f32 v[50:51], v[50:51], v[6:7] op_sel:[0,1] op_sel_hi:[1,1]
CV v28,v44,v45
CV v29,v46,v47
CV v30,v48,v49
CV v31,v50,v51
buffer_store_dwordx4 v[28:31], v10, s[32:35], s51 offen offset:3072 sc1
v_and_b32 v44, s4, v28
v_and_b32 v45, s4, v29
v_and_b32 v46, s4, v30
v_and_b32 v47, s4, v31
v_pk_max_u16 v32, v32, v44
v_pk_max_u16 v32, v32, v45
v_pk_max_u16 v32, v32, v46
v_pk_max_u16 v32, v32, v47
M a[192:195],v[12:15],v[76:79],a[192:195]
M a[196:199],v[12:15],v[80:83],a[196:199]
M a[200:203],v[12:15],v[84:87],a[200:203]
M a[204:207],v[12:15],v[88:91],a[204:207]
WL 4
M a[208:211],v[16:19],v[76:79],a[208:211]
M a[212:215],v[16:19],v[80:83],a[212:215]
M a[216:219],v[16:19],v[84:87],a[216:219]
M a[220:223],v[16:19],v[88:91],a[220:223]
WL 2
s_add_u32 s51, s63, 25600
s_add_u32 s50, s63, 29696
AR v56,a160
AR v57,a161
AR v58,a162
AR v59,a163
v_pk_mul_f32 v[56:57], v[56:57], v[4:5] op_sel_hi:[1,0]
v_pk_mul_f32 v[58:59], v[58:59], v[4:5] op_sel_hi:[1,0]
AR v60,a176
AR v61,a177
AR v62,a178
AR v63,a179
v_pk_mul_f32 v[60:61], v[60:61], v[4:5] op_sel_hi:[1,0]
v_pk_mul_f32 v[62:63], v[62:63], v[4:5] op_sel_hi:[1,0]
CV v64,v56,v57
CV v65,v58,v59
CV v66,v60,v61
CV v67,v62,v63
buffer_store_dwordx4 v[64:67], v10, s[32:35], s51 offen offset:0 sc1
v_and_b32 v56, s4, v64
v_and_b32 v57, s4, v65
v_and_b32 v58, s4, v66
v_and_b32 v59, s4, v67
v_pk_max_u16 v32, v32, v56
v_pk_max_u16 v32, v32, v57
v_pk_max_u16 v32, v32, v58
v_pk_max_u16 v32, v32, v59
AR v36,a164
AR v37,a165
AR v38,a166
AR v39,a167
v_pk_mul_f32 v[36:37], v[36:37], v[4:5] op_sel:[0,1] op_sel_hi:[1,1]
v_pk_mul_f32 v[38:39], v[38:39], v[4:5] op_sel:[0,1] op_sel_hi:[1,1]
AR v40,a180
AR v41,a181
AR v42,a182
AR v43,a183
v_pk_mul_f32 v[40:41], v[40:41], v[4:5] op_sel:[0,1] op_sel_hi:[1,1]
v_pk_mul_f32 v[42:43], v[42:43], v[4:5] op_sel:[0,1] op_sel_hi:[1,1]
CV v68,v36,v37
CV v69,v38,v39
CV v70,v40,v41
CV v71,v42,v43
buffer_store_dwordx4 v[68:71], v10, s[32:35], s51 offen offset:1024 sc1
v_and_b32 v36, s4, v68
v_and_b32 v37, s4, v69
v_and_b32 v38, s4, v70
v_and_b32 v39, s4, v71
v_pk_max_u16 v32, v32, v36
v_pk_max_u16 v32, v32, v37
v_pk_max_u16 v32, v32, v38
v_pk_max_u16 v32, v32, v39
AR v44,a168
AR v45,a169
AR v46,a170
AR v47,a171
v_pk_mul_f32 v[44:45], v[44:45], v[6:7] op_sel_hi:[1,0]
v_pk_mul_f32 v[46:47], v[46:47], v[6:7] op_sel_hi:[1,0]
AR v48,a184
AR v49,a185
AR v50,a186
AR v51,a187
v_pk_mul_f32 v[48:49], v[48:49], v[6:7] op_sel_hi:[1,0]
v_pk_mul_f32 v[50:51], v[50:51], v[6:7] op_sel_hi:[1,0]
CV v72,v44,v45
CV v73,v46,v47
CV v74,v48,v49
CV v75,v50,v51
buffer_store_dwordx4 v[72:75], v10, s[32:35], s51 offen offset:2048 sc1
v_and_b32 v44, s4, v72
v_and_b32 v45, s4, v73
v_and_b32 v46, s4, v74
v_and_b32 v47, s4, v75
v_pk_max_u16 v32, v32, v44
v_pk_max_u16 v32, v32, v45
v_pk_max_u16 v32, v32, v46
v_pk_max_u16 v32, v32, v47
AR v56,a172
AR v57,a173
AR v58,a174
AR v59,a175
v_pk_mul_f32 v[56:57], v[56:57], v[6:7] op_sel:[0,1] op_sel_hi:[1,1]
v_pk_mul_f32 v[58:59], v[58:59], v[6:7] op_sel:[0,1] op_sel_hi:[1,1]
AR v60,a188
AR v61,a189
AR v62,a190
AR v63,a191
v_pk_mul_f32 v[60:61], v[60:61], v[6:7] op_sel:[0,1] op_sel_hi:[1,1]
v_pk_mul_f32 v[62:63], v[62:63], v[6:7] op_sel:[0,1] op_sel_hi:[1,1]
CV v52,v56,v57
CV v53,v58,v59
CV v54,v60,v61
CV v55,v62,v63
buffer_store_dwordx4 v[52:55], v10, s[32:35], s51 offen offset:3072 sc1
v_and_b32 v56, s4, v52
v_and_b32 v57, s4, v53
v_and_b32 v58, s4, v54
v_and_b32 v59, s4, v55
v_pk_max_u16 v32, v32, v56
v_pk_max_u16 v32, v32, v57
v_pk_max_u16 v32, v32, v58
v_pk_max_u16 v32, v32, v59
M a[224:227],v[20:23],v[76:79],a[224:227]
M a[228:231],v[20:23],v[80:83],a[228:231]
M a[232:235],v[20:23],v[84:87],a[232:235]
M a[236:239],v[20:23],v[88:91],a[236:239]
WL 0
M a[240:243],v[24:27],v[76:79],a[240:243]
M a[244:247],v[24:27],v[80:83],a[244:247]
M a[248:251],v[24:27],v[84:87],a[248:251]
M a[252:255],v[24:27],v[88:91],a[252:255]
s_add_u32 s51, s63, 30720
s_add_u32 s50, s63, 34816
AR v36,a192
AR v37,a193
AR v38,a194
AR v39,a195
v_pk_mul_f32 v[36:37], v[36:37], v[4:5] op_sel_hi:[1,0]
v_pk_mul_f32 v[38:39], v[38:39], v[4:5] op_sel_hi:[1,0]
AR v40,a208
AR v41,a209
AR v42,a210
AR v43,a211
v_pk_mul_f32 v[40:41], v[40:41], v[4:5] op_sel_hi:[1,0]
v_pk_mul_f32 v[42:43], v[42:43], v[4:5] op_sel_hi:[1,0]
CV v28,v36,v37
CV v29,v38,v39
CV v30,v40,v41
CV v31,v42,v43
buffer_store_dwordx4 v[28:31], v10, s[32:35], s51 offen offset:0 sc1
v_and_b32 v36, s4, v28
v_and_b32 v37, s4, v29
v_and_b32 v38, s4, v30
v_and_b32 v39, s4, v31
v_pk_max_u16 v32, v32, v36
v_pk_max_u16 v32, v32, v37
v_pk_max_u16 v32, v32, v38
v_pk_max_u16 v32, v32, v39
AR v44,a196
AR v45,a197
AR v46,a198
AR v47,a199
v_pk_mul_f32 v[44:45], v[44:45], v[4:5] op_sel:[0,1] op_sel_hi:[1,1]
v_pk_mul_f32 v[46:47], v[46:47], v[4:5] op_sel:[0,1] op_sel_hi:[1,1]
AR v48,a212
AR v49,a213
AR v50,a214
AR v51,a215
v_pk_mul_f32 v[48:49], v[48:49], v[4:5] op_sel:[0,1] op_sel_hi:[1,1]
v_pk_mul_f32 v[50:51], v[50:51], v[4:5] op_sel:[0,1] op_sel_hi:[1,1]
CV v64,v44,v45
CV v65,v46,v47
CV v66,v48,v49
CV v67,v50,v51
buffer_store_dwordx4 v[64:67], v10, s[32:35], s51 offen offset:1024 sc1
v_and_b32 v44, s4, v64
v_and_b32 v45, s4, v65
v_and_b32 v46, s4, v66
v_and_b32 v47, s4, v67
v_pk_max_u16 v32, v32, v44
v_pk_max_u16 v32, v32, v45
v_pk_max_u16 v32, v32, v46
v_pk_max_u16 v32, v32, v47
AR v56,a200
AR v57,a201
AR v58,a202
AR v59,a203
v_pk_mul_f32 v[56:57], v[56:57], v[6:7] op_sel_hi:[1,0]
v_pk_mul_f32 v[58:59], v[58:59], v[6:7] op_sel_hi:[1,0]
AR v60,a216
AR v61,a217
AR v62,a218
AR v63,a219
v_pk_mul_f32 v[60:61], v[60:61], v[6:7] op_sel_hi:[1,0]
v_pk_mul_f32 v[62:63], v[62:63], v[6:7] op_sel_hi:[1,0]
CV v68,v56,v57
CV v69,v58,v59
CV v70,v60,v61
CV v71,v62,v63
buffer_store_dwordx4 v[68:71], v10, s[32:35], s51 offen offset:2048 sc1
v_and_b32 v56, s4, v68
v_and_b32 v57, s4, v69
v_and_b32 v58, s4, v70
v_and_b32 v59, s4, v71
v_pk_max_u16 v32, v32, v56
v_pk_max_u16 v32, v32, v57
v_pk_max_u16 v32, v32, v58
v_pk_max_u16 v32, v32, v59
AR v36,a204
AR v37,a205
AR v38,a206
AR v39,a207
v_pk_mul_f32 v[36:37], v[36:37], v[6:7] op_sel:[0,1] op_sel_hi:[1,1]
v_pk_mul_f32 v[38:39], v[38:39], v[6:7] op_sel:[0,1] op_sel_hi:[1,1]
AR v40,a220
AR v41,a221
AR v42,a222
AR v43,a223
v_pk_mul_f32 v[40:41], v[40:41], v[6:7] op_sel:[0,1] op_sel_hi:[1,1]
v_pk_mul_f32 v[42:43], v[42:43], v[6:7] op_sel:[0,1] op_sel_hi:[1,1]
CV v72,v36,v37
CV v73,v38,v39
CV v74,v40,v41
CV v75,v42,v43
buffer_store_dwordx4 v[72:75], v10, s[32:35], s51 offen offset:3072 sc1
v_and_b32 v36, s4, v72
v_and_b32 v37, s4, v73
v_and_b32 v38, s4, v74
v_and_b32 v39, s4, v75
v_pk_max_u16 v32, v32, v36
v_pk_max_u16 v32, v32, v37
v_pk_max_u16 v32, v32, v38
v_pk_max_u16 v32, v32, v39
s_nop 7
s_add_u32 s51, s63, 35840
s_add_u32 s50, s63, 39936
AR v44,a224
AR v45,a225
AR v46,a226
AR v47,a227
v_pk_mul_f32 v[44:45], v[44:45], v[4:5] op_sel_hi:[1,0]
v_pk_mul_f32 v[46:47], v[46:47], v[4:5] op_sel_hi:[1,0]
AR v48,a240
AR v49,a241
AR v50,a242
AR v51,a243
v_pk_mul_f32 v[48:49], v[48:49], v[4:5] op_sel_hi:[1,0]
v_pk_mul_f32 v[50:51], v[50:51], v[4:5] op_sel_hi:[1,0]
CV v52,v44,v45
CV v53,v46,v47
CV v54,v48,v49
CV v55,v50,v51
buffer_store_dwordx4 v[52:55], v10, s[32:35], s51 offen offset:0 sc1
v_and_b32 v44, s4, v52
v_and_b32 v45, s4, v53
v_and_b32 v46, s4, v54
v_and_b32 v47, s4, v55
v_pk_max_u16 v32, v32, v44
v_pk_max_u16 v32, v32, v45
v_pk_max_u16 v32, v32, v46
v_pk_max_u16 v32, v32, v47
AR v56,a228
AR v57,a229
AR v58,a230
AR v59,a231
v_pk_mul_f32 v[56:57], v[56:57], v[4:5] op_sel:[0,1] op_sel_hi:[1,1]
v_pk_mul_f32 v[58:59], v[58:59], v[4:5] op_sel:[0,1] op_sel_hi:[1,1]
AR v60,a244
AR v61,a245
AR v62,a246
AR v63,a247
v_pk_mul_f32 v[60:61], v[60:61], v[4:5] op_sel:[0,1] op_sel_hi:[1,1]
v_pk_mul_f32 v[62:63], v[62:63], v[4:5] op_sel:[0,1] op_sel_hi:[1,1]
CV v28,v56,v57
CV v29,v58,v59
CV v30,v60,v61
CV v31,v62,v63
buffer_store_dwordx4 v[28:31], v10, s[32:35], s51 offen offset:1024 sc1
v_and_b32 v56, s4, v28
v_and_b32 v57, s4, v29
v_and_b32 v58, s4, v30
v_and_b32 v59, s4, v31
v_pk_max_u16 v32, v32, v56
v_pk_max_u16 v32, v32, v57
v_pk_max_u16 v32, v32, v58
v_pk_max_u16 v32, v32, v59
AR v36,a232
AR v37,a233
AR v38,a234
AR v39,a235
v_pk_mul_f32 v[36:37], v[36:37], v[6:7] op_sel_hi:[1,0]
v_pk_mul_f32 v[38:39], v[38:39], v[6:7] op_sel_hi:[1,0]
AR v40,a248
AR v41,a249
AR v42,a250
AR v43,a251
v_pk_mul_f32 v[40:41], v[40:41], v[6:7] op_sel_hi:[1,0]
v_pk_mul_f32 v[42:43], v[42:43], v[6:7] op_sel_hi:[1,0]
CV v64,v36,v37
CV v65,v38,v39
CV v66,v40,v41
CV v67,v42,v43
buffer_store_dwordx4 v[64:67], v10, s[32:35], s51 offen offset:2048 sc1
v_and_b32 v36, s4, v64
v_and_b32 v37, s4, v65
v_and_b32 v38, s4, v66
v_and_b32 v39, s4, v67
v_pk_max_u16 v32, v32, v36
v_pk_max_u16 v32, v32, v37
v_pk_max_u16 v32, v32, v38
v_pk_max_u16 v32, v32, v39
AR v44,a236
AR v45,a237
AR v46,a238
AR v47,a239
v_pk_mul_f32 v[44:45], v[44:45], v[6:7] op_sel:[0,1] op_sel_hi:[1,1]
v_pk_mul_f32 v[46:47], v[46:47], v[6:7] op_sel:[0,1] op_sel_hi:[1,1]
AR v48,a252
AR v49,a253
AR v50,a254
AR v51,a255
v_pk_mul_f32 v[48:49], v[48:49], v[6:7] op_sel:[0,1] op_sel_hi:[1,1]
v_pk_mul_f32 v[50:51], v[50:51], v[6:7] op_sel:[0,1] op_sel_hi:[1,1]
CV v68,v44,v45
CV v69,v46,v47
CV v70,v48,v49
CV v71,v50,v51
buffer_store_dwordx4 v[68:71], v10, s[32:35], s51 offen offset:3072 sc1
v_and_b32 v44, s4, v68
v_and_b32 v45, s4, v69
v_and_b32 v46, s4, v70
v_and_b32 v47, s4, v71
v_pk_max_u16 v32, v32, v44
v_pk_max_u16 v32, v32, v45
v_pk_max_u16 v32, v32, v46
v_pk_max_u16 v32, v32, v47
v_lshrrev_b32 v36, 16, v32
v_and_b32 v32, 0xffff, v32
v_max_u32 v32, v32, v36
s_movk_i32 s4, 0x7f80
v_cmp_le_u32 vcc, s4, v32
s_nop 1
s_cmp_lg_u64 vcc, 0
s_cselect_b32 s4, 1, 0
s_or_b32 s60, s60, s4
s_lshl_b32 s5, s3, 2
s_add_u32 s5, s5, 81920
v_mov_b32 v56, s5
v_mov_b32 v57, s60
v_mov_b32 v58, 81920
ds_write_b32 v56, v57
WL 0
s_barrier
ds_read_b128 v[60:63], v58
WL 0
v_or_b32 v60, v60, v61
v_or_b32 v62, v62, v63
v_or_b32 v60, v60, v62
s_nop 0
v_readfirstlane_b32 s4, v60
s_nop 3
s_cmp_lg_u32 s4, 0
s_cbranch_scc1 L1_slow_4
s_branch L2_join
L1_norm_4:
v_subrev_u32 v10, s62, v2
v_rcp_f32 v4, v4
v_rcp_f32 v5, v5
v_rcp_f32 v6, v6
v_rcp_f32 v7, v7
s_nop 0
v_mov_b32 v76, v4
v_mov_b32 v77, v4
v_mov_b32 v78, v5
v_mov_b32 v79, v5
v_mov_b32 v80, v6
v_mov_b32 v81, v6
v_mov_b32 v82, v7
v_mov_b32 v83, v7
s_add_u32 s51, s63, 0
s_add_u32 s50, s63, 4096
AR v96,a0
AR v97,a1
AR v98,a2
AR v99,a3
PM v[96:97],v[96:97],v[76:77]
PM v[98:99],v[98:99],v[76:77]
AR v100,a16
AR v101,a17
AR v102,a18
AR v103,a19
PM v[100:101],v[100:101],v[76:77]
PM v[102:103],v[102:103],v[76:77]
CV v128,v96,v97
CV v129,v98,v99
CV v130,v100,v101
CV v131,v102,v103
buffer_store_dwordx4 v[128:131], v10, s[32:35], s51 offen offset:0 sc1
AR v104,a4
AR v105,a5
AR v106,a6
AR v107,a7
PM v[104:105],v[104:105],v[78:79]
PM v[106:107],v[106:107],v[78:79]
AR v108,a20
AR v109,a21
AR v110,a22
AR v111,a23
PM v[108:109],v[108:109],v[78:79]
PM v[110:111],v[110:111],v[78:79]
CV v132,v104,v105
CV v133,v106,v107
CV v134,v108,v109
CV v135,v110,v111
buffer_store_dwordx4 v[132:135], v10, s[32:35], s51 offen offset:1024 sc1
AR v112,a8
AR v113,a9
AR v114,a10
AR v115,a11
PM v[112:113],v[112:113],v[80:81]
PM v[114:115],v[114:115],v[80:81]
AR v116,a24
AR v117,a25
AR v118,a26
AR v119,a27
PM v[116:117],v[116:117],v[80:81]
PM v[118:119],v[118:119],v[80:81]
CV v136,v112,v113
CV v137,v114,v115
CV v138,v116,v117
CV v139,v118,v119
buffer_store_dwordx4 v[136:139], v10, s[32:35], s51 offen offset:2048 sc1
AR v120,a12
AR v121,a13
AR v122,a14
AR v123,a15
PM v[120:121],v[120:121],v[82:83]
PM v[122:123],v[122:123],v[82:83]
AR v124,a28
AR v125,a29
AR v126,a30
AR v127,a31
PM v[124:125],v[124:125],v[82:83]
PM v[126:127],v[126:127],v[82:83]
CV v140,v120,v121
CV v141,v122,v123
CV v142,v124,v125
CV v143,v126,v127
buffer_store_dwordx4 v[140:143], v10, s[32:35], s51 offen offset:3072 sc1
s_add_u32 s51, s63, 5120
s_add_u32 s50, s63, 9216
AR v96,a32
AR v97,a33
AR v98,a34
AR v99,a35
PM v[96:97],v[96:97],v[76:77]
PM v[98:99],v[98:99],v[76:77]
AR v100,a48
AR v101,a49
AR v102,a50
AR v103,a51
PM v[100:101],v[100:101],v[76:77]
PM v[102:103],v[102:103],v[76:77]
CV v144,v96,v97
CV v145,v98,v99
CV v146,v100,v101
CV v147,v102,v103
buffer_store_dwordx4 v[144:147], v10, s[32:35], s51 offen offset:0 sc1
AR v104,a36
AR v105,a37
AR v106,a38
AR v107,a39
PM v[104:105],v[104:105],v[78:79]
PM v[106:107],v[106:107],v[78:79]
AR v108,a52
AR v109,a53
AR v110,a54
AR v111,a55
PM v[108:109],v[108:109],v[78:79]
PM v[110:111],v[110:111],v[78:79]
CV v148,v104,v105
CV v149,v106,v107
CV v150,v108,v109
CV v151,v110,v111
buffer_store_dwordx4 v[148:151], v10, s[32:35], s51 offen offset:1024 sc1
AR v112,a40
AR v113,a41
AR v114,a42
AR v115,a43
PM v[112:113],v[112:113],v[80:81]
PM v[114:115],v[114:115],v[80:81]
AR v116,a56
AR v117,a57
AR v118,a58
AR v119,a59
PM v[116:117],v[116:117],v[80:81]
PM v[118:119],v[118:119],v[80:81]
CV v128,v112,v113
CV v129,v114,v115
CV v130,v116,v117
CV v131,v118,v119
buffer_store_dwordx4 v[128:131], v10, s[32:35], s51 offen offset:2048 sc1
AR v120,a44
AR v121,a45
AR v122,a46
AR v123,a47
PM v[120:121],v[120:121],v[82:83]
PM v[122:123],v[122:123],v[82:83]
AR v124,a60
AR v125,a61
AR v126,a62
AR v127,a63
PM v[124:125],v[124:125],v[82:83]
PM v[126:127],v[126:127],v[82:83]
CV v132,v120,v121
CV v133,v122,v123
CV v134,v124,v125
CV v135,v126,v127
buffer_store_dwordx4 v[132:135], v10, s[32:35], s51 offen offset:3072 sc1
s_add_u32 s51, s63, 10240
s_add_u32 s50, s63, 14336
AR v96,a64
AR v97,a65
AR v98,a66
AR v99,a67
PM v[96:97],v[96:97],v[76:77]
PM v[98:99],v[98:99],v[76:77]
AR v100,a80
AR v101,a81
AR v102,a82
AR v103,a83
PM v[100:101],v[100:101],v[76:77]
PM v[102:103],v[102:103],v[76:77]
CV v136,v96,v97
CV v137,v98,v99
CV v138,v100,v101
CV v139,v102,v103
buffer_store_dwordx4 v[136:139], v10, s[32:35], s51 offen offset:0 sc1
AR v104,a68
AR v105,a69
AR v106,a70
AR v107,a71
PM v[104:105],v[104:105],v[78:79]
PM v[106:107],v[106:107],v[78:79]
AR v108,a84
AR v109,a85
AR v110,a86
AR v111,a87
PM v[108:109],v[108:109],v[78:79]
PM v[110:111],v[110:111],v[78:79]
CV v140,v104,v105
CV v141,v106,v107
CV v142,v108,v109
CV v143,v110,v111
buffer_store_dwordx4 v[140:143], v10, s[32:35], s51 offen offset:1024 sc1
AR v112,a72
AR v113,a73
AR v114,a74
AR v115,a75
PM v[112:113],v[112:113],v[80:81]
PM v[114:115],v[114:115],v[80:81]
AR v116,a88
AR v117,a89
AR v118,a90
AR v119,a91
PM v[116:117],v[116:117],v[80:81]
PM v[118:119],v[118:119],v[80:81]
CV v144,v112,v113
CV v145,v114,v115
CV v146,v116,v117
CV v147,v118,v119
buffer_store_dwordx4 v[144:147], v10, s[32:35], s51 offen offset:2048 sc1
AR v120,a76
AR v121,a77
AR v122,a78
AR v123,a79
PM v[120:121],v[120:121],v[82:83]
PM v[122:123],v[122:123],v[82:83]
AR v124,a92
AR v125,a93
AR v126,a94
AR v127,a95
PM v[124:125],v[124:125],v[82:83]
PM v[126:127],v[126:127],v[82:83]
CV v148,v120,v121
CV v149,v122,v123
CV v150,v124,v125
CV v151,v126,v127
buffer_store_dwordx4 v[148:151], v10, s[32:35], s51 offen offset:3072 sc1
s_add_u32 s51, s63, 15360
s_add_u32 s50, s63, 19456
AR v96,a96
AR v97,a97
AR v98,a98
AR v99,a99
PM v[96:97],v[96:97],v[76:77]
PM v[98:99],v[98:99],v[76:77]
AR v100,a112
AR v101,a113
AR v102,a114
AR v103,a115
PM v[100:101],v[100:101],v[76:77]
PM v[102:103],v[102:103],v[76:77]
CV v128,v96,v97
CV v129,v98,v99
CV v130,v100,v101
CV v131,v102,v103
buffer_store_dwordx4 v[128:131], v10, s[32:35], s51 offen offset:0 sc1
AR v104,a100
AR v105,a101
AR v106,a102
AR v107,a103
PM v[104:105],v[104:105],v[78:79]
PM v[106:107],v[106:107],v[78:79]
AR v108,a116
AR v109,a117
AR v110,a118
AR v111,a119
PM v[108:109],v[108:109],v[78:79]
PM v[110:111],v[110:111],v[78:79]
CV v132,v104,v105
CV v133,v106,v107
CV v134,v108,v109
CV v135,v110,v111
buffer_store_dwordx4 v[132:135], v10, s[32:35], s51 offen offset:1024 sc1
AR v112,a104
AR v113,a105
AR v114,a106
AR v115,a107
PM v[112:113],v[112:113],v[80:81]
PM v[114:115],v[114:115],v[80:81]
AR v116,a120
AR v117,a121
AR v118,a122
AR v119,a123
PM v[116:117],v[116:117],v[80:81]
PM v[118:119],v[118:119],v[80:81]
CV v136,v112,v113
CV v137,v114,v115
CV v138,v116,v117
CV v139,v118,v119
buffer_store_dwordx4 v[136:139], v10, s[32:35], s51 offen offset:2048 sc1
AR v120,a108
AR v121,a109
AR v122,a110
AR v123,a111
PM v[120:121],v[120:121],v[82:83]
PM v[122:123],v[122:123],v[82:83]
AR v124,a124
AR v125,a125
AR v126,a126
AR v127,a127
PM v[124:125],v[124:125],v[82:83]
PM v[126:127],v[126:127],v[82:83]
CV v140,v120,v121
CV v141,v122,v123
CV v142,v124,v125
CV v143,v126,v127
buffer_store_dwordx4 v[140:143], v10, s[32:35], s51 offen offset:3072 sc1
s_add_u32 s51, s63, 20480
s_add_u32 s50, s63, 24576
AR v96,a128
AR v97,a129
AR v98,a130
AR v99,a131
PM v[96:97],v[96:97],v[76:77]
PM v[98:99],v[98:99],v[76:77]
AR v100,a144
AR v101,a145
AR v102,a146
AR v103,a147
PM v[100:101],v[100:101],v[76:77]
PM v[102:103],v[102:103],v[76:77]
CV v144,v96,v97
CV v145,v98,v99
CV v146,v100,v101
CV v147,v102,v103
buffer_store_dwordx4 v[144:147], v10, s[32:35], s51 offen offset:0 sc1
AR v104,a132
AR v105,a133
AR v106,a134
AR v107,a135
PM v[104:105],v[104:105],v[78:79]
PM v[106:107],v[106:107],v[78:79]
AR v108,a148
AR v109,a149
AR v110,a150
AR v111,a151
PM v[108:109],v[108:109],v[78:79]
PM v[110:111],v[110:111],v[78:79]
CV v148,v104,v105
CV v149,v106,v107
CV v150,v108,v109
CV v151,v110,v111
buffer_store_dwordx4 v[148:151], v10, s[32:35], s51 offen offset:1024 sc1
AR v112,a136
AR v113,a137
AR v114,a138
AR v115,a139
PM v[112:113],v[112:113],v[80:81]
PM v[114:115],v[114:115],v[80:81]
AR v116,a152
AR v117,a153
AR v118,a154
AR v119,a155
PM v[116:117],v[116:117],v[80:81]
PM v[118:119],v[118:119],v[80:81]
CV v128,v112,v113
CV v129,v114,v115
CV v130,v116,v117
CV v131,v118,v119
buffer_store_dwordx4 v[128:131], v10, s[32:35], s51 offen offset:2048 sc1
AR v120,a140
AR v121,a141
AR v122,a142
AR v123,a143
PM v[120:121],v[120:121],v[82:83]
PM v[122:123],v[122:123],v[82:83]
AR v124,a156
AR v125,a157
AR v126,a158
AR v127,a159
PM v[124:125],v[124:125],v[82:83]
PM v[126:127],v[126:127],v[82:83]
CV v132,v120,v121
CV v133,v122,v123
CV v134,v124,v125
CV v135,v126,v127
buffer_store_dwordx4 v[132:135], v10, s[32:35], s51 offen offset:3072 sc1
s_add_u32 s51, s63, 25600
s_add_u32 s50, s63, 29696
AR v96,a160
AR v97,a161
AR v98,a162
AR v99,a163
PM v[96:97],v[96:97],v[76:77]
PM v[98:99],v[98:99],v[76:77]
AR v100,a176
AR v101,a177
AR v102,a178
AR v103,a179
PM v[100:101],v[100:101],v[76:77]
PM v[102:103],v[102:103],v[76:77]
CV v136,v96,v97
CV v137,v98,v99
CV v138,v100,v101
CV v139,v102,v103
buffer_store_dwordx4 v[136:139], v10, s[32:35], s51 offen offset:0 sc1
AR v104,a164
AR v105,a165
AR v106,a166
AR v107,a167
PM v[104:105],v[104:105],v[78:79]
PM v[106:107],v[106:107],v[78:79]
AR v108,a180
AR v109,a181
AR v110,a182
AR v111,a183
PM v[108:109],v[108:109],v[78:79]
PM v[110:111],v[110:111],v[78:79]
CV v140,v104,v105
CV v141,v106,v107
CV v142,v108,v109
CV v143,v110,v111
buffer_store_dwordx4 v[140:143], v10, s[32:35], s51 offen offset:1024 sc1
AR v112,a168
AR v113,a169
AR v114,a170
AR v115,a171
PM v[112:113],v[112:113],v[80:81]
PM v[114:115],v[114:115],v[80:81]
AR v116,a184
AR v117,a185
AR v118,a186
AR v119,a187
PM v[116:117],v[116:117],v[80:81]
PM v[118:119],v[118:119],v[80:81]
CV v144,v112,v113
CV v145,v114,v115
CV v146,v116,v117
CV v147,v118,v119
buffer_store_dwordx4 v[144:147], v10, s[32:35], s51 offen offset:2048 sc1
AR v120,a172
AR v121,a173
AR v122,a174
AR v123,a175
PM v[120:121],v[120:121],v[82:83]
PM v[122:123],v[122:123],v[82:83]
AR v124,a188
AR v125,a189
AR v126,a190
AR v127,a191
PM v[124:125],v[124:125],v[82:83]
PM v[126:127],v[126:127],v[82:83]
CV v148,v120,v121
CV v149,v122,v123
CV v150,v124,v125
CV v151,v126,v127
buffer_store_dwordx4 v[148:151], v10, s[32:35], s51 offen offset:3072 sc1
s_add_u32 s51, s63, 30720
s_add_u32 s50, s63, 34816
AR v96,a192
AR v97,a193
AR v98,a194
AR v99,a195
PM v[96:97],v[96:97],v[76:77]
PM v[98:99],v[98:99],v[76:77]
AR v100,a208
AR v101,a209
AR v102,a210
AR v103,a211
PM v[100:101],v[100:101],v[76:77]
PM v[102:103],v[102:103],v[76:77]
CV v128,v96,v97
CV v129,v98,v99
CV v130,v100,v101
CV v131,v102,v103
buffer_store_dwordx4 v[128:131], v10, s[32:35], s51 offen offset:0 sc1
AR v104,a196
AR v105,a197
AR v106,a198
AR v107,a199
PM v[104:105],v[104:105],v[78:79]
PM v[106:107],v[106:107],v[78:79]
AR v108,a212
AR v109,a213
AR v110,a214
AR v111,a215
PM v[108:109],v[108:109],v[78:79]
PM v[110:111],v[110:111],v[78:79]
CV v132,v104,v105
CV v133,v106,v107
CV v134,v108,v109
CV v135,v110,v111
buffer_store_dwordx4 v[132:135], v10, s[32:35], s51 offen offset:1024 sc1
AR v112,a200
AR v113,a201
AR v114,a202
AR v115,a203
PM v[112:113],v[112:113],v[80:81]
PM v[114:115],v[114:115],v[80:81]
AR v116,a216
AR v117,a217
AR v118,a218
AR v119,a219
PM v[116:117],v[116:117],v[80:81]
PM v[118:119],v[118:119],v[80:81]
CV v136,v112,v113
CV v137,v114,v115
CV v138,v116,v117
CV v139,v118,v119
buffer_store_dwordx4 v[136:139], v10, s[32:35], s51 offen offset:2048 sc1
AR v120,a204
AR v121,a205
AR v122,a206
AR v123,a207
PM v[120:121],v[120:121],v[82:83]
PM v[122:123],v[122:123],v[82:83]
AR v124,a220
AR v125,a221
AR v126,a222
AR v127,a223
PM v[124:125],v[124:125],v[82:83]
PM v[126:127],v[126:127],v[82:83]
CV v140,v120,v121
CV v141,v122,v123
CV v142,v124,v125
CV v143,v126,v127
buffer_store_dwordx4 v[140:143], v10, s[32:35], s51 offen offset:3072 sc1
s_add_u32 s51, s63, 35840
s_add_u32 s50, s63, 39936
AR v96,a224
AR v97,a225
AR v98,a226
AR v99,a227
PM v[96:97],v[96:97],v[76:77]
PM v[98:99],v[98:99],v[76:77]
AR v100,a240
AR v101,a241
AR v102,a242
AR v103,a243
PM v[100:101],v[100:101],v[76:77]
PM v[102:103],v[102:103],v[76:77]
CV v144,v96,v97
CV v145,v98,v99
CV v146,v100,v101
CV v147,v102,v103
buffer_store_dwordx4 v[144:147], v10, s[32:35], s51 offen offset:0 sc1
AR v104,a228
AR v105,a229
AR v106,a230
AR v107,a231
PM v[104:105],v[104:105],v[78:79]
PM v[106:107],v[106:107],v[78:79]
AR v108,a244
AR v109,a245
AR v110,a246
AR v111,a247
PM v[108:109],v[108:109],v[78:79]
PM v[110:111],v[110:111],v[78:79]
CV v148,v104,v105
CV v149,v106,v107
CV v150,v108,v109
CV v151,v110,v111
buffer_store_dwordx4 v[148:151], v10, s[32:35], s51 offen offset:1024 sc1
AR v112,a232
AR v113,a233
AR v114,a234
AR v115,a235
PM v[112:113],v[112:113],v[80:81]
PM v[114:115],v[114:115],v[80:81]
AR v116,a248
AR v117,a249
AR v118,a250
AR v119,a251
PM v[116:117],v[116:117],v[80:81]
PM v[118:119],v[118:119],v[80:81]
CV v128,v112,v113
CV v129,v114,v115
CV v130,v116,v117
CV v131,v118,v119
buffer_store_dwordx4 v[128:131], v10, s[32:35], s51 offen offset:2048 sc1
AR v120,a236
AR v121,a237
AR v122,a238
AR v123,a239
PM v[120:121],v[120:121],v[82:83]
PM v[122:123],v[122:123],v[82:83]
AR v124,a252
AR v125,a253
AR v126,a254
AR v127,a255
PM v[124:125],v[124:125],v[82:83]
PM v[126:127],v[126:127],v[82:83]
CV v132,v120,v121
CV v133,v122,v123
CV v134,v124,v125
CV v135,v126,v127
buffer_store_dwordx4 v[132:135], v10, s[32:35], s51 offen offset:3072 sc1
s_branch L2_join
L2_join:
v_lshlrev_b32 v4, 0, v10
v_mov_b32 v1, v4
v_lshrrev_b32 v3, 4, v4
v_and_b32 v4, 15, v3
v_lshrrev_b32 v5, 4, v3
v_lshlrev_b32 v5, 3, v5
s_movk_i32 s6, 1792
v_mad_u32_u24 v2, v4, s6, v5
s_lshr_b32 s27, s56, 2
s_and_b32 s28, s56, 3
s_lshl_b32 s6, s58, 2
s_add_u32 s6, s6, s28
s_lshl_b32 s6, s6, 2
s_add_u32 s6, s6, s3
s_mul_i32 s6, s6, 229376
s_add_u32 s6, s6, 41943040
s_add_u32 s8, s68, s6
s_addc_u32 s9, s69, 0
s_and_b32 s9, s9, 0xffff
s_mov_b32 s10, 229376
s_mov_b32 s11, 0x20000
s_lshl_b32 s6, s59, 2
s_add_u32 s6, s6, s27
s_lshl_b32 s6, s6, 2
s_add_u32 s6, s6, s3
s_mul_i32 s6, s6, 163840
s_add_u32 s12, s68, s6
s_addc_u32 s13, s69, 0
s_and_b32 s13, s13, 0xffff
s_mov_b32 s14, 163840
s_mov_b32 s15, 0x20000
s_add_u32 s16, s70, 0
s_addc_u32 s17, s71, 0
s_and_b32 s17, s17, 0xffff
s_mov_b32 s18, 4358144
s_mov_b32 s19, 0x20000
s_mul_i32 s6, s57, 304
s_mul_i32 s7, s27, 80
s_add_u32 s6, s6, s7
s_mul_i32 s6, s6, 1792
s_mul_i32 s7, s58, 896
s_add_u32 s6, s6, s7
s_mul_i32 s7, s28, 224
s_add_u32 s26, s6, s7
s_mov_b32 s20, 0
s_mov_b32 s21, 4096
s_mov_b32 s22, 0
s_mov_b32 s23, 4096
s_mov_b32 s29, 0
WV 0
v_readfirstlane_b32 s6, v11
s_nop 3
s_cmp_ge_u32 s6, 128
s_cbranch_scc1 L2_wof_ok2
s_lshl_b32 s4, s58, 2
s_mov_b32 s5, 20000
v_mov_b32 v9, 0
L2_wof:
buffer_load_dword v8, v9, s[64:67], s4 offen offset:128 sc1
WV 0
v_readfirstlane_b32 s6, v8
s_nop 3
s_cmp_ge_u32 s6, 128
s_cbranch_scc1 L2_wof_ok
s_sleep 2
s_sub_u32 s5, s5, 1
s_cmp_lg_u32 s5, 0
s_cbranch_scc1 L2_wof
s_mov_b32 s29, 1
L2_wof_ok:
L2_wof_ok2:
WV 0
s_barrier
s_cmp_lg_u32 s3, 0
s_cbranch_scc1 L2_noadd
s_lshl_b32 s4, s59, 2
s_mov_b64 s[6:7], exec
s_mov_b64 exec, 1
v_mov_b32 v8, 1
v_mov_b32 v9, 0
buffer_atomic_add v8, v9, s[64:67], s4 offen offset:64
s_mov_b64 exec, s[6:7]
L2_noadd:
buffer_load_dwordx4 v[16:19], v1, s[8:11], s20 offen offset:0 sc1
buffer_load_dwordx4 v[20:23], v1, s[8:11], s20 offen offset:1024 sc1
buffer_load_dwordx4 v[24:27], v1, s[8:11], s20 offen offset:2048 sc1
buffer_load_dwordx4 v[28:31], v1, s[8:11], s20 offen offset:3072 sc1
buffer_load_dwordx4 v[32:35], v1, s[8:11], s21 offen offset:0 sc1
buffer_load_dwordx4 v[36:39], v1, s[8:11], s21 offen offset:1024 sc1
buffer_load_dwordx4 v[40:43], v1, s[8:11], s21 offen offset:2048 sc1
s_add_u32 s20, s20, 7168
s_add_u32 s21, s21, 7168
buffer_load_dwordx4 v[64:67], v1, s[8:11], s20 offen offset:0 sc1
buffer_load_dwordx4 v[68:71], v1, s[8:11], s20 offen offset:1024 sc1
buffer_load_dwordx4 v[72:75], v1, s[8:11], s20 offen offset:2048 sc1
buffer_load_dwordx4 v[76:79], v1, s[8:11], s20 offen offset:3072 sc1
buffer_load_dwordx4 v[80:83], v1, s[8:11], s21 offen offset:0 sc1
buffer_load_dwordx4 v[84:87], v1, s[8:11], s21 offen offset:1024 sc1
buffer_load_dwordx4 v[88:91], v1, s[8:11], s21 offen offset:2048 sc1
s_add_u32 s20, s20, 7168
s_add_u32 s21, s21, 7168
buffer_load_dwordx4 v[112:115], v1, s[8:11], s20 offen offset:0 sc1
buffer_load_dwordx4 v[116:119], v1, s[8:11], s20 offen offset:1024 sc1
buffer_load_dwordx4 v[120:123], v1, s[8:11], s20 offen offset:2048 sc1
buffer_load_dwordx4 v[124:127], v1, s[8:11], s20 offen offset:3072 sc1
buffer_load_dwordx4 v[128:131], v1, s[8:11], s21 offen offset:0 sc1
buffer_load_dwordx4 v[132:135], v1, s[8:11], s21 offen offset:1024 sc1
buffer_load_dwordx4 v[136:139], v1, s[8:11], s21 offen offset:2048 sc1
s_add_u32 s20, s20, 7168
s_add_u32 s21, s21, 7168
s_cmp_lg_u32 s3, 0
s_cbranch_scc1 L2_nopoll
s_lshl_b32 s4, s59, 2
s_mov_b32 s5, 20000
v_mov_b32 v9, 0
L2_grp:
buffer_load_dword v8, v9, s[64:67], s4 offen offset:64 sc1
WV 0
v_readfirstlane_b32 s6, v8
s_nop 3
s_cmp_ge_u32 s6, 16
s_cbranch_scc1 L2_grp_ok
s_sleep 2
s_sub_u32 s5, s5, 1
s_cmp_lg_u32 s5, 0
s_cbranch_scc1 L2_grp
s_mov_b32 s29, 1
L2_grp_ok:
L2_nopoll:
s_barrier
s_cmp_eq_u32 s27, 3
s_cbranch_scc1 L2_v4
L2_v5:
buffer_load_dwordx4 v[44:47], v1, s[12:15], s22 offen offset:0 sc1
buffer_load_dwordx4 v[48:51], v1, s[12:15], s22 offen offset:1024 sc1
buffer_load_dwordx4 v[52:55], v1, s[12:15], s22 offen offset:2048 sc1
buffer_load_dwordx4 v[56:59], v1, s[12:15], s22 offen offset:3072 sc1
buffer_load_dwordx4 v[60:63], v1, s[12:15], s23 offen offset:0 sc1
s_add_u32 s22, s22, 5120
s_add_u32 s23, s23, 5120
buffer_load_dwordx4 v[92:95], v1, s[12:15], s22 offen offset:0 sc1
buffer_load_dwordx4 v[96:99], v1, s[12:15], s22 offen offset:1024 sc1
buffer_load_dwordx4 v[100:103], v1, s[12:15], s22 offen offset:2048 sc1
buffer_load_dwordx4 v[104:107], v1, s[12:15], s22 offen offset:3072 sc1
buffer_load_dwordx4 v[108:111], v1, s[12:15], s23 offen offset:0 sc1
s_add_u32 s22, s22, 5120
s_add_u32 s23, s23, 5120
buffer_load_dwordx4 v[140:143], v1, s[12:15], s22 offen offset:0 sc1
buffer_load_dwordx4 v[144:147], v1, s[12:15], s22 offen offset:1024 sc1
buffer_load_dwordx4 v[148:151], v1, s[12:15], s22 offen offset:2048 sc1
buffer_load_dwordx4 v[152:155], v1, s[12:15], s22 offen offset:3072 sc1
buffer_load_dwordx4 v[156:159], v1, s[12:15], s23 offen offset:0 sc1
s_add_u32 s22, s22, 5120
s_add_u32 s23, s23, 5120
WV 14
M a[0:3],v[16:19],v[44:47],0
WV 13
buffer_load_dwordx4 v[160:163], v1, s[8:11], s20 offen offset:0 sc1
M a[28:31],v[16:19],v[48:51],0
WV 13
M a[56:59],v[16:19],v[52:55],0
WV 12
buffer_load_dwordx4 v[188:191], v1, s[12:15], s22 offen offset:0 sc1
M a[84:87],v[16:19],v[56:59],0
WV 12
M a[112:115],v[16:19],v[60:63],0
buffer_load_dwordx4 v[192:195], v1, s[12:15], s22 offen offset:1024 sc1
M a[4:7],v[20:23],v[44:47],0
M a[32:35],v[20:23],v[48:51],0
buffer_load_dwordx4 v[196:199], v1, s[12:15], s22 offen offset:2048 sc1
M a[60:63],v[20:23],v[52:55],0
M a[88:91],v[20:23],v[56:59],0
buffer_load_dwordx4 v[200:203], v1, s[12:15], s22 offen offset:3072 sc1
M a[116:119],v[20:23],v[60:63],0
M a[8:11],v[24:27],v[44:47],0
buffer_load_dwordx4 v[204:207], v1, s[12:15], s23 offen offset:0 sc1
M a[36:39],v[24:27],v[48:51],0
M a[64:67],v[24:27],v[52:55],0
buffer_load_dwordx4 v[164:167], v1, s[8:11], s20 offen offset:1024 sc1
M a[92:95],v[24:27],v[56:59],0
M a[120:123],v[24:27],v[60:63],0
buffer_load_dwordx4 v[168:171], v1, s[8:11], s20 offen offset:2048 sc1
M a[12:15],v[28:31],v[44:47],0
M a[40:43],v[28:31],v[48:51],0
buffer_load_dwordx4 v[172:175], v1, s[8:11], s20 offen offset:3072 sc1
M a[68:71],v[28:31],v[52:55],0
M a[96:99],v[28:31],v[56:59],0
buffer_load_dwordx4 v[176:179], v1, s[8:11], s21 offen offset:0 sc1
M a[124:127],v[28:31],v[60:63],0
M a[16:19],v[32:35],v[44:47],0
buffer_load_dwordx4 v[180:183], v1, s[8:11], s21 offen offset:1024 sc1
M a[44:47],v[32:35],v[48:51],0
M a[72:75],v[32:35],v[52:55],0
buffer_load_dwordx4 v[184:187], v1, s[8:11], s21 offen offset:2048 sc1
M a[100:103],v[32:35],v[56:59],0
M a[128:131],v[32:35],v[60:63],0
M a[20:23],v[36:39],v[44:47],0
M a[48:51],v[36:39],v[48:51],0
M a[76:79],v[36:39],v[52:55],0
M a[104:107],v[36:39],v[56:59],0
M a[132:135],v[36:39],v[60:63],0
M a[24:27],v[40:43],v[44:47],0
M a[52:55],v[40:43],v[48:51],0
M a[80:83],v[40:43],v[52:55],0
M a[108:111],v[40:43],v[56:59],0
M a[136:139],v[40:43],v[60:63],0
WV 21
s_add_u32 s20, s20, 7168
s_add_u32 s21, s21, 7168
s_add_u32 s22, s22, 5120
s_add_u32 s23, s23, 5120
M a[0:3],v[64:67],v[92:95],a[0:3]
WV 20
buffer_load_dwordx4 v[16:19], v1, s[8:11], s20 offen offset:0 sc1
M a[28:31],v[64:67],v[96:99],a[28:31]
WV 20
M a[56:59],v[64:67],v[100:103],a[56:59]
WV 19
buffer_load_dwordx4 v[44:47], v1, s[12:15], s22 offen offset:0 sc1
M a[84:87],v[64:67],v[104:107],a[84:87]
WV 19
M a[112:115],v[64:67],v[108:111],a[112:115]
buffer_load_dwordx4 v[48:51], v1, s[12:15], s22 offen offset:1024 sc1
M a[4:7],v[68:71],v[92:95],a[4:7]
M a[32:35],v[68:71],v[96:99],a[32:35]
buffer_load_dwordx4 v[52:55], v1, s[12:15], s22 offen offset:2048 sc1
M a[60:63],v[68:71],v[100:103],a[60:63]
M a[88:91],v[68:71],v[104:107],a[88:91]
buffer_load_dwordx4 v[56:59], v1, s[12:15], s22 offen offset:3072 sc1
M a[116:119],v[68:71],v[108:111],a[116:119]
M a[8:11],v[72:75],v[92:95],a[8:11]
buffer_load_dwordx4 v[60:63], v1, s[12:15], s23 offen offset:0 sc1
M a[36:39],v[72:75],v[96:99],a[36:39]
M a[64:67],v[72:75],v[100:103],a[64:67]
buffer_load_dwordx4 v[20:23], v1, s[8:11], s20 offen offset:1024 sc1
M a[92:95],v[72:75],v[104:107],a[92:95]
M a[120:123],v[72:75],v[108:111],a[120:123]
buffer_load_dwordx4 v[24:27], v1, s[8:11], s20 offen offset:2048 sc1
M a[12:15],v[76:79],v[92:95],a[12:15]
M a[40:43],v[76:79],v[96:99],a[40:43]
buffer_load_dwordx4 v[28:31], v1, s[8:11], s20 offen offset:3072 sc1
M a[68:71],v[76:79],v[100:103],a[68:71]
M a[96:99],v[76:79],v[104:107],a[96:99]
buffer_load_dwordx4 v[32:35], v1, s[8:11], s21 offen offset:0 sc1
M a[124:127],v[76:79],v[108:111],a[124:127]
M a[16:19],v[80:83],v[92:95],a[16:19]
buffer_load_dwordx4 v[36:39], v1, s[8:11], s21 offen offset:1024 sc1
M a[44:47],v[80:83],v[96:99],a[44:47]
M a[72:75],v[80:83],v[100:103],a[72:75]
buffer_load_dwordx4 v[40:43], v1, s[8:11], s21 offen offset:2048 sc1
M a[100:103],v[80:83],v[104:107],a[100:103]
M a[128:131],v[80:83],v[108:111],a[128:131]
M a[20:23],v[84:87],v[92:95],a[20:23]
M a[48:51],v[84:87],v[96:99],a[48:51]
M a[76:79],v[84:87],v[100:103],a[76:79]
M a[104:107],v[84:87],v[104:107],a[104:107]
M a[132:135],v[84:87],v[108:111],a[132:135]
M a[24:27],v[88:91],v[92:95],a[24:27]
M a[52:55],v[88:91],v[96:99],a[52:55]
M a[80:83],v[88:91],v[100:103],a[80:83]
M a[108:111],v[88:91],v[104:107],a[108:111]
M a[136:139],v[88:91],v[108:111],a[136:139]
WV 28
s_add_u32 s20, s20, 7168
s_add_u32 s21, s21, 7168
s_add_u32 s22, s22, 5120
s_add_u32 s23, s23, 5120
M a[0:3],v[112:115],v[140:143],a[0:3]
WV 27
buffer_load_dwordx4 v[64:67], v1, s[8:11], s20 offen offset:0 sc1
M a[28:31],v[112:115],v[144:147],a[28:31]
WV 27
M a[56:59],v[112:115],v[148:151],a[56:59]
WV 26
buffer_load_dwordx4 v[92:95], v1, s[12:15], s22 offen offset:0 sc1
M a[84:87],v[112:115],v[152:155],a[84:87]
WV 26
M a[112:115],v[112:115],v[156:159],a[112:115]
buffer_load_dwordx4 v[96:99], v1, s[12:15], s22 offen offset:1024 sc1
M a[4:7],v[116:119],v[140:143],a[4:7]
M a[32:35],v[116:119],v[144:147],a[32:35]
buffer_load_dwordx4 v[100:103], v1, s[12:15], s22 offen offset:2048 sc1
M a[60:63],v[116:119],v[148:151],a[60:63]
M a[88:91],v[116:119],v[152:155],a[88:91]
buffer_load_dwordx4 v[104:107], v1, s[12:15], s22 offen offset:3072 sc1
M a[116:119],v[116:119],v[156:159],a[116:119]
M a[8:11],v[120:123],v[140:143],a[8:11]
buffer_load_dwordx4 v[108:111], v1, s[12:15], s23 offen offset:0 sc1
M a[36:39],v[120:123],v[144:147],a[36:39]
M a[64:67],v[120:123],v[148:151],a[64:67]
buffer_load_dwordx4 v[68:71], v1, s[8:11], s20 offen offset:1024 sc1
M a[92:95],v[120:123],v[152:155],a[92:95]
M a[120:123],v[120:123],v[156:159],a[120:123]
buffer_load_dwordx4 v[72:75], v1, s[8:11], s20 offen offset:2048 sc1
M a[12:15],v[124:127],v[140:143],a[12:15]
M a[40:43],v[124:127],v[144:147],a[40:43]
buffer_load_dwordx4 v[76:79], v1, s[8:11], s20 offen offset:3072 sc1
M a[68:71],v[124:127],v[148:151],a[68:71]
M a[96:99],v[124:127],v[152:155],a[96:99]
buffer_load_dwordx4 v[80:83], v1, s[8:11], s21 offen offset:0 sc1
M a[124:127],v[124:127],v[156:159],a[124:127]
M a[16:19],v[128:131],v[140:143],a[16:19]
buffer_load_dwordx4 v[84:87], v1, s[8:11], s21 offen offset:1024 sc1
M a[44:47],v[128:131],v[144:147],a[44:47]
M a[72:75],v[128:131],v[148:151],a[72:75]
buffer_load_dwordx4 v[88:91], v1, s[8:11], s21 offen offset:2048 sc1
M a[100:103],v[128:131],v[152:155],a[100:103]
M a[128:131],v[128:131],v[156:159],a[128:131]
M a[20:23],v[132:135],v[140:143],a[20:23]
M a[48:51],v[132:135],v[144:147],a[48:51]
M a[76:79],v[132:135],v[148:151],a[76:79]
M a[104:107],v[132:135],v[152:155],a[104:107]
M a[132:135],v[132:135],v[156:159],a[132:135]
M a[24:27],v[136:139],v[140:143],a[24:27]
M a[52:55],v[136:139],v[144:147],a[52:55]
M a[80:83],v[136:139],v[148:151],a[80:83]
M a[108:111],v[136:139],v[152:155],a[108:111]
M a[136:139],v[136:139],v[156:159],a[136:139]
WV 34
s_add_u32 s20, s20, 7168
s_add_u32 s21, s21, 7168
s_add_u32 s22, s22, 5120
s_add_u32 s23, s23, 5120
M a[0:3],v[160:163],v[188:191],a[0:3]
WV 33
buffer_load_dwordx4 v[112:115], v1, s[8:11], s20 offen offset:0 sc1
M a[28:31],v[160:163],v[192:195],a[28:31]
WV 33
M a[56:59],v[160:163],v[196:199],a[56:59]
WV 32
buffer_load_dwordx4 v[140:143], v1, s[12:15], s22 offen offset:0 sc1
M a[84:87],v[160:163],v[200:203],a[84:87]
WV 32
M a[112:115],v[160:163],v[204:207],a[112:115]
WV 31
buffer_load_dwordx4 v[144:147], v1, s[12:15], s22 offen offset:1024 sc1
M a[4:7],v[164:167],v[188:191],a[4:7]
M a[32:35],v[164:167],v[192:195],a[32:35]
buffer_load_dwordx4 v[148:151], v1, s[12:15], s22 offen offset:2048 sc1
M a[60:63],v[164:167],v[196:199],a[60:63]
M a[88:91],v[164:167],v[200:203],a[88:91]
buffer_load_dwordx4 v[152:155], v1, s[12:15], s22 offen offset:3072 sc1
M a[116:119],v[164:167],v[204:207],a[116:119]
WV 33
M a[8:11],v[168:171],v[188:191],a[8:11]
buffer_load_dwordx4 v[156:159], v1, s[12:15], s23 offen offset:0 sc1
M a[36:39],v[168:171],v[192:195],a[36:39]
M a[64:67],v[168:171],v[196:199],a[64:67]
buffer_load_dwordx4 v[116:119], v1, s[8:11], s20 offen offset:1024 sc1
M a[92:95],v[168:171],v[200:203],a[92:95]
M a[120:123],v[168:171],v[204:207],a[120:123]
WV 34
buffer_load_dwordx4 v[120:123], v1, s[8:11], s20 offen offset:2048 sc1
M a[12:15],v[172:175],v[188:191],a[12:15]
M a[40:43],v[172:175],v[192:195],a[40:43]
buffer_load_dwordx4 v[124:127], v1, s[8:11], s20 offen offset:3072 sc1
M a[68:71],v[172:175],v[196:199],a[68:71]
M a[96:99],v[172:175],v[200:203],a[96:99]
buffer_load_dwordx4 v[128:131], v1, s[8:11], s21 offen offset:0 sc1
M a[124:127],v[172:175],v[204:207],a[124:127]
WV 36
M a[16:19],v[176:179],v[188:191],a[16:19]
buffer_load_dwordx4 v[132:135], v1, s[8:11], s21 offen offset:1024 sc1
M a[44:47],v[176:179],v[192:195],a[44:47]
M a[72:75],v[176:179],v[196:199],a[72:75]
buffer_load_dwordx4 v[136:139], v1, s[8:11], s21 offen offset:2048 sc1
M a[100:103],v[176:179],v[200:203],a[100:103]
M a[128:131],v[176:179],v[204:207],a[128:131]
WV 37
M a[20:23],v[180:183],v[188:191],a[20:23]
M a[48:51],v[180:183],v[192:195],a[48:51]
M a[76:79],v[180:183],v[196:199],a[76:79]
M a[104:107],v[180:183],v[200:203],a[104:107]
M a[132:135],v[180:183],v[204:207],a[132:135]
WV 36
M a[24:27],v[184:187],v[188:191],a[24:27]
M a[52:55],v[184:187],v[192:195],a[52:55]
M a[80:83],v[184:187],v[196:199],a[80:83]
M a[108:111],v[184:187],v[200:203],a[108:111]
M a[136:139],v[184:187],v[204:207],a[136:139]
s_add_u32 s20, s20, 7168
s_add_u32 s21, s21, 7168
s_add_u32 s22, s22, 5120
s_add_u32 s23, s23, 5120
s_mov_b32 s24, 7
L2_loop_5:
WV 34
M a[0:3],v[16:19],v[44:47],a[0:3]
WV 33
buffer_load_dwordx4 v[160:163], v1, s[8:11], s20 offen offset:0 sc1
M a[28:31],v[16:19],v[48:51],a[28:31]
WV 33
M a[56:59],v[16:19],v[52:55],a[56:59]
WV 32
buffer_load_dwordx4 v[188:191], v1, s[12:15], s22 offen offset:0 sc1
M a[84:87],v[16:19],v[56:59],a[84:87]
WV 32
M a[112:115],v[16:19],v[60:63],a[112:115]
WV 31
buffer_load_dwordx4 v[192:195], v1, s[12:15], s22 offen offset:1024 sc1
M a[4:7],v[20:23],v[44:47],a[4:7]
M a[32:35],v[20:23],v[48:51],a[32:35]
buffer_load_dwordx4 v[196:199], v1, s[12:15], s22 offen offset:2048 sc1
M a[60:63],v[20:23],v[52:55],a[60:63]
M a[88:91],v[20:23],v[56:59],a[88:91]
buffer_load_dwordx4 v[200:203], v1, s[12:15], s22 offen offset:3072 sc1
M a[116:119],v[20:23],v[60:63],a[116:119]
WV 33
M a[8:11],v[24:27],v[44:47],a[8:11]
buffer_load_dwordx4 v[204:207], v1, s[12:15], s23 offen offset:0 sc1
M a[36:39],v[24:27],v[48:51],a[36:39]
M a[64:67],v[24:27],v[52:55],a[64:67]
buffer_load_dwordx4 v[164:167], v1, s[8:11], s20 offen offset:1024 sc1
M a[92:95],v[24:27],v[56:59],a[92:95]
M a[120:123],v[24:27],v[60:63],a[120:123]
WV 34
buffer_load_dwordx4 v[168:171], v1, s[8:11], s20 offen offset:2048 sc1
M a[12:15],v[28:31],v[44:47],a[12:15]
M a[40:43],v[28:31],v[48:51],a[40:43]
buffer_load_dwordx4 v[172:175], v1, s[8:11], s20 offen offset:3072 sc1
M a[68:71],v[28:31],v[52:55],a[68:71]
M a[96:99],v[28:31],v[56:59],a[96:99]
buffer_load_dwordx4 v[176:179], v1, s[8:11], s21 offen offset:0 sc1
M a[124:127],v[28:31],v[60:63],a[124:127]
WV 36
M a[16:19],v[32:35],v[44:47],a[16:19]
buffer_load_dwordx4 v[180:183], v1, s[8:11], s21 offen offset:1024 sc1
M a[44:47],v[32:35],v[48:51],a[44:47]
M a[72:75],v[32:35],v[52:55],a[72:75]
buffer_load_dwordx4 v[184:187], v1, s[8:11], s21 offen offset:2048 sc1
M a[100:103],v[32:35],v[56:59],a[100:103]
M a[128:131],v[32:35],v[60:63],a[128:131]
WV 37
M a[20:23],v[36:39],v[44:47],a[20:23]
M a[48:51],v[36:39],v[48:51],a[48:51]
M a[76:79],v[36:39],v[52:55],a[76:79]
M a[104:107],v[36:39],v[56:59],a[104:107]
M a[132:135],v[36:39],v[60:63],a[132:135]
WV 36
M a[24:27],v[40:43],v[44:47],a[24:27]
M a[52:55],v[40:43],v[48:51],a[52:55]
M a[80:83],v[40:43],v[52:55],a[80:83]
M a[108:111],v[40:43],v[56:59],a[108:111]
M a[136:139],v[40:43],v[60:63],a[136:139]
WV 34
s_add_u32 s20, s20, 7168
s_add_u32 s21, s21, 7168
s_add_u32 s22, s22, 5120
s_add_u32 s23, s23, 5120
M a[0:3],v[64:67],v[92:95],a[0:3]
WV 33
buffer_load_dwordx4 v[16:19], v1, s[8:11], s20 offen offset:0 sc1
M a[28:31],v[64:67],v[96:99],a[28:31]
WV 33
M a[56:59],v[64:67],v[100:103],a[56:59]
WV 32
buffer_load_dwordx4 v[44:47], v1, s[12:15], s22 offen offset:0 sc1
M a[84:87],v[64:67],v[104:107],a[84:87]
WV 32
M a[112:115],v[64:67],v[108:111],a[112:115]
WV 31
buffer_load_dwordx4 v[48:51], v1, s[12:15], s22 offen offset:1024 sc1
M a[4:7],v[68:71],v[92:95],a[4:7]
M a[32:35],v[68:71],v[96:99],a[32:35]
buffer_load_dwordx4 v[52:55], v1, s[12:15], s22 offen offset:2048 sc1
M a[60:63],v[68:71],v[100:103],a[60:63]
M a[88:91],v[68:71],v[104:107],a[88:91]
buffer_load_dwordx4 v[56:59], v1, s[12:15], s22 offen offset:3072 sc1
M a[116:119],v[68:71],v[108:111],a[116:119]
WV 33
M a[8:11],v[72:75],v[92:95],a[8:11]
buffer_load_dwordx4 v[60:63], v1, s[12:15], s23 offen offset:0 sc1
M a[36:39],v[72:75],v[96:99],a[36:39]
M a[64:67],v[72:75],v[100:103],a[64:67]
buffer_load_dwordx4 v[20:23], v1, s[8:11], s20 offen offset:1024 sc1
M a[92:95],v[72:75],v[104:107],a[92:95]
M a[120:123],v[72:75],v[108:111],a[120:123]
WV 34
buffer_load_dwordx4 v[24:27], v1, s[8:11], s20 offen offset:2048 sc1
M a[12:15],v[76:79],v[92:95],a[12:15]
M a[40:43],v[76:79],v[96:99],a[40:43]
buffer_load_dwordx4 v[28:31], v1, s[8:11], s20 offen offset:3072 sc1
M a[68:71],v[76:79],v[100:103],a[68:71]
M a[96:99],v[76:79],v[104:107],a[96:99]
buffer_load_dwordx4 v[32:35], v1, s[8:11], s21 offen offset:0 sc1
M a[124:127],v[76:79],v[108:111],a[124:127]
WV 36
M a[16:19],v[80:83],v[92:95],a[16:19]
buffer_load_dwordx4 v[36:39], v1, s[8:11], s21 offen offset:1024 sc1
M a[44:47],v[80:83],v[96:99],a[44:47]
M a[72:75],v[80:83],v[100:103],a[72:75]
buffer_load_dwordx4 v[40:43], v1, s[8:11], s21 offen offset:2048 sc1
M a[100:103],v[80:83],v[104:107],a[100:103]
M a[128:131],v[80:83],v[108:111],a[128:131]
WV 37
M a[20:23],v[84:87],v[92:95],a[20:23]
M a[48:51],v[84:87],v[96:99],a[48:51]
M a[76:79],v[84:87],v[100:103],a[76:79]
M a[104:107],v[84:87],v[104:107],a[104:107]
M a[132:135],v[84:87],v[108:111],a[132:135]
WV 36
M a[24:27],v[88:91],v[92:95],a[24:27]
M a[52:55],v[88:91],v[96:99],a[52:55]
M a[80:83],v[88:91],v[100:103],a[80:83]
M a[108:111],v[88:91],v[104:107],a[108:111]
M a[136:139],v[88:91],v[108:111],a[136:139]
WV 34
s_add_u32 s20, s20, 7168
s_add_u32 s21, s21, 7168
s_add_u32 s22, s22, 5120
s_add_u32 s23, s23, 5120
M a[0:3],v[112:115],v[140:143],a[0:3]
WV 33
buffer_load_dwordx4 v[64:67], v1, s[8:11], s20 offen offset:0 sc1
M a[28:31],v[112:115],v[144:147],a[28:31]
WV 33
M a[56:59],v[112:115],v[148:151],a[56:59]
WV 32
buffer_load_dwordx4 v[92:95], v1, s[12:15], s22 offen offset:0 sc1
M a[84:87],v[112:115],v[152:155],a[84:87]
WV 32
M a[112:115],v[112:115],v[156:159],a[112:115]
WV 31
buffer_load_dwordx4 v[96:99], v1, s[12:15], s22 offen offset:1024 sc1
M a[4:7],v[116:119],v[140:143],a[4:7]
M a[32:35],v[116:119],v[144:147],a[32:35]
buffer_load_dwordx4 v[100:103], v1, s[12:15], s22 offen offset:2048 sc1
M a[60:63],v[116:119],v[148:151],a[60:63]
M a[88:91],v[116:119],v[152:155],a[88:91]
buffer_load_dwordx4 v[104:107], v1, s[12:15], s22 offen offset:3072 sc1
M a[116:119],v[116:119],v[156:159],a[116:119]
WV 33
M a[8:11],v[120:123],v[140:143],a[8:11]
buffer_load_dwordx4 v[108:111], v1, s[12:15], s23 offen offset:0 sc1
M a[36:39],v[120:123],v[144:147],a[36:39]
M a[64:67],v[120:123],v[148:151],a[64:67]
buffer_load_dwordx4 v[68:71], v1, s[8:11], s20 offen offset:1024 sc1
M a[92:95],v[120:123],v[152:155],a[92:95]
M a[120:123],v[120:123],v[156:159],a[120:123]
WV 34
buffer_load_dwordx4 v[72:75], v1, s[8:11], s20 offen offset:2048 sc1
M a[12:15],v[124:127],v[140:143],a[12:15]
M a[40:43],v[124:127],v[144:147],a[40:43]
buffer_load_dwordx4 v[76:79], v1, s[8:11], s20 offen offset:3072 sc1
M a[68:71],v[124:127],v[148:151],a[68:71]
M a[96:99],v[124:127],v[152:155],a[96:99]
buffer_load_dwordx4 v[80:83], v1, s[8:11], s21 offen offset:0 sc1
M a[124:127],v[124:127],v[156:159],a[124:127]
WV 36
M a[16:19],v[128:131],v[140:143],a[16:19]
buffer_load_dwordx4 v[84:87], v1, s[8:11], s21 offen offset:1024 sc1
M a[44:47],v[128:131],v[144:147],a[44:47]
M a[72:75],v[128:131],v[148:151],a[72:75]
buffer_load_dwordx4 v[88:91], v1, s[8:11], s21 offen offset:2048 sc1
M a[100:103],v[128:131],v[152:155],a[100:103]
M a[128:131],v[128:131],v[156:159],a[128:131]
WV 37
M a[20:23],v[132:135],v[140:143],a[20:23]
M a[48:51],v[132:135],v[144:147],a[48:51]
M a[76:79],v[132:135],v[148:151],a[76:79]
M a[104:107],v[132:135],v[152:155],a[104:107]
M a[132:135],v[132:135],v[156:159],a[132:135]
WV 36
M a[24:27],v[136:139],v[140:143],a[24:27]
M a[52:55],v[136:139],v[144:147],a[52:55]
M a[80:83],v[136:139],v[148:151],a[80:83]
M a[108:111],v[136:139],v[152:155],a[108:111]
M a[136:139],v[136:139],v[156:159],a[136:139]
WV 34
s_add_u32 s20, s20, 7168
s_add_u32 s21, s21, 7168
s_add_u32 s22, s22, 5120
s_add_u32 s23, s23, 5120
M a[0:3],v[160:163],v[188:191],a[0:3]
WV 33
buffer_load_dwordx4 v[112:115], v1, s[8:11], s20 offen offset:0 sc1
M a[28:31],v[160:163],v[192:195],a[28:31]
WV 33
M a[56:59],v[160:163],v[196:199],a[56:59]
WV 32
buffer_load_dwordx4 v[140:143], v1, s[12:15], s22 offen offset:0 sc1
M a[84:87],v[160:163],v[200:203],a[84:87]
WV 32
M a[112:115],v[160:163],v[204:207],a[112:115]
WV 31
buffer_load_dwordx4 v[144:147], v1, s[12:15], s22 offen offset:1024 sc1
M a[4:7],v[164:167],v[188:191],a[4:7]
M a[32:35],v[164:167],v[192:195],a[32:35]
buffer_load_dwordx4 v[148:151], v1, s[12:15], s22 offen offset:2048 sc1
M a[60:63],v[164:167],v[196:199],a[60:63]
M a[88:91],v[164:167],v[200:203],a[88:91]
buffer_load_dwordx4 v[152:155], v1, s[12:15], s22 offen offset:3072 sc1
M a[116:119],v[164:167],v[204:207],a[116:119]
WV 33
M a[8:11],v[168:171],v[188:191],a[8:11]
buffer_load_dwordx4 v[156:159], v1, s[12:15], s23 offen offset:0 sc1
M a[36:39],v[168:171],v[192:195],a[36:39]
M a[64:67],v[168:171],v[196:199],a[64:67]
buffer_load_dwordx4 v[116:119], v1, s[8:11], s20 offen offset:1024 sc1
M a[92:95],v[168:171],v[200:203],a[92:95]
M a[120:123],v[168:171],v[204:207],a[120:123]
WV 34
buffer_load_dwordx4 v[120:123], v1, s[8:11], s20 offen offset:2048 sc1
M a[12:15],v[172:175],v[188:191],a[12:15]
M a[40:43],v[172:175],v[192:195],a[40:43]
buffer_load_dwordx4 v[124:127], v1, s[8:11], s20 offen offset:3072 sc1
M a[68:71],v[172:175],v[196:199],a[68:71]
M a[96:99],v[172:175],v[200:203],a[96:99]
buffer_load_dwordx4 v[128:131], v1, s[8:11], s21 offen offset:0 sc1
M a[124:127],v[172:175],v[204:207],a[124:127]
WV 36
M a[16:19],v[176:179],v[188:191],a[16:19]
buffer_load_dwordx4 v[132:135], v1, s[8:11], s21 offen offset:1024 sc1
M a[44:47],v[176:179],v[192:195],a[44:47]
M a[72:75],v[176:179],v[196:199],a[72:75]
buffer_load_dwordx4 v[136:139], v1, s[8:11], s21 offen offset:2048 sc1
M a[100:103],v[176:179],v[200:203],a[100:103]
M a[128:131],v[176:179],v[204:207],a[128:131]
WV 37
M a[20:23],v[180:183],v[188:191],a[20:23]
M a[48:51],v[180:183],v[192:195],a[48:51]
M a[76:79],v[180:183],v[196:199],a[76:79]
M a[104:107],v[180:183],v[200:203],a[104:107]
M a[132:135],v[180:183],v[204:207],a[132:135]
WV 36
M a[24:27],v[184:187],v[188:191],a[24:27]
M a[52:55],v[184:187],v[192:195],a[52:55]
M a[80:83],v[184:187],v[196:199],a[80:83]
M a[108:111],v[184:187],v[200:203],a[108:111]
M a[136:139],v[184:187],v[204:207],a[136:139]
s_add_u32 s20, s20, 7168
s_add_u32 s21, s21, 7168
s_add_u32 s22, s22, 5120
s_add_u32 s23, s23, 5120
s_sub_u32 s24, s24, 1
s_cmp_lg_u32 s24, 0
s_cbranch_scc1 L2_loop_5
WV 0
s_nop 7
s_cmp_eq_u32 s3, 0
s_cbranch_scc1 L2_r0_5
s_cmp_eq_u32 s3, 1
s_cbranch_scc1 L2_r1_5
s_cmp_eq_u32 s3, 2
s_cbranch_scc1 L2_r2_5
s_branch L2_r3_5
L2_r0_5:
v_add_u32 v4, 32768, v1
v_add_u32 v5, 65536, v1
v_add_u32 v6, 98304, v1
ds_write_b128 v1, a[36:39] offset:27648
ds_write_b128 v1, a[40:43] offset:30720
ds_write_b128 v4, a[44:47] offset:1024
ds_write_b128 v4, a[48:51] offset:4096
ds_write_b128 v4, a[52:55] offset:7168
ds_write_b128 v4, a[56:59] offset:10240
ds_write_b128 v4, a[60:63] offset:13312
ds_write_b128 v4, a[64:67] offset:16384
ds_write_b128 v4, a[68:71] offset:19456
ds_write_b128 v4, a[72:75] offset:22528
ds_write_b128 v4, a[76:79] offset:25600
ds_write_b128 v4, a[80:83] offset:28672
ds_write_b128 v4, a[84:87] offset:31744
ds_write_b128 v5, a[88:91] offset:2048
ds_write_b128 v5, a[92:95] offset:5120
ds_write_b128 v5, a[96:99] offset:8192
ds_write_b128 v5, a[100:103] offset:11264
ds_write_b128 v5, a[104:107] offset:14336
ds_write_b128 v5, a[108:111] offset:17408
ds_write_b128 v5, a[112:115] offset:20480
ds_write_b128 v5, a[116:119] offset:23552
ds_write_b128 v5, a[120:123] offset:26624
ds_write_b128 v5, a[124:127] offset:29696
ds_write_b128 v6, a[128:131] offset:0
ds_write_b128 v6, a[132:135] offset:3072
ds_write_b128 v6, a[136:139] offset:6144
WL 0
s_barrier
RD v[16:19],v1,0
RD v[20:23],v1,1024
RD v[24:27],v1,2048
RD v[32:35],v1,3072
RD v[36:39],v1,4096
RD v[40:43],v1,5120
RD v[48:51],v1,6144
RD v[52:55],v1,7168
RD v[56:59],v1,8192
RD v[64:67],v1,9216
RD v[68:71],v1,10240
RD v[72:75],v1,11264
RD v[80:83],v1,12288
RD v[84:87],v1,13312
RD v[88:91],v1,14336
RD v[96:99],v1,15360
RD v[100:103],v1,16384
RD v[104:107],v1,17408
RD v[112:115],v1,18432
RD v[116:119],v1,19456
RD v[120:123],v1,20480
RD v[128:131],v1,21504
RD v[132:135],v1,22528
RD v[136:139],v1,23552
RD v[144:147],v1,24576
RD v[148:151],v1,25600
RD v[152:155],v1,26624
AR v28,a0
AR v29,a1
AR v30,a2
AR v31,a3
WL 15
v_pk_add_f32 v[20:21], v[20:21], v[24:25]
v_pk_add_f32 v[22:23], v[22:23], v[26:27]
v_pk_add_f32 v[28:29], v[28:29], v[16:17]
v_pk_add_f32 v[30:31], v[30:31], v[18:19]
v_pk_add_f32 v[28:29], v[28:29], v[20:21]
v_pk_add_f32 v[30:31], v[30:31], v[22:23]
CV v16,v28,v29
CV v17,v30,v31
s_add_u32 s25, s26, 0
buffer_store_dwordx2 v[16:17], v2, s[16:19], s25 offen
AR v44,a4
AR v45,a5
AR v46,a6
AR v47,a7
v_pk_add_f32 v[36:37], v[36:37], v[40:41]
v_pk_add_f32 v[38:39], v[38:39], v[42:43]
v_pk_add_f32 v[44:45], v[44:45], v[32:33]
v_pk_add_f32 v[46:47], v[46:47], v[34:35]
v_pk_add_f32 v[44:45], v[44:45], v[36:37]
v_pk_add_f32 v[46:47], v[46:47], v[38:39]
CV v32,v44,v45
CV v33,v46,v47
s_add_u32 s25, s26, 32
buffer_store_dwordx2 v[32:33], v2, s[16:19], s25 offen
AR v60,a8
AR v61,a9
AR v62,a10
AR v63,a11
v_pk_add_f32 v[52:53], v[52:53], v[56:57]
v_pk_add_f32 v[54:55], v[54:55], v[58:59]
v_pk_add_f32 v[60:61], v[60:61], v[48:49]
v_pk_add_f32 v[62:63], v[62:63], v[50:51]
v_pk_add_f32 v[60:61], v[60:61], v[52:53]
v_pk_add_f32 v[62:63], v[62:63], v[54:55]
CV v48,v60,v61
CV v49,v62,v63
s_add_u32 s25, s26, 64
buffer_store_dwordx2 v[48:49], v2, s[16:19], s25 offen
AR v76,a12
AR v77,a13
AR v78,a14
AR v79,a15
v_pk_add_f32 v[68:69], v[68:69], v[72:73]
v_pk_add_f32 v[70:71], v[70:71], v[74:75]
v_pk_add_f32 v[76:77], v[76:77], v[64:65]
v_pk_add_f32 v[78:79], v[78:79], v[66:67]
v_pk_add_f32 v[76:77], v[76:77], v[68:69]
v_pk_add_f32 v[78:79], v[78:79], v[70:71]
CV v64,v76,v77
CV v65,v78,v79
s_add_u32 s25, s26, 96
buffer_store_dwordx2 v[64:65], v2, s[16:19], s25 offen
AR v92,a16
AR v93,a17
AR v94,a18
AR v95,a19
WL 12
v_pk_add_f32 v[84:85], v[84:85], v[88:89]
v_pk_add_f32 v[86:87], v[86:87], v[90:91]
v_pk_add_f32 v[92:93], v[92:93], v[80:81]
v_pk_add_f32 v[94:95], v[94:95], v[82:83]
v_pk_add_f32 v[92:93], v[92:93], v[84:85]
v_pk_add_f32 v[94:95], v[94:95], v[86:87]
CV v80,v92,v93
CV v81,v94,v95
s_add_u32 s25, s26, 128
buffer_store_dwordx2 v[80:81], v2, s[16:19], s25 offen
AR v108,a20
AR v109,a21
AR v110,a22
AR v111,a23
WL 9
v_pk_add_f32 v[100:101], v[100:101], v[104:105]
v_pk_add_f32 v[102:103], v[102:103], v[106:107]
v_pk_add_f32 v[108:109], v[108:109], v[96:97]
v_pk_add_f32 v[110:111], v[110:111], v[98:99]
v_pk_add_f32 v[108:109], v[108:109], v[100:101]
v_pk_add_f32 v[110:111], v[110:111], v[102:103]
CV v96,v108,v109
CV v97,v110,v111
s_add_u32 s25, s26, 160
buffer_store_dwordx2 v[96:97], v2, s[16:19], s25 offen
AR v124,a24
AR v125,a25
AR v126,a26
AR v127,a27
WL 6
v_pk_add_f32 v[116:117], v[116:117], v[120:121]
v_pk_add_f32 v[118:119], v[118:119], v[122:123]
v_pk_add_f32 v[124:125], v[124:125], v[112:113]
v_pk_add_f32 v[126:127], v[126:127], v[114:115]
v_pk_add_f32 v[124:125], v[124:125], v[116:117]
v_pk_add_f32 v[126:127], v[126:127], v[118:119]
CV v112,v124,v125
CV v113,v126,v127
s_add_u32 s25, s26, 192
buffer_store_dwordx2 v[112:113], v2, s[16:19], s25 offen
AR v140,a28
AR v141,a29
AR v142,a30
AR v143,a31
WL 3
v_pk_add_f32 v[132:133], v[132:133], v[136:137]
v_pk_add_f32 v[134:135], v[134:135], v[138:139]
v_pk_add_f32 v[140:141], v[140:141], v[128:129]
v_pk_add_f32 v[142:143], v[142:143], v[130:131]
v_pk_add_f32 v[140:141], v[140:141], v[132:133]
v_pk_add_f32 v[142:143], v[142:143], v[134:135]
CV v128,v140,v141
CV v129,v142,v143
s_add_u32 s25, s26, 28672
buffer_store_dwordx2 v[128:129], v2, s[16:19], s25 offen
AR v156,a32
AR v157,a33
AR v158,a34
AR v159,a35
WL 0
v_pk_add_f32 v[148:149], v[148:149], v[152:153]
v_pk_add_f32 v[150:151], v[150:151], v[154:155]
v_pk_add_f32 v[156:157], v[156:157], v[144:145]
v_pk_add_f32 v[158:159], v[158:159], v[146:147]
v_pk_add_f32 v[156:157], v[156:157], v[148:149]
v_pk_add_f32 v[158:159], v[158:159], v[150:151]
CV v144,v156,v157
CV v145,v158,v159
s_add_u32 s25, s26, 28704
buffer_store_dwordx2 v[144:145], v2, s[16:19], s25 offen
WV 0
s_endpgm
L2_r1_5:
v_add_u32 v4, 32768, v1
v_add_u32 v5, 65536, v1
v_add_u32 v6, 98304, v1
ds_write_b128 v1, a[0:3] offset:0
ds_write_b128 v1, a[4:7] offset:3072
ds_write_b128 v1, a[8:11] offset:6144
ds_write_b128 v1, a[12:15] offset:9216
ds_write_b128 v1, a[16:19] offset:12288
ds_write_b128 v1, a[20:23] offset:15360
ds_write_b128 v1, a[24:27] offset:18432
ds_write_b128 v1, a[28:31] offset:21504
ds_write_b128 v1, a[32:35] offset:24576
ds_write_b128 v4, a[72:75] offset:23552
ds_write_b128 v4, a[76:79] offset:26624
ds_write_b128 v4, a[80:83] offset:29696
ds_write_b128 v5, a[84:87] offset:0
ds_write_b128 v5, a[88:91] offset:3072
ds_write_b128 v5, a[92:95] offset:6144
ds_write_b128 v5, a[96:99] offset:9216
ds_write_b128 v5, a[100:103] offset:12288
ds_write_b128 v5, a[104:107] offset:15360
ds_write_b128 v5, a[108:111] offset:18432
ds_write_b128 v5, a[112:115] offset:21504
ds_write_b128 v5, a[116:119] offset:24576
ds_write_b128 v5, a[120:123] offset:27648
ds_write_b128 v5, a[124:127] offset:30720
ds_write_b128 v6, a[128:131] offset:1024
ds_write_b128 v6, a[132:135] offset:4096
ds_write_b128 v6, a[136:139] offset:7168
WL 0
s_barrier
RD v[16:19],v1,27648
RD v[20:23],v1,28672
RD v[24:27],v1,29696
RD v[32:35],v1,30720
RD v[36:39],v1,31744
RD v[40:43],v4,0
RD v[48:51],v4,1024
RD v[52:55],v4,2048
RD v[56:59],v4,3072
RD v[64:67],v4,4096
RD v[68:71],v4,5120
RD v[72:75],v4,6144
RD v[80:83],v4,7168
RD v[84:87],v4,8192
RD v[88:91],v4,9216
RD v[96:99],v4,10240
RD v[100:103],v4,11264
RD v[104:107],v4,12288
RD v[112:115],v4,13312
RD v[116:119],v4,14336
RD v[120:123],v4,15360
RD v[128:131],v4,16384
RD v[132:135],v4,17408
RD v[136:139],v4,18432
RD v[144:147],v4,19456
RD v[148:151],v4,20480
RD v[152:155],v4,21504
AR v28,a36
AR v29,a37
AR v30,a38
AR v31,a39
WL 15
v_pk_add_f32 v[20:21], v[20:21], v[24:25]
v_pk_add_f32 v[22:23], v[22:23], v[26:27]
v_pk_add_f32 v[28:29], v[28:29], v[16:17]
v_pk_add_f32 v[30:31], v[30:31], v[18:19]
v_pk_add_f32 v[28:29], v[28:29], v[20:21]
v_pk_add_f32 v[30:31], v[30:31], v[22:23]
CV v16,v28,v29
CV v17,v30,v31
s_add_u32 s25, s26, 28736
buffer_store_dwordx2 v[16:17], v2, s[16:19], s25 offen
AR v44,a40
AR v45,a41
AR v46,a42
AR v47,a43
v_pk_add_f32 v[36:37], v[36:37], v[40:41]
v_pk_add_f32 v[38:39], v[38:39], v[42:43]
v_pk_add_f32 v[44:45], v[44:45], v[32:33]
v_pk_add_f32 v[46:47], v[46:47], v[34:35]
v_pk_add_f32 v[44:45], v[44:45], v[36:37]
v_pk_add_f32 v[46:47], v[46:47], v[38:39]
CV v32,v44,v45
CV v33,v46,v47
s_add_u32 s25, s26, 28768
buffer_store_dwordx2 v[32:33], v2, s[16:19], s25 offen
AR v60,a44
AR v61,a45
AR v62,a46
AR v63,a47
v_pk_add_f32 v[52:53], v[52:53], v[56:57]
v_pk_add_f32 v[54:55], v[54:55], v[58:59]
v_pk_add_f32 v[60:61], v[60:61], v[48:49]
v_pk_add_f32 v[62:63], v[62:63], v[50:51]
v_pk_add_f32 v[60:61], v[60:61], v[52:53]
v_pk_add_f32 v[62:63], v[62:63], v[54:55]
CV v48,v60,v61
CV v49,v62,v63
s_add_u32 s25, s26, 28800
buffer_store_dwordx2 v[48:49], v2, s[16:19], s25 offen
AR v76,a48
AR v77,a49
AR v78,a50
AR v79,a51
v_pk_add_f32 v[68:69], v[68:69], v[72:73]
v_pk_add_f32 v[70:71], v[70:71], v[74:75]
v_pk_add_f32 v[76:77], v[76:77], v[64:65]
v_pk_add_f32 v[78:79], v[78:79], v[66:67]
v_pk_add_f32 v[76:77], v[76:77], v[68:69]
v_pk_add_f32 v[78:79], v[78:79], v[70:71]
CV v64,v76,v77
CV v65,v78,v79
s_add_u32 s25, s26, 28832
buffer_store_dwordx2 v[64:65], v2, s[16:19], s25 offen
AR v92,a52
AR v93,a53
AR v94,a54
AR v95,a55
WL 12
v_pk_add_f32 v[84:85], v[84:85], v[88:89]
v_pk_add_f32 v[86:87], v[86:87], v[90:91]
v_pk_add_f32 v[92:93], v[92:93], v[80:81]
v_pk_add_f32 v[94:95], v[94:95], v[82:83]
v_pk_add_f32 v[92:93], v[92:93], v[84:85]
v_pk_add_f32 v[94:95], v[94:95], v[86:87]
CV v80,v92,v93
CV v81,v94,v95
s_add_u32 s25, s26, 28864
buffer_store_dwordx2 v[80:81], v2, s[16:19], s25 offen
AR v108,a56
AR v109,a57
AR v110,a58
AR v111,a59
WL 9
v_pk_add_f32 v[100:101], v[100:101], v[104:105]
v_pk_add_f32 v[102:103], v[102:103], v[106:107]
v_pk_add_f32 v[108:109], v[108:109], v[96:97]
v_pk_add_f32 v[110:111], v[110:111], v[98:99]
v_pk_add_f32 v[108:109], v[108:109], v[100:101]
v_pk_add_f32 v[110:111], v[110:111], v[102:103]
CV v96,v108,v109
CV v97,v110,v111
s_add_u32 s25, s26, 57344
buffer_store_dwordx2 v[96:97], v2, s[16:19], s25 offen
AR v124,a60
AR v125,a61
AR v126,a62
AR v127,a63
WL 6
v_pk_add_f32 v[116:117], v[116:117], v[120:121]
v_pk_add_f32 v[118:119], v[118:119], v[122:123]
v_pk_add_f32 v[124:125], v[124:125], v[112:113]
v_pk_add_f32 v[126:127], v[126:127], v[114:115]
v_pk_add_f32 v[124:125], v[124:125], v[116:117]
v_pk_add_f32 v[126:127], v[126:127], v[118:119]
CV v112,v124,v125
CV v113,v126,v127
s_add_u32 s25, s26, 57376
buffer_store_dwordx2 v[112:113], v2, s[16:19], s25 offen
AR v140,a64
AR v141,a65
AR v142,a66
AR v143,a67
WL 3
v_pk_add_f32 v[132:133], v[132:133], v[136:137]
v_pk_add_f32 v[134:135], v[134:135], v[138:139]
v_pk_add_f32 v[140:141], v[140:141], v[128:129]
v_pk_add_f32 v[142:143], v[142:143], v[130:131]
v_pk_add_f32 v[140:141], v[140:141], v[132:133]
v_pk_add_f32 v[142:143], v[142:143], v[134:135]
CV v128,v140,v141
CV v129,v142,v143
s_add_u32 s25, s26, 57408
buffer_store_dwordx2 v[128:129], v2, s[16:19], s25 offen
AR v156,a68
AR v157,a69
AR v158,a70
AR v159,a71
WL 0
v_pk_add_f32 v[148:149], v[148:149], v[152:153]
v_pk_add_f32 v[150:151], v[150:151], v[154:155]
v_pk_add_f32 v[156:157], v[156:157], v[144:145]
v_pk_add_f32 v[158:159], v[158:159], v[146:147]
v_pk_add_f32 v[156:157], v[156:157], v[148:149]
v_pk_add_f32 v[158:159], v[158:159], v[150:151]
CV v144,v156,v157
CV v145,v158,v159
s_add_u32 s25, s26, 57440
buffer_store_dwordx2 v[144:145], v2, s[16:19], s25 offen
WV 0
s_endpgm
L2_r2_5:
v_add_u32 v4, 32768, v1
v_add_u32 v5, 65536, v1
v_add_u32 v6, 98304, v1
ds_write_b128 v1, a[0:3] offset:1024
ds_write_b128 v1, a[4:7] offset:4096
ds_write_b128 v1, a[8:11] offset:7168
ds_write_b128 v1, a[12:15] offset:10240
ds_write_b128 v1, a[16:19] offset:13312
ds_write_b128 v1, a[20:23] offset:16384
ds_write_b128 v1, a[24:27] offset:19456
ds_write_b128 v1, a[28:31] offset:22528
ds_write_b128 v1, a[32:35] offset:25600
ds_write_b128 v1, a[36:39] offset:28672
ds_write_b128 v1, a[40:43] offset:31744
ds_write_b128 v4, a[44:47] offset:2048
ds_write_b128 v4, a[48:51] offset:5120
ds_write_b128 v4, a[52:55] offset:8192
ds_write_b128 v4, a[56:59] offset:11264
ds_write_b128 v4, a[60:63] offset:14336
ds_write_b128 v4, a[64:67] offset:17408
ds_write_b128 v4, a[68:71] offset:20480
ds_write_b128 v5, a[108:111] offset:19456
ds_write_b128 v5, a[112:115] offset:22528
ds_write_b128 v5, a[116:119] offset:25600
ds_write_b128 v5, a[120:123] offset:28672
ds_write_b128 v5, a[124:127] offset:31744
ds_write_b128 v6, a[128:131] offset:2048
ds_write_b128 v6, a[132:135] offset:5120
ds_write_b128 v6, a[136:139] offset:8192
WL 0
s_barrier
RD v[16:19],v4,22528
RD v[20:23],v4,23552
RD v[24:27],v4,24576
RD v[32:35],v4,25600
RD v[36:39],v4,26624
RD v[40:43],v4,27648
RD v[48:51],v4,28672
RD v[52:55],v4,29696
RD v[56:59],v4,30720
RD v[64:67],v4,31744
RD v[68:71],v5,0
RD v[72:75],v5,1024
RD v[80:83],v5,2048
RD v[84:87],v5,3072
RD v[88:91],v5,4096
RD v[96:99],v5,5120
RD v[100:103],v5,6144
RD v[104:107],v5,7168
RD v[112:115],v5,8192
RD v[116:119],v5,9216
RD v[120:123],v5,10240
RD v[128:131],v5,11264
RD v[132:135],v5,12288
RD v[136:139],v5,13312
RD v[144:147],v5,14336
RD v[148:151],v5,15360
RD v[152:155],v5,16384
AR v28,a72
AR v29,a73
AR v30,a74
AR v31,a75
WL 15
v_pk_add_f32 v[20:21], v[20:21], v[24:25]
v_pk_add_f32 v[22:23], v[22:23], v[26:27]
v_pk_add_f32 v[28:29], v[28:29], v[16:17]
v_pk_add_f32 v[30:31], v[30:31], v[18:19]
v_pk_add_f32 v[28:29], v[28:29], v[20:21]
v_pk_add_f32 v[30:31], v[30:31], v[22:23]
CV v16,v28,v29
CV v17,v30,v31
s_add_u32 s25, s26, 57472
buffer_store_dwordx2 v[16:17], v2, s[16:19], s25 offen
AR v44,a76
AR v45,a77
AR v46,a78
AR v47,a79
v_pk_add_f32 v[36:37], v[36:37], v[40:41]
v_pk_add_f32 v[38:39], v[38:39], v[42:43]
v_pk_add_f32 v[44:45], v[44:45], v[32:33]
v_pk_add_f32 v[46:47], v[46:47], v[34:35]
v_pk_add_f32 v[44:45], v[44:45], v[36:37]
v_pk_add_f32 v[46:47], v[46:47], v[38:39]
CV v32,v44,v45
CV v33,v46,v47
s_add_u32 s25, s26, 57504
buffer_store_dwordx2 v[32:33], v2, s[16:19], s25 offen
AR v60,a80
AR v61,a81
AR v62,a82
AR v63,a83
v_pk_add_f32 v[52:53], v[52:53], v[56:57]
v_pk_add_f32 v[54:55], v[54:55], v[58:59]
v_pk_add_f32 v[60:61], v[60:61], v[48:49]
v_pk_add_f32 v[62:63], v[62:63], v[50:51]
v_pk_add_f32 v[60:61], v[60:61], v[52:53]
v_pk_add_f32 v[62:63], v[62:63], v[54:55]
CV v48,v60,v61
CV v49,v62,v63
s_add_u32 s25, s26, 57536
buffer_store_dwordx2 v[48:49], v2, s[16:19], s25 offen
AR v76,a84
AR v77,a85
AR v78,a86
AR v79,a87
v_pk_add_f32 v[68:69], v[68:69], v[72:73]
v_pk_add_f32 v[70:71], v[70:71], v[74:75]
v_pk_add_f32 v[76:77], v[76:77], v[64:65]
v_pk_add_f32 v[78:79], v[78:79], v[66:67]
v_pk_add_f32 v[76:77], v[76:77], v[68:69]
v_pk_add_f32 v[78:79], v[78:79], v[70:71]
CV v64,v76,v77
CV v65,v78,v79
s_add_u32 s25, s26, 86016
buffer_store_dwordx2 v[64:65], v2, s[16:19], s25 offen
AR v92,a88
AR v93,a89
AR v94,a90
AR v95,a91
WL 12
v_pk_add_f32 v[84:85], v[84:85], v[88:89]
v_pk_add_f32 v[86:87], v[86:87], v[90:91]
v_pk_add_f32 v[92:93], v[92:93], v[80:81]
v_pk_add_f32 v[94:95], v[94:95], v[82:83]
v_pk_add_f32 v[92:93], v[92:93], v[84:85]
v_pk_add_f32 v[94:95], v[94:95], v[86:87]
CV v80,v92,v93
CV v81,v94,v95
s_add_u32 s25, s26, 86048
buffer_store_dwordx2 v[80:81], v2, s[16:19], s25 offen
AR v108,a92
AR v109,a93
AR v110,a94
AR v111,a95
WL 9
v_pk_add_f32 v[100:101], v[100:101], v[104:105]
v_pk_add_f32 v[102:103], v[102:103], v[106:107]
v_pk_add_f32 v[108:109], v[108:109], v[96:97]
v_pk_add_f32 v[110:111], v[110:111], v[98:99]
v_pk_add_f32 v[108:109], v[108:109], v[100:101]
v_pk_add_f32 v[110:111], v[110:111], v[102:103]
CV v96,v108,v109
CV v97,v110,v111
s_add_u32 s25, s26, 86080
buffer_store_dwordx2 v[96:97], v2, s[16:19], s25 offen
AR v124,a96
AR v125,a97
AR v126,a98
AR v127,a99
WL 6
v_pk_add_f32 v[116:117], v[116:117], v[120:121]
v_pk_add_f32 v[118:119], v[118:119], v[122:123]
v_pk_add_f32 v[124:125], v[124:125], v[112:113]
v_pk_add_f32 v[126:127], v[126:127], v[114:115]
v_pk_add_f32 v[124:125], v[124:125], v[116:117]
v_pk_add_f32 v[126:127], v[126:127], v[118:119]
CV v112,v124,v125
CV v113,v126,v127
s_add_u32 s25, s26, 86112
buffer_store_dwordx2 v[112:113], v2, s[16:19], s25 offen
AR v140,a100
AR v141,a101
AR v142,a102
AR v143,a103
WL 3
v_pk_add_f32 v[132:133], v[132:133], v[136:137]
v_pk_add_f32 v[134:135], v[134:135], v[138:139]
v_pk_add_f32 v[140:141], v[140:141], v[128:129]
v_pk_add_f32 v[142:143], v[142:143], v[130:131]
v_pk_add_f32 v[140:141], v[140:141], v[132:133]
v_pk_add_f32 v[142:143], v[142:143], v[134:135]
CV v128,v140,v141
CV v129,v142,v143
s_add_u32 s25, s26, 86144
buffer_store_dwordx2 v[128:129], v2, s[16:19], s25 offen
AR v156,a104
AR v157,a105
AR v158,a106
AR v159,a107
WL 0
v_pk_add_f32 v[148:149], v[148:149], v[152:153]
v_pk_add_f32 v[150:151], v[150:151], v[154:155]
v_pk_add_f32 v[156:157], v[156:157], v[144:145]
v_pk_add_f32 v[158:159], v[158:159], v[146:147]
v_pk_add_f32 v[156:157], v[156:157], v[148:149]
v_pk_add_f32 v[158:159], v[158:159], v[150:151]
CV v144,v156,v157
CV v145,v158,v159
s_add_u32 s25, s26, 86176
buffer_store_dwordx2 v[144:145], v2, s[16:19], s25 offen
WV 0
s_endpgm
L2_r3_5:
v_add_u32 v4, 32768, v1
v_add_u32 v5, 65536, v1
v_add_u32 v6, 98304, v1
ds_write_b128 v1, a[0:3] offset:2048
ds_write_b128 v1, a[4:7] offset:5120
ds_write_b128 v1, a[8:11] offset:8192
ds_write_b128 v1, a[12:15] offset:11264
ds_write_b128 v1, a[16:19] offset:14336
ds_write_b128 v1, a[20:23] offset:17408
ds_write_b128 v1, a[24:27] offset:20480
ds_write_b128 v1, a[28:31] offset:23552
ds_write_b128 v1, a[32:35] offset:26624
ds_write_b128 v1, a[36:39] offset:29696
ds_write_b128 v4, a[40:43] offset:0
ds_write_b128 v4, a[44:47] offset:3072
ds_write_b128 v4, a[48:51] offset:6144
ds_write_b128 v4, a[52:55] offset:9216
ds_write_b128 v4, a[56:59] offset:12288
ds_write_b128 v4, a[60:63] offset:15360
ds_write_b128 v4, a[64:67] offset:18432
ds_write_b128 v4, a[68:71] offset:21504
ds_write_b128 v4, a[72:75] offset:24576
ds_write_b128 v4, a[76:79] offset:27648
ds_write_b128 v4, a[80:83] offset:30720
ds_write_b128 v5, a[84:87] offset:1024
ds_write_b128 v5, a[88:91] offset:4096
ds_write_b128 v5, a[92:95] offset:7168
ds_write_b128 v5, a[96:99] offset:10240
ds_write_b128 v5, a[100:103] offset:13312
ds_write_b128 v5, a[104:107] offset:16384
WL 0
s_barrier
RD v[16:19],v5,17408
RD v[20:23],v5,18432
RD v[24:27],v5,19456
RD v[32:35],v5,20480
RD v[36:39],v5,21504
RD v[40:43],v5,22528
RD v[48:51],v5,23552
RD v[52:55],v5,24576
RD v[56:59],v5,25600
RD v[64:67],v5,26624
RD v[68:71],v5,27648
RD v[72:75],v5,28672
RD v[80:83],v5,29696
RD v[84:87],v5,30720
RD v[88:91],v5,31744
RD v[96:99],v6,0
RD v[100:103],v6,1024
RD v[104:107],v6,2048
RD v[112:115],v6,3072
RD v[116:119],v6,4096
RD v[120:123],v6,5120
RD v[128:131],v6,6144
RD v[132:135],v6,7168
RD v[136:139],v6,8192
AR v28,a108
AR v29,a109
AR v30,a110
AR v31,a111
WL 15
v_pk_add_f32 v[20:21], v[20:21], v[24:25]
v_pk_add_f32 v[22:23], v[22:23], v[26:27]
v_pk_add_f32 v[28:29], v[28:29], v[16:17]
v_pk_add_f32 v[30:31], v[30:31], v[18:19]
v_pk_add_f32 v[28:29], v[28:29], v[20:21]
v_pk_add_f32 v[30:31], v[30:31], v[22:23]
CV v16,v28,v29
CV v17,v30,v31
s_add_u32 s25, s26, 86208
buffer_store_dwordx2 v[16:17], v2, s[16:19], s25 offen
AR v44,a112
AR v45,a113
AR v46,a114
AR v47,a115
v_pk_add_f32 v[36:37], v[36:37], v[40:41]
v_pk_add_f32 v[38:39], v[38:39], v[42:43]
v_pk_add_f32 v[44:45], v[44:45], v[32:33]
v_pk_add_f32 v[46:47], v[46:47], v[34:35]
v_pk_add_f32 v[44:45], v[44:45], v[36:37]
v_pk_add_f32 v[46:47], v[46:47], v[38:39]
CV v32,v44,v45
CV v33,v46,v47
s_add_u32 s25, s26, 114688
buffer_store_dwordx2 v[32:33], v2, s[16:19], s25 offen
AR v60,a116
AR v61,a117
AR v62,a118
AR v63,a119
v_pk_add_f32 v[52:53], v[52:53], v[56:57]
v_pk_add_f32 v[54:55], v[54:55], v[58:59]
v_pk_add_f32 v[60:61], v[60:61], v[48:49]
v_pk_add_f32 v[62:63], v[62:63], v[50:51]
v_pk_add_f32 v[60:61], v[60:61], v[52:53]
v_pk_add_f32 v[62:63], v[62:63], v[54:55]
CV v48,v60,v61
CV v49,v62,v63
s_add_u32 s25, s26, 114720
buffer_store_dwordx2 v[48:49], v2, s[16:19], s25 offen
AR v76,a120
AR v77,a121
AR v78,a122
AR v79,a123
WL 12
v_pk_add_f32 v[68:69], v[68:69], v[72:73]
v_pk_add_f32 v[70:71], v[70:71], v[74:75]
v_pk_add_f32 v[76:77], v[76:77], v[64:65]
v_pk_add_f32 v[78:79], v[78:79], v[66:67]
v_pk_add_f32 v[76:77], v[76:77], v[68:69]
v_pk_add_f32 v[78:79], v[78:79], v[70:71]
CV v64,v76,v77
CV v65,v78,v79
s_add_u32 s25, s26, 114752
buffer_store_dwordx2 v[64:65], v2, s[16:19], s25 offen
AR v92,a124
AR v93,a125
AR v94,a126
AR v95,a127
WL 9
v_pk_add_f32 v[84:85], v[84:85], v[88:89]
v_pk_add_f32 v[86:87], v[86:87], v[90:91]
v_pk_add_f32 v[92:93], v[92:93], v[80:81]
v_pk_add_f32 v[94:95], v[94:95], v[82:83]
v_pk_add_f32 v[92:93], v[92:93], v[84:85]
v_pk_add_f32 v[94:95], v[94:95], v[86:87]
CV v80,v92,v93
CV v81,v94,v95
s_add_u32 s25, s26, 114784
buffer_store_dwordx2 v[80:81], v2, s[16:19], s25 offen
AR v108,a128
AR v109,a129
AR v110,a130
AR v111,a131
WL 6
v_pk_add_f32 v[100:101], v[100:101], v[104:105]
v_pk_add_f32 v[102:103], v[102:103], v[106:107]
v_pk_add_f32 v[108:109], v[108:109], v[96:97]
v_pk_add_f32 v[110:111], v[110:111], v[98:99]
v_pk_add_f32 v[108:109], v[108:109], v[100:101]
v_pk_add_f32 v[110:111], v[110:111], v[102:103]
CV v96,v108,v109
CV v97,v110,v111
s_add_u32 s25, s26, 114816
buffer_store_dwordx2 v[96:97], v2, s[16:19], s25 offen
AR v124,a132
AR v125,a133
AR v126,a134
AR v127,a135
WL 3
v_pk_add_f32 v[116:117], v[116:117], v[120:121]
v_pk_add_f32 v[118:119], v[118:119], v[122:123]
v_pk_add_f32 v[124:125], v[124:125], v[112:113]
v_pk_add_f32 v[126:127], v[126:127], v[114:115]
v_pk_add_f32 v[124:125], v[124:125], v[116:117]
v_pk_add_f32 v[126:127], v[126:127], v[118:119]
CV v112,v124,v125
CV v113,v126,v127
s_add_u32 s25, s26, 114848
buffer_store_dwordx2 v[112:113], v2, s[16:19], s25 offen
AR v140,a136
AR v141,a137
AR v142,a138
AR v143,a139
WL 0
v_pk_add_f32 v[132:133], v[132:133], v[136:137]
v_pk_add_f32 v[134:135], v[134:135], v[138:139]
v_pk_add_f32 v[140:141], v[140:141], v[128:129]
v_pk_add_f32 v[142:143], v[142:143], v[130:131]
v_pk_add_f32 v[140:141], v[140:141], v[132:133]
v_pk_add_f32 v[142:143], v[142:143], v[134:135]
CV v128,v140,v141
CV v129,v142,v143
s_add_u32 s25, s26, 114880
buffer_store_dwordx2 v[128:129], v2, s[16:19], s25 offen
WV 0
s_endpgm
L2_v4:
buffer_load_dwordx4 v[44:47], v1, s[12:15], s22 offen offset:0 sc1
buffer_load_dwordx4 v[48:51], v1, s[12:15], s22 offen offset:1024 sc1
buffer_load_dwordx4 v[52:55], v1, s[12:15], s22 offen offset:2048 sc1
buffer_load_dwordx4 v[56:59], v1, s[12:15], s22 offen offset:3072 sc1
s_add_u32 s22, s22, 5120
s_add_u32 s23, s23, 5120
buffer_load_dwordx4 v[92:95], v1, s[12:15], s22 offen offset:0 sc1
buffer_load_dwordx4 v[96:99], v1, s[12:15], s22 offen offset:1024 sc1
buffer_load_dwordx4 v[100:103], v1, s[12:15], s22 offen offset:2048 sc1
buffer_load_dwordx4 v[104:107], v1, s[12:15], s22 offen offset:3072 sc1
s_add_u32 s22, s22, 5120
s_add_u32 s23, s23, 5120
buffer_load_dwordx4 v[140:143], v1, s[12:15], s22 offen offset:0 sc1
buffer_load_dwordx4 v[144:147], v1, s[12:15], s22 offen offset:1024 sc1
buffer_load_dwordx4 v[148:151], v1, s[12:15], s22 offen offset:2048 sc1
buffer_load_dwordx4 v[152:155], v1, s[12:15], s22 offen offset:3072 sc1
s_add_u32 s22, s22, 5120
s_add_u32 s23, s23, 5120
WV 11
M a[0:3],v[16:19],v[44:47],0
WV 10
buffer_load_dwordx4 v[160:163], v1, s[8:11], s20 offen offset:0 sc1
M a[28:31],v[16:19],v[48:51],0
WV 10
M a[56:59],v[16:19],v[52:55],0
WV 9
buffer_load_dwordx4 v[188:191], v1, s[12:15], s22 offen offset:0 sc1
M a[84:87],v[16:19],v[56:59],0
M a[4:7],v[20:23],v[44:47],0
buffer_load_dwordx4 v[192:195], v1, s[12:15], s22 offen offset:1024 sc1
M a[32:35],v[20:23],v[48:51],0
M a[60:63],v[20:23],v[52:55],0
buffer_load_dwordx4 v[196:199], v1, s[12:15], s22 offen offset:2048 sc1
M a[88:91],v[20:23],v[56:59],0
M a[8:11],v[24:27],v[44:47],0
buffer_load_dwordx4 v[200:203], v1, s[12:15], s22 offen offset:3072 sc1
M a[36:39],v[24:27],v[48:51],0
M a[64:67],v[24:27],v[52:55],0
buffer_load_dwordx4 v[164:167], v1, s[8:11], s20 offen offset:1024 sc1
M a[92:95],v[24:27],v[56:59],0
M a[12:15],v[28:31],v[44:47],0
buffer_load_dwordx4 v[168:171], v1, s[8:11], s20 offen offset:2048 sc1
M a[40:43],v[28:31],v[48:51],0
M a[68:71],v[28:31],v[52:55],0
buffer_load_dwordx4 v[172:175], v1, s[8:11], s20 offen offset:3072 sc1
M a[96:99],v[28:31],v[56:59],0
M a[16:19],v[32:35],v[44:47],0
buffer_load_dwordx4 v[176:179], v1, s[8:11], s21 offen offset:0 sc1
M a[44:47],v[32:35],v[48:51],0
M a[72:75],v[32:35],v[52:55],0
buffer_load_dwordx4 v[180:183], v1, s[8:11], s21 offen offset:1024 sc1
M a[100:103],v[32:35],v[56:59],0
M a[20:23],v[36:39],v[44:47],0
buffer_load_dwordx4 v[184:187], v1, s[8:11], s21 offen offset:2048 sc1
M a[48:51],v[36:39],v[48:51],0
M a[76:79],v[36:39],v[52:55],0
M a[104:107],v[36:39],v[56:59],0
M a[24:27],v[40:43],v[44:47],0
M a[52:55],v[40:43],v[48:51],0
M a[80:83],v[40:43],v[52:55],0
M a[108:111],v[40:43],v[56:59],0
WV 18
s_add_u32 s20, s20, 7168
s_add_u32 s21, s21, 7168
s_add_u32 s22, s22, 5120
s_add_u32 s23, s23, 5120
M a[0:3],v[64:67],v[92:95],a[0:3]
WV 17
buffer_load_dwordx4 v[16:19], v1, s[8:11], s20 offen offset:0 sc1
M a[28:31],v[64:67],v[96:99],a[28:31]
WV 17
M a[56:59],v[64:67],v[100:103],a[56:59]
WV 16
buffer_load_dwordx4 v[44:47], v1, s[12:15], s22 offen offset:0 sc1
M a[84:87],v[64:67],v[104:107],a[84:87]
M a[4:7],v[68:71],v[92:95],a[4:7]
buffer_load_dwordx4 v[48:51], v1, s[12:15], s22 offen offset:1024 sc1
M a[32:35],v[68:71],v[96:99],a[32:35]
M a[60:63],v[68:71],v[100:103],a[60:63]
buffer_load_dwordx4 v[52:55], v1, s[12:15], s22 offen offset:2048 sc1
M a[88:91],v[68:71],v[104:107],a[88:91]
M a[8:11],v[72:75],v[92:95],a[8:11]
buffer_load_dwordx4 v[56:59], v1, s[12:15], s22 offen offset:3072 sc1
M a[36:39],v[72:75],v[96:99],a[36:39]
M a[64:67],v[72:75],v[100:103],a[64:67]
buffer_load_dwordx4 v[20:23], v1, s[8:11], s20 offen offset:1024 sc1
M a[92:95],v[72:75],v[104:107],a[92:95]
M a[12:15],v[76:79],v[92:95],a[12:15]
buffer_load_dwordx4 v[24:27], v1, s[8:11], s20 offen offset:2048 sc1
M a[40:43],v[76:79],v[96:99],a[40:43]
M a[68:71],v[76:79],v[100:103],a[68:71]
buffer_load_dwordx4 v[28:31], v1, s[8:11], s20 offen offset:3072 sc1
M a[96:99],v[76:79],v[104:107],a[96:99]
M a[16:19],v[80:83],v[92:95],a[16:19]
buffer_load_dwordx4 v[32:35], v1, s[8:11], s21 offen offset:0 sc1
M a[44:47],v[80:83],v[96:99],a[44:47]
M a[72:75],v[80:83],v[100:103],a[72:75]
buffer_load_dwordx4 v[36:39], v1, s[8:11], s21 offen offset:1024 sc1
M a[100:103],v[80:83],v[104:107],a[100:103]
M a[20:23],v[84:87],v[92:95],a[20:23]
buffer_load_dwordx4 v[40:43], v1, s[8:11], s21 offen offset:2048 sc1
M a[48:51],v[84:87],v[96:99],a[48:51]
M a[76:79],v[84:87],v[100:103],a[76:79]
M a[104:107],v[84:87],v[104:107],a[104:107]
M a[24:27],v[88:91],v[92:95],a[24:27]
M a[52:55],v[88:91],v[96:99],a[52:55]
M a[80:83],v[88:91],v[100:103],a[80:83]
M a[108:111],v[88:91],v[104:107],a[108:111]
WV 25
s_add_u32 s20, s20, 7168
s_add_u32 s21, s21, 7168
s_add_u32 s22, s22, 5120
s_add_u32 s23, s23, 5120
M a[0:3],v[112:115],v[140:143],a[0:3]
WV 24
buffer_load_dwordx4 v[64:67], v1, s[8:11], s20 offen offset:0 sc1
M a[28:31],v[112:115],v[144:147],a[28:31]
WV 24
M a[56:59],v[112:115],v[148:151],a[56:59]
WV 23
buffer_load_dwordx4 v[92:95], v1, s[12:15], s22 offen offset:0 sc1
M a[84:87],v[112:115],v[152:155],a[84:87]
M a[4:7],v[116:119],v[140:143],a[4:7]
buffer_load_dwordx4 v[96:99], v1, s[12:15], s22 offen offset:1024 sc1
M a[32:35],v[116:119],v[144:147],a[32:35]
M a[60:63],v[116:119],v[148:151],a[60:63]
buffer_load_dwordx4 v[100:103], v1, s[12:15], s22 offen offset:2048 sc1
M a[88:91],v[116:119],v[152:155],a[88:91]
M a[8:11],v[120:123],v[140:143],a[8:11]
buffer_load_dwordx4 v[104:107], v1, s[12:15], s22 offen offset:3072 sc1
M a[36:39],v[120:123],v[144:147],a[36:39]
M a[64:67],v[120:123],v[148:151],a[64:67]
buffer_load_dwordx4 v[68:71], v1, s[8:11], s20 offen offset:1024 sc1
M a[92:95],v[120:123],v[152:155],a[92:95]
M a[12:15],v[124:127],v[140:143],a[12:15]
buffer_load_dwordx4 v[72:75], v1, s[8:11], s20 offen offset:2048 sc1
M a[40:43],v[124:127],v[144:147],a[40:43]
M a[68:71],v[124:127],v[148:151],a[68:71]
buffer_load_dwordx4 v[76:79], v1, s[8:11], s20 offen offset:3072 sc1
M a[96:99],v[124:127],v[152:155],a[96:99]
M a[16:19],v[128:131],v[140:143],a[16:19]
buffer_load_dwordx4 v[80:83], v1, s[8:11], s21 offen offset:0 sc1
M a[44:47],v[128:131],v[144:147],a[44:47]
M a[72:75],v[128:131],v[148:151],a[72:75]
buffer_load_dwordx4 v[84:87], v1, s[8:11], s21 offen offset:1024 sc1
M a[100:103],v[128:131],v[152:155],a[100:103]
M a[20:23],v[132:135],v[140:143],a[20:23]
buffer_load_dwordx4 v[88:91], v1, s[8:11], s21 offen offset:2048 sc1
M a[48:51],v[132:135],v[144:147],a[48:51]
M a[76:79],v[132:135],v[148:151],a[76:79]
M a[104:107],v[132:135],v[152:155],a[104:107]
M a[24:27],v[136:139],v[140:143],a[24:27]
M a[52:55],v[136:139],v[144:147],a[52:55]
M a[80:83],v[136:139],v[148:151],a[80:83]
M a[108:111],v[136:139],v[152:155],a[108:111]
WV 31
s_add_u32 s20, s20, 7168
s_add_u32 s21, s21, 7168
s_add_u32 s22, s22, 5120
s_add_u32 s23, s23, 5120
M a[0:3],v[160:163],v[188:191],a[0:3]
WV 30
buffer_load_dwordx4 v[112:115], v1, s[8:11], s20 offen offset:0 sc1
M a[28:31],v[160:163],v[192:195],a[28:31]
WV 30
M a[56:59],v[160:163],v[196:199],a[56:59]
WV 29
buffer_load_dwordx4 v[140:143], v1, s[12:15], s22 offen offset:0 sc1
M a[84:87],v[160:163],v[200:203],a[84:87]
WV 29
M a[4:7],v[164:167],v[188:191],a[4:7]
buffer_load_dwordx4 v[144:147], v1, s[12:15], s22 offen offset:1024 sc1
M a[32:35],v[164:167],v[192:195],a[32:35]
M a[60:63],v[164:167],v[196:199],a[60:63]
buffer_load_dwordx4 v[148:151], v1, s[12:15], s22 offen offset:2048 sc1
M a[88:91],v[164:167],v[200:203],a[88:91]
WV 30
M a[8:11],v[168:171],v[188:191],a[8:11]
buffer_load_dwordx4 v[152:155], v1, s[12:15], s22 offen offset:3072 sc1
M a[36:39],v[168:171],v[192:195],a[36:39]
M a[64:67],v[168:171],v[196:199],a[64:67]
buffer_load_dwordx4 v[116:119], v1, s[8:11], s20 offen offset:1024 sc1
M a[92:95],v[168:171],v[200:203],a[92:95]
WV 31
M a[12:15],v[172:175],v[188:191],a[12:15]
buffer_load_dwordx4 v[120:123], v1, s[8:11], s20 offen offset:2048 sc1
M a[40:43],v[172:175],v[192:195],a[40:43]
M a[68:71],v[172:175],v[196:199],a[68:71]
buffer_load_dwordx4 v[124:127], v1, s[8:11], s20 offen offset:3072 sc1
M a[96:99],v[172:175],v[200:203],a[96:99]
WV 32
M a[16:19],v[176:179],v[188:191],a[16:19]
buffer_load_dwordx4 v[128:131], v1, s[8:11], s21 offen offset:0 sc1
M a[44:47],v[176:179],v[192:195],a[44:47]
M a[72:75],v[176:179],v[196:199],a[72:75]
buffer_load_dwordx4 v[132:135], v1, s[8:11], s21 offen offset:1024 sc1
M a[100:103],v[176:179],v[200:203],a[100:103]
WV 33
M a[20:23],v[180:183],v[188:191],a[20:23]
buffer_load_dwordx4 v[136:139], v1, s[8:11], s21 offen offset:2048 sc1
M a[48:51],v[180:183],v[192:195],a[48:51]
M a[76:79],v[180:183],v[196:199],a[76:79]
M a[104:107],v[180:183],v[200:203],a[104:107]
WV 33
M a[24:27],v[184:187],v[188:191],a[24:27]
M a[52:55],v[184:187],v[192:195],a[52:55]
M a[80:83],v[184:187],v[196:199],a[80:83]
M a[108:111],v[184:187],v[200:203],a[108:111]
s_add_u32 s20, s20, 7168
s_add_u32 s21, s21, 7168
s_add_u32 s22, s22, 5120
s_add_u32 s23, s23, 5120
s_mov_b32 s24, 7
L2_loop_4:
WV 31
M a[0:3],v[16:19],v[44:47],a[0:3]
WV 30
buffer_load_dwordx4 v[160:163], v1, s[8:11], s20 offen offset:0 sc1
M a[28:31],v[16:19],v[48:51],a[28:31]
WV 30
M a[56:59],v[16:19],v[52:55],a[56:59]
WV 29
buffer_load_dwordx4 v[188:191], v1, s[12:15], s22 offen offset:0 sc1
M a[84:87],v[16:19],v[56:59],a[84:87]
WV 29
M a[4:7],v[20:23],v[44:47],a[4:7]
buffer_load_dwordx4 v[192:195], v1, s[12:15], s22 offen offset:1024 sc1
M a[32:35],v[20:23],v[48:51],a[32:35]
M a[60:63],v[20:23],v[52:55],a[60:63]
buffer_load_dwordx4 v[196:199], v1, s[12:15], s22 offen offset:2048 sc1
M a[88:91],v[20:23],v[56:59],a[88:91]
WV 30
M a[8:11],v[24:27],v[44:47],a[8:11]
buffer_load_dwordx4 v[200:203], v1, s[12:15], s22 offen offset:3072 sc1
M a[36:39],v[24:27],v[48:51],a[36:39]
M a[64:67],v[24:27],v[52:55],a[64:67]
buffer_load_dwordx4 v[164:167], v1, s[8:11], s20 offen offset:1024 sc1
M a[92:95],v[24:27],v[56:59],a[92:95]
WV 31
M a[12:15],v[28:31],v[44:47],a[12:15]
buffer_load_dwordx4 v[168:171], v1, s[8:11], s20 offen offset:2048 sc1
M a[40:43],v[28:31],v[48:51],a[40:43]
M a[68:71],v[28:31],v[52:55],a[68:71]
buffer_load_dwordx4 v[172:175], v1, s[8:11], s20 offen offset:3072 sc1
M a[96:99],v[28:31],v[56:59],a[96:99]
WV 32
M a[16:19],v[32:35],v[44:47],a[16:19]
buffer_load_dwordx4 v[176:179], v1, s[8:11], s21 offen offset:0 sc1
M a[44:47],v[32:35],v[48:51],a[44:47]
M a[72:75],v[32:35],v[52:55],a[72:75]
buffer_load_dwordx4 v[180:183], v1, s[8:11], s21 offen offset:1024 sc1
M a[100:103],v[32:35],v[56:59],a[100:103]
WV 33
M a[20:23],v[36:39],v[44:47],a[20:23]
buffer_load_dwordx4 v[184:187], v1, s[8:11], s21 offen offset:2048 sc1
M a[48:51],v[36:39],v[48:51],a[48:51]
M a[76:79],v[36:39],v[52:55],a[76:79]
M a[104:107],v[36:39],v[56:59],a[104:107]
WV 33
M a[24:27],v[40:43],v[44:47],a[24:27]
M a[52:55],v[40:43],v[48:51],a[52:55]
M a[80:83],v[40:43],v[52:55],a[80:83]
M a[108:111],v[40:43],v[56:59],a[108:111]
WV 31
s_add_u32 s20, s20, 7168
s_add_u32 s21, s21, 7168
s_add_u32 s22, s22, 5120
s_add_u32 s23, s23, 5120
M a[0:3],v[64:67],v[92:95],a[0:3]
WV 30
buffer_load_dwordx4 v[16:19], v1, s[8:11], s20 offen offset:0 sc1
M a[28:31],v[64:67],v[96:99],a[28:31]
WV 30
M a[56:59],v[64:67],v[100:103],a[56:59]
WV 29
buffer_load_dwordx4 v[44:47], v1, s[12:15], s22 offen offset:0 sc1
M a[84:87],v[64:67],v[104:107],a[84:87]
WV 29
M a[4:7],v[68:71],v[92:95],a[4:7]
buffer_load_dwordx4 v[48:51], v1, s[12:15], s22 offen offset:1024 sc1
M a[32:35],v[68:71],v[96:99],a[32:35]
M a[60:63],v[68:71],v[100:103],a[60:63]
buffer_load_dwordx4 v[52:55], v1, s[12:15], s22 offen offset:2048 sc1
M a[88:91],v[68:71],v[104:107],a[88:91]
WV 30
M a[8:11],v[72:75],v[92:95],a[8:11]
buffer_load_dwordx4 v[56:59], v1, s[12:15], s22 offen offset:3072 sc1
M a[36:39],v[72:75],v[96:99],a[36:39]
M a[64:67],v[72:75],v[100:103],a[64:67]
buffer_load_dwordx4 v[20:23], v1, s[8:11], s20 offen offset:1024 sc1
M a[92:95],v[72:75],v[104:107],a[92:95]
WV 31
M a[12:15],v[76:79],v[92:95],a[12:15]
buffer_load_dwordx4 v[24:27], v1, s[8:11], s20 offen offset:2048 sc1
M a[40:43],v[76:79],v[96:99],a[40:43]
M a[68:71],v[76:79],v[100:103],a[68:71]
buffer_load_dwordx4 v[28:31], v1, s[8:11], s20 offen offset:3072 sc1
M a[96:99],v[76:79],v[104:107],a[96:99]
WV 32
M a[16:19],v[80:83],v[92:95],a[16:19]
buffer_load_dwordx4 v[32:35], v1, s[8:11], s21 offen offset:0 sc1
M a[44:47],v[80:83],v[96:99],a[44:47]
M a[72:75],v[80:83],v[100:103],a[72:75]
buffer_load_dwordx4 v[36:39], v1, s[8:11], s21 offen offset:1024 sc1
M a[100:103],v[80:83],v[104:107],a[100:103]
WV 33
M a[20:23],v[84:87],v[92:95],a[20:23]
buffer_load_dwordx4 v[40:43], v1, s[8:11], s21 offen offset:2048 sc1
M a[48:51],v[84:87],v[96:99],a[48:51]
M a[76:79],v[84:87],v[100:103],a[76:79]
M a[104:107],v[84:87],v[104:107],a[104:107]
WV 33
M a[24:27],v[88:91],v[92:95],a[24:27]
M a[52:55],v[88:91],v[96:99],a[52:55]
M a[80:83],v[88:91],v[100:103],a[80:83]
M a[108:111],v[88:91],v[104:107],a[108:111]
WV 31
s_add_u32 s20, s20, 7168
s_add_u32 s21, s21, 7168
s_add_u32 s22, s22, 5120
s_add_u32 s23, s23, 5120
M a[0:3],v[112:115],v[140:143],a[0:3]
WV 30
buffer_load_dwordx4 v[64:67], v1, s[8:11], s20 offen offset:0 sc1
M a[28:31],v[112:115],v[144:147],a[28:31]
WV 30
M a[56:59],v[112:115],v[148:151],a[56:59]
WV 29
buffer_load_dwordx4 v[92:95], v1, s[12:15], s22 offen offset:0 sc1
M a[84:87],v[112:115],v[152:155],a[84:87]
WV 29
M a[4:7],v[116:119],v[140:143],a[4:7]
buffer_load_dwordx4 v[96:99], v1, s[12:15], s22 offen offset:1024 sc1
M a[32:35],v[116:119],v[144:147],a[32:35]
M a[60:63],v[116:119],v[148:151],a[60:63]
buffer_load_dwordx4 v[100:103], v1, s[12:15], s22 offen offset:2048 sc1
M a[88:91],v[116:119],v[152:155],a[88:91]
WV 30
M a[8:11],v[120:123],v[140:143],a[8:11]
buffer_load_dwordx4 v[104:107], v1, s[12:15], s22 offen offset:3072 sc1
M a[36:39],v[120:123],v[144:147],a[36:39]
M a[64:67],v[120:123],v[148:151],a[64:67]
buffer_load_dwordx4 v[68:71], v1, s[8:11], s20 offen offset:1024 sc1
M a[92:95],v[120:123],v[152:155],a[92:95]
WV 31
M a[12:15],v[124:127],v[140:143],a[12:15]
buffer_load_dwordx4 v[72:75], v1, s[8:11], s20 offen offset:2048 sc1
M a[40:43],v[124:127],v[144:147],a[40:43]
M a[68:71],v[124:127],v[148:151],a[68:71]
buffer_load_dwordx4 v[76:79], v1, s[8:11], s20 offen offset:3072 sc1
M a[96:99],v[124:127],v[152:155],a[96:99]
WV 32
M a[16:19],v[128:131],v[140:143],a[16:19]
buffer_load_dwordx4 v[80:83], v1, s[8:11], s21 offen offset:0 sc1
M a[44:47],v[128:131],v[144:147],a[44:47]
M a[72:75],v[128:131],v[148:151],a[72:75]
buffer_load_dwordx4 v[84:87], v1, s[8:11], s21 offen offset:1024 sc1
M a[100:103],v[128:131],v[152:155],a[100:103]
WV 33
M a[20:23],v[132:135],v[140:143],a[20:23]
buffer_load_dwordx4 v[88:91], v1, s[8:11], s21 offen offset:2048 sc1
M a[48:51],v[132:135],v[144:147],a[48:51]
M a[76:79],v[132:135],v[148:151],a[76:79]
M a[104:107],v[132:135],v[152:155],a[104:107]
WV 33
M a[24:27],v[136:139],v[140:143],a[24:27]
M a[52:55],v[136:139],v[144:147],a[52:55]
M a[80:83],v[136:139],v[148:151],a[80:83]
M a[108:111],v[136:139],v[152:155],a[108:111]
WV 31
s_add_u32 s20, s20, 7168
s_add_u32 s21, s21, 7168
s_add_u32 s22, s22, 5120
s_add_u32 s23, s23, 5120
M a[0:3],v[160:163],v[188:191],a[0:3]
WV 30
buffer_load_dwordx4 v[112:115], v1, s[8:11], s20 offen offset:0 sc1
M a[28:31],v[160:163],v[192:195],a[28:31]
WV 30
M a[56:59],v[160:163],v[196:199],a[56:59]
WV 29
buffer_load_dwordx4 v[140:143], v1, s[12:15], s22 offen offset:0 sc1
M a[84:87],v[160:163],v[200:203],a[84:87]
WV 29
M a[4:7],v[164:167],v[188:191],a[4:7]
buffer_load_dwordx4 v[144:147], v1, s[12:15], s22 offen offset:1024 sc1
M a[32:35],v[164:167],v[192:195],a[32:35]
M a[60:63],v[164:167],v[196:199],a[60:63]
buffer_load_dwordx4 v[148:151], v1, s[12:15], s22 offen offset:2048 sc1
M a[88:91],v[164:167],v[200:203],a[88:91]
WV 30
M a[8:11],v[168:171],v[188:191],a[8:11]
buffer_load_dwordx4 v[152:155], v1, s[12:15], s22 offen offset:3072 sc1
M a[36:39],v[168:171],v[192:195],a[36:39]
M a[64:67],v[168:171],v[196:199],a[64:67]
buffer_load_dwordx4 v[116:119], v1, s[8:11], s20 offen offset:1024 sc1
M a[92:95],v[168:171],v[200:203],a[92:95]
WV 31
M a[12:15],v[172:175],v[188:191],a[12:15]
buffer_load_dwordx4 v[120:123], v1, s[8:11], s20 offen offset:2048 sc1
M a[40:43],v[172:175],v[192:195],a[40:43]
M a[68:71],v[172:175],v[196:199],a[68:71]
buffer_load_dwordx4 v[124:127], v1, s[8:11], s20 offen offset:3072 sc1
M a[96:99],v[172:175],v[200:203],a[96:99]
WV 32
M a[16:19],v[176:179],v[188:191],a[16:19]
buffer_load_dwordx4 v[128:131], v1, s[8:11], s21 offen offset:0 sc1
M a[44:47],v[176:179],v[192:195],a[44:47]
M a[72:75],v[176:179],v[196:199],a[72:75]
buffer_load_dwordx4 v[132:135], v1, s[8:11], s21 offen offset:1024 sc1
M a[100:103],v[176:179],v[200:203],a[100:103]
WV 33
M a[20:23],v[180:183],v[188:191],a[20:23]
buffer_load_dwordx4 v[136:139], v1, s[8:11], s21 offen offset:2048 sc1
M a[48:51],v[180:183],v[192:195],a[48:51]
M a[76:79],v[180:183],v[196:199],a[76:79]
M a[104:107],v[180:183],v[200:203],a[104:107]
WV 33
M a[24:27],v[184:187],v[188:191],a[24:27]
M a[52:55],v[184:187],v[192:195],a[52:55]
M a[80:83],v[184:187],v[196:199],a[80:83]
M a[108:111],v[184:187],v[200:203],a[108:111]
s_add_u32 s20, s20, 7168
s_add_u32 s21, s21, 7168
s_add_u32 s22, s22, 5120
s_add_u32 s23, s23, 5120
s_sub_u32 s24, s24, 1
s_cmp_lg_u32 s24, 0
s_cbranch_scc1 L2_loop_4
WV 0
s_nop 7
s_cmp_eq_u32 s3, 0
s_cbranch_scc1 L2_r0_4
s_cmp_eq_u32 s3, 1
s_cbranch_scc1 L2_r1_4
s_cmp_eq_u32 s3, 2
s_cbranch_scc1 L2_r2_4
s_branch L2_r3_4
L2_r0_4:
v_add_u32 v4, 32768, v1
v_add_u32 v5, 65536, v1
v_add_u32 v6, 98304, v1
ds_write_b128 v1, a[28:31] offset:21504
ds_write_b128 v1, a[32:35] offset:24576
ds_write_b128 v1, a[36:39] offset:27648
ds_write_b128 v1, a[40:43] offset:30720
ds_write_b128 v4, a[44:47] offset:1024
ds_write_b128 v4, a[48:51] offset:4096
ds_write_b128 v4, a[52:55] offset:7168
ds_write_b128 v4, a[56:59] offset:10240
ds_write_b128 v4, a[60:63] offset:13312
ds_write_b128 v4, a[64:67] offset:16384
ds_write_b128 v4, a[68:71] offset:19456
ds_write_b128 v4, a[72:75] offset:22528
ds_write_b128 v4, a[76:79] offset:25600
ds_write_b128 v4, a[80:83] offset:28672
ds_write_b128 v4, a[84:87] offset:31744
ds_write_b128 v5, a[88:91] offset:2048
ds_write_b128 v5, a[92:95] offset:5120
ds_write_b128 v5, a[96:99] offset:8192
ds_write_b128 v5, a[100:103] offset:11264
ds_write_b128 v5, a[104:107] offset:14336
ds_write_b128 v5, a[108:111] offset:17408
WL 0
s_barrier
RD v[16:19],v1,0
RD v[20:23],v1,1024
RD v[24:27],v1,2048
RD v[32:35],v1,3072
RD v[36:39],v1,4096
RD v[40:43],v1,5120
RD v[48:51],v1,6144
RD v[52:55],v1,7168
RD v[56:59],v1,8192
RD v[64:67],v1,9216
RD v[68:71],v1,10240
RD v[72:75],v1,11264
RD v[80:83],v1,12288
RD v[84:87],v1,13312
RD v[88:91],v1,14336
RD v[96:99],v1,15360
RD v[100:103],v1,16384
RD v[104:107],v1,17408
RD v[112:115],v1,18432
RD v[116:119],v1,19456
RD v[120:123],v1,20480
AR v28,a0
AR v29,a1
AR v30,a2
AR v31,a3
WL 15
v_pk_add_f32 v[20:21], v[20:21], v[24:25]
v_pk_add_f32 v[22:23], v[22:23], v[26:27]
v_pk_add_f32 v[28:29], v[28:29], v[16:17]
v_pk_add_f32 v[30:31], v[30:31], v[18:19]
v_pk_add_f32 v[28:29], v[28:29], v[20:21]
v_pk_add_f32 v[30:31], v[30:31], v[22:23]
CV v16,v28,v29
CV v17,v30,v31
s_add_u32 s25, s26, 0
buffer_store_dwordx2 v[16:17], v2, s[16:19], s25 offen
AR v44,a4
AR v45,a5
AR v46,a6
AR v47,a7
v_pk_add_f32 v[36:37], v[36:37], v[40:41]
v_pk_add_f32 v[38:39], v[38:39], v[42:43]
v_pk_add_f32 v[44:45], v[44:45], v[32:33]
v_pk_add_f32 v[46:47], v[46:47], v[34:35]
v_pk_add_f32 v[44:45], v[44:45], v[36:37]
v_pk_add_f32 v[46:47], v[46:47], v[38:39]
CV v32,v44,v45
CV v33,v46,v47
s_add_u32 s25, s26, 32
buffer_store_dwordx2 v[32:33], v2, s[16:19], s25 offen
AR v60,a8
AR v61,a9
AR v62,a10
AR v63,a11
WL 12
v_pk_add_f32 v[52:53], v[52:53], v[56:57]
v_pk_add_f32 v[54:55], v[54:55], v[58:59]
v_pk_add_f32 v[60:61], v[60:61], v[48:49]
v_pk_add_f32 v[62:63], v[62:63], v[50:51]
v_pk_add_f32 v[60:61], v[60:61], v[52:53]
v_pk_add_f32 v[62:63], v[62:63], v[54:55]
CV v48,v60,v61
CV v49,v62,v63
s_add_u32 s25, s26, 64
buffer_store_dwordx2 v[48:49], v2, s[16:19], s25 offen
AR v76,a12
AR v77,a13
AR v78,a14
AR v79,a15
WL 9
v_pk_add_f32 v[68:69], v[68:69], v[72:73]
v_pk_add_f32 v[70:71], v[70:71], v[74:75]
v_pk_add_f32 v[76:77], v[76:77], v[64:65]
v_pk_add_f32 v[78:79], v[78:79], v[66:67]
v_pk_add_f32 v[76:77], v[76:77], v[68:69]
v_pk_add_f32 v[78:79], v[78:79], v[70:71]
CV v64,v76,v77
CV v65,v78,v79
s_add_u32 s25, s26, 96
buffer_store_dwordx2 v[64:65], v2, s[16:19], s25 offen
AR v92,a16
AR v93,a17
AR v94,a18
AR v95,a19
WL 6
v_pk_add_f32 v[84:85], v[84:85], v[88:89]
v_pk_add_f32 v[86:87], v[86:87], v[90:91]
v_pk_add_f32 v[92:93], v[92:93], v[80:81]
v_pk_add_f32 v[94:95], v[94:95], v[82:83]
v_pk_add_f32 v[92:93], v[92:93], v[84:85]
v_pk_add_f32 v[94:95], v[94:95], v[86:87]
CV v80,v92,v93
CV v81,v94,v95
s_add_u32 s25, s26, 128
buffer_store_dwordx2 v[80:81], v2, s[16:19], s25 offen
AR v108,a20
AR v109,a21
AR v110,a22
AR v111,a23
WL 3
v_pk_add_f32 v[100:101], v[100:101], v[104:105]
v_pk_add_f32 v[102:103], v[102:103], v[106:107]
v_pk_add_f32 v[108:109], v[108:109], v[96:97]
v_pk_add_f32 v[110:111], v[110:111], v[98:99]
v_pk_add_f32 v[108:109], v[108:109], v[100:101]
v_pk_add_f32 v[110:111], v[110:111], v[102:103]
CV v96,v108,v109
CV v97,v110,v111
s_add_u32 s25, s26, 160
buffer_store_dwordx2 v[96:97], v2, s[16:19], s25 offen
AR v124,a24
AR v125,a25
AR v126,a26
AR v127,a27
WL 0
v_pk_add_f32 v[116:117], v[116:117], v[120:121]
v_pk_add_f32 v[118:119], v[118:119], v[122:123]
v_pk_add_f32 v[124:125], v[124:125], v[112:113]
v_pk_add_f32 v[126:127], v[126:127], v[114:115]
v_pk_add_f32 v[124:125], v[124:125], v[116:117]
v_pk_add_f32 v[126:127], v[126:127], v[118:119]
CV v112,v124,v125
CV v113,v126,v127
s_add_u32 s25, s26, 192
buffer_store_dwordx2 v[112:113], v2, s[16:19], s25 offen
WV 0
s_endpgm
L2_r1_4:
v_add_u32 v4, 32768, v1
v_add_u32 v5, 65536, v1
v_add_u32 v6, 98304, v1
ds_write_b128 v1, a[0:3] offset:0
ds_write_b128 v1, a[4:7] offset:3072
ds_write_b128 v1, a[8:11] offset:6144
ds_write_b128 v1, a[12:15] offset:9216
ds_write_b128 v1, a[16:19] offset:12288
ds_write_b128 v1, a[20:23] offset:15360
ds_write_b128 v1, a[24:27] offset:18432
ds_write_b128 v4, a[56:59] offset:11264
ds_write_b128 v4, a[60:63] offset:14336
ds_write_b128 v4, a[64:67] offset:17408
ds_write_b128 v4, a[68:71] offset:20480
ds_write_b128 v4, a[72:75] offset:23552
ds_write_b128 v4, a[76:79] offset:26624
ds_write_b128 v4, a[80:83] offset:29696
ds_write_b128 v5, a[84:87] offset:0
ds_write_b128 v5, a[88:91] offset:3072
ds_write_b128 v5, a[92:95] offset:6144
ds_write_b128 v5, a[96:99] offset:9216
ds_write_b128 v5, a[100:103] offset:12288
ds_write_b128 v5, a[104:107] offset:15360
ds_write_b128 v5, a[108:111] offset:18432
WL 0
s_barrier
RD v[16:19],v1,21504
RD v[20:23],v1,22528
RD v[24:27],v1,23552
RD v[32:35],v1,24576
RD v[36:39],v1,25600
RD v[40:43],v1,26624
RD v[48:51],v1,27648
RD v[52:55],v1,28672
RD v[56:59],v1,29696
RD v[64:67],v1,30720
RD v[68:71],v1,31744
RD v[72:75],v4,0
RD v[80:83],v4,1024
RD v[84:87],v4,2048
RD v[88:91],v4,3072
RD v[96:99],v4,4096
RD v[100:103],v4,5120
RD v[104:107],v4,6144
RD v[112:115],v4,7168
RD v[116:119],v4,8192
RD v[120:123],v4,9216
AR v28,a28
AR v29,a29
AR v30,a30
AR v31,a31
WL 15
v_pk_add_f32 v[20:21], v[20:21], v[24:25]
v_pk_add_f32 v[22:23], v[22:23], v[26:27]
v_pk_add_f32 v[28:29], v[28:29], v[16:17]
v_pk_add_f32 v[30:31], v[30:31], v[18:19]
v_pk_add_f32 v[28:29], v[28:29], v[20:21]
v_pk_add_f32 v[30:31], v[30:31], v[22:23]
CV v16,v28,v29
CV v17,v30,v31
s_add_u32 s25, s26, 28672
buffer_store_dwordx2 v[16:17], v2, s[16:19], s25 offen
AR v44,a32
AR v45,a33
AR v46,a34
AR v47,a35
v_pk_add_f32 v[36:37], v[36:37], v[40:41]
v_pk_add_f32 v[38:39], v[38:39], v[42:43]
v_pk_add_f32 v[44:45], v[44:45], v[32:33]
v_pk_add_f32 v[46:47], v[46:47], v[34:35]
v_pk_add_f32 v[44:45], v[44:45], v[36:37]
v_pk_add_f32 v[46:47], v[46:47], v[38:39]
CV v32,v44,v45
CV v33,v46,v47
s_add_u32 s25, s26, 28704
buffer_store_dwordx2 v[32:33], v2, s[16:19], s25 offen
AR v60,a36
AR v61,a37
AR v62,a38
AR v63,a39
WL 12
v_pk_add_f32 v[52:53], v[52:53], v[56:57]
v_pk_add_f32 v[54:55], v[54:55], v[58:59]
v_pk_add_f32 v[60:61], v[60:61], v[48:49]
v_pk_add_f32 v[62:63], v[62:63], v[50:51]
v_pk_add_f32 v[60:61], v[60:61], v[52:53]
v_pk_add_f32 v[62:63], v[62:63], v[54:55]
CV v48,v60,v61
CV v49,v62,v63
s_add_u32 s25, s26, 28736
buffer_store_dwordx2 v[48:49], v2, s[16:19], s25 offen
AR v76,a40
AR v77,a41
AR v78,a42
AR v79,a43
WL 9
v_pk_add_f32 v[68:69], v[68:69], v[72:73]
v_pk_add_f32 v[70:71], v[70:71], v[74:75]
v_pk_add_f32 v[76:77], v[76:77], v[64:65]
v_pk_add_f32 v[78:79], v[78:79], v[66:67]
v_pk_add_f32 v[76:77], v[76:77], v[68:69]
v_pk_add_f32 v[78:79], v[78:79], v[70:71]
CV v64,v76,v77
CV v65,v78,v79
s_add_u32 s25, s26, 28768
buffer_store_dwordx2 v[64:65], v2, s[16:19], s25 offen
AR v92,a44
AR v93,a45
AR v94,a46
AR v95,a47
WL 6
v_pk_add_f32 v[84:85], v[84:85], v[88:89]
v_pk_add_f32 v[86:87], v[86:87], v[90:91]
v_pk_add_f32 v[92:93], v[92:93], v[80:81]
v_pk_add_f32 v[94:95], v[94:95], v[82:83]
v_pk_add_f32 v[92:93], v[92:93], v[84:85]
v_pk_add_f32 v[94:95], v[94:95], v[86:87]
CV v80,v92,v93
CV v81,v94,v95
s_add_u32 s25, s26, 28800
buffer_store_dwordx2 v[80:81], v2, s[16:19], s25 offen
AR v108,a48
AR v109,a49
AR v110,a50
AR v111,a51
WL 3
v_pk_add_f32 v[100:101], v[100:101], v[104:105]
v_pk_add_f32 v[102:103], v[102:103], v[106:107]
v_pk_add_f32 v[108:109], v[108:109], v[96:97]
v_pk_add_f32 v[110:111], v[110:111], v[98:99]
v_pk_add_f32 v[108:109], v[108:109], v[100:101]
v_pk_add_f32 v[110:111], v[110:111], v[102:103]
CV v96,v108,v109
CV v97,v110,v111
s_add_u32 s25, s26, 28832
buffer_store_dwordx2 v[96:97], v2, s[16:19], s25 offen
AR v124,a52
AR v125,a53
AR v126,a54
AR v127,a55
WL 0
v_pk_add_f32 v[116:117], v[116:117], v[120:121]
v_pk_add_f32 v[118:119], v[118:119], v[122:123]
v_pk_add_f32 v[124:125], v[124:125], v[112:113]
v_pk_add_f32 v[126:127], v[126:127], v[114:115]
v_pk_add_f32 v[124:125], v[124:125], v[116:117]
v_pk_add_f32 v[126:127], v[126:127], v[118:119]
CV v112,v124,v125
CV v113,v126,v127
s_add_u32 s25, s26, 28864
buffer_store_dwordx2 v[112:113], v2, s[16:19], s25 offen
WV 0
s_endpgm
L2_r2_4:
v_add_u32 v4, 32768, v1
v_add_u32 v5, 65536, v1
v_add_u32 v6, 98304, v1
ds_write_b128 v1, a[0:3] offset:1024
ds_write_b128 v1, a[4:7] offset:4096
ds_write_b128 v1, a[8:11] offset:7168
ds_write_b128 v1, a[12:15] offset:10240
ds_write_b128 v1, a[16:19] offset:13312
ds_write_b128 v1, a[20:23] offset:16384
ds_write_b128 v1, a[24:27] offset:19456
ds_write_b128 v1, a[28:31] offset:22528
ds_write_b128 v1, a[32:35] offset:25600
ds_write_b128 v1, a[36:39] offset:28672
ds_write_b128 v1, a[40:43] offset:31744
ds_write_b128 v4, a[44:47] offset:2048
ds_write_b128 v4, a[48:51] offset:5120
ds_write_b128 v4, a[52:55] offset:8192
ds_write_b128 v5, a[84:87] offset:1024
ds_write_b128 v5, a[88:91] offset:4096
ds_write_b128 v5, a[92:95] offset:7168
ds_write_b128 v5, a[96:99] offset:10240
ds_write_b128 v5, a[100:103] offset:13312
ds_write_b128 v5, a[104:107] offset:16384
ds_write_b128 v5, a[108:111] offset:19456
WL 0
s_barrier
RD v[16:19],v4,10240
RD v[20:23],v4,11264
RD v[24:27],v4,12288
RD v[32:35],v4,13312
RD v[36:39],v4,14336
RD v[40:43],v4,15360
RD v[48:51],v4,16384
RD v[52:55],v4,17408
RD v[56:59],v4,18432
RD v[64:67],v4,19456
RD v[68:71],v4,20480
RD v[72:75],v4,21504
RD v[80:83],v4,22528
RD v[84:87],v4,23552
RD v[88:91],v4,24576
RD v[96:99],v4,25600
RD v[100:103],v4,26624
RD v[104:107],v4,27648
RD v[112:115],v4,28672
RD v[116:119],v4,29696
RD v[120:123],v4,30720
AR v28,a56
AR v29,a57
AR v30,a58
AR v31,a59
WL 15
v_pk_add_f32 v[20:21], v[20:21], v[24:25]
v_pk_add_f32 v[22:23], v[22:23], v[26:27]
v_pk_add_f32 v[28:29], v[28:29], v[16:17]
v_pk_add_f32 v[30:31], v[30:31], v[18:19]
v_pk_add_f32 v[28:29], v[28:29], v[20:21]
v_pk_add_f32 v[30:31], v[30:31], v[22:23]
CV v16,v28,v29
CV v17,v30,v31
s_add_u32 s25, s26, 57344
buffer_store_dwordx2 v[16:17], v2, s[16:19], s25 offen
AR v44,a60
AR v45,a61
AR v46,a62
AR v47,a63
v_pk_add_f32 v[36:37], v[36:37], v[40:41]
v_pk_add_f32 v[38:39], v[38:39], v[42:43]
v_pk_add_f32 v[44:45], v[44:45], v[32:33]
v_pk_add_f32 v[46:47], v[46:47], v[34:35]
v_pk_add_f32 v[44:45], v[44:45], v[36:37]
v_pk_add_f32 v[46:47], v[46:47], v[38:39]
CV v32,v44,v45
CV v33,v46,v47
s_add_u32 s25, s26, 57376
buffer_store_dwordx2 v[32:33], v2, s[16:19], s25 offen
AR v60,a64
AR v61,a65
AR v62,a66
AR v63,a67
WL 12
v_pk_add_f32 v[52:53], v[52:53], v[56:57]
v_pk_add_f32 v[54:55], v[54:55], v[58:59]
v_pk_add_f32 v[60:61], v[60:61], v[48:49]
v_pk_add_f32 v[62:63], v[62:63], v[50:51]
v_pk_add_f32 v[60:61], v[60:61], v[52:53]
v_pk_add_f32 v[62:63], v[62:63], v[54:55]
CV v48,v60,v61
CV v49,v62,v63
s_add_u32 s25, s26, 57408
buffer_store_dwordx2 v[48:49], v2, s[16:19], s25 offen
AR v76,a68
AR v77,a69
AR v78,a70
AR v79,a71
WL 9
v_pk_add_f32 v[68:69], v[68:69], v[72:73]
v_pk_add_f32 v[70:71], v[70:71], v[74:75]
v_pk_add_f32 v[76:77], v[76:77], v[64:65]
v_pk_add_f32 v[78:79], v[78:79], v[66:67]
v_pk_add_f32 v[76:77], v[76:77], v[68:69]
v_pk_add_f32 v[78:79], v[78:79], v[70:71]
CV v64,v76,v77
CV v65,v78,v79
s_add_u32 s25, s26, 57440
buffer_store_dwordx2 v[64:65], v2, s[16:19], s25 offen
AR v92,a72
AR v93,a73
AR v94,a74
AR v95,a75
WL 6
v_pk_add_f32 v[84:85], v[84:85], v[88:89]
v_pk_add_f32 v[86:87], v[86:87], v[90:91]
v_pk_add_f32 v[92:93], v[92:93], v[80:81]
v_pk_add_f32 v[94:95], v[94:95], v[82:83]
v_pk_add_f32 v[92:93], v[92:93], v[84:85]
v_pk_add_f32 v[94:95], v[94:95], v[86:87]
CV v80,v92,v93
CV v81,v94,v95
s_add_u32 s25, s26, 57472
buffer_store_dwordx2 v[80:81], v2, s[16:19], s25 offen
AR v108,a76
AR v109,a77
AR v110,a78
AR v111,a79
WL 3
v_pk_add_f32 v[100:101], v[100:101], v[104:105]
v_pk_add_f32 v[102:103], v[102:103], v[106:107]
v_pk_add_f32 v[108:109], v[108:109], v[96:97]
v_pk_add_f32 v[110:111], v[110:111], v[98:99]
v_pk_add_f32 v[108:109], v[108:109], v[100:101]
v_pk_add_f32 v[110:111], v[110:111], v[102:103]
CV v96,v108,v109
CV v97,v110,v111
s_add_u32 s25, s26, 57504
buffer_store_dwordx2 v[96:97], v2, s[16:19], s25 offen
AR v124,a80
AR v125,a81
AR v126,a82
AR v127,a83
WL 0
v_pk_add_f32 v[116:117], v[116:117], v[120:121]
v_pk_add_f32 v[118:119], v[118:119], v[122:123]
v_pk_add_f32 v[124:125], v[124:125], v[112:113]
v_pk_add_f32 v[126:127], v[126:127], v[114:115]
v_pk_add_f32 v[124:125], v[124:125], v[116:117]
v_pk_add_f32 v[126:127], v[126:127], v[118:119]
CV v112,v124,v125
CV v113,v126,v127
s_add_u32 s25, s26, 57536
buffer_store_dwordx2 v[112:113], v2, s[16:19], s25 offen
WV 0
s_endpgm
L2_r3_4:
v_add_u32 v4, 32768, v1
v_add_u32 v5, 65536, v1
v_add_u32 v6, 98304, v1
ds_write_b128 v1, a[0:3] offset:2048
ds_write_b128 v1, a[4:7] offset:5120
ds_write_b128 v1, a[8:11] offset:8192
ds_write_b128 v1, a[12:15] offset:11264
ds_write_b128 v1, a[16:19] offset:14336
ds_write_b128 v1, a[20:23] offset:17408
ds_write_b128 v1, a[24:27] offset:20480
ds_write_b128 v1, a[28:31] offset:23552
ds_write_b128 v1, a[32:35] offset:26624
ds_write_b128 v1, a[36:39] offset:29696
ds_write_b128 v4, a[40:43] offset:0
ds_write_b128 v4, a[44:47] offset:3072
ds_write_b128 v4, a[48:51] offset:6144
ds_write_b128 v4, a[52:55] offset:9216
ds_write_b128 v4, a[56:59] offset:12288
ds_write_b128 v4, a[60:63] offset:15360
ds_write_b128 v4, a[64:67] offset:18432
ds_write_b128 v4, a[68:71] offset:21504
ds_write_b128 v4, a[72:75] offset:24576
ds_write_b128 v4, a[76:79] offset:27648
ds_write_b128 v4, a[80:83] offset:30720
WL 0
s_barrier
RD v[16:19],v4,31744
RD v[20:23],v5,0
RD v[24:27],v5,1024
RD v[32:35],v5,2048
RD v[36:39],v5,3072
RD v[40:43],v5,4096
RD v[48:51],v5,5120
RD v[52:55],v5,6144
RD v[56:59],v5,7168
RD v[64:67],v5,8192
RD v[68:71],v5,9216
RD v[72:75],v5,10240
RD v[80:83],v5,11264
RD v[84:87],v5,12288
RD v[88:91],v5,13312
RD v[96:99],v5,14336
RD v[100:103],v5,15360
RD v[104:107],v5,16384
RD v[112:115],v5,17408
RD v[116:119],v5,18432
RD v[120:123],v5,19456
AR v28,a84
AR v29,a85
AR v30,a86
AR v31,a87
WL 15
v_pk_add_f32 v[20:21], v[20:21], v[24:25]
v_pk_add_f32 v[22:23], v[22:23], v[26:27]
v_pk_add_f32 v[28:29], v[28:29], v[16:17]
v_pk_add_f32 v[30:31], v[30:31], v[18:19]
v_pk_add_f32 v[28:29], v[28:29], v[20:21]
v_pk_add_f32 v[30:31], v[30:31], v[22:23]
CV v16,v28,v29
CV v17,v30,v31
s_add_u32 s25, s26, 86016
buffer_store_dwordx2 v[16:17], v2, s[16:19], s25 offen
AR v44,a88
AR v45,a89
AR v46,a90
AR v47,a91
v_pk_add_f32 v[36:37], v[36:37], v[40:41]
v_pk_add_f32 v[38:39], v[38:39], v[42:43]
v_pk_add_f32 v[44:45], v[44:45], v[32:33]
v_pk_add_f32 v[46:47], v[46:47], v[34:35]
v_pk_add_f32 v[44:45], v[44:45], v[36:37]
v_pk_add_f32 v[46:47], v[46:47], v[38:39]
CV v32,v44,v45
CV v33,v46,v47
s_add_u32 s25, s26, 86048
buffer_store_dwordx2 v[32:33], v2, s[16:19], s25 offen
AR v60,a92
AR v61,a93
AR v62,a94
AR v63,a95
WL 12
v_pk_add_f32 v[52:53], v[52:53], v[56:57]
v_pk_add_f32 v[54:55], v[54:55], v[58:59]
v_pk_add_f32 v[60:61], v[60:61], v[48:49]
v_pk_add_f32 v[62:63], v[62:63], v[50:51]
v_pk_add_f32 v[60:61], v[60:61], v[52:53]
v_pk_add_f32 v[62:63], v[62:63], v[54:55]
CV v48,v60,v61
CV v49,v62,v63
s_add_u32 s25, s26, 86080
buffer_store_dwordx2 v[48:49], v2, s[16:19], s25 offen
AR v76,a96
AR v77,a97
AR v78,a98
AR v79,a99
WL 9
v_pk_add_f32 v[68:69], v[68:69], v[72:73]
v_pk_add_f32 v[70:71], v[70:71], v[74:75]
v_pk_add_f32 v[76:77], v[76:77], v[64:65]
v_pk_add_f32 v[78:79], v[78:79], v[66:67]
v_pk_add_f32 v[76:77], v[76:77], v[68:69]
v_pk_add_f32 v[78:79], v[78:79], v[70:71]
CV v64,v76,v77
CV v65,v78,v79
s_add_u32 s25, s26, 86112
buffer_store_dwordx2 v[64:65], v2, s[16:19], s25 offen
AR v92,a100
AR v93,a101
AR v94,a102
AR v95,a103
WL 6
v_pk_add_f32 v[84:85], v[84:85], v[88:89]
v_pk_add_f32 v[86:87], v[86:87], v[90:91]
v_pk_add_f32 v[92:93], v[92:93], v[80:81]
v_pk_add_f32 v[94:95], v[94:95], v[82:83]
v_pk_add_f32 v[92:93], v[92:93], v[84:85]
v_pk_add_f32 v[94:95], v[94:95], v[86:87]
CV v80,v92,v93
CV v81,v94,v95
s_add_u32 s25, s26, 86144
buffer_store_dwordx2 v[80:81], v2, s[16:19], s25 offen
AR v108,a104
AR v109,a105
AR v110,a106
AR v111,a107
WL 3
v_pk_add_f32 v[100:101], v[100:101], v[104:105]
v_pk_add_f32 v[102:103], v[102:103], v[106:107]
v_pk_add_f32 v[108:109], v[108:109], v[96:97]
v_pk_add_f32 v[110:111], v[110:111], v[98:99]
v_pk_add_f32 v[108:109], v[108:109], v[100:101]
v_pk_add_f32 v[110:111], v[110:111], v[102:103]
CV v96,v108,v109
CV v97,v110,v111
s_add_u32 s25, s26, 86176
buffer_store_dwordx2 v[96:97], v2, s[16:19], s25 offen
AR v124,a108
AR v125,a109
AR v126,a110
AR v127,a111
WL 0
v_pk_add_f32 v[116:117], v[116:117], v[120:121]
v_pk_add_f32 v[118:119], v[118:119], v[122:123]
v_pk_add_f32 v[124:125], v[124:125], v[112:113]
v_pk_add_f32 v[126:127], v[126:127], v[114:115]
v_pk_add_f32 v[124:125], v[124:125], v[116:117]
v_pk_add_f32 v[126:127], v[126:127], v[118:119]
CV v112,v124,v125
CV v113,v126,v127
s_add_u32 s25, s26, 86208
buffer_store_dwordx2 v[112:113], v2, s[16:19], s25 offen
WV 0
s_endpgm
L1_slow_5:
s_waitcnt vmcnt(0) lgkmcnt(0)
v_mov_b32 v76, 0xff800000
v_mov_b32 v4, 0
v_mov_b32 v77, 0xff800000
v_mov_b32 v5, 0
v_mov_b32 v78, 0xff800000
v_mov_b32 v6, 0
v_mov_b32 v79, 0xff800000
v_mov_b32 v7, 0
v_mov_b32 v80, 0xff800000
v_mov_b32 v8, 0
AW a0,0
AW a1,0
AW a2,0
AW a3,0
AW a4,0
AW a5,0
AW a6,0
AW a7,0
AW a8,0
AW a9,0
AW a10,0
AW a11,0
AW a12,0
AW a13,0
AW a14,0
AW a15,0
AW a16,0
AW a17,0
AW a18,0
AW a19,0
AW a20,0
AW a21,0
AW a22,0
AW a23,0
AW a24,0
AW a25,0
AW a26,0
AW a27,0
AW a28,0
AW a29,0
AW a30,0
AW a31,0
AW a32,0
AW a33,0
AW a34,0
AW a35,0
AW a36,0
AW a37,0
AW a38,0
AW a39,0
AW a40,0
AW a41,0
AW a42,0
AW a43,0
AW a44,0
AW a45,0
AW a46,0
AW a47,0
AW a48,0
AW a49,0
AW a50,0
AW a51,0
AW a52,0
AW a53,0
AW a54,0
AW a55,0
AW a56,0
AW a57,0
AW a58,0
AW a59,0
AW a60,0
AW a61,0
AW a62,0
AW a63,0
AW a64,0
AW a65,0
AW a66,0
AW a67,0
AW a68,0
AW a69,0
AW a70,0
AW a71,0
AW a72,0
AW a73,0
AW a74,0
AW a75,0
AW a76,0
AW a77,0
AW a78,0
AW a79,0
AW a80,0
AW a81,0
AW a82,0
AW a83,0
AW a84,0
AW a85,0
AW a86,0
AW a87,0
AW a88,0
AW a89,0
AW a90,0
AW a91,0
AW a92,0
AW a93,0
AW a94,0
AW a95,0
AW a96,0
AW a97,0
AW a98,0
AW a99,0
AW a100,0
AW a101,0
AW a102,0
AW a103,0
AW a104,0
AW a105,0
AW a106,0
AW a107,0
AW a108,0
AW a109,0
AW a110,0
AW a111,0
AW a112,0
AW a113,0
AW a114,0
AW a115,0
AW a116,0
AW a117,0
AW a118,0
AW a119,0
AW a120,0
AW a121,0
AW a122,0
AW a123,0
AW a124,0
AW a125,0
AW a126,0
AW a127,0
AW a128,0
AW a129,0
AW a130,0
AW a131,0
AW a132,0
AW a133,0
AW a134,0
AW a135,0
AW a136,0
AW a137,0
AW a138,0
AW a139,0
AW a140,0
AW a141,0
AW a142,0
AW a143,0
AW a144,0
AW a145,0
AW a146,0
AW a147,0
AW a148,0
AW a149,0
AW a150,0
AW a151,0
AW a152,0
AW a153,0
AW a154,0
AW a155,0
AW a156,0
AW a157,0
AW a158,0
AW a159,0
AW a160,0
AW a161,0
AW a162,0
AW a163,0
AW a164,0
AW a165,0
AW a166,0
AW a167,0
AW a168,0
AW a169,0
AW a170,0
AW a171,0
AW a172,0
AW a173,0
AW a174,0
AW a175,0
AW a176,0
AW a177,0
AW a178,0
AW a179,0
AW a180,0
AW a181,0
AW a182,0
AW a183,0
AW a184,0
AW a185,0
AW a186,0
AW a187,0
AW a188,0
AW a189,0
AW a190,0
AW a191,0
AW a192,0
AW a193,0
AW a194,0
AW a195,0
AW a196,0
AW a197,0
AW a198,0
AW a199,0
AW a200,0
AW a201,0
AW a202,0
AW a203,0
AW a204,0
AW a205,0
AW a206,0
AW a207,0
AW a208,0
AW a209,0
AW a210,0
AW a211,0
AW a212,0
AW a213,0
AW a214,0
AW a215,0
AW a216,0
AW a217,0
AW a218,0
AW a219,0
AW a220,0
AW a221,0
AW a222,0
AW a223,0
AW a224,0
AW a225,0
AW a226,0
AW a227,0
AW a228,0
AW a229,0
AW a230,0
AW a231,0
AW a232,0
AW a233,0
AW a234,0
AW a235,0
AW a236,0
AW a237,0
AW a238,0
AW a239,0
AW a240,0
AW a241,0
AW a242,0
AW a243,0
AW a244,0
AW a245,0
AW a246,0
AW a247,0
AW a248,0
AW a249,0
AW a250,0
AW a251,0
AW a252,0
AW a253,0
AW a254,0
AW a255,0
v_mov_b32 v192, 0
v_mov_b32 v193, 0
v_mov_b32 v194, 0
v_mov_b32 v195, 0
v_mov_b32 v196, 0
v_mov_b32 v197, 0
v_mov_b32 v198, 0
v_mov_b32 v199, 0
v_mov_b32 v200, 0
v_mov_b32 v201, 0
v_mov_b32 v202, 0
v_mov_b32 v203, 0
v_mov_b32 v204, 0
v_mov_b32 v205, 0
v_mov_b32 v206, 0
v_mov_b32 v207, 0
v_mov_b32 v208, 0
v_mov_b32 v209, 0
v_mov_b32 v210, 0
v_mov_b32 v211, 0
v_mov_b32 v212, 0
v_mov_b32 v213, 0
v_mov_b32 v214, 0
v_mov_b32 v215, 0
v_mov_b32 v216, 0
v_mov_b32 v217, 0
v_mov_b32 v218, 0
v_mov_b32 v219, 0
v_mov_b32 v220, 0
v_mov_b32 v221, 0
v_mov_b32 v222, 0
v_mov_b32 v223, 0
v_mov_b32 v224, 0
v_mov_b32 v225, 0
v_mov_b32 v226, 0
v_mov_b32 v227, 0
v_mov_b32 v228, 0
v_mov_b32 v229, 0
v_mov_b32 v230, 0
v_mov_b32 v231, 0
v_mov_b32 v232, 0
v_mov_b32 v233, 0
v_mov_b32 v234, 0
v_mov_b32 v235, 0
v_mov_b32 v236, 0
v_mov_b32 v237, 0
v_mov_b32 v238, 0
v_mov_b32 v239, 0
v_mov_b32 v240, 0
v_mov_b32 v241, 0
v_mov_b32 v242, 0
v_mov_b32 v243, 0
v_mov_b32 v244, 0
v_mov_b32 v245, 0
v_mov_b32 v246, 0
v_mov_b32 v247, 0
v_mov_b32 v248, 0
v_mov_b32 v249, 0
v_mov_b32 v250, 0
v_mov_b32 v251, 0
v_mov_b32 v252, 0
v_mov_b32 v253, 0
v_mov_b32 v254, 0
v_mov_b32 v255, 0
v_subrev_u32 v88, s62, v2
v_lshrrev_b32 v88, 4, v88
v_bfe_u32 v89, v88, 2, 1
v_lshlrev_b32 v89, 1, v89
v_lshrrev_b32 v0, 4, v88
v_xor_b32 v89, v89, v0
v_lshlrev_b32 v0, 4, v89
v_and_b32 v89, 7, v88
v_lshl_add_u32 v0, v89, 6, v0
v_bfe_u32 v89, v88, 3, 1
v_lshl_add_u32 v0, v89, 12, v0
v_add_u32 v0, 65536, v0
v_lshrrev_b32 v89, 5, v88
v_lshlrev_b32 v1, 12, v89
v_bfe_u32 v89, v88, 2, 3
v_lshl_add_u32 v1, v89, 6, v1
v_bfe_u32 v89, v88, 4, 1
v_lshl_add_u32 v1, v89, 5, v1
v_and_b32 v89, 3, v88
v_lshl_add_u32 v1, v89, 3, v1
v_add_u32 v1, 81920, v1
v_xor_b32 v9, 32, v1
s_sub_u32 s42, s53, 65536
s_mov_b32 s52, 32
L1_slowloop_5:
s_barrier
s_add_u32 m0, s53, 0
s_nop 0
buffer_load_dwordx4 v3, s[16:19], s42 offen offset:0 nt lds
s_add_u32 m0, s53, 896
s_nop 0
buffer_load_dwordx4 v3, s[16:19], s42 offen offset:128 nt lds
s_add_u32 m0, s53, 1792
s_nop 0
buffer_load_dwordx4 v3, s[16:19], s42 offen offset:256 nt lds
s_add_u32 m0, s53, 2688
s_nop 0
buffer_load_dwordx4 v3, s[16:19], s42 offen offset:384 nt lds
s_add_u32 m0, s53, 16384
s_nop 0
buffer_load_dwordx4 v3, s[20:23], s42 offen offset:0 nt lds
s_add_u32 m0, s53, 17280
s_nop 0
buffer_load_dwordx4 v3, s[20:23], s42 offen offset:128 nt lds
s_add_u32 m0, s53, 18176
s_nop 0
buffer_load_dwordx4 v3, s[20:23], s42 offen offset:256 nt lds
s_add_u32 m0, s53, 19072
s_nop 0
buffer_load_dwordx4 v3, s[20:23], s42 offen offset:384 nt lds
s_add_u32 s42, s42, 16384
WV 0
s_barrier
RD v[12:15],v0,0
RD v[16:19],v0,8192
RD v[28:31],v2,0
RD v[32:35],v2,8192
WL 3
M v[36:39],v[12:15],v[96:99],0
M v[40:43],v[12:15],v[128:131],0
M v[44:47],v[12:15],v[160:163],0
WL 1
M v[48:51],v[12:15],v[28:31],0
WL 0
M v[52:55],v[12:15],v[32:35],0
M v[56:59],v[16:19],v[96:99],0
M v[60:63],v[16:19],v[128:131],0
M v[64:67],v[16:19],v[160:163],0
M v[68:71],v[16:19],v[28:31],0
M v[72:75],v[16:19],v[32:35],0
RD v[20:23],v0,512
RD v[24:27],v0,8704
RD v[28:31],v2,1024
RD v[32:35],v2,9216
WL 3
M v[36:39],v[20:23],v[100:103],v[36:39]
M v[40:43],v[20:23],v[132:135],v[40:43]
M v[44:47],v[20:23],v[164:167],v[44:47]
WL 1
M v[48:51],v[20:23],v[28:31],v[48:51]
WL 0
M v[52:55],v[20:23],v[32:35],v[52:55]
M v[56:59],v[24:27],v[100:103],v[56:59]
M v[60:63],v[24:27],v[132:135],v[60:63]
M v[64:67],v[24:27],v[164:167],v[64:67]
M v[68:71],v[24:27],v[28:31],v[68:71]
M v[72:75],v[24:27],v[32:35],v[72:75]
RD v[12:15],v0,1024
RD v[16:19],v0,9216
RD v[28:31],v2,2048
RD v[32:35],v2,10240
WL 3
M v[36:39],v[12:15],v[104:107],v[36:39]
M v[40:43],v[12:15],v[136:139],v[40:43]
M v[44:47],v[12:15],v[168:171],v[44:47]
WL 1
M v[48:51],v[12:15],v[28:31],v[48:51]
WL 0
M v[52:55],v[12:15],v[32:35],v[52:55]
M v[56:59],v[16:19],v[104:107],v[56:59]
M v[60:63],v[16:19],v[136:139],v[60:63]
M v[64:67],v[16:19],v[168:171],v[64:67]
M v[68:71],v[16:19],v[28:31],v[68:71]
M v[72:75],v[16:19],v[32:35],v[72:75]
RD v[20:23],v0,1536
RD v[24:27],v0,9728
RD v[28:31],v2,3072
RD v[32:35],v2,11264
WL 3
M v[36:39],v[20:23],v[108:111],v[36:39]
M v[40:43],v[20:23],v[140:143],v[40:43]
M v[44:47],v[20:23],v[172:175],v[44:47]
WL 1
M v[48:51],v[20:23],v[28:31],v[48:51]
WL 0
M v[52:55],v[20:23],v[32:35],v[52:55]
M v[56:59],v[24:27],v[108:111],v[56:59]
M v[60:63],v[24:27],v[140:143],v[60:63]
M v[64:67],v[24:27],v[172:175],v[64:67]
M v[68:71],v[24:27],v[28:31],v[68:71]
M v[72:75],v[24:27],v[32:35],v[72:75]
RD v[12:15],v0,2048
RD v[16:19],v0,10240
RD v[28:31],v2,4096
RD v[32:35],v2,12288
WL 3
M v[36:39],v[12:15],v[112:115],v[36:39]
M v[40:43],v[12:15],v[144:147],v[40:43]
M v[44:47],v[12:15],v[176:179],v[44:47]
WL 1
M v[48:51],v[12:15],v[28:31],v[48:51]
WL 0
M v[52:55],v[12:15],v[32:35],v[52:55]
M v[56:59],v[16:19],v[112:115],v[56:59]
M v[60:63],v[16:19],v[144:147],v[60:63]
M v[64:67],v[16:19],v[176:179],v[64:67]
M v[68:71],v[16:19],v[28:31],v[68:71]
M v[72:75],v[16:19],v[32:35],v[72:75]
RD v[20:23],v0,2560
RD v[24:27],v0,10752
RD v[28:31],v2,5120
RD v[32:35],v2,13312
WL 3
M v[36:39],v[20:23],v[116:119],v[36:39]
M v[40:43],v[20:23],v[148:151],v[40:43]
M v[44:47],v[20:23],v[180:183],v[44:47]
WL 1
M v[48:51],v[20:23],v[28:31],v[48:51]
WL 0
M v[52:55],v[20:23],v[32:35],v[52:55]
M v[56:59],v[24:27],v[116:119],v[56:59]
M v[60:63],v[24:27],v[148:151],v[60:63]
M v[64:67],v[24:27],v[180:183],v[64:67]
M v[68:71],v[24:27],v[28:31],v[68:71]
M v[72:75],v[24:27],v[32:35],v[72:75]
RD v[12:15],v0,3072
RD v[16:19],v0,11264
RD v[28:31],v2,6144
RD v[32:35],v2,14336
WL 3
M v[36:39],v[12:15],v[120:123],v[36:39]
M v[40:43],v[12:15],v[152:155],v[40:43]
M v[44:47],v[12:15],v[184:187],v[44:47]
WL 1
M v[48:51],v[12:15],v[28:31],v[48:51]
WL 0
M v[52:55],v[12:15],v[32:35],v[52:55]
M v[56:59],v[16:19],v[120:123],v[56:59]
M v[60:63],v[16:19],v[152:155],v[60:63]
M v[64:67],v[16:19],v[184:187],v[64:67]
M v[68:71],v[16:19],v[28:31],v[68:71]
M v[72:75],v[16:19],v[32:35],v[72:75]
RD v[20:23],v0,3584
RD v[24:27],v0,11776
RD v[28:31],v2,7168
RD v[32:35],v2,15360
WL 3
M v[36:39],v[20:23],v[124:127],v[36:39]
M v[40:43],v[20:23],v[156:159],v[40:43]
M v[44:47],v[20:23],v[188:191],v[44:47]
WL 1
M v[48:51],v[20:23],v[28:31],v[48:51]
WL 0
M v[52:55],v[20:23],v[32:35],v[52:55]
M v[56:59],v[24:27],v[124:127],v[56:59]
M v[60:63],v[24:27],v[156:159],v[60:63]
M v[64:67],v[24:27],v[188:191],v[64:67]
M v[68:71],v[24:27],v[28:31],v[68:71]
M v[72:75],v[24:27],v[32:35],v[72:75]
s_nop 7
v_max3_f32 v81, v36, v37, v38
v_max3_f32 v81, v81, v39, v56
v_max3_f32 v81, v81, v57, v58
v_max_f32 v81, v81, v59
v_max3_f32 v82, v40, v41, v42
v_max3_f32 v82, v82, v43, v60
v_max3_f32 v82, v82, v61, v62
v_max_f32 v82, v82, v63
v_max3_f32 v83, v44, v45, v46
v_max3_f32 v83, v83, v47, v64
v_max3_f32 v83, v83, v65, v66
v_max_f32 v83, v83, v67
v_max3_f32 v84, v48, v49, v50
v_max3_f32 v84, v84, v51, v68
v_max3_f32 v84, v84, v69, v70
v_max_f32 v84, v84, v71
v_max3_f32 v85, v52, v53, v54
v_max3_f32 v85, v85, v55, v72
v_max3_f32 v85, v85, v73, v74
v_max_f32 v85, v85, v75
v_mov_b32 v86, v81
v_mov_b32 v87, v81
s_nop 1
v_permlane32_swap_b32 v86, v87
s_nop 1
v_max_f32 v81, v86, v87
v_mov_b32 v86, v82
v_mov_b32 v87, v82
s_nop 1
v_permlane32_swap_b32 v86, v87
s_nop 1
v_max_f32 v82, v86, v87
v_mov_b32 v86, v83
v_mov_b32 v87, v83
s_nop 1
v_permlane32_swap_b32 v86, v87
s_nop 1
v_max_f32 v83, v86, v87
v_mov_b32 v86, v84
v_mov_b32 v87, v84
s_nop 1
v_permlane32_swap_b32 v86, v87
s_nop 1
v_max_f32 v84, v86, v87
v_mov_b32 v86, v85
v_mov_b32 v87, v85
s_nop 1
v_permlane32_swap_b32 v86, v87
s_nop 1
v_max_f32 v85, v86, v87
v_mov_b32 v86, v81
v_mov_b32 v87, v81
s_nop 1
v_permlane16_swap_b32 v86, v87
s_nop 1
v_max_f32 v81, v86, v87
v_mov_b32 v86, v82
v_mov_b32 v87, v82
s_nop 1
v_permlane16_swap_b32 v86, v87
s_nop 1
v_max_f32 v82, v86, v87
v_mov_b32 v86, v83
v_mov_b32 v87, v83
s_nop 1
v_permlane16_swap_b32 v86, v87
s_nop 1
v_max_f32 v83, v86, v87
v_mov_b32 v86, v84
v_mov_b32 v87, v84
s_nop 1
v_permlane16_swap_b32 v86, v87
s_nop 1
v_max_f32 v84, v86, v87
v_mov_b32 v86, v85
v_mov_b32 v87, v85
s_nop 1
v_permlane16_swap_b32 v86, v87
s_nop 1
v_max_f32 v85, v86, v87
v_max_f32 v88, v76, v81
v_sub_f32 v81, v76, v88
v_mov_b32 v76, v88
v_exp_f32 v81, v81
v_sub_f32 v36, v36, v88
v_sub_f32 v37, v37, v88
v_sub_f32 v38, v38, v88
v_sub_f32 v39, v39, v88
v_sub_f32 v56, v56, v88
v_sub_f32 v57, v57, v88
v_sub_f32 v58, v58, v88
v_sub_f32 v59, v59, v88
v_exp_f32 v36, v36
v_exp_f32 v37, v37
v_exp_f32 v38, v38
v_exp_f32 v39, v39
v_exp_f32 v56, v56
v_exp_f32 v57, v57
v_exp_f32 v58, v58
v_exp_f32 v59, v59
s_nop 0
v_mul_f32 v4, v4, v81
v_add_f32 v4, v4, v36
v_add_f32 v4, v4, v37
v_add_f32 v4, v4, v38
v_add_f32 v4, v4, v39
v_add_f32 v4, v4, v56
v_add_f32 v4, v4, v57
v_add_f32 v4, v4, v58
v_add_f32 v4, v4, v59
CV v36,v36,v37
CV v37,v38,v39
CV v38,v56,v57
CV v39,v58,v59
v_max_f32 v88, v77, v82
v_sub_f32 v82, v77, v88
v_mov_b32 v77, v88
v_exp_f32 v82, v82
v_sub_f32 v40, v40, v88
v_sub_f32 v41, v41, v88
v_sub_f32 v42, v42, v88
v_sub_f32 v43, v43, v88
v_sub_f32 v60, v60, v88
v_sub_f32 v61, v61, v88
v_sub_f32 v62, v62, v88
v_sub_f32 v63, v63, v88
v_exp_f32 v40, v40
v_exp_f32 v41, v41
v_exp_f32 v42, v42
v_exp_f32 v43, v43
v_exp_f32 v60, v60
v_exp_f32 v61, v61
v_exp_f32 v62, v62
v_exp_f32 v63, v63
s_nop 0
v_mul_f32 v5, v5, v82
v_add_f32 v5, v5, v40
v_add_f32 v5, v5, v41
v_add_f32 v5, v5, v42
v_add_f32 v5, v5, v43
v_add_f32 v5, v5, v60
v_add_f32 v5, v5, v61
v_add_f32 v5, v5, v62
v_add_f32 v5, v5, v63
CV v40,v40,v41
CV v41,v42,v43
CV v42,v60,v61
CV v43,v62,v63
v_max_f32 v88, v78, v83
v_sub_f32 v83, v78, v88
v_mov_b32 v78, v88
v_exp_f32 v83, v83
v_sub_f32 v44, v44, v88
v_sub_f32 v45, v45, v88
v_sub_f32 v46, v46, v88
v_sub_f32 v47, v47, v88
v_sub_f32 v64, v64, v88
v_sub_f32 v65, v65, v88
v_sub_f32 v66, v66, v88
v_sub_f32 v67, v67, v88
v_exp_f32 v44, v44
v_exp_f32 v45, v45
v_exp_f32 v46, v46
v_exp_f32 v47, v47
v_exp_f32 v64, v64
v_exp_f32 v65, v65
v_exp_f32 v66, v66
v_exp_f32 v67, v67
s_nop 0
v_mul_f32 v6, v6, v83
v_add_f32 v6, v6, v44
v_add_f32 v6, v6, v45
v_add_f32 v6, v6, v46
v_add_f32 v6, v6, v47
v_add_f32 v6, v6, v64
v_add_f32 v6, v6, v65
v_add_f32 v6, v6, v66
v_add_f32 v6, v6, v67
CV v44,v44,v45
CV v45,v46,v47
CV v46,v64,v65
CV v47,v66,v67
v_max_f32 v88, v79, v84
v_sub_f32 v84, v79, v88
v_mov_b32 v79, v88
v_exp_f32 v84, v84
v_sub_f32 v48, v48, v88
v_sub_f32 v49, v49, v88
v_sub_f32 v50, v50, v88
v_sub_f32 v51, v51, v88
v_sub_f32 v68, v68, v88
v_sub_f32 v69, v69, v88
v_sub_f32 v70, v70, v88
v_sub_f32 v71, v71, v88
v_exp_f32 v48, v48
v_exp_f32 v49, v49
v_exp_f32 v50, v50
v_exp_f32 v51, v51
v_exp_f32 v68, v68
v_exp_f32 v69, v69
v_exp_f32 v70, v70
v_exp_f32 v71, v71
s_nop 0
v_mul_f32 v7, v7, v84
v_add_f32 v7, v7, v48
v_add_f32 v7, v7, v49
v_add_f32 v7, v7, v50
v_add_f32 v7, v7, v51
v_add_f32 v7, v7, v68
v_add_f32 v7, v7, v69
v_add_f32 v7, v7, v70
v_add_f32 v7, v7, v71
CV v48,v48,v49
CV v49,v50,v51
CV v50,v68,v69
CV v51,v70,v71
v_max_f32 v88, v80, v85
v_sub_f32 v85, v80, v88
v_mov_b32 v80, v88
v_exp_f32 v85, v85
v_sub_f32 v52, v52, v88
v_sub_f32 v53, v53, v88
v_sub_f32 v54, v54, v88
v_sub_f32 v55, v55, v88
v_sub_f32 v72, v72, v88
v_sub_f32 v73, v73, v88
v_sub_f32 v74, v74, v88
v_sub_f32 v75, v75, v88
v_exp_f32 v52, v52
v_exp_f32 v53, v53
v_exp_f32 v54, v54
v_exp_f32 v55, v55
v_exp_f32 v72, v72
v_exp_f32 v73, v73
v_exp_f32 v74, v74
v_exp_f32 v75, v75
s_nop 0
v_mul_f32 v8, v8, v85
v_add_f32 v8, v8, v52
v_add_f32 v8, v8, v53
v_add_f32 v8, v8, v54
v_add_f32 v8, v8, v55
v_add_f32 v8, v8, v72
v_add_f32 v8, v8, v73
v_add_f32 v8, v8, v74
v_add_f32 v8, v8, v75
CV v52,v52,v53
CV v53,v54,v55
CV v54,v72,v73
CV v55,v74,v75
AR v88,a0
AR v89,a1
AR v90,a2
AR v91,a3
v_mul_f32 v88, v88, v81
v_mul_f32 v89, v89, v81
v_mul_f32 v90, v90, v81
v_mul_f32 v91, v91, v81
AW a0,v88
AW a1,v89
AW a2,v90
AW a3,v91
AR v88,a4
AR v89,a5
AR v90,a6
AR v91,a7
v_mul_f32 v88, v88, v82
v_mul_f32 v89, v89, v82
v_mul_f32 v90, v90, v82
v_mul_f32 v91, v91, v82
AW a4,v88
AW a5,v89
AW a6,v90
AW a7,v91
AR v88,a8
AR v89,a9
AR v90,a10
AR v91,a11
v_mul_f32 v88, v88, v83
v_mul_f32 v89, v89, v83
v_mul_f32 v90, v90, v83
v_mul_f32 v91, v91, v83
AW a8,v88
AW a9,v89
AW a10,v90
AW a11,v91
AR v88,a12
AR v89,a13
AR v90,a14
AR v91,a15
v_mul_f32 v88, v88, v84
v_mul_f32 v89, v89, v84
v_mul_f32 v90, v90, v84
v_mul_f32 v91, v91, v84
AW a12,v88
AW a13,v89
AW a14,v90
AW a15,v91
AR v88,a16
AR v89,a17
AR v90,a18
AR v91,a19
v_mul_f32 v88, v88, v85
v_mul_f32 v89, v89, v85
v_mul_f32 v90, v90, v85
v_mul_f32 v91, v91, v85
AW a16,v88
AW a17,v89
AW a18,v90
AW a19,v91
AR v88,a20
AR v89,a21
AR v90,a22
AR v91,a23
v_mul_f32 v88, v88, v81
v_mul_f32 v89, v89, v81
v_mul_f32 v90, v90, v81
v_mul_f32 v91, v91, v81
AW a20,v88
AW a21,v89
AW a22,v90
AW a23,v91
AR v88,a24
AR v89,a25
AR v90,a26
AR v91,a27
v_mul_f32 v88, v88, v82
v_mul_f32 v89, v89, v82
v_mul_f32 v90, v90, v82
v_mul_f32 v91, v91, v82
AW a24,v88
AW a25,v89
AW a26,v90
AW a27,v91
AR v88,a28
AR v89,a29
AR v90,a30
AR v91,a31
v_mul_f32 v88, v88, v83
v_mul_f32 v89, v89, v83
v_mul_f32 v90, v90, v83
v_mul_f32 v91, v91, v83
AW a28,v88
AW a29,v89
AW a30,v90
AW a31,v91
AR v88,a32
AR v89,a33
AR v90,a34
AR v91,a35
v_mul_f32 v88, v88, v84
v_mul_f32 v89, v89, v84
v_mul_f32 v90, v90, v84
v_mul_f32 v91, v91, v84
AW a32,v88
AW a33,v89
AW a34,v90
AW a35,v91
AR v88,a36
AR v89,a37
AR v90,a38
AR v91,a39
v_mul_f32 v88, v88, v85
v_mul_f32 v89, v89, v85
v_mul_f32 v90, v90, v85
v_mul_f32 v91, v91, v85
AW a36,v88
AW a37,v89
AW a38,v90
AW a39,v91
AR v88,a40
AR v89,a41
AR v90,a42
AR v91,a43
v_mul_f32 v88, v88, v81
v_mul_f32 v89, v89, v81
v_mul_f32 v90, v90, v81
v_mul_f32 v91, v91, v81
AW a40,v88
AW a41,v89
AW a42,v90
AW a43,v91
AR v88,a44
AR v89,a45
AR v90,a46
AR v91,a47
v_mul_f32 v88, v88, v82
v_mul_f32 v89, v89, v82
v_mul_f32 v90, v90, v82
v_mul_f32 v91, v91, v82
AW a44,v88
AW a45,v89
AW a46,v90
AW a47,v91
AR v88,a48
AR v89,a49
AR v90,a50
AR v91,a51
v_mul_f32 v88, v88, v83
v_mul_f32 v89, v89, v83
v_mul_f32 v90, v90, v83
v_mul_f32 v91, v91, v83
AW a48,v88
AW a49,v89
AW a50,v90
AW a51,v91
AR v88,a52
AR v89,a53
AR v90,a54
AR v91,a55
v_mul_f32 v88, v88, v84
v_mul_f32 v89, v89, v84
v_mul_f32 v90, v90, v84
v_mul_f32 v91, v91, v84
AW a52,v88
AW a53,v89
AW a54,v90
AW a55,v91
AR v88,a56
AR v89,a57
AR v90,a58
AR v91,a59
v_mul_f32 v88, v88, v85
v_mul_f32 v89, v89, v85
v_mul_f32 v90, v90, v85
v_mul_f32 v91, v91, v85
AW a56,v88
AW a57,v89
AW a58,v90
AW a59,v91
AR v88,a60
AR v89,a61
AR v90,a62
AR v91,a63
v_mul_f32 v88, v88, v81
v_mul_f32 v89, v89, v81
v_mul_f32 v90, v90, v81
v_mul_f32 v91, v91, v81
AW a60,v88
AW a61,v89
AW a62,v90
AW a63,v91
AR v88,a64
AR v89,a65
AR v90,a66
AR v91,a67
v_mul_f32 v88, v88, v82
v_mul_f32 v89, v89, v82
v_mul_f32 v90, v90, v82
v_mul_f32 v91, v91, v82
AW a64,v88
AW a65,v89
AW a66,v90
AW a67,v91
AR v88,a68
AR v89,a69
AR v90,a70
AR v91,a71
v_mul_f32 v88, v88, v83
v_mul_f32 v89, v89, v83
v_mul_f32 v90, v90, v83
v_mul_f32 v91, v91, v83
AW a68,v88
AW a69,v89
AW a70,v90
AW a71,v91
AR v88,a72
AR v89,a73
AR v90,a74
AR v91,a75
v_mul_f32 v88, v88, v84
v_mul_f32 v89, v89, v84
v_mul_f32 v90, v90, v84
v_mul_f32 v91, v91, v84
AW a72,v88
AW a73,v89
AW a74,v90
AW a75,v91
AR v88,a76
AR v89,a77
AR v90,a78
AR v91,a79
v_mul_f32 v88, v88, v85
v_mul_f32 v89, v89, v85
v_mul_f32 v90, v90, v85
v_mul_f32 v91, v91, v85
AW a76,v88
AW a77,v89
AW a78,v90
AW a79,v91
AR v88,a80
AR v89,a81
AR v90,a82
AR v91,a83
v_mul_f32 v88, v88, v81
v_mul_f32 v89, v89, v81
v_mul_f32 v90, v90, v81
v_mul_f32 v91, v91, v81
AW a80,v88
AW a81,v89
AW a82,v90
AW a83,v91
AR v88,a84
AR v89,a85
AR v90,a86
AR v91,a87
v_mul_f32 v88, v88, v82
v_mul_f32 v89, v89, v82
v_mul_f32 v90, v90, v82
v_mul_f32 v91, v91, v82
AW a84,v88
AW a85,v89
AW a86,v90
AW a87,v91
AR v88,a88
AR v89,a89
AR v90,a90
AR v91,a91
v_mul_f32 v88, v88, v83
v_mul_f32 v89, v89, v83
v_mul_f32 v90, v90, v83
v_mul_f32 v91, v91, v83
AW a88,v88
AW a89,v89
AW a90,v90
AW a91,v91
AR v88,a92
AR v89,a93
AR v90,a94
AR v91,a95
v_mul_f32 v88, v88, v84
v_mul_f32 v89, v89, v84
v_mul_f32 v90, v90, v84
v_mul_f32 v91, v91, v84
AW a92,v88
AW a93,v89
AW a94,v90
AW a95,v91
AR v88,a96
AR v89,a97
AR v90,a98
AR v91,a99
v_mul_f32 v88, v88, v85
v_mul_f32 v89, v89, v85
v_mul_f32 v90, v90, v85
v_mul_f32 v91, v91, v85
AW a96,v88
AW a97,v89
AW a98,v90
AW a99,v91
AR v88,a100
AR v89,a101
AR v90,a102
AR v91,a103
v_mul_f32 v88, v88, v81
v_mul_f32 v89, v89, v81
v_mul_f32 v90, v90, v81
v_mul_f32 v91, v91, v81
AW a100,v88
AW a101,v89
AW a102,v90
AW a103,v91
AR v88,a104
AR v89,a105
AR v90,a106
AR v91,a107
v_mul_f32 v88, v88, v82
v_mul_f32 v89, v89, v82
v_mul_f32 v90, v90, v82
v_mul_f32 v91, v91, v82
AW a104,v88
AW a105,v89
AW a106,v90
AW a107,v91
AR v88,a108
AR v89,a109
AR v90,a110
AR v91,a111
v_mul_f32 v88, v88, v83
v_mul_f32 v89, v89, v83
v_mul_f32 v90, v90, v83
v_mul_f32 v91, v91, v83
AW a108,v88
AW a109,v89
AW a110,v90
AW a111,v91
AR v88,a112
AR v89,a113
AR v90,a114
AR v91,a115
v_mul_f32 v88, v88, v84
v_mul_f32 v89, v89, v84
v_mul_f32 v90, v90, v84
v_mul_f32 v91, v91, v84
AW a112,v88
AW a113,v89
AW a114,v90
AW a115,v91
AR v88,a116
AR v89,a117
AR v90,a118
AR v91,a119
v_mul_f32 v88, v88, v85
v_mul_f32 v89, v89, v85
v_mul_f32 v90, v90, v85
v_mul_f32 v91, v91, v85
AW a116,v88
AW a117,v89
AW a118,v90
AW a119,v91
AR v88,a120
AR v89,a121
AR v90,a122
AR v91,a123
v_mul_f32 v88, v88, v81
v_mul_f32 v89, v89, v81
v_mul_f32 v90, v90, v81
v_mul_f32 v91, v91, v81
AW a120,v88
AW a121,v89
AW a122,v90
AW a123,v91
AR v88,a124
AR v89,a125
AR v90,a126
AR v91,a127
v_mul_f32 v88, v88, v82
v_mul_f32 v89, v89, v82
v_mul_f32 v90, v90, v82
v_mul_f32 v91, v91, v82
AW a124,v88
AW a125,v89
AW a126,v90
AW a127,v91
AR v88,a128
AR v89,a129
AR v90,a130
AR v91,a131
v_mul_f32 v88, v88, v83
v_mul_f32 v89, v89, v83
v_mul_f32 v90, v90, v83
v_mul_f32 v91, v91, v83
AW a128,v88
AW a129,v89
AW a130,v90
AW a131,v91
AR v88,a132
AR v89,a133
AR v90,a134
AR v91,a135
v_mul_f32 v88, v88, v84
v_mul_f32 v89, v89, v84
v_mul_f32 v90, v90, v84
v_mul_f32 v91, v91, v84
AW a132,v88
AW a133,v89
AW a134,v90
AW a135,v91
AR v88,a136
AR v89,a137
AR v90,a138
AR v91,a139
v_mul_f32 v88, v88, v85
v_mul_f32 v89, v89, v85
v_mul_f32 v90, v90, v85
v_mul_f32 v91, v91, v85
AW a136,v88
AW a137,v89
AW a138,v90
AW a139,v91
AR v88,a140
AR v89,a141
AR v90,a142
AR v91,a143
v_mul_f32 v88, v88, v81
v_mul_f32 v89, v89, v81
v_mul_f32 v90, v90, v81
v_mul_f32 v91, v91, v81
AW a140,v88
AW a141,v89
AW a142,v90
AW a143,v91
AR v88,a144
AR v89,a145
AR v90,a146
AR v91,a147
v_mul_f32 v88, v88, v82
v_mul_f32 v89, v89, v82
v_mul_f32 v90, v90, v82
v_mul_f32 v91, v91, v82
AW a144,v88
AW a145,v89
AW a146,v90
AW a147,v91
AR v88,a148
AR v89,a149
AR v90,a150
AR v91,a151
v_mul_f32 v88, v88, v83
v_mul_f32 v89, v89, v83
v_mul_f32 v90, v90, v83
v_mul_f32 v91, v91, v83
AW a148,v88
AW a149,v89
AW a150,v90
AW a151,v91
AR v88,a152
AR v89,a153
AR v90,a154
AR v91,a155
v_mul_f32 v88, v88, v84
v_mul_f32 v89, v89, v84
v_mul_f32 v90, v90, v84
v_mul_f32 v91, v91, v84
AW a152,v88
AW a153,v89
AW a154,v90
AW a155,v91
AR v88,a156
AR v89,a157
AR v90,a158
AR v91,a159
v_mul_f32 v88, v88, v85
v_mul_f32 v89, v89, v85
v_mul_f32 v90, v90, v85
v_mul_f32 v91, v91, v85
AW a156,v88
AW a157,v89
AW a158,v90
AW a159,v91
AR v88,a160
AR v89,a161
AR v90,a162
AR v91,a163
v_mul_f32 v88, v88, v81
v_mul_f32 v89, v89, v81
v_mul_f32 v90, v90, v81
v_mul_f32 v91, v91, v81
AW a160,v88
AW a161,v89
AW a162,v90
AW a163,v91
AR v88,a164
AR v89,a165
AR v90,a166
AR v91,a167
v_mul_f32 v88, v88, v82
v_mul_f32 v89, v89, v82
v_mul_f32 v90, v90, v82
v_mul_f32 v91, v91, v82
AW a164,v88
AW a165,v89
AW a166,v90
AW a167,v91
AR v88,a168
AR v89,a169
AR v90,a170
AR v91,a171
v_mul_f32 v88, v88, v83
v_mul_f32 v89, v89, v83
v_mul_f32 v90, v90, v83
v_mul_f32 v91, v91, v83
AW a168,v88
AW a169,v89
AW a170,v90
AW a171,v91
AR v88,a172
AR v89,a173
AR v90,a174
AR v91,a175
v_mul_f32 v88, v88, v84
v_mul_f32 v89, v89, v84
v_mul_f32 v90, v90, v84
v_mul_f32 v91, v91, v84
AW a172,v88
AW a173,v89
AW a174,v90
AW a175,v91
AR v88,a176
AR v89,a177
AR v90,a178
AR v91,a179
v_mul_f32 v88, v88, v85
v_mul_f32 v89, v89, v85
v_mul_f32 v90, v90, v85
v_mul_f32 v91, v91, v85
AW a176,v88
AW a177,v89
AW a178,v90
AW a179,v91
AR v88,a180
AR v89,a181
AR v90,a182
AR v91,a183
v_mul_f32 v88, v88, v81
v_mul_f32 v89, v89, v81
v_mul_f32 v90, v90, v81
v_mul_f32 v91, v91, v81
AW a180,v88
AW a181,v89
AW a182,v90
AW a183,v91
AR v88,a184
AR v89,a185
AR v90,a186
AR v91,a187
v_mul_f32 v88, v88, v82
v_mul_f32 v89, v89, v82
v_mul_f32 v90, v90, v82
v_mul_f32 v91, v91, v82
AW a184,v88
AW a185,v89
AW a186,v90
AW a187,v91
AR v88,a188
AR v89,a189
AR v90,a190
AR v91,a191
v_mul_f32 v88, v88, v83
v_mul_f32 v89, v89, v83
v_mul_f32 v90, v90, v83
v_mul_f32 v91, v91, v83
AW a188,v88
AW a189,v89
AW a190,v90
AW a191,v91
AR v88,a192
AR v89,a193
AR v90,a194
AR v91,a195
v_mul_f32 v88, v88, v84
v_mul_f32 v89, v89, v84
v_mul_f32 v90, v90, v84
v_mul_f32 v91, v91, v84
AW a192,v88
AW a193,v89
AW a194,v90
AW a195,v91
AR v88,a196
AR v89,a197
AR v90,a198
AR v91,a199
v_mul_f32 v88, v88, v85
v_mul_f32 v89, v89, v85
v_mul_f32 v90, v90, v85
v_mul_f32 v91, v91, v85
AW a196,v88
AW a197,v89
AW a198,v90
AW a199,v91
AR v88,a200
AR v89,a201
AR v90,a202
AR v91,a203
v_mul_f32 v88, v88, v81
v_mul_f32 v89, v89, v81
v_mul_f32 v90, v90, v81
v_mul_f32 v91, v91, v81
AW a200,v88
AW a201,v89
AW a202,v90
AW a203,v91
AR v88,a204
AR v89,a205
AR v90,a206
AR v91,a207
v_mul_f32 v88, v88, v82
v_mul_f32 v89, v89, v82
v_mul_f32 v90, v90, v82
v_mul_f32 v91, v91, v82
AW a204,v88
AW a205,v89
AW a206,v90
AW a207,v91
AR v88,a208
AR v89,a209
AR v90,a210
AR v91,a211
v_mul_f32 v88, v88, v83
v_mul_f32 v89, v89, v83
v_mul_f32 v90, v90, v83
v_mul_f32 v91, v91, v83
AW a208,v88
AW a209,v89
AW a210,v90
AW a211,v91
AR v88,a212
AR v89,a213
AR v90,a214
AR v91,a215
v_mul_f32 v88, v88, v84
v_mul_f32 v89, v89, v84
v_mul_f32 v90, v90, v84
v_mul_f32 v91, v91, v84
AW a212,v88
AW a213,v89
AW a214,v90
AW a215,v91
AR v88,a216
AR v89,a217
AR v90,a218
AR v91,a219
v_mul_f32 v88, v88, v85
v_mul_f32 v89, v89, v85
v_mul_f32 v90, v90, v85
v_mul_f32 v91, v91, v85
AW a216,v88
AW a217,v89
AW a218,v90
AW a219,v91
AR v88,a220
AR v89,a221
AR v90,a222
AR v91,a223
v_mul_f32 v88, v88, v81
v_mul_f32 v89, v89, v81
v_mul_f32 v90, v90, v81
v_mul_f32 v91, v91, v81
AW a220,v88
AW a221,v89
AW a222,v90
AW a223,v91
AR v88,a224
AR v89,a225
AR v90,a226
AR v91,a227
v_mul_f32 v88, v88, v82
v_mul_f32 v89, v89, v82
v_mul_f32 v90, v90, v82
v_mul_f32 v91, v91, v82
AW a224,v88
AW a225,v89
AW a226,v90
AW a227,v91
AR v88,a228
AR v89,a229
AR v90,a230
AR v91,a231
v_mul_f32 v88, v88, v83
v_mul_f32 v89, v89, v83
v_mul_f32 v90, v90, v83
v_mul_f32 v91, v91, v83
AW a228,v88
AW a229,v89
AW a230,v90
AW a231,v91
AR v88,a232
AR v89,a233
AR v90,a234
AR v91,a235
v_mul_f32 v88, v88, v84
v_mul_f32 v89, v89, v84
v_mul_f32 v90, v90, v84
v_mul_f32 v91, v91, v84
AW a232,v88
AW a233,v89
AW a234,v90
AW a235,v91
AR v88,a236
AR v89,a237
AR v90,a238
AR v91,a239
v_mul_f32 v88, v88, v85
v_mul_f32 v89, v89, v85
v_mul_f32 v90, v90, v85
v_mul_f32 v91, v91, v85
AW a236,v88
AW a237,v89
AW a238,v90
AW a239,v91
AR v88,a240
AR v89,a241
AR v90,a242
AR v91,a243
v_mul_f32 v88, v88, v81
v_mul_f32 v89, v89, v81
v_mul_f32 v90, v90, v81
v_mul_f32 v91, v91, v81
AW a240,v88
AW a241,v89
AW a242,v90
AW a243,v91
AR v88,a244
AR v89,a245
AR v90,a246
AR v91,a247
v_mul_f32 v88, v88, v82
v_mul_f32 v89, v89, v82
v_mul_f32 v90, v90, v82
v_mul_f32 v91, v91, v82
AW a244,v88
AW a245,v89
AW a246,v90
AW a247,v91
AR v88,a248
AR v89,a249
AR v90,a250
AR v91,a251
v_mul_f32 v88, v88, v83
v_mul_f32 v89, v89, v83
v_mul_f32 v90, v90, v83
v_mul_f32 v91, v91, v83
AW a248,v88
AW a249,v89
AW a250,v90
AW a251,v91
AR v88,a252
AR v89,a253
AR v90,a254
AR v91,a255
v_mul_f32 v88, v88, v84
v_mul_f32 v89, v89, v84
v_mul_f32 v90, v90, v84
v_mul_f32 v91, v91, v84
AW a252,v88
AW a253,v89
AW a254,v90
AW a255,v91
v_mul_f32 v192, v192, v85
v_mul_f32 v193, v193, v85
v_mul_f32 v194, v194, v85
v_mul_f32 v195, v195, v85
v_mul_f32 v196, v196, v81
v_mul_f32 v197, v197, v81
v_mul_f32 v198, v198, v81
v_mul_f32 v199, v199, v81
v_mul_f32 v200, v200, v82
v_mul_f32 v201, v201, v82
v_mul_f32 v202, v202, v82
v_mul_f32 v203, v203, v82
v_mul_f32 v204, v204, v83
v_mul_f32 v205, v205, v83
v_mul_f32 v206, v206, v83
v_mul_f32 v207, v207, v83
v_mul_f32 v208, v208, v84
v_mul_f32 v209, v209, v84
v_mul_f32 v210, v210, v84
v_mul_f32 v211, v211, v84
v_mul_f32 v212, v212, v85
v_mul_f32 v213, v213, v85
v_mul_f32 v214, v214, v85
v_mul_f32 v215, v215, v85
v_mul_f32 v216, v216, v81
v_mul_f32 v217, v217, v81
v_mul_f32 v218, v218, v81
v_mul_f32 v219, v219, v81
v_mul_f32 v220, v220, v82
v_mul_f32 v221, v221, v82
v_mul_f32 v222, v222, v82
v_mul_f32 v223, v223, v82
v_mul_f32 v224, v224, v83
v_mul_f32 v225, v225, v83
v_mul_f32 v226, v226, v83
v_mul_f32 v227, v227, v83
v_mul_f32 v228, v228, v84
v_mul_f32 v229, v229, v84
v_mul_f32 v230, v230, v84
v_mul_f32 v231, v231, v84
v_mul_f32 v232, v232, v85
v_mul_f32 v233, v233, v85
v_mul_f32 v234, v234, v85
v_mul_f32 v235, v235, v85
v_mul_f32 v236, v236, v81
v_mul_f32 v237, v237, v81
v_mul_f32 v238, v238, v81
v_mul_f32 v239, v239, v81
v_mul_f32 v240, v240, v82
v_mul_f32 v241, v241, v82
v_mul_f32 v242, v242, v82
v_mul_f32 v243, v243, v82
v_mul_f32 v244, v244, v83
v_mul_f32 v245, v245, v83
v_mul_f32 v246, v246, v83
v_mul_f32 v247, v247, v83
v_mul_f32 v248, v248, v84
v_mul_f32 v249, v249, v84
v_mul_f32 v250, v250, v84
v_mul_f32 v251, v251, v84
v_mul_f32 v252, v252, v85
v_mul_f32 v253, v253, v85
v_mul_f32 v254, v254, v85
v_mul_f32 v255, v255, v85
s_nop 1
TR v[12:13],v1,0
TR v[14:15],v1,8192
WL 0
M a[0:3],v[12:15],v[36:39],a[0:3]
M a[4:7],v[12:15],v[40:43],a[4:7]
M a[8:11],v[12:15],v[44:47],a[8:11]
M a[12:15],v[12:15],v[48:51],a[12:15]
M a[16:19],v[12:15],v[52:55],a[16:19]
TR v[16:17],v9,0
TR v[18:19],v9,8192
WL 0
M a[20:23],v[16:19],v[36:39],a[20:23]
M a[24:27],v[16:19],v[40:43],a[24:27]
M a[28:31],v[16:19],v[44:47],a[28:31]
M a[32:35],v[16:19],v[48:51],a[32:35]
M a[36:39],v[16:19],v[52:55],a[36:39]
TR v[20:21],v1,512
TR v[22:23],v1,8704
WL 0
M a[40:43],v[20:23],v[36:39],a[40:43]
M a[44:47],v[20:23],v[40:43],a[44:47]
M a[48:51],v[20:23],v[44:47],a[48:51]
M a[52:55],v[20:23],v[48:51],a[52:55]
M a[56:59],v[20:23],v[52:55],a[56:59]
TR v[24:25],v9,512
TR v[26:27],v9,8704
WL 0
M a[60:63],v[24:27],v[36:39],a[60:63]
M a[64:67],v[24:27],v[40:43],a[64:67]
M a[68:71],v[24:27],v[44:47],a[68:71]
M a[72:75],v[24:27],v[48:51],a[72:75]
M a[76:79],v[24:27],v[52:55],a[76:79]
TR v[12:13],v1,1024
TR v[14:15],v1,9216
WL 0
M a[80:83],v[12:15],v[36:39],a[80:83]
M a[84:87],v[12:15],v[40:43],a[84:87]
M a[88:91],v[12:15],v[44:47],a[88:91]
M a[92:95],v[12:15],v[48:51],a[92:95]
M a[96:99],v[12:15],v[52:55],a[96:99]
TR v[16:17],v9,1024
TR v[18:19],v9,9216
WL 0
M a[100:103],v[16:19],v[36:39],a[100:103]
M a[104:107],v[16:19],v[40:43],a[104:107]
M a[108:111],v[16:19],v[44:47],a[108:111]
M a[112:115],v[16:19],v[48:51],a[112:115]
M a[116:119],v[16:19],v[52:55],a[116:119]
TR v[20:21],v1,1536
TR v[22:23],v1,9728
WL 0
M a[120:123],v[20:23],v[36:39],a[120:123]
M a[124:127],v[20:23],v[40:43],a[124:127]
M a[128:131],v[20:23],v[44:47],a[128:131]
M a[132:135],v[20:23],v[48:51],a[132:135]
M a[136:139],v[20:23],v[52:55],a[136:139]
TR v[24:25],v9,1536
TR v[26:27],v9,9728
WL 0
M a[140:143],v[24:27],v[36:39],a[140:143]
M a[144:147],v[24:27],v[40:43],a[144:147]
M a[148:151],v[24:27],v[44:47],a[148:151]
M a[152:155],v[24:27],v[48:51],a[152:155]
M a[156:159],v[24:27],v[52:55],a[156:159]
TR v[12:13],v1,2048
TR v[14:15],v1,10240
WL 0
M a[160:163],v[12:15],v[36:39],a[160:163]
M a[164:167],v[12:15],v[40:43],a[164:167]
M a[168:171],v[12:15],v[44:47],a[168:171]
M a[172:175],v[12:15],v[48:51],a[172:175]
M a[176:179],v[12:15],v[52:55],a[176:179]
TR v[16:17],v9,2048
TR v[18:19],v9,10240
WL 0
M a[180:183],v[16:19],v[36:39],a[180:183]
M a[184:187],v[16:19],v[40:43],a[184:187]
M a[188:191],v[16:19],v[44:47],a[188:191]
M a[192:195],v[16:19],v[48:51],a[192:195]
M a[196:199],v[16:19],v[52:55],a[196:199]
TR v[20:21],v1,2560
TR v[22:23],v1,10752
WL 0
M a[200:203],v[20:23],v[36:39],a[200:203]
M a[204:207],v[20:23],v[40:43],a[204:207]
M a[208:211],v[20:23],v[44:47],a[208:211]
M a[212:215],v[20:23],v[48:51],a[212:215]
M a[216:219],v[20:23],v[52:55],a[216:219]
TR v[24:25],v9,2560
TR v[26:27],v9,10752
WL 0
M a[220:223],v[24:27],v[36:39],a[220:223]
M a[224:227],v[24:27],v[40:43],a[224:227]
M a[228:231],v[24:27],v[44:47],a[228:231]
M a[232:235],v[24:27],v[48:51],a[232:235]
M a[236:239],v[24:27],v[52:55],a[236:239]
TR v[12:13],v1,3072
TR v[14:15],v1,11264
WL 0
M a[240:243],v[12:15],v[36:39],a[240:243]
M a[244:247],v[12:15],v[40:43],a[244:247]
M a[248:251],v[12:15],v[44:47],a[248:251]
M a[252:255],v[12:15],v[48:51],a[252:255]
M v[192:195],v[12:15],v[52:55],v[192:195]
TR v[16:17],v9,3072
TR v[18:19],v9,11264
WL 0
M v[196:199],v[16:19],v[36:39],v[196:199]
M v[200:203],v[16:19],v[40:43],v[200:203]
M v[204:207],v[16:19],v[44:47],v[204:207]
M v[208:211],v[16:19],v[48:51],v[208:211]
M v[212:215],v[16:19],v[52:55],v[212:215]
TR v[20:21],v1,3584
TR v[22:23],v1,11776
WL 0
M v[216:219],v[20:23],v[36:39],v[216:219]
M v[220:223],v[20:23],v[40:43],v[220:223]
M v[224:227],v[20:23],v[44:47],v[224:227]
M v[228:231],v[20:23],v[48:51],v[228:231]
M v[232:235],v[20:23],v[52:55],v[232:235]
TR v[24:25],v9,3584
TR v[26:27],v9,11776
WL 0
M v[236:239],v[24:27],v[36:39],v[236:239]
M v[240:243],v[24:27],v[40:43],v[240:243]
M v[244:247],v[24:27],v[44:47],v[244:247]
M v[248:251],v[24:27],v[48:51],v[248:251]
M v[252:255],v[24:27],v[52:55],v[252:255]
s_sub_u32 s52, s52, 1
s_cmp_lg_u32 s52, 0
s_nop 7
s_cbranch_scc1 L1_slowloop_5
s_nop 7
v_mov_b32 v56, v4
v_mov_b32 v57, v4
v_mov_b32 v58, v5
v_mov_b32 v59, v5
v_mov_b32 v60, v6
v_mov_b32 v61, v6
v_mov_b32 v62, v7
v_mov_b32 v63, v7
v_mov_b32 v64, v8
v_mov_b32 v65, v8
s_nop 1
v_permlane32_swap_b32 v56, v57
v_permlane32_swap_b32 v58, v59
v_permlane32_swap_b32 v60, v61
v_permlane32_swap_b32 v62, v63
v_permlane32_swap_b32 v64, v65
s_nop 1
v_add_f32 v4, v56, v57
v_add_f32 v5, v58, v59
v_add_f32 v6, v60, v61
v_add_f32 v7, v62, v63
v_add_f32 v8, v64, v65
v_mov_b32 v56, v4
v_mov_b32 v57, v4
v_mov_b32 v58, v5
v_mov_b32 v59, v5
v_mov_b32 v60, v6
v_mov_b32 v61, v6
v_mov_b32 v62, v7
v_mov_b32 v63, v7
v_mov_b32 v64, v8
v_mov_b32 v65, v8
s_nop 1
v_permlane16_swap_b32 v56, v57
v_permlane16_swap_b32 v58, v59
v_permlane16_swap_b32 v60, v61
v_permlane16_swap_b32 v62, v63
v_permlane16_swap_b32 v64, v65
s_nop 1
v_add_f32 v4, v56, v57
v_add_f32 v5, v58, v59
v_add_f32 v6, v60, v61
v_add_f32 v7, v62, v63
v_add_f32 v8, v64, v65
s_branch L1_norm_5
L1_slow_4:
s_waitcnt vmcnt(0) lgkmcnt(0)
v_mov_b32 v76, 0xff800000
v_mov_b32 v4, 0
v_mov_b32 v77, 0xff800000
v_mov_b32 v5, 0
v_mov_b32 v78, 0xff800000
v_mov_b32 v6, 0
v_mov_b32 v79, 0xff800000
v_mov_b32 v7, 0
AW a0,0
AW a1,0
AW a2,0
AW a3,0
AW a4,0
AW a5,0
AW a6,0
AW a7,0
AW a8,0
AW a9,0
AW a10,0
AW a11,0
AW a12,0
AW a13,0
AW a14,0
AW a15,0
AW a16,0
AW a17,0
AW a18,0
AW a19,0
AW a20,0
AW a21,0
AW a22,0
AW a23,0
AW a24,0
AW a25,0
AW a26,0
AW a27,0
AW a28,0
AW a29,0
AW a30,0
AW a31,0
AW a32,0
AW a33,0
AW a34,0
AW a35,0
AW a36,0
AW a37,0
AW a38,0
AW a39,0
AW a40,0
AW a41,0
AW a42,0
AW a43,0
AW a44,0
AW a45,0
AW a46,0
AW a47,0
AW a48,0
AW a49,0
AW a50,0
AW a51,0
AW a52,0
AW a53,0
AW a54,0
AW a55,0
AW a56,0
AW a57,0
AW a58,0
AW a59,0
AW a60,0
AW a61,0
AW a62,0
AW a63,0
AW a64,0
AW a65,0
AW a66,0
AW a67,0
AW a68,0
AW a69,0
AW a70,0
AW a71,0
AW a72,0
AW a73,0
AW a74,0
AW a75,0
AW a76,0
AW a77,0
AW a78,0
AW a79,0
AW a80,0
AW a81,0
AW a82,0
AW a83,0
AW a84,0
AW a85,0
AW a86,0
AW a87,0
AW a88,0
AW a89,0
AW a90,0
AW a91,0
AW a92,0
AW a93,0
AW a94,0
AW a95,0
AW a96,0
AW a97,0
AW a98,0
AW a99,0
AW a100,0
AW a101,0
AW a102,0
AW a103,0
AW a104,0
AW a105,0
AW a106,0
AW a107,0
AW a108,0
AW a109,0
AW a110,0
AW a111,0
AW a112,0
AW a113,0
AW a114,0
AW a115,0
AW a116,0
AW a117,0
AW a118,0
AW a119,0
AW a120,0
AW a121,0
AW a122,0
AW a123,0
AW a124,0
AW a125,0
AW a126,0
AW a127,0
AW a128,0
AW a129,0
AW a130,0
AW a131,0
AW a132,0
AW a133,0
AW a134,0
AW a135,0
AW a136,0
AW a137,0
AW a138,0
AW a139,0
AW a140,0
AW a141,0
AW a142,0
AW a143,0
AW a144,0
AW a145,0
AW a146,0
AW a147,0
AW a148,0
AW a149,0
AW a150,0
AW a151,0
AW a152,0
AW a153,0
AW a154,0
AW a155,0
AW a156,0
AW a157,0
AW a158,0
AW a159,0
AW a160,0
AW a161,0
AW a162,0
AW a163,0
AW a164,0
AW a165,0
AW a166,0
AW a167,0
AW a168,0
AW a169,0
AW a170,0
AW a171,0
AW a172,0
AW a173,0
AW a174,0
AW a175,0
AW a176,0
AW a177,0
AW a178,0
AW a179,0
AW a180,0
AW a181,0
AW a182,0
AW a183,0
AW a184,0
AW a185,0
AW a186,0
AW a187,0
AW a188,0
AW a189,0
AW a190,0
AW a191,0
AW a192,0
AW a193,0
AW a194,0
AW a195,0
AW a196,0
AW a197,0
AW a198,0
AW a199,0
AW a200,0
AW a201,0
AW a202,0
AW a203,0
AW a204,0
AW a205,0
AW a206,0
AW a207,0
AW a208,0
AW a209,0
AW a210,0
AW a211,0
AW a212,0
AW a213,0
AW a214,0
AW a215,0
AW a216,0
AW a217,0
AW a218,0
AW a219,0
AW a220,0
AW a221,0
AW a222,0
AW a223,0
AW a224,0
AW a225,0
AW a226,0
AW a227,0
AW a228,0
AW a229,0
AW a230,0
AW a231,0
AW a232,0
AW a233,0
AW a234,0
AW a235,0
AW a236,0
AW a237,0
AW a238,0
AW a239,0
AW a240,0
AW a241,0
AW a242,0
AW a243,0
AW a244,0
AW a245,0
AW a246,0
AW a247,0
AW a248,0
AW a249,0
AW a250,0
AW a251,0
AW a252,0
AW a253,0
AW a254,0
AW a255,0
v_subrev_u32 v88, s62, v2
v_lshrrev_b32 v88, 4, v88
v_bfe_u32 v89, v88, 2, 1
v_lshlrev_b32 v89, 1, v89
v_lshrrev_b32 v0, 4, v88
v_xor_b32 v89, v89, v0
v_lshlrev_b32 v0, 4, v89
v_and_b32 v89, 7, v88
v_lshl_add_u32 v0, v89, 6, v0
v_bfe_u32 v89, v88, 3, 1
v_lshl_add_u32 v0, v89, 12, v0
v_add_u32 v0, 65536, v0
v_lshrrev_b32 v89, 5, v88
v_lshlrev_b32 v1, 12, v89
v_bfe_u32 v89, v88, 2, 3
v_lshl_add_u32 v1, v89, 6, v1
v_bfe_u32 v89, v88, 4, 1
v_lshl_add_u32 v1, v89, 5, v1
v_and_b32 v89, 3, v88
v_lshl_add_u32 v1, v89, 3, v1
v_add_u32 v1, 81920, v1
v_xor_b32 v9, 32, v1
s_sub_u32 s42, s53, 65536
s_mov_b32 s52, 32
L1_slowloop_4:
s_barrier
s_add_u32 m0, s53, 0
s_nop 0
buffer_load_dwordx4 v3, s[16:19], s42 offen offset:0 nt lds
s_add_u32 m0, s53, 896
s_nop 0
buffer_load_dwordx4 v3, s[16:19], s42 offen offset:128 nt lds
s_add_u32 m0, s53, 1792
s_nop 0
buffer_load_dwordx4 v3, s[16:19], s42 offen offset:256 nt lds
s_add_u32 m0, s53, 2688
s_nop 0
buffer_load_dwordx4 v3, s[16:19], s42 offen offset:384 nt lds
s_add_u32 m0, s53, 16384
s_nop 0
buffer_load_dwordx4 v3, s[20:23], s42 offen offset:0 nt lds
s_add_u32 m0, s53, 17280
s_nop 0
buffer_load_dwordx4 v3, s[20:23], s42 offen offset:128 nt lds
s_add_u32 m0, s53, 18176
s_nop 0
buffer_load_dwordx4 v3, s[20:23], s42 offen offset:256 nt lds
s_add_u32 m0, s53, 19072
s_nop 0
buffer_load_dwordx4 v3, s[20:23], s42 offen offset:384 nt lds
s_add_u32 s42, s42, 16384
WV 0
s_barrier
RD v[12:15],v0,0
RD v[16:19],v0,8192
WL 1
M v[36:39],v[12:15],v[96:99],0
M v[40:43],v[12:15],v[128:131],0
M v[44:47],v[12:15],v[160:163],0
M v[48:51],v[12:15],v[192:195],0
WL 0
M v[56:59],v[16:19],v[96:99],0
M v[60:63],v[16:19],v[128:131],0
M v[64:67],v[16:19],v[160:163],0
M v[68:71],v[16:19],v[192:195],0
RD v[20:23],v0,512
RD v[24:27],v0,8704
WL 1
M v[36:39],v[20:23],v[100:103],v[36:39]
M v[40:43],v[20:23],v[132:135],v[40:43]
M v[44:47],v[20:23],v[164:167],v[44:47]
M v[48:51],v[20:23],v[196:199],v[48:51]
WL 0
M v[56:59],v[24:27],v[100:103],v[56:59]
M v[60:63],v[24:27],v[132:135],v[60:63]
M v[64:67],v[24:27],v[164:167],v[64:67]
M v[68:71],v[24:27],v[196:199],v[68:71]
RD v[12:15],v0,1024
RD v[16:19],v0,9216
WL 1
M v[36:39],v[12:15],v[104:107],v[36:39]
M v[40:43],v[12:15],v[136:139],v[40:43]
M v[44:47],v[12:15],v[168:171],v[44:47]
M v[48:51],v[12:15],v[200:203],v[48:51]
WL 0
M v[56:59],v[16:19],v[104:107],v[56:59]
M v[60:63],v[16:19],v[136:139],v[60:63]
M v[64:67],v[16:19],v[168:171],v[64:67]
M v[68:71],v[16:19],v[200:203],v[68:71]
RD v[20:23],v0,1536
RD v[24:27],v0,9728
WL 1
M v[36:39],v[20:23],v[108:111],v[36:39]
M v[40:43],v[20:23],v[140:143],v[40:43]
M v[44:47],v[20:23],v[172:175],v[44:47]
M v[48:51],v[20:23],v[204:207],v[48:51]
WL 0
M v[56:59],v[24:27],v[108:111],v[56:59]
M v[60:63],v[24:27],v[140:143],v[60:63]
M v[64:67],v[24:27],v[172:175],v[64:67]
M v[68:71],v[24:27],v[204:207],v[68:71]
RD v[12:15],v0,2048
RD v[16:19],v0,10240
WL 1
M v[36:39],v[12:15],v[112:115],v[36:39]
M v[40:43],v[12:15],v[144:147],v[40:43]
M v[44:47],v[12:15],v[176:179],v[44:47]
M v[48:51],v[12:15],v[208:211],v[48:51]
WL 0
M v[56:59],v[16:19],v[112:115],v[56:59]
M v[60:63],v[16:19],v[144:147],v[60:63]
M v[64:67],v[16:19],v[176:179],v[64:67]
M v[68:71],v[16:19],v[208:211],v[68:71]
RD v[20:23],v0,2560
RD v[24:27],v0,10752
WL 1
M v[36:39],v[20:23],v[116:119],v[36:39]
M v[40:43],v[20:23],v[148:151],v[40:43]
M v[44:47],v[20:23],v[180:183],v[44:47]
M v[48:51],v[20:23],v[212:215],v[48:51]
WL 0
M v[56:59],v[24:27],v[116:119],v[56:59]
M v[60:63],v[24:27],v[148:151],v[60:63]
M v[64:67],v[24:27],v[180:183],v[64:67]
M v[68:71],v[24:27],v[212:215],v[68:71]
RD v[12:15],v0,3072
RD v[16:19],v0,11264
WL 1
M v[36:39],v[12:15],v[120:123],v[36:39]
M v[40:43],v[12:15],v[152:155],v[40:43]
M v[44:47],v[12:15],v[184:187],v[44:47]
M v[48:51],v[12:15],v[216:219],v[48:51]
WL 0
M v[56:59],v[16:19],v[120:123],v[56:59]
M v[60:63],v[16:19],v[152:155],v[60:63]
M v[64:67],v[16:19],v[184:187],v[64:67]
M v[68:71],v[16:19],v[216:219],v[68:71]
RD v[20:23],v0,3584
RD v[24:27],v0,11776
WL 1
M v[36:39],v[20:23],v[124:127],v[36:39]
M v[40:43],v[20:23],v[156:159],v[40:43]
M v[44:47],v[20:23],v[188:191],v[44:47]
M v[48:51],v[20:23],v[220:223],v[48:51]
WL 0
M v[56:59],v[24:27],v[124:127],v[56:59]
M v[60:63],v[24:27],v[156:159],v[60:63]
M v[64:67],v[24:27],v[188:191],v[64:67]
M v[68:71],v[24:27],v[220:223],v[68:71]
s_nop 7
v_max3_f32 v81, v36, v37, v38
v_max3_f32 v81, v81, v39, v56
v_max3_f32 v81, v81, v57, v58
v_max_f32 v81, v81, v59
v_max3_f32 v82, v40, v41, v42
v_max3_f32 v82, v82, v43, v60
v_max3_f32 v82, v82, v61, v62
v_max_f32 v82, v82, v63
v_max3_f32 v83, v44, v45, v46
v_max3_f32 v83, v83, v47, v64
v_max3_f32 v83, v83, v65, v66
v_max_f32 v83, v83, v67
v_max3_f32 v84, v48, v49, v50
v_max3_f32 v84, v84, v51, v68
v_max3_f32 v84, v84, v69, v70
v_max_f32 v84, v84, v71
v_mov_b32 v86, v81
v_mov_b32 v87, v81
s_nop 1
v_permlane32_swap_b32 v86, v87
s_nop 1
v_max_f32 v81, v86, v87
v_mov_b32 v86, v82
v_mov_b32 v87, v82
s_nop 1
v_permlane32_swap_b32 v86, v87
s_nop 1
v_max_f32 v82, v86, v87
v_mov_b32 v86, v83
v_mov_b32 v87, v83
s_nop 1
v_permlane32_swap_b32 v86, v87
s_nop 1
v_max_f32 v83, v86, v87
v_mov_b32 v86, v84
v_mov_b32 v87, v84
s_nop 1
v_permlane32_swap_b32 v86, v87
s_nop 1
v_max_f32 v84, v86, v87
v_mov_b32 v86, v81
v_mov_b32 v87, v81
s_nop 1
v_permlane16_swap_b32 v86, v87
s_nop 1
v_max_f32 v81, v86, v87
v_mov_b32 v86, v82
v_mov_b32 v87, v82
s_nop 1
v_permlane16_swap_b32 v86, v87
s_nop 1
v_max_f32 v82, v86, v87
v_mov_b32 v86, v83
v_mov_b32 v87, v83
s_nop 1
v_permlane16_swap_b32 v86, v87
s_nop 1
v_max_f32 v83, v86, v87
v_mov_b32 v86, v84
v_mov_b32 v87, v84
s_nop 1
v_permlane16_swap_b32 v86, v87
s_nop 1
v_max_f32 v84, v86, v87
v_max_f32 v88, v76, v81
v_sub_f32 v81, v76, v88
v_mov_b32 v76, v88
v_exp_f32 v81, v81
v_sub_f32 v36, v36, v88
v_sub_f32 v37, v37, v88
v_sub_f32 v38, v38, v88
v_sub_f32 v39, v39, v88
v_sub_f32 v56, v56, v88
v_sub_f32 v57, v57, v88
v_sub_f32 v58, v58, v88
v_sub_f32 v59, v59, v88
v_exp_f32 v36, v36
v_exp_f32 v37, v37
v_exp_f32 v38, v38
v_exp_f32 v39, v39
v_exp_f32 v56, v56
v_exp_f32 v57, v57
v_exp_f32 v58, v58
v_exp_f32 v59, v59
s_nop 0
v_mul_f32 v4, v4, v81
v_add_f32 v4, v4, v36
v_add_f32 v4, v4, v37
v_add_f32 v4, v4, v38
v_add_f32 v4, v4, v39
v_add_f32 v4, v4, v56
v_add_f32 v4, v4, v57
v_add_f32 v4, v4, v58
v_add_f32 v4, v4, v59
CV v36,v36,v37
CV v37,v38,v39
CV v38,v56,v57
CV v39,v58,v59
v_max_f32 v88, v77, v82
v_sub_f32 v82, v77, v88
v_mov_b32 v77, v88
v_exp_f32 v82, v82
v_sub_f32 v40, v40, v88
v_sub_f32 v41, v41, v88
v_sub_f32 v42, v42, v88
v_sub_f32 v43, v43, v88
v_sub_f32 v60, v60, v88
v_sub_f32 v61, v61, v88
v_sub_f32 v62, v62, v88
v_sub_f32 v63, v63, v88
v_exp_f32 v40, v40
v_exp_f32 v41, v41
v_exp_f32 v42, v42
v_exp_f32 v43, v43
v_exp_f32 v60, v60
v_exp_f32 v61, v61
v_exp_f32 v62, v62
v_exp_f32 v63, v63
s_nop 0
v_mul_f32 v5, v5, v82
v_add_f32 v5, v5, v40
v_add_f32 v5, v5, v41
v_add_f32 v5, v5, v42
v_add_f32 v5, v5, v43
v_add_f32 v5, v5, v60
v_add_f32 v5, v5, v61
v_add_f32 v5, v5, v62
v_add_f32 v5, v5, v63
CV v40,v40,v41
CV v41,v42,v43
CV v42,v60,v61
CV v43,v62,v63
v_max_f32 v88, v78, v83
v_sub_f32 v83, v78, v88
v_mov_b32 v78, v88
v_exp_f32 v83, v83
v_sub_f32 v44, v44, v88
v_sub_f32 v45, v45, v88
v_sub_f32 v46, v46, v88
v_sub_f32 v47, v47, v88
v_sub_f32 v64, v64, v88
v_sub_f32 v65, v65, v88
v_sub_f32 v66, v66, v88
v_sub_f32 v67, v67, v88
v_exp_f32 v44, v44
v_exp_f32 v45, v45
v_exp_f32 v46, v46
v_exp_f32 v47, v47
v_exp_f32 v64, v64
v_exp_f32 v65, v65
v_exp_f32 v66, v66
v_exp_f32 v67, v67
s_nop 0
v_mul_f32 v6, v6, v83
v_add_f32 v6, v6, v44
v_add_f32 v6, v6, v45
v_add_f32 v6, v6, v46
v_add_f32 v6, v6, v47
v_add_f32 v6, v6, v64
v_add_f32 v6, v6, v65
v_add_f32 v6, v6, v66
v_add_f32 v6, v6, v67
CV v44,v44,v45
CV v45,v46,v47
CV v46,v64,v65
CV v47,v66,v67
v_max_f32 v88, v79, v84
v_sub_f32 v84, v79, v88
v_mov_b32 v79, v88
v_exp_f32 v84, v84
v_sub_f32 v48, v48, v88
v_sub_f32 v49, v49, v88
v_sub_f32 v50, v50, v88
v_sub_f32 v51, v51, v88
v_sub_f32 v68, v68, v88
v_sub_f32 v69, v69, v88
v_sub_f32 v70, v70, v88
v_sub_f32 v71, v71, v88
v_exp_f32 v48, v48
v_exp_f32 v49, v49
v_exp_f32 v50, v50
v_exp_f32 v51, v51
v_exp_f32 v68, v68
v_exp_f32 v69, v69
v_exp_f32 v70, v70
v_exp_f32 v71, v71
s_nop 0
v_mul_f32 v7, v7, v84
v_add_f32 v7, v7, v48
v_add_f32 v7, v7, v49
v_add_f32 v7, v7, v50
v_add_f32 v7, v7, v51
v_add_f32 v7, v7, v68
v_add_f32 v7, v7, v69
v_add_f32 v7, v7, v70
v_add_f32 v7, v7, v71
CV v48,v48,v49
CV v49,v50,v51
CV v50,v68,v69
CV v51,v70,v71
AR v88,a0
AR v89,a1
AR v90,a2
AR v91,a3
v_mul_f32 v88, v88, v81
v_mul_f32 v89, v89, v81
v_mul_f32 v90, v90, v81
v_mul_f32 v91, v91, v81
AW a0,v88
AW a1,v89
AW a2,v90
AW a3,v91
AR v88,a4
AR v89,a5
AR v90,a6
AR v91,a7
v_mul_f32 v88, v88, v82
v_mul_f32 v89, v89, v82
v_mul_f32 v90, v90, v82
v_mul_f32 v91, v91, v82
AW a4,v88
AW a5,v89
AW a6,v90
AW a7,v91
AR v88,a8
AR v89,a9
AR v90,a10
AR v91,a11
v_mul_f32 v88, v88, v83
v_mul_f32 v89, v89, v83
v_mul_f32 v90, v90, v83
v_mul_f32 v91, v91, v83
AW a8,v88
AW a9,v89
AW a10,v90
AW a11,v91
AR v88,a12
AR v89,a13
AR v90,a14
AR v91,a15
v_mul_f32 v88, v88, v84
v_mul_f32 v89, v89, v84
v_mul_f32 v90, v90, v84
v_mul_f32 v91, v91, v84
AW a12,v88
AW a13,v89
AW a14,v90
AW a15,v91
AR v88,a16
AR v89,a17
AR v90,a18
AR v91,a19
v_mul_f32 v88, v88, v81
v_mul_f32 v89, v89, v81
v_mul_f32 v90, v90, v81
v_mul_f32 v91, v91, v81
AW a16,v88
AW a17,v89
AW a18,v90
AW a19,v91
AR v88,a20
AR v89,a21
AR v90,a22
AR v91,a23
v_mul_f32 v88, v88, v82
v_mul_f32 v89, v89, v82
v_mul_f32 v90, v90, v82
v_mul_f32 v91, v91, v82
AW a20,v88
AW a21,v89
AW a22,v90
AW a23,v91
AR v88,a24
AR v89,a25
AR v90,a26
AR v91,a27
v_mul_f32 v88, v88, v83
v_mul_f32 v89, v89, v83
v_mul_f32 v90, v90, v83
v_mul_f32 v91, v91, v83
AW a24,v88
AW a25,v89
AW a26,v90
AW a27,v91
AR v88,a28
AR v89,a29
AR v90,a30
AR v91,a31
v_mul_f32 v88, v88, v84
v_mul_f32 v89, v89, v84
v_mul_f32 v90, v90, v84
v_mul_f32 v91, v91, v84
AW a28,v88
AW a29,v89
AW a30,v90
AW a31,v91
AR v88,a32
AR v89,a33
AR v90,a34
AR v91,a35
v_mul_f32 v88, v88, v81
v_mul_f32 v89, v89, v81
v_mul_f32 v90, v90, v81
v_mul_f32 v91, v91, v81
AW a32,v88
AW a33,v89
AW a34,v90
AW a35,v91
AR v88,a36
AR v89,a37
AR v90,a38
AR v91,a39
v_mul_f32 v88, v88, v82
v_mul_f32 v89, v89, v82
v_mul_f32 v90, v90, v82
v_mul_f32 v91, v91, v82
AW a36,v88
AW a37,v89
AW a38,v90
AW a39,v91
AR v88,a40
AR v89,a41
AR v90,a42
AR v91,a43
v_mul_f32 v88, v88, v83
v_mul_f32 v89, v89, v83
v_mul_f32 v90, v90, v83
v_mul_f32 v91, v91, v83
AW a40,v88
AW a41,v89
AW a42,v90
AW a43,v91
AR v88,a44
AR v89,a45
AR v90,a46
AR v91,a47
v_mul_f32 v88, v88, v84
v_mul_f32 v89, v89, v84
v_mul_f32 v90, v90, v84
v_mul_f32 v91, v91, v84
AW a44,v88
AW a45,v89
AW a46,v90
AW a47,v91
AR v88,a48
AR v89,a49
AR v90,a50
AR v91,a51
v_mul_f32 v88, v88, v81
v_mul_f32 v89, v89, v81
v_mul_f32 v90, v90, v81
v_mul_f32 v91, v91, v81
AW a48,v88
AW a49,v89
AW a50,v90
AW a51,v91
AR v88,a52
AR v89,a53
AR v90,a54
AR v91,a55
v_mul_f32 v88, v88, v82
v_mul_f32 v89, v89, v82
v_mul_f32 v90, v90, v82
v_mul_f32 v91, v91, v82
AW a52,v88
AW a53,v89
AW a54,v90
AW a55,v91
AR v88,a56
AR v89,a57
AR v90,a58
AR v91,a59
v_mul_f32 v88, v88, v83
v_mul_f32 v89, v89, v83
v_mul_f32 v90, v90, v83
v_mul_f32 v91, v91, v83
AW a56,v88
AW a57,v89
AW a58,v90
AW a59,v91
AR v88,a60
AR v89,a61
AR v90,a62
AR v91,a63
v_mul_f32 v88, v88, v84
v_mul_f32 v89, v89, v84
v_mul_f32 v90, v90, v84
v_mul_f32 v91, v91, v84
AW a60,v88
AW a61,v89
AW a62,v90
AW a63,v91
AR v88,a64
AR v89,a65
AR v90,a66
AR v91,a67
v_mul_f32 v88, v88, v81
v_mul_f32 v89, v89, v81
v_mul_f32 v90, v90, v81
v_mul_f32 v91, v91, v81
AW a64,v88
AW a65,v89
AW a66,v90
AW a67,v91
AR v88,a68
AR v89,a69
AR v90,a70
AR v91,a71
v_mul_f32 v88, v88, v82
v_mul_f32 v89, v89, v82
v_mul_f32 v90, v90, v82
v_mul_f32 v91, v91, v82
AW a68,v88
AW a69,v89
AW a70,v90
AW a71,v91
AR v88,a72
AR v89,a73
AR v90,a74
AR v91,a75
v_mul_f32 v88, v88, v83
v_mul_f32 v89, v89, v83
v_mul_f32 v90, v90, v83
v_mul_f32 v91, v91, v83
AW a72,v88
AW a73,v89
AW a74,v90
AW a75,v91
AR v88,a76
AR v89,a77
AR v90,a78
AR v91,a79
v_mul_f32 v88, v88, v84
v_mul_f32 v89, v89, v84
v_mul_f32 v90, v90, v84
v_mul_f32 v91, v91, v84
AW a76,v88
AW a77,v89
AW a78,v90
AW a79,v91
AR v88,a80
AR v89,a81
AR v90,a82
AR v91,a83
v_mul_f32 v88, v88, v81
v_mul_f32 v89, v89, v81
v_mul_f32 v90, v90, v81
v_mul_f32 v91, v91, v81
AW a80,v88
AW a81,v89
AW a82,v90
AW a83,v91
AR v88,a84
AR v89,a85
AR v90,a86
AR v91,a87
v_mul_f32 v88, v88, v82
v_mul_f32 v89, v89, v82
v_mul_f32 v90, v90, v82
v_mul_f32 v91, v91, v82
AW a84,v88
AW a85,v89
AW a86,v90
AW a87,v91
AR v88,a88
AR v89,a89
AR v90,a90
AR v91,a91
v_mul_f32 v88, v88, v83
v_mul_f32 v89, v89, v83
v_mul_f32 v90, v90, v83
v_mul_f32 v91, v91, v83
AW a88,v88
AW a89,v89
AW a90,v90
AW a91,v91
AR v88,a92
AR v89,a93
AR v90,a94
AR v91,a95
v_mul_f32 v88, v88, v84
v_mul_f32 v89, v89, v84
v_mul_f32 v90, v90, v84
v_mul_f32 v91, v91, v84
AW a92,v88
AW a93,v89
AW a94,v90
AW a95,v91
AR v88,a96
AR v89,a97
AR v90,a98
AR v91,a99
v_mul_f32 v88, v88, v81
v_mul_f32 v89, v89, v81
v_mul_f32 v90, v90, v81
v_mul_f32 v91, v91, v81
AW a96,v88
AW a97,v89
AW a98,v90
AW a99,v91
AR v88,a100
AR v89,a101
AR v90,a102
AR v91,a103
v_mul_f32 v88, v88, v82
v_mul_f32 v89, v89, v82
v_mul_f32 v90, v90, v82
v_mul_f32 v91, v91, v82
AW a100,v88
AW a101,v89
AW a102,v90
AW a103,v91
AR v88,a104
AR v89,a105
AR v90,a106
AR v91,a107
v_mul_f32 v88, v88, v83
v_mul_f32 v89, v89, v83
v_mul_f32 v90, v90, v83
v_mul_f32 v91, v91, v83
AW a104,v88
AW a105,v89
AW a106,v90
AW a107,v91
AR v88,a108
AR v89,a109
AR v90,a110
AR v91,a111
v_mul_f32 v88, v88, v84
v_mul_f32 v89, v89, v84
v_mul_f32 v90, v90, v84
v_mul_f32 v91, v91, v84
AW a108,v88
AW a109,v89
AW a110,v90
AW a111,v91
AR v88,a112
AR v89,a113
AR v90,a114
AR v91,a115
v_mul_f32 v88, v88, v81
v_mul_f32 v89, v89, v81
v_mul_f32 v90, v90, v81
v_mul_f32 v91, v91, v81
AW a112,v88
AW a113,v89
AW a114,v90
AW a115,v91
AR v88,a116
AR v89,a117
AR v90,a118
AR v91,a119
v_mul_f32 v88, v88, v82
v_mul_f32 v89, v89, v82
v_mul_f32 v90, v90, v82
v_mul_f32 v91, v91, v82
AW a116,v88
AW a117,v89
AW a118,v90
AW a119,v91
AR v88,a120
AR v89,a121
AR v90,a122
AR v91,a123
v_mul_f32 v88, v88, v83
v_mul_f32 v89, v89, v83
v_mul_f32 v90, v90, v83
v_mul_f32 v91, v91, v83
AW a120,v88
AW a121,v89
AW a122,v90
AW a123,v91
AR v88,a124
AR v89,a125
AR v90,a126
AR v91,a127
v_mul_f32 v88, v88, v84
v_mul_f32 v89, v89, v84
v_mul_f32 v90, v90, v84
v_mul_f32 v91, v91, v84
AW a124,v88
AW a125,v89
AW a126,v90
AW a127,v91
AR v88,a128
AR v89,a129
AR v90,a130
AR v91,a131
v_mul_f32 v88, v88, v81
v_mul_f32 v89, v89, v81
v_mul_f32 v90, v90, v81
v_mul_f32 v91, v91, v81
AW a128,v88
AW a129,v89
AW a130,v90
AW a131,v91
AR v88,a132
AR v89,a133
AR v90,a134
AR v91,a135
v_mul_f32 v88, v88, v82
v_mul_f32 v89, v89, v82
v_mul_f32 v90, v90, v82
v_mul_f32 v91, v91, v82
AW a132,v88
AW a133,v89
AW a134,v90
AW a135,v91
AR v88,a136
AR v89,a137
AR v90,a138
AR v91,a139
v_mul_f32 v88, v88, v83
v_mul_f32 v89, v89, v83
v_mul_f32 v90, v90, v83
v_mul_f32 v91, v91, v83
AW a136,v88
AW a137,v89
AW a138,v90
AW a139,v91
AR v88,a140
AR v89,a141
AR v90,a142
AR v91,a143
v_mul_f32 v88, v88, v84
v_mul_f32 v89, v89, v84
v_mul_f32 v90, v90, v84
v_mul_f32 v91, v91, v84
AW a140,v88
AW a141,v89
AW a142,v90
AW a143,v91
AR v88,a144
AR v89,a145
AR v90,a146
AR v91,a147
v_mul_f32 v88, v88, v81
v_mul_f32 v89, v89, v81
v_mul_f32 v90, v90, v81
v_mul_f32 v91, v91, v81
AW a144,v88
AW a145,v89
AW a146,v90
AW a147,v91
AR v88,a148
AR v89,a149
AR v90,a150
AR v91,a151
v_mul_f32 v88, v88, v82
v_mul_f32 v89, v89, v82
v_mul_f32 v90, v90, v82
v_mul_f32 v91, v91, v82
AW a148,v88
AW a149,v89
AW a150,v90
AW a151,v91
AR v88,a152
AR v89,a153
AR v90,a154
AR v91,a155
v_mul_f32 v88, v88, v83
v_mul_f32 v89, v89, v83
v_mul_f32 v90, v90, v83
v_mul_f32 v91, v91, v83
AW a152,v88
AW a153,v89
AW a154,v90
AW a155,v91
AR v88,a156
AR v89,a157
AR v90,a158
AR v91,a159
v_mul_f32 v88, v88, v84
v_mul_f32 v89, v89, v84
v_mul_f32 v90, v90, v84
v_mul_f32 v91, v91, v84
AW a156,v88
AW a157,v89
AW a158,v90
AW a159,v91
AR v88,a160
AR v89,a161
AR v90,a162
AR v91,a163
v_mul_f32 v88, v88, v81
v_mul_f32 v89, v89, v81
v_mul_f32 v90, v90, v81
v_mul_f32 v91, v91, v81
AW a160,v88
AW a161,v89
AW a162,v90
AW a163,v91
AR v88,a164
AR v89,a165
AR v90,a166
AR v91,a167
v_mul_f32 v88, v88, v82
v_mul_f32 v89, v89, v82
v_mul_f32 v90, v90, v82
v_mul_f32 v91, v91, v82
AW a164,v88
AW a165,v89
AW a166,v90
AW a167,v91
AR v88,a168
AR v89,a169
AR v90,a170
AR v91,a171
v_mul_f32 v88, v88, v83
v_mul_f32 v89, v89, v83
v_mul_f32 v90, v90, v83
v_mul_f32 v91, v91, v83
AW a168,v88
AW a169,v89
AW a170,v90
AW a171,v91
AR v88,a172
AR v89,a173
AR v90,a174
AR v91,a175
v_mul_f32 v88, v88, v84
v_mul_f32 v89, v89, v84
v_mul_f32 v90, v90, v84
v_mul_f32 v91, v91, v84
AW a172,v88
AW a173,v89
AW a174,v90
AW a175,v91
AR v88,a176
AR v89,a177
AR v90,a178
AR v91,a179
v_mul_f32 v88, v88, v81
v_mul_f32 v89, v89, v81
v_mul_f32 v90, v90, v81
v_mul_f32 v91, v91, v81
AW a176,v88
AW a177,v89
AW a178,v90
AW a179,v91
AR v88,a180
AR v89,a181
AR v90,a182
AR v91,a183
v_mul_f32 v88, v88, v82
v_mul_f32 v89, v89, v82
v_mul_f32 v90, v90, v82
v_mul_f32 v91, v91, v82
AW a180,v88
AW a181,v89
AW a182,v90
AW a183,v91
AR v88,a184
AR v89,a185
AR v90,a186
AR v91,a187
v_mul_f32 v88, v88, v83
v_mul_f32 v89, v89, v83
v_mul_f32 v90, v90, v83
v_mul_f32 v91, v91, v83
AW a184,v88
AW a185,v89
AW a186,v90
AW a187,v91
AR v88,a188
AR v89,a189
AR v90,a190
AR v91,a191
v_mul_f32 v88, v88, v84
v_mul_f32 v89, v89, v84
v_mul_f32 v90, v90, v84
v_mul_f32 v91, v91, v84
AW a188,v88
AW a189,v89
AW a190,v90
AW a191,v91
AR v88,a192
AR v89,a193
AR v90,a194
AR v91,a195
v_mul_f32 v88, v88, v81
v_mul_f32 v89, v89, v81
v_mul_f32 v90, v90, v81
v_mul_f32 v91, v91, v81
AW a192,v88
AW a193,v89
AW a194,v90
AW a195,v91
AR v88,a196
AR v89,a197
AR v90,a198
AR v91,a199
v_mul_f32 v88, v88, v82
v_mul_f32 v89, v89, v82
v_mul_f32 v90, v90, v82
v_mul_f32 v91, v91, v82
AW a196,v88
AW a197,v89
AW a198,v90
AW a199,v91
AR v88,a200
AR v89,a201
AR v90,a202
AR v91,a203
v_mul_f32 v88, v88, v83
v_mul_f32 v89, v89, v83
v_mul_f32 v90, v90, v83
v_mul_f32 v91, v91, v83
AW a200,v88
AW a201,v89
AW a202,v90
AW a203,v91
AR v88,a204
AR v89,a205
AR v90,a206
AR v91,a207
v_mul_f32 v88, v88, v84
v_mul_f32 v89, v89, v84
v_mul_f32 v90, v90, v84
v_mul_f32 v91, v91, v84
AW a204,v88
AW a205,v89
AW a206,v90
AW a207,v91
AR v88,a208
AR v89,a209
AR v90,a210
AR v91,a211
v_mul_f32 v88, v88, v81
v_mul_f32 v89, v89, v81
v_mul_f32 v90, v90, v81
v_mul_f32 v91, v91, v81
AW a208,v88
AW a209,v89
AW a210,v90
AW a211,v91
AR v88,a212
AR v89,a213
AR v90,a214
AR v91,a215
v_mul_f32 v88, v88, v82
v_mul_f32 v89, v89, v82
v_mul_f32 v90, v90, v82
v_mul_f32 v91, v91, v82
AW a212,v88
AW a213,v89
AW a214,v90
AW a215,v91
AR v88,a216
AR v89,a217
AR v90,a218
AR v91,a219
v_mul_f32 v88, v88, v83
v_mul_f32 v89, v89, v83
v_mul_f32 v90, v90, v83
v_mul_f32 v91, v91, v83
AW a216,v88
AW a217,v89
AW a218,v90
AW a219,v91
AR v88,a220
AR v89,a221
AR v90,a222
AR v91,a223
v_mul_f32 v88, v88, v84
v_mul_f32 v89, v89, v84
v_mul_f32 v90, v90, v84
v_mul_f32 v91, v91, v84
AW a220,v88
AW a221,v89
AW a222,v90
AW a223,v91
AR v88,a224
AR v89,a225
AR v90,a226
AR v91,a227
v_mul_f32 v88, v88, v81
v_mul_f32 v89, v89, v81
v_mul_f32 v90, v90, v81
v_mul_f32 v91, v91, v81
AW a224,v88
AW a225,v89
AW a226,v90
AW a227,v91
AR v88,a228
AR v89,a229
AR v90,a230
AR v91,a231
v_mul_f32 v88, v88, v82
v_mul_f32 v89, v89, v82
v_mul_f32 v90, v90, v82
v_mul_f32 v91, v91, v82
AW a228,v88
AW a229,v89
AW a230,v90
AW a231,v91
AR v88,a232
AR v89,a233
AR v90,a234
AR v91,a235
v_mul_f32 v88, v88, v83
v_mul_f32 v89, v89, v83
v_mul_f32 v90, v90, v83
v_mul_f32 v91, v91, v83
AW a232,v88
AW a233,v89
AW a234,v90
AW a235,v91
AR v88,a236
AR v89,a237
AR v90,a238
AR v91,a239
v_mul_f32 v88, v88, v84
v_mul_f32 v89, v89, v84
v_mul_f32 v90, v90, v84
v_mul_f32 v91, v91, v84
AW a236,v88
AW a237,v89
AW a238,v90
AW a239,v91
AR v88,a240
AR v89,a241
AR v90,a242
AR v91,a243
v_mul_f32 v88, v88, v81
v_mul_f32 v89, v89, v81
v_mul_f32 v90, v90, v81
v_mul_f32 v91, v91, v81
AW a240,v88
AW a241,v89
AW a242,v90
AW a243,v91
AR v88,a244
AR v89,a245
AR v90,a246
AR v91,a247
v_mul_f32 v88, v88, v82
v_mul_f32 v89, v89, v82
v_mul_f32 v90, v90, v82
v_mul_f32 v91, v91, v82
AW a244,v88
AW a245,v89
AW a246,v90
AW a247,v91
AR v88,a248
AR v89,a249
AR v90,a250
AR v91,a251
v_mul_f32 v88, v88, v83
v_mul_f32 v89, v89, v83
v_mul_f32 v90, v90, v83
v_mul_f32 v91, v91, v83
AW a248,v88
AW a249,v89
AW a250,v90
AW a251,v91
AR v88,a252
AR v89,a253
AR v90,a254
AR v91,a255
v_mul_f32 v88, v88, v84
v_mul_f32 v89, v89, v84
v_mul_f32 v90, v90, v84
v_mul_f32 v91, v91, v84
AW a252,v88
AW a253,v89
AW a254,v90
AW a255,v91
s_nop 1
TR v[12:13],v1,0
TR v[14:15],v1,8192
WL 0
M a[0:3],v[12:15],v[36:39],a[0:3]
M a[4:7],v[12:15],v[40:43],a[4:7]
M a[8:11],v[12:15],v[44:47],a[8:11]
M a[12:15],v[12:15],v[48:51],a[12:15]
TR v[16:17],v9,0
TR v[18:19],v9,8192
WL 0
M a[16:19],v[16:19],v[36:39],a[16:19]
M a[20:23],v[16:19],v[40:43],a[20:23]
M a[24:27],v[16:19],v[44:47],a[24:27]
M a[28:31],v[16:19],v[48:51],a[28:31]
TR v[20:21],v1,512
TR v[22:23],v1,8704
WL 0
M a[32:35],v[20:23],v[36:39],a[32:35]
M a[36:39],v[20:23],v[40:43],a[36:39]
M a[40:43],v[20:23],v[44:47],a[40:43]
M a[44:47],v[20:23],v[48:51],a[44:47]
TR v[24:25],v9,512
TR v[26:27],v9,8704
WL 0
M a[48:51],v[24:27],v[36:39],a[48:51]
M a[52:55],v[24:27],v[40:43],a[52:55]
M a[56:59],v[24:27],v[44:47],a[56:59]
M a[60:63],v[24:27],v[48:51],a[60:63]
TR v[12:13],v1,1024
TR v[14:15],v1,9216
WL 0
M a[64:67],v[12:15],v[36:39],a[64:67]
M a[68:71],v[12:15],v[40:43],a[68:71]
M a[72:75],v[12:15],v[44:47],a[72:75]
M a[76:79],v[12:15],v[48:51],a[76:79]
TR v[16:17],v9,1024
TR v[18:19],v9,9216
WL 0
M a[80:83],v[16:19],v[36:39],a[80:83]
M a[84:87],v[16:19],v[40:43],a[84:87]
M a[88:91],v[16:19],v[44:47],a[88:91]
M a[92:95],v[16:19],v[48:51],a[92:95]
TR v[20:21],v1,1536
TR v[22:23],v1,9728
WL 0
M a[96:99],v[20:23],v[36:39],a[96:99]
M a[100:103],v[20:23],v[40:43],a[100:103]
M a[104:107],v[20:23],v[44:47],a[104:107]
M a[108:111],v[20:23],v[48:51],a[108:111]
TR v[24:25],v9,1536
TR v[26:27],v9,9728
WL 0
M a[112:115],v[24:27],v[36:39],a[112:115]
M a[116:119],v[24:27],v[40:43],a[116:119]
M a[120:123],v[24:27],v[44:47],a[120:123]
M a[124:127],v[24:27],v[48:51],a[124:127]
TR v[12:13],v1,2048
TR v[14:15],v1,10240
WL 0
M a[128:131],v[12:15],v[36:39],a[128:131]
M a[132:135],v[12:15],v[40:43],a[132:135]
M a[136:139],v[12:15],v[44:47],a[136:139]
M a[140:143],v[12:15],v[48:51],a[140:143]
TR v[16:17],v9,2048
TR v[18:19],v9,10240
WL 0
M a[144:147],v[16:19],v[36:39],a[144:147]
M a[148:151],v[16:19],v[40:43],a[148:151]
M a[152:155],v[16:19],v[44:47],a[152:155]
M a[156:159],v[16:19],v[48:51],a[156:159]
TR v[20:21],v1,2560
TR v[22:23],v1,10752
WL 0
M a[160:163],v[20:23],v[36:39],a[160:163]
M a[164:167],v[20:23],v[40:43],a[164:167]
M a[168:171],v[20:23],v[44:47],a[168:171]
M a[172:175],v[20:23],v[48:51],a[172:175]
TR v[24:25],v9,2560
TR v[26:27],v9,10752
WL 0
M a[176:179],v[24:27],v[36:39],a[176:179]
M a[180:183],v[24:27],v[40:43],a[180:183]
M a[184:187],v[24:27],v[44:47],a[184:187]
M a[188:191],v[24:27],v[48:51],a[188:191]
TR v[12:13],v1,3072
TR v[14:15],v1,11264
WL 0
M a[192:195],v[12:15],v[36:39],a[192:195]
M a[196:199],v[12:15],v[40:43],a[196:199]
M a[200:203],v[12:15],v[44:47],a[200:203]
M a[204:207],v[12:15],v[48:51],a[204:207]
TR v[16:17],v9,3072
TR v[18:19],v9,11264
WL 0
M a[208:211],v[16:19],v[36:39],a[208:211]
M a[212:215],v[16:19],v[40:43],a[212:215]
M a[216:219],v[16:19],v[44:47],a[216:219]
M a[220:223],v[16:19],v[48:51],a[220:223]
TR v[20:21],v1,3584
TR v[22:23],v1,11776
WL 0
M a[224:227],v[20:23],v[36:39],a[224:227]
M a[228:231],v[20:23],v[40:43],a[228:231]
M a[232:235],v[20:23],v[44:47],a[232:235]
M a[236:239],v[20:23],v[48:51],a[236:239]
TR v[24:25],v9,3584
TR v[26:27],v9,11776
WL 0
M a[240:243],v[24:27],v[36:39],a[240:243]
M a[244:247],v[24:27],v[40:43],a[244:247]
M a[248:251],v[24:27],v[44:47],a[248:251]
M a[252:255],v[24:27],v[48:51],a[252:255]
s_sub_u32 s52, s52, 1
s_cmp_lg_u32 s52, 0
s_nop 7
s_cbranch_scc1 L1_slowloop_4
s_nop 7
v_mov_b32 v56, v4
v_mov_b32 v57, v4
v_mov_b32 v58, v5
v_mov_b32 v59, v5
v_mov_b32 v60, v6
v_mov_b32 v61, v6
v_mov_b32 v62, v7
v_mov_b32 v63, v7
s_nop 1
v_permlane32_swap_b32 v56, v57
v_permlane32_swap_b32 v58, v59
v_permlane32_swap_b32 v60, v61
v_permlane32_swap_b32 v62, v63
s_nop 1
v_add_f32 v4, v56, v57
v_add_f32 v5, v58, v59
v_add_f32 v6, v60, v61
v_add_f32 v7, v62, v63
v_mov_b32 v56, v4
v_mov_b32 v57, v4
v_mov_b32 v58, v5
v_mov_b32 v59, v5
v_mov_b32 v60, v6
v_mov_b32 v61, v6
v_mov_b32 v62, v7
v_mov_b32 v63, v7
s_nop 1
v_permlane16_swap_b32 v56, v57
v_permlane16_swap_b32 v58, v59
v_permlane16_swap_b32 v60, v61
v_permlane16_swap_b32 v62, v63
s_nop 1
v_add_f32 v4, v56, v57
v_add_f32 v5, v58, v59
v_add_f32 v6, v60, v61
v_add_f32 v7, v62, v63
s_branch L1_norm_4
L1_end:
s_endpgm
.section .rodata,"a"
.p2align 6
.amdhsa_kernel concat_heads__mha_block_cached__mha_block_cached__near_ridge_kernel
  .amdhsa_next_free_vgpr 512
  .amdhsa_next_free_sgpr 102
  .amdhsa_accum_offset 256
  .amdhsa_group_segment_fixed_size 0
  .amdhsa_kernarg_size 104
  .amdhsa_user_sgpr_count 2
  .amdhsa_user_sgpr_kernarg_segment_ptr 1
  .amdhsa_system_sgpr_workgroup_id_x 1
.end_amdhsa_kernel
```
